```python
import torch

def _softmax(x, axis=-1):
    return torch.softmax(x, dim=axis)

def _gelu(x):
    return torch.nn.functional.gelu(x, approximate='tanh')

def _silu(x):
    return torch.nn.functional.silu(x)

def _sigmoid(x):
    return torch.sigmoid(x)

def _layernorm(x, axis=-1, eps=1e-05):
    m = x.mean(dim=axis, keepdim=True)
    v = x.var(dim=axis, keepdim=True, unbiased=False)
    return (x - m) / torch.sqrt(v + eps)

def _scatter_add(tgt, idx, src, axis=0):
    return tgt.clone().index_add_(axis, idx, src)

def _segment_sum(src, seg, n):
    out = torch.zeros((n,) + src.shape[1:], dtype=src.dtype)
    return out.index_add_(0, seg, src)

def _pad(x, pw):
    flat = tuple((v for pair in reversed(pw) for v in pair))
    return torch.nn.functional.pad(x, flat)
kernel_name = 'adaLN_cond__compressed_kv_cla__dense_activation_mish__prompt'

def setup_inputs():

    _w = lambda a: (lambda t: t.to(torch.bfloat16) if t.is_floating_point() else t)(torch.as_tensor(a))

    def _A_setup():
        B, H, Sq, Sk, D, M = (1, 32, 2048, 2048, 128, 512)
        Dc = 4 * D
        return {'x': _w((lambda *s: torch.randn(*s, dtype=torch.bfloat16) * 0.05)(B, Sq, M)), 'c_kv': _w((lambda *s: torch.randn(*s, dtype=torch.bfloat16) * 0.4)(B, Sk, Dc)), 'w_q': _w((lambda *s: torch.randn(*s, dtype=torch.bfloat16) * 3.2)(M, H, D) * M ** (-0.5)), 'w_uk': _w((lambda *s: torch.randn(*s, dtype=torch.bfloat16) * 3.2)(Dc, H, D) * Dc ** (-0.5)), 'w_uv': _w((lambda *s: torch.randn(*s, dtype=torch.bfloat16) * 0.4)(Dc, H, D) * Dc ** (-0.5)), 'w_o': _w((lambda *s: torch.randn(*s, dtype=torch.bfloat16) * 0.4)(H, D, M) * (H * D) ** (-0.5))}
    _A_in = _A_setup()

    def _B_setup():
        B, S, D, F = (1, 2048, 512, 1792)
        return {'x': _w((lambda *s: torch.randn(*s, dtype=torch.bfloat16) * 0.05)(B, S, D)), 'w1': _w((lambda *s: torch.randn(*s, dtype=torch.bfloat16) * 0.8)(D, F) * D ** (-0.5)), 'b1': _w((lambda *s: torch.randn(*s, dtype=torch.bfloat16) * 0.2)(F)), 'w2': _w((lambda *s: torch.randn(*s, dtype=torch.bfloat16) * 0.1)(F, D) * F ** (-0.5))}
    _B_in = _B_setup()
    return {'A_x': _A_in['x'], 'A_c_kv': _A_in['c_kv'], 'A_w_q': _A_in['w_q'], 'A_w_uk': _A_in['w_uk'], 'A_w_uv': _A_in['w_uv'], 'A_w_o': _A_in['w_o'], 'B_x': _B_in['x'], 'B_w1': _B_in['w1'], 'B_b1': _B_in['b1'], 'B_w2': _B_in['w2'], 'c': _w((lambda *s: torch.randn(*s, dtype=torch.bfloat16) * 0.1)(1, 512) * 8.0), 'w_mod': _w((lambda *s: torch.randn(*s, dtype=torch.bfloat16) * 0.1)(512, 6 * 512) * 512 ** (-0.5) * 8.0)}

def reference(A_x, A_c_kv, A_w_q, A_w_uk, A_w_uv, A_w_o, B_x, B_w1, B_b1, B_w2, c, w_mod):

    def _A_ref(x, c_kv, w_q, w_uk, w_uv, w_o):
        B, Sq, M = (x.shape[0], x.shape[1], x.shape[2])
        Sk = c_kv.shape[1]
        H, D = (w_q.shape[1], w_q.shape[2])
        q = torch.einsum('bqm,mhd->bhqd', x, w_q)
        k = torch.einsum('bkc,chd->bhkd', c_kv, w_uk)
        v = torch.einsum('bkc,chd->bhkd', c_kv, w_uv)
        scores = torch.einsum('bhqd,bhkd->bhqk', q, k) * D ** (-0.5)
        off = Sk - Sq
        qi = torch.arange(Sq)[:, None]
        kj = torch.arange(Sk)[None, :]
        cmask = kj <= qi + off
        scores = torch.where(cmask[None, None], scores, -1000000000.0)
        p = _softmax(scores, axis=-1)
        ctx = torch.einsum('bhqk,bhkd->bhqd', p, v)
        return torch.einsum('bhqd,hdm->bqm', ctx, w_o)

    def _B_ref(x, w1, b1, w2):
        h = torch.einsum('bsd,df->bsf', x, w1) + b1
        sp = torch.log1p(torch.exp(-torch.abs(h))) + torch.where(h > 0, h, torch.zeros_like(h))
        act = h * torch.tanh(sp)
        return torch.einsum('bsf,fd->bsd', act, w2)
    x = A_x
    mod = (_silu(c) @ w_mod).reshape(c.shape[0], 6, 1, -1)
    sa, ca, ga, sb, cb, gb = (mod[:, 0].clone(), mod[:, 1].clone(), mod[:, 2].clone(), mod[:, 3].clone(), mod[:, 4].clone(), mod[:, 5].clone())
    h = _layernorm(x, axis=-1) * (1 + ca) + sa
    x = x + ga * _A_ref(h, A_c_kv, A_w_q, A_w_uk, A_w_uv, A_w_o)
    h = _layernorm(x, axis=-1) * (1 + cb) + sb
    x = x + gb * _B_ref(h, B_w1, B_b1, B_w2)
    return x
```

```asm
; @launch grid=(256,1,1) block=(256,1,1) lds=163840
.amdgcn_target "amdgcn-amd-amdhsa--gfx950"
.text
.globl adaLN_cond__compressed_kv_cla__dense_activation_mish__prompt_kernel
.p2align 8
.type adaLN_cond__compressed_kv_cla__dense_activation_mish__prompt_kernel,@function
adaLN_cond__compressed_kv_cla__dense_activation_mish__prompt_kernel:

  s_getpc_b64 s[64:65]
  s_cmp_ge_u32 s2, 256
  s_cbranch_scc1 K2_END
  s_load_dwordx16 s[36:51], s[0:1], 0
  s_load_dwordx8 s[52:59], s[0:1], 64
  s_load_dwordx2 s[60:61], s[0:1], 104
  s_load_dwordx2 s[20:21], s[0:1], 112
  v_lshrrev_b32 v3, 6, v0
  v_and_b32 v2, 63, v0
  v_readfirstlane_b32 s30, v3
  v_lshlrev_b32 v1, 4, v2
  s_and_b32 s4, s2, 7
  s_lshr_b32 s5, s2, 3
  s_and_b32 s33, s5, 3
  s_lshl_b32 s4, s4, 2
  s_add_u32 s33, s33, s4
  s_lshr_b32 s34, s5, 2
  s_and_b32 s31, s30, 1
  s_lshr_b32 s32, s30, 1
  v_lshrrev_b32 v22, 3, v2
  v_lshrrev_b32 v23, 4, v2
  v_and_b32 v24, 7, v2
  v_xor_b32 v25, v24, v23
  v_lshlrev_b32 v25, 4, v25
  v_lshl_add_u32 v25, v22, 10, v25
  s_lshl_b32 s4, s30, 16
  v_add_u32 v25, s4, v25
  v_add_u32 v4, 0, v25
  v_add_u32 v5, 7168, v25
  v_xor_b32 v5, 64, v5
  v_add_u32 v6, 14336, v25
  v_add_u32 v7, 21504, v25
  v_xor_b32 v7, 64, v7
  v_add_u32 v8, 32768, v25
  v_add_u32 v9, 39936, v25
  v_xor_b32 v9, 64, v9
  v_add_u32 v10, 47104, v25
  v_add_u32 v11, 54272, v25
  v_xor_b32 v11, 64, v11
  v_and_b32 v23, 1, v23
  v_lshlrev_b32 v23, 1, v23
  v_xor_b32 v25, v24, v23
  v_lshlrev_b32 v25, 4, v25
  v_lshl_add_u32 v25, v22, 13, v25
  s_lshl_b32 s4, s30, 18
  v_add_u32 v25, s4, v25
  v_add_u32 v12, 0, v25
  v_add_u32 v13, 64512, v25
  v_xor_b32 v13, 64, v13
  v_add_u32 v14, 129024, v25
  v_add_u32 v15, 193536, v25
  v_xor_b32 v15, 64, v15
  v_lshlrev_b32 v22, 7, v2
  v_lshlrev_b32 v28, 13, v2
  s_lshl_b32 s4, s34, 18
  s_lshl_b32 s6, s33, 8
  s_mov_b32 s14, 0x40000
  s_mov_b32 s15, 0x00020000
  s_mov_b32 s18, 4186368
  s_mov_b32 s19, 0x00020000
  s_waitcnt lgkmcnt(0)
  s_add_u32 s12, s38, s4
  s_addc_u32 s13, s39, 0
  s_add_u32 s16, s42, s6
  s_addc_u32 s17, s43, 0
  s_lshr_b32 s11, s2, 3
  s_cmp_eq_u32 s30, 0
  s_cbranch_scc1 KA_PF0
  s_cmp_eq_u32 s30, 3
  s_cbranch_scc0 KA_PF1
  s_and_b32 s10, s11, 15
  s_lshl_b32 s10, s10, 12
  v_lshrrev_b32 v22, 1, v22
  v_add_u32 v22, s10, v22
  global_load_dword v26, v22, s[64:65]
  s_branch KA_PFD
KA_PF0:
  s_lshl_b32 s10, s33, 13
  buffer_load_dword v26, v22, s[12:15], s10 offen
  s_branch KA_PFD
KA_PF1:
  s_lshl_b32 s10, s34, 19
  s_lshl_b32 s28, s30, 7
  s_add_u32 s10, s10, s28
  s_sub_u32 s10, s10, 128
  buffer_load_dword v26, v28, s[16:19], s10 offen nt
KA_PFD:
  s_add_u32 s24, s44, s6
  s_addc_u32 s25, s45, 0
  s_add_u32 s8, s40, s6
  s_addc_u32 s9, s41, 0
  s_mov_b32 s4, s46
  s_mov_b32 s5, s47
  s_mov_b32 s62, s50
  s_mov_b32 s63, s51
  s_lshl_b32 s50, s30, 12
  s_lshl_b32 s49, s30, 14
  s_add_u32 s49, s49, 98304
  s_add_u32 m0, s50, 0
  s_mov_b32 s46, 0
  buffer_load_dwordx4 v12, s[16:19], s46 offen offset:0 lds
  buffer_load_dwordx4 v13, s[16:19], s46 offen offset:1024 lds
  buffer_load_dwordx4 v14, s[16:19], s46 offen offset:2048 lds
  buffer_load_dwordx4 v15, s[16:19], s46 offen offset:3072 lds
  s_add_u32 m0, s49, 0
  s_mov_b32 s46, 0
  buffer_load_dwordx4 v4, s[12:15], s46 offen offset:0 lds
  buffer_load_dwordx4 v5, s[12:15], s46 offen offset:1024 lds
  buffer_load_dwordx4 v6, s[12:15], s46 offen offset:2048 lds
  buffer_load_dwordx4 v7, s[12:15], s46 offen offset:3072 lds
  s_add_u32 m0, s49, 4096
  s_mov_b32 s46, 0
  buffer_load_dwordx4 v8, s[12:15], s46 offen offset:0 lds
  buffer_load_dwordx4 v9, s[12:15], s46 offen offset:1024 lds
  buffer_load_dwordx4 v10, s[12:15], s46 offen offset:2048 lds
  buffer_load_dwordx4 v11, s[12:15], s46 offen offset:3072 lds
  s_sub_u32 s48, 255, s2
  s_lshl_b32 s48, s48, 2
  s_add_u32 s48, s48, s30
  s_mov_b32 s6, 4194304
  s_mov_b32 s7, 0x00020000
  s_cmp_ge_u32 s48, 736
  s_cselect_b32 s4, s54, s4
  s_cselect_b32 s5, s55, s5
  s_cselect_b32 s6, 1835008, s6
  s_cselect_b32 s40, 736, 0
  s_cselect_b32 s28, 6291456, 0
  s_mov_b32 s29, 524288
  s_cselect_b32 s29, 229376, s29
  s_sub_u32 s40, s48, s40
  s_lshr_b32 s41, s40, 2
  s_and_b32 s42, s40, 3
  s_mov_b32 s11, 1024
  s_sub_u32 s40, s48, 512
  s_mul_i32 s43, s40, 9363
  s_lshr_b32 s43, s43, 17
  s_mul_i32 s52, s43, 14
  s_sub_u32 s52, s40, s52
  s_cmp_lt_u32 s40, 224
  s_cselect_b32 s41, s43, s41
  s_cselect_b32 s42, s52, s42
  s_cselect_b32 s11, 3584, s11
  s_cselect_b32 s29, 65536, s29
  s_cselect_b32 s28, 4194304, s28
  s_cselect_b32 s4, s62, s4
  s_cselect_b32 s5, s63, s5
  s_cselect_b32 s6, 1835008, s6
  s_mul_i32 s10, s41, s11
  s_lshl_b32 s10, s10, 5
  s_lshl_b32 s43, s42, 8
  s_add_u32 s10, s10, s43
  s_mul_i32 s43, s42, s29
  s_lshl_b32 s43, s43, 1
  s_add_u32 s28, s28, s43
  s_lshl_b32 s43, s41, 12
  s_add_u32 s28, s28, s43
  s_add_u32 s28, s28, 67108864
  s_cmp_ge_u32 s48, 960
  s_cselect_b32 s28, 0x80000000, s28
  s_lshl_b32 s35, s30, 13
  s_add_u32 s35, s35, 0x20000
  s_mov_b32 s40, s58
  s_mov_b32 s41, s59
  s_mov_b32 s42, 3145728
  s_mov_b32 s43, 0x00020000
  s_mov_b32 s58, 1024
  s_mov_b32 s59, 0x00020000
  s_mov_b32 s38, 0x200000
  s_mov_b32 s39, 0x00020000
  s_mov_b32 s62, 256
  s_mov_b32 s63, 0x00020000
  s_mov_b32 s26, 4186368
  s_mov_b32 s27, 0x00020000
  s_mov_b32 s22, 75497472
  s_mov_b32 s23, 0x00020000
  s_and_b32 s44, s2, 7
  s_lshr_b32 s45, s2, 3
  v_and_b32 v22, 7, v2
  v_bfe_u32 v23, v2, 3, 1
  v_lshl_add_u32 v22, v23, 3, v22
  v_lshrrev_b32 v23, 4, v2
  v_lshlrev_b32 v30, 4, v22
  v_lshl_add_u32 v30, v23, 9, v30
  v_bfe_u32 v24, v22, 1, 3
  v_xor_b32 v24, v24, v23
  v_lshlrev_b32 v25, 7, v22
  v_add_u32 v25, s49, v25
  v_lshl_add_u32 v16, v24, 4, v25
  v_xor_b32 v17, 64, v16
  v_bfe_u32 v22, v2, 2, 2
  v_lshl_add_u32 v25, v23, 3, v22
  v_lshlrev_b32 v25, 7, v25
  v_and_b32 v24, 3, v2
  v_lshl_add_u32 v25, v24, 3, v25
  v_lshrrev_b32 v22, 1, v22
  v_and_b32 v23, 1, v23
  v_lshl_add_u32 v22, v23, 1, v22
  v_lshl_add_u32 v18, v22, 5, v25
  v_xor_b32 v19, 32, v18
  v_xor_b32 v20, 64, v18
  v_xor_b32 v21, 96, v18
  s_lshl_b32 s51, s33, 19
  s_lshl_b32 s47, s34, 16
  s_add_u32 s51, s51, s47
  s_lshl_b32 s47, s30, 14
  s_add_u32 s51, s51, s47
  v_lshrrev_b32 v22, 1, v0
  v_and_b32 v23, 1, v0
  v_mul_u32_u24 v24, 6144, v22
  v_lshl_add_u32 v24, v23, 4, v24
  s_mul_i32 s55, s44, 768
  s_lshl_b32 s53, s45, 5
  s_add_u32 s52, s55, s53
  s_cmp_lt_u32 s45, 24
  s_cselect_b32 s52, s52, 0x40000000
  v_lshlrev_b32 v22, 1, v22
  s_mov_b32 s53, s52
  v_subrev_u32 v29, 128, v0
  v_and_b32 v25, 7, v29
  v_lshrrev_b32 v29, 3, v29
  v_mul_u32_u24 v29, 6144, v29
  v_lshl_add_u32 v29, v25, 7, v29
  v_cmp_lt_u32 vcc, 5, v25
  v_mov_b32 v25, 0x40000000
  s_mul_i32 s54, s45, 98304
  v_cndmask_b32 v29, v29, v25, vcc
  s_add_u32 s54, s54, s55
  s_cmp_ge_u32 s30, 2
  s_cselect_b32 s54, s54, 0x80000000
  v_and_b32 v29, 0x4fffffff, v29
  buffer_load_dword v26, v29, s[40:43], s54 offen nt
  s_lshl_b32 s3, s2, 7
  s_add_u32 s3, s3, 65536
  s_cmp_eq_u32 s30, 0
  s_cselect_b32 s3, s3, 0x80000000
  v_and_b32 v252, 7, v2
  v_lshrrev_b32 v253, 3, v2
  v_lshlrev_b32 v254, 10, v252
  v_lshl_add_u32 v254, v253, 4, v254
  s_lshl_b32 s55, s2, 5
  s_add_u32 s55, s55, s30
  s_lshl_b32 s55, s55, 8
  buffer_load_dwordx4 v[224:227], v254, s[36:39], s55 offen
  buffer_load_dwordx4 v[228:231], v254, s[36:39], s55 offen offset:128
  s_add_u32 m0, s49, 8192
  s_mov_b32 s46, 128
  buffer_load_dwordx4 v4, s[12:15], s46 offen offset:0 lds
  buffer_load_dwordx4 v5, s[12:15], s46 offen offset:1024 lds
  buffer_load_dwordx4 v6, s[12:15], s46 offen offset:2048 lds
  buffer_load_dwordx4 v7, s[12:15], s46 offen offset:3072 lds
  s_add_u32 m0, s49, 12288
  s_mov_b32 s46, 128
  buffer_load_dwordx4 v8, s[12:15], s46 offen offset:0 lds
  buffer_load_dwordx4 v9, s[12:15], s46 offen offset:1024 lds
  buffer_load_dwordx4 v10, s[12:15], s46 offen offset:2048 lds
  buffer_load_dwordx4 v11, s[12:15], s46 offen offset:3072 lds
  s_waitcnt vmcnt(11)
  s_barrier
  ds_read_b64_tr_b16 v[32:33], v18 offset:0
  ds_read_b64_tr_b16 v[34:35], v18 offset:512
  ds_read_b64_tr_b16 v[36:37], v19 offset:0
  ds_read_b64_tr_b16 v[38:39], v19 offset:512
  ds_read_b64_tr_b16 v[40:41], v20 offset:0
  ds_read_b64_tr_b16 v[42:43], v20 offset:512
  ds_read_b64_tr_b16 v[44:45], v21 offset:0
  ds_read_b64_tr_b16 v[46:47], v21 offset:512
  ds_read_b128 a[0:3], v16 offset:0
  ds_read_b128 a[4:7], v16 offset:2048
  ds_read_b128 a[8:11], v16 offset:4096
  ds_read_b128 a[12:15], v16 offset:6144
  ds_read_b128 a[16:19], v17 offset:0
  ds_read_b128 a[20:23], v17 offset:2048
  ds_read_b128 a[24:27], v17 offset:4096
  ds_read_b128 a[28:31], v17 offset:6144
  s_waitcnt lgkmcnt(0)
  v_mfma_f32_16x16x32_bf16 v[64:67], v[32:35], a[0:3], 0
  ds_read_b64_tr_b16 v[48:49], v18 offset:4096
  v_mfma_f32_16x16x32_bf16 v[80:83], v[32:35], a[4:7], 0
  ds_read_b64_tr_b16 v[50:51], v18 offset:4608
  s_add_u32 m0, s50, 16384
  s_mov_b32 s46, 128
  v_mfma_f32_16x16x32_bf16 v[96:99], v[32:35], a[8:11], 0
  ds_read_b64_tr_b16 v[52:53], v19 offset:4096
  buffer_load_dwordx4 v12, s[16:19], s46 offen offset:0 lds
  v_mfma_f32_16x16x32_bf16 v[112:115], v[32:35], a[12:15], 0
  ds_read_b64_tr_b16 v[54:55], v19 offset:4608
  v_mfma_f32_16x16x32_bf16 v[68:71], v[36:39], a[0:3], 0
  ds_read_b64_tr_b16 v[56:57], v20 offset:4096
  buffer_load_dwordx4 v13, s[16:19], s46 offen offset:1024 lds
  v_mfma_f32_16x16x32_bf16 v[84:87], v[36:39], a[4:7], 0
  ds_read_b64_tr_b16 v[58:59], v20 offset:4608
  v_mfma_f32_16x16x32_bf16 v[100:103], v[36:39], a[8:11], 0
  ds_read_b64_tr_b16 v[60:61], v21 offset:4096
  buffer_load_dwordx4 v14, s[16:19], s46 offen offset:2048 lds
  v_mfma_f32_16x16x32_bf16 v[116:119], v[36:39], a[12:15], 0
  ds_read_b64_tr_b16 v[62:63], v21 offset:4608
  v_mfma_f32_16x16x32_bf16 v[72:75], v[40:43], a[0:3], 0
  buffer_load_dwordx4 v15, s[16:19], s46 offen offset:3072 lds
  v_mfma_f32_16x16x32_bf16 v[88:91], v[40:43], a[4:7], 0
  buffer_load_dwordx4 v[192:195], v24, s[40:43], s53 offen
  s_add_u32 s53, s53, 786432
  v_mfma_f32_16x16x32_bf16 v[104:107], v[40:43], a[8:11], 0
  v_mfma_f32_16x16x32_bf16 v[120:123], v[40:43], a[12:15], 0
  v_mfma_f32_16x16x32_bf16 v[76:79], v[44:47], a[0:3], 0
  v_mfma_f32_16x16x32_bf16 v[92:95], v[44:47], a[4:7], 0
  v_mfma_f32_16x16x32_bf16 v[108:111], v[44:47], a[8:11], 0
  v_mfma_f32_16x16x32_bf16 v[124:127], v[44:47], a[12:15], 0
  s_waitcnt lgkmcnt(0)
  s_waitcnt vmcnt(5)
  s_add_u32 m0, s49, 0
  s_mov_b32 s46, 256
  v_mfma_f32_16x16x32_bf16 v[64:67], v[48:51], a[16:19], v[64:67]
  ds_read_b64_tr_b16 v[32:33], v18 offset:8192
  buffer_load_dwordx4 v4, s[12:15], s46 offen offset:0 lds
  v_mfma_f32_16x16x32_bf16 v[80:83], v[48:51], a[20:23], v[80:83]
  ds_read_b64_tr_b16 v[34:35], v18 offset:8704
  ds_read_b128 a[32:35], v16 offset:8192
  v_mfma_f32_16x16x32_bf16 v[96:99], v[48:51], a[24:27], v[96:99]
  ds_read_b64_tr_b16 v[36:37], v19 offset:8192
  ds_read_b128 a[36:39], v16 offset:10240
  v_mfma_f32_16x16x32_bf16 v[112:115], v[48:51], a[28:31], v[112:115]
  ds_read_b64_tr_b16 v[38:39], v19 offset:8704
  ds_read_b128 a[40:43], v16 offset:12288
  buffer_load_dwordx4 v5, s[12:15], s46 offen offset:1024 lds
  v_mfma_f32_16x16x32_bf16 v[68:71], v[52:55], a[16:19], v[68:71]
  ds_read_b64_tr_b16 v[40:41], v20 offset:8192
  ds_read_b128 a[44:47], v16 offset:14336
  v_mfma_f32_16x16x32_bf16 v[84:87], v[52:55], a[20:23], v[84:87]
  ds_read_b64_tr_b16 v[42:43], v20 offset:8704
  ds_read_b128 a[48:51], v17 offset:8192
  v_mfma_f32_16x16x32_bf16 v[100:103], v[52:55], a[24:27], v[100:103]
  ds_read_b64_tr_b16 v[44:45], v21 offset:8192
  ds_read_b128 a[52:55], v17 offset:10240
  buffer_load_dwordx4 v6, s[12:15], s46 offen offset:2048 lds
  v_mfma_f32_16x16x32_bf16 v[116:119], v[52:55], a[28:31], v[116:119]
  ds_read_b64_tr_b16 v[46:47], v21 offset:8704
  ds_read_b128 a[56:59], v17 offset:12288
  v_mfma_f32_16x16x32_bf16 v[72:75], v[56:59], a[16:19], v[72:75]
  ds_read_b128 a[60:63], v17 offset:14336
  v_mfma_f32_16x16x32_bf16 v[88:91], v[56:59], a[20:23], v[88:91]
  buffer_load_dwordx4 v7, s[12:15], s46 offen offset:3072 lds
  buffer_load_dwordx4 v[196:199], v24, s[40:43], s53 offen
  s_add_u32 s53, s53, 786432
  v_mfma_f32_16x16x32_bf16 v[104:107], v[56:59], a[24:27], v[104:107]
  v_mfma_f32_16x16x32_bf16 v[120:123], v[56:59], a[28:31], v[120:123]
  s_add_u32 m0, s49, 4096
  s_mov_b32 s46, 256
  v_mfma_f32_16x16x32_bf16 v[76:79], v[60:63], a[16:19], v[76:79]
  buffer_load_dwordx4 v8, s[12:15], s46 offen offset:0 lds
  v_mfma_f32_16x16x32_bf16 v[92:95], v[60:63], a[20:23], v[92:95]
  v_mfma_f32_16x16x32_bf16 v[108:111], v[60:63], a[24:27], v[108:111]
  v_mfma_f32_16x16x32_bf16 v[124:127], v[60:63], a[28:31], v[124:127]
  s_waitcnt lgkmcnt(0)
  buffer_load_dwordx4 v9, s[12:15], s46 offen offset:1024 lds
  v_mfma_f32_16x16x32_bf16 v[64:67], v[32:35], a[32:35], v[64:67]
  ds_read_b64_tr_b16 v[48:49], v18 offset:12288
  v_mfma_f32_16x16x32_bf16 v[80:83], v[32:35], a[36:39], v[80:83]
  ds_read_b64_tr_b16 v[50:51], v18 offset:12800
  v_mfma_f32_16x16x32_bf16 v[96:99], v[32:35], a[40:43], v[96:99]
  ds_read_b64_tr_b16 v[52:53], v19 offset:12288
  buffer_load_dwordx4 v10, s[12:15], s46 offen offset:2048 lds
  v_mfma_f32_16x16x32_bf16 v[112:115], v[32:35], a[44:47], v[112:115]
  ds_read_b64_tr_b16 v[54:55], v19 offset:12800
  v_mfma_f32_16x16x32_bf16 v[68:71], v[36:39], a[32:35], v[68:71]
  ds_read_b64_tr_b16 v[56:57], v20 offset:12288
  v_mfma_f32_16x16x32_bf16 v[84:87], v[36:39], a[36:39], v[84:87]
  ds_read_b64_tr_b16 v[58:59], v20 offset:12800
  buffer_load_dwordx4 v11, s[12:15], s46 offen offset:3072 lds
  v_mfma_f32_16x16x32_bf16 v[100:103], v[36:39], a[40:43], v[100:103]
  ds_read_b64_tr_b16 v[60:61], v21 offset:12288
  v_mfma_f32_16x16x32_bf16 v[116:119], v[36:39], a[44:47], v[116:119]
  ds_read_b64_tr_b16 v[62:63], v21 offset:12800
  s_add_u32 m0, s50, 32768
  s_mov_b32 s46, 1048576
  v_mfma_f32_16x16x32_bf16 v[72:75], v[40:43], a[32:35], v[72:75]
  buffer_load_dwordx4 v12, s[16:19], s46 offen offset:0 lds
  v_mfma_f32_16x16x32_bf16 v[88:91], v[40:43], a[36:39], v[88:91]
  buffer_load_dwordx4 v[200:203], v24, s[40:43], s53 offen
  s_add_u32 s53, s53, 786432
  v_mfma_f32_16x16x32_bf16 v[104:107], v[40:43], a[40:43], v[104:107]
  v_mfma_f32_16x16x32_bf16 v[120:123], v[40:43], a[44:47], v[120:123]
  buffer_load_dwordx4 v13, s[16:19], s46 offen offset:1024 lds
  v_mfma_f32_16x16x32_bf16 v[76:79], v[44:47], a[32:35], v[76:79]
  v_mfma_f32_16x16x32_bf16 v[92:95], v[44:47], a[36:39], v[92:95]
  v_mfma_f32_16x16x32_bf16 v[108:111], v[44:47], a[40:43], v[108:111]
  buffer_load_dwordx4 v14, s[16:19], s46 offen offset:2048 lds
  v_mfma_f32_16x16x32_bf16 v[124:127], v[44:47], a[44:47], v[124:127]
  s_waitcnt vmcnt(14) lgkmcnt(0)
  v_mfma_f32_16x16x32_bf16 v[64:67], v[48:51], a[48:51], v[64:67]
  s_barrier
  v_lshrrev_b32 v27, 2, v2
  v_lshlrev_b32 v27, 15, v27
  v_and_b32 v3, 3, v2
  v_lshl_add_u32 v27, v3, 7, v27
  v_mfma_f32_16x16x32_bf16 v[80:83], v[48:51], a[52:55], v[80:83]
  ds_read_b64_tr_b16 v[32:33], v18 offset:16384
  buffer_load_dwordx4 v15, s[16:19], s46 offen offset:3072 lds
  v_mfma_f32_16x16x32_bf16 v[96:99], v[48:51], a[56:59], v[96:99]
  ds_read_b64_tr_b16 v[34:35], v18 offset:16896
  v_cmp_lt_u32 vcc, 39, v2
  v_mov_b32 v3, 0
  s_nop 0
  v_cndmask_b32 v27, v27, v25, vcc
  v_mfma_f32_16x16x32_bf16 v[112:115], v[48:51], a[60:63], v[112:115]
  ds_read_b64_tr_b16 v[36:37], v19 offset:16384
  s_lshl_b32 s54, s52, 4
  s_add_u32 s54, s54, 65536
  s_add_u32 m0, s49, 8192
  s_mov_b32 s46, 384
  v_mfma_f32_16x16x32_bf16 v[68:71], v[52:55], a[48:51], v[68:71]
  ds_read_b64_tr_b16 v[38:39], v19 offset:16896
  buffer_load_dwordx4 v4, s[12:15], s46 offen offset:0 lds
  v_mfma_f32_16x16x32_bf16 v[84:87], v[52:55], a[52:55], v[84:87]
  ds_read_b64_tr_b16 v[40:41], v20 offset:16384
  s_cmp_lt_u32 s52, 2048
  s_cselect_b32 s54, s54, 0x80000000
  s_cmp_eq_u32 s30, 0
  s_cselect_b32 s54, s54, 0x80000000
  v_mfma_f32_16x16x32_bf16 v[100:103], v[52:55], a[56:59], v[100:103]
  ds_read_b64_tr_b16 v[42:43], v20 offset:16896
  buffer_store_dword v3, v27, s[20:23], s54 offen sc1
  v_lshlrev_b32 v27, 12, v0
  v_mov_b32 v29, 1
  v_mfma_f32_16x16x32_bf16 v[116:119], v[52:55], a[60:63], v[116:119]
  ds_read_b64_tr_b16 v[44:45], v21 offset:16384
  buffer_load_dwordx4 v5, s[12:15], s46 offen offset:1024 lds
  s_lshr_b32 s44, s52, 10
  v_mfma_f32_16x16x32_bf16 v[72:75], v[56:59], a[48:51], v[72:75]
  ds_read_b64_tr_b16 v[46:47], v21 offset:16896
  s_cmp_eq_u32 s44, 0
  s_cselect_b32 s45, 0x3e0293ee, 1.0
  s_cmp_eq_u32 s44, 1
  s_cselect_b32 s44, 1.0, 0
  v_mfma_f32_16x16x32_bf16 v[88:91], v[56:59], a[52:55], v[88:91]
  buffer_load_dwordx4 v[204:207], v24, s[40:43], s53 offen
  v_mfma_f32_16x16x32_bf16 v[104:107], v[56:59], a[56:59], v[104:107]
  buffer_load_dwordx4 v6, s[12:15], s46 offen offset:2048 lds
  buffer_load_ushort v208, v22, s[56:59], 0 offen offset:0
  v_mfma_f32_16x16x32_bf16 v[120:123], v[56:59], a[60:63], v[120:123]
  buffer_load_ushort v209, v22, s[56:59], 0 offen offset:256
  buffer_load_ushort v210, v22, s[56:59], 0 offen offset:512
  v_mfma_f32_16x16x32_bf16 v[76:79], v[60:63], a[48:51], v[76:79]
  buffer_load_ushort v211, v22, s[56:59], 0 offen offset:768
  v_mfma_f32_16x16x32_bf16 v[92:95], v[60:63], a[52:55], v[92:95]
  buffer_load_dwordx4 v7, s[12:15], s46 offen offset:3072 lds
  v_mfma_f32_16x16x32_bf16 v[108:111], v[60:63], a[56:59], v[108:111]
  v_mfma_f32_16x16x32_bf16 v[124:127], v[60:63], a[60:63], v[124:127]
  s_waitcnt lgkmcnt(0)
  s_add_u32 m0, s49, 12288
  s_mov_b32 s46, 384
  v_mfma_f32_16x16x32_bf16 v[128:131], v[32:35], a[0:3], 0
  ds_read_b64_tr_b16 v[48:49], v18 offset:20480
  buffer_load_dwordx4 v8, s[12:15], s46 offen offset:0 lds
  v_mfma_f32_16x16x32_bf16 v[144:147], v[32:35], a[4:7], 0
  ds_read_b64_tr_b16 v[50:51], v18 offset:20992
  v_mfma_f32_16x16x32_bf16 v[160:163], v[32:35], a[8:11], 0
  ds_read_b64_tr_b16 v[52:53], v19 offset:20480
  v_mfma_f32_16x16x32_bf16 v[176:179], v[32:35], a[12:15], 0
  ds_read_b64_tr_b16 v[54:55], v19 offset:20992
  buffer_load_dwordx4 v9, s[12:15], s46 offen offset:1024 lds
  v_mfma_f32_16x16x32_bf16 v[132:135], v[36:39], a[0:3], 0
  ds_read_b64_tr_b16 v[56:57], v20 offset:20480
  v_mfma_f32_16x16x32_bf16 v[148:151], v[36:39], a[4:7], 0
  ds_read_b64_tr_b16 v[58:59], v20 offset:20992
  v_mfma_f32_16x16x32_bf16 v[164:167], v[36:39], a[8:11], 0
  ds_read_b64_tr_b16 v[60:61], v21 offset:20480
  buffer_load_dwordx4 v10, s[12:15], s46 offen offset:2048 lds
  v_mfma_f32_16x16x32_bf16 v[180:183], v[36:39], a[12:15], 0
  ds_read_b64_tr_b16 v[62:63], v21 offset:20992
  v_mfma_f32_16x16x32_bf16 v[136:139], v[40:43], a[0:3], 0
  v_mfma_f32_16x16x32_bf16 v[152:155], v[40:43], a[4:7], 0
  buffer_load_dwordx4 v11, s[12:15], s46 offen offset:3072 lds
  v_mfma_f32_16x16x32_bf16 v[168:171], v[40:43], a[8:11], 0
  v_mfma_f32_16x16x32_bf16 v[184:187], v[40:43], a[12:15], 0
  s_add_u32 m0, s50, 49152
  s_mov_b32 s46, 1048704
  v_mfma_f32_16x16x32_bf16 v[140:143], v[44:47], a[0:3], 0
  buffer_load_dwordx4 v12, s[16:19], s46 offen offset:0 lds
  v_mfma_f32_16x16x32_bf16 v[156:159], v[44:47], a[4:7], 0
  v_mfma_f32_16x16x32_bf16 v[172:175], v[44:47], a[8:11], 0
  v_mfma_f32_16x16x32_bf16 v[188:191], v[44:47], a[12:15], 0
  s_waitcnt lgkmcnt(0)
  buffer_load_dwordx4 v13, s[16:19], s46 offen offset:1024 lds
  s_waitcnt vmcnt(21)
  v_mfma_f32_16x16x32_bf16 v[128:131], v[48:51], a[16:19], v[128:131]
  ds_read_b64_tr_b16 v[32:33], v18 offset:24576
  s_lshl_b32 s48, s34, 19
  s_lshl_b32 s55, s30, 7
  v_mfma_f32_16x16x32_bf16 v[144:147], v[48:51], a[20:23], v[144:147]
  ds_read_b64_tr_b16 v[34:35], v18 offset:25088
  ds_read_b128 a[64:67], v16 offset:0
  s_add_u32 s48, s48, s55
  v_mfma_f32_16x16x32_bf16 v[160:163], v[48:51], a[24:27], v[160:163]
  ds_read_b64_tr_b16 v[36:37], v19 offset:24576
  ds_read_b128 a[68:71], v16 offset:2048
  buffer_load_dwordx4 v14, s[16:19], s46 offen offset:2048 lds
  v_mfma_f32_16x16x32_bf16 v[176:179], v[48:51], a[28:31], v[176:179]
  ds_read_b64_tr_b16 v[38:39], v19 offset:25088
  ds_read_b128 a[72:75], v16 offset:4096
  v_mfma_f32_16x16x32_bf16 v[132:135], v[52:55], a[16:19], v[132:135]
  ds_read_b64_tr_b16 v[40:41], v20 offset:24576
  ds_read_b128 a[76:79], v16 offset:6144
  s_waitcnt vmcnt(8)
  s_mov_b32 s53, 1069066811
  v_mfma_f32_16x16x32_bf16 v[148:151], v[52:55], a[20:23], v[148:151]
  ds_read_b64_tr_b16 v[42:43], v20 offset:25088
  ds_read_b128 a[80:83], v17 offset:0
  buffer_load_dwordx4 v15, s[16:19], s46 offen offset:3072 lds
  v_mfma_f32_16x16x32_bf16 v[164:167], v[52:55], a[24:27], v[164:167]
  ds_read_b64_tr_b16 v[44:45], v21 offset:24576
  ds_read_b128 a[84:87], v17 offset:2048
  v_lshlrev_b32 v208, 16, v208
  v_lshlrev_b32 v209, 16, v209
  v_mfma_f32_16x16x32_bf16 v[180:183], v[52:55], a[28:31], v[180:183]
  ds_read_b64_tr_b16 v[46:47], v21 offset:25088
  ds_read_b128 a[88:91], v17 offset:4096
  v_lshlrev_b32 v210, 16, v210
  v_lshlrev_b32 v211, 16, v211
  v_mfma_f32_16x16x32_bf16 v[136:139], v[56:59], a[16:19], v[136:139]
  ds_read_b128 a[92:95], v17 offset:6144
  s_cmp_lt_u32 s30, 2
  s_cselect_b32 s48, s48, 0x80000000
  v_mul_f32 v220, s53, v208
  v_mfma_f32_16x16x32_bf16 v[152:155], v[56:59], a[20:23], v[152:155]
  v_mul_f32 v221, s53, v209
  v_mul_f32 v222, s53, v210
  v_mul_f32 v223, s53, v211
  v_mfma_f32_16x16x32_bf16 v[168:171], v[56:59], a[24:27], v[168:171]
  v_exp_f32 v220, -v220
  v_mfma_f32_16x16x32_bf16 v[184:187], v[56:59], a[28:31], v[184:187]
  v_exp_f32 v221, -v221
  v_mfma_f32_16x16x32_bf16 v[140:143], v[60:63], a[16:19], v[140:143]
  v_exp_f32 v222, -v222
  v_mfma_f32_16x16x32_bf16 v[156:159], v[60:63], a[20:23], v[156:159]
  v_exp_f32 v223, -v223
  v_add_f32 v220, 1.0, v220
  v_mfma_f32_16x16x32_bf16 v[172:175], v[60:63], a[24:27], v[172:175]
  v_add_f32 v221, 1.0, v221
  v_add_f32 v222, 1.0, v222
  v_add_f32 v223, 1.0, v223
  v_mfma_f32_16x16x32_bf16 v[188:191], v[60:63], a[28:31], v[188:191]
  s_waitcnt lgkmcnt(0)
  v_rcp_f32 v220, v220
  v_mfma_f32_16x16x32_bf16 v[128:131], v[32:35], a[32:35], v[128:131]
  ds_read_b64_tr_b16 v[48:49], v18 offset:28672
  s_add_u32 m0, s49, 0
  s_mov_b32 s46, 512
  v_mfma_f32_16x16x32_bf16 v[144:147], v[32:35], a[36:39], v[144:147]
  ds_read_b64_tr_b16 v[50:51], v18 offset:29184
  buffer_load_dwordx4 v4, s[12:15], s46 offen offset:0 lds
  v_mfma_f32_16x16x32_bf16 v[160:163], v[32:35], a[40:43], v[160:163]
  ds_read_b64_tr_b16 v[52:53], v19 offset:28672
  v_rcp_f32 v221, v221
  v_mfma_f32_16x16x32_bf16 v[176:179], v[32:35], a[44:47], v[176:179]
  ds_read_b64_tr_b16 v[54:55], v19 offset:29184
  v_rcp_f32 v222, v222
  v_mfma_f32_16x16x32_bf16 v[132:135], v[36:39], a[32:35], v[132:135]
  ds_read_b64_tr_b16 v[56:57], v20 offset:28672
  buffer_load_dwordx4 v5, s[12:15], s46 offen offset:1024 lds
  v_mfma_f32_16x16x32_bf16 v[148:151], v[36:39], a[36:39], v[148:151]
  ds_read_b64_tr_b16 v[58:59], v20 offset:29184
  v_rcp_f32 v223, v223
  v_mul_f32 v208, v208, v220
  v_mfma_f32_16x16x32_bf16 v[164:167], v[36:39], a[40:43], v[164:167]
  ds_read_b64_tr_b16 v[60:61], v21 offset:28672
  v_mul_f32 v209, v209, v221
  v_mul_f32 v210, v210, v222
  v_mul_f32 v211, v211, v223
  v_mfma_f32_16x16x32_bf16 v[180:183], v[36:39], a[44:47], v[180:183]
  ds_read_b64_tr_b16 v[62:63], v21 offset:29184
  buffer_load_dwordx4 v6, s[12:15], s46 offen offset:2048 lds
  v_cvt_pk_bf16_f32 v208, v208, v208
  v_mfma_f32_16x16x32_bf16 v[136:139], v[40:43], a[32:35], v[136:139]
  v_cvt_pk_bf16_f32 v209, v209, v209
  v_cvt_pk_bf16_f32 v210, v210, v210
  v_cvt_pk_bf16_f32 v211, v211, v211
  v_mfma_f32_16x16x32_bf16 v[152:155], v[40:43], a[36:39], v[152:155]
  v_lshlrev_b32 v208, 16, v208
  v_lshlrev_b32 v209, 16, v209
  v_lshlrev_b32 v210, 16, v210
  v_mfma_f32_16x16x32_bf16 v[168:171], v[40:43], a[40:43], v[168:171]
  buffer_load_dwordx4 v7, s[12:15], s46 offen offset:3072 lds
  v_lshlrev_b32 v211, 16, v211
  v_lshlrev_b32 v220, 16, v192
  v_mfma_f32_16x16x32_bf16 v[184:187], v[40:43], a[44:47], v[184:187]
  v_and_b32 v221, 0xffff0000, v192
  v_mul_f32 v212, v208, v220
  v_mul_f32 v213, v208, v221
  v_mfma_f32_16x16x32_bf16 v[140:143], v[44:47], a[32:35], v[140:143]
  v_lshlrev_b32 v220, 16, v193
  s_add_u32 m0, s49, 4096
  s_mov_b32 s46, 512
  v_mfma_f32_16x16x32_bf16 v[156:159], v[44:47], a[36:39], v[156:159]
  buffer_load_dwordx4 v8, s[12:15], s46 offen offset:0 lds
  v_and_b32 v221, 0xffff0000, v193
  v_mul_f32 v214, v208, v220
  v_mfma_f32_16x16x32_bf16 v[172:175], v[44:47], a[40:43], v[172:175]
  v_mul_f32 v215, v208, v221
  v_lshlrev_b32 v220, 16, v194
  v_and_b32 v221, 0xffff0000, v194
  v_mfma_f32_16x16x32_bf16 v[188:191], v[44:47], a[44:47], v[188:191]
  s_waitcnt lgkmcnt(0)
  v_mul_f32 v216, v208, v220
  v_mul_f32 v217, v208, v221
  v_lshlrev_b32 v220, 16, v195
  v_mfma_f32_16x16x32_bf16 v[128:131], v[48:51], a[48:51], v[128:131]
  s_barrier
  buffer_load_dwordx4 v9, s[12:15], s46 offen offset:1024 lds
  v_and_b32 v221, 0xffff0000, v195
  v_mfma_f32_16x16x32_bf16 v[144:147], v[48:51], a[52:55], v[144:147]
  ds_read_b64_tr_b16 v[32:33], v18 offset:32768
  v_mul_f32 v218, v208, v220
  v_mul_f32 v219, v208, v221
  v_lshlrev_b32 v220, 16, v196
  v_mfma_f32_16x16x32_bf16 v[160:163], v[48:51], a[56:59], v[160:163]
  ds_read_b64_tr_b16 v[34:35], v18 offset:33280
  v_and_b32 v221, 0xffff0000, v196
  v_fmac_f32 v212, v209, v220
  v_fmac_f32 v213, v209, v221
  v_mfma_f32_16x16x32_bf16 v[176:179], v[48:51], a[60:63], v[176:179]
  ds_read_b64_tr_b16 v[36:37], v19 offset:32768
  buffer_load_dwordx4 v10, s[12:15], s46 offen offset:2048 lds
  v_lshlrev_b32 v220, 16, v197
  v_mfma_f32_16x16x32_bf16 v[132:135], v[52:55], a[48:51], v[132:135]
  ds_read_b64_tr_b16 v[38:39], v19 offset:33280
  v_and_b32 v221, 0xffff0000, v197
  v_fmac_f32 v214, v209, v220
  v_fmac_f32 v215, v209, v221
  v_mfma_f32_16x16x32_bf16 v[148:151], v[52:55], a[52:55], v[148:151]
  ds_read_b64_tr_b16 v[40:41], v20 offset:32768
  v_lshlrev_b32 v220, 16, v198
  v_and_b32 v221, 0xffff0000, v198
  v_fmac_f32 v216, v209, v220
  v_mfma_f32_16x16x32_bf16 v[164:167], v[52:55], a[56:59], v[164:167]
  ds_read_b64_tr_b16 v[42:43], v20 offset:33280
  buffer_load_dwordx4 v11, s[12:15], s46 offen offset:3072 lds
  v_fmac_f32 v217, v209, v221
  v_mfma_f32_16x16x32_bf16 v[180:183], v[52:55], a[60:63], v[180:183]
  ds_read_b64_tr_b16 v[44:45], v21 offset:32768
  v_lshlrev_b32 v220, 16, v199
  v_and_b32 v221, 0xffff0000, v199
  v_fmac_f32 v218, v209, v220
  v_mfma_f32_16x16x32_bf16 v[136:139], v[56:59], a[48:51], v[136:139]
  ds_read_b64_tr_b16 v[46:47], v21 offset:33280
  v_fmac_f32 v219, v209, v221
  s_add_u32 m0, s50, 65536
  s_mov_b32 s46, 2097152
  v_mfma_f32_16x16x32_bf16 v[152:155], v[56:59], a[52:55], v[152:155]
  buffer_load_dwordx4 v12, s[16:19], s46 offen offset:0 lds
  v_lshlrev_b32 v220, 16, v200
  v_and_b32 v221, 0xffff0000, v200
  v_mfma_f32_16x16x32_bf16 v[168:171], v[56:59], a[56:59], v[168:171]
  v_fmac_f32 v212, v210, v220
  v_fmac_f32 v213, v210, v221
  v_lshlrev_b32 v220, 16, v201
  v_mfma_f32_16x16x32_bf16 v[184:187], v[56:59], a[60:63], v[184:187]
  v_and_b32 v221, 0xffff0000, v201
  v_fmac_f32 v214, v210, v220
  v_fmac_f32 v215, v210, v221
  v_mfma_f32_16x16x32_bf16 v[140:143], v[60:63], a[48:51], v[140:143]
  buffer_load_dwordx4 v13, s[16:19], s46 offen offset:1024 lds
  v_lshlrev_b32 v220, 16, v202
  v_and_b32 v221, 0xffff0000, v202
  v_mfma_f32_16x16x32_bf16 v[156:159], v[60:63], a[52:55], v[156:159]
  v_fmac_f32 v216, v210, v220
  v_fmac_f32 v217, v210, v221
  v_lshlrev_b32 v220, 16, v203
  v_mfma_f32_16x16x32_bf16 v[172:175], v[60:63], a[56:59], v[172:175]
  v_and_b32 v221, 0xffff0000, v203
  v_fmac_f32 v218, v210, v220
  v_fmac_f32 v219, v210, v221
  v_mfma_f32_16x16x32_bf16 v[188:191], v[60:63], a[60:63], v[188:191]
  s_waitcnt lgkmcnt(0)
  buffer_load_dwordx4 v14, s[16:19], s46 offen offset:2048 lds
  s_waitcnt vmcnt(15)
  v_mfma_f32_16x16x32_bf16 v[64:67], v[32:35], a[64:67], v[64:67]
  ds_read_b64_tr_b16 v[48:49], v18 offset:36864
  v_lshlrev_b32 v220, 16, v204
  v_and_b32 v221, 0xffff0000, v204
  v_fmac_f32 v212, v211, v220
  v_mfma_f32_16x16x32_bf16 v[80:83], v[32:35], a[68:71], v[80:83]
  ds_read_b64_tr_b16 v[50:51], v18 offset:37376
  ds_read_b128 a[96:99], v16 offset:8192
  v_fmac_f32 v213, v211, v221
  v_lshlrev_b32 v220, 16, v205
  v_mfma_f32_16x16x32_bf16 v[96:99], v[32:35], a[72:75], v[96:99]
  ds_read_b64_tr_b16 v[52:53], v19 offset:36864
  ds_read_b128 a[100:103], v16 offset:10240
  buffer_load_dwordx4 v15, s[16:19], s46 offen offset:3072 lds
  v_mfma_f32_16x16x32_bf16 v[112:115], v[32:35], a[76:79], v[112:115]
  ds_read_b64_tr_b16 v[54:55], v19 offset:37376
  ds_read_b128 a[104:107], v16 offset:12288
  v_and_b32 v221, 0xffff0000, v205
  v_fmac_f32 v214, v211, v220
  v_mfma_f32_16x16x32_bf16 v[68:71], v[36:39], a[64:67], v[68:71]
  ds_read_b64_tr_b16 v[56:57], v20 offset:36864
  ds_read_b128 a[108:111], v16 offset:14336
  v_fmac_f32 v215, v211, v221
  v_lshlrev_b32 v220, 16, v206
  v_mfma_f32_16x16x32_bf16 v[84:87], v[36:39], a[68:71], v[84:87]
  ds_read_b64_tr_b16 v[58:59], v20 offset:37376
  ds_read_b128 a[112:115], v17 offset:8192
  v_and_b32 v221, 0xffff0000, v206
  v_fmac_f32 v216, v211, v220
  v_mfma_f32_16x16x32_bf16 v[100:103], v[36:39], a[72:75], v[100:103]
  ds_read_b64_tr_b16 v[60:61], v21 offset:36864
  ds_read_b128 a[116:119], v17 offset:10240
  v_fmac_f32 v217, v211, v221
  v_lshlrev_b32 v220, 16, v207
  v_mfma_f32_16x16x32_bf16 v[116:119], v[36:39], a[76:79], v[116:119]
  ds_read_b64_tr_b16 v[62:63], v21 offset:37376
  ds_read_b128 a[120:123], v17 offset:12288
  v_and_b32 v221, 0xffff0000, v207
  v_fmac_f32 v218, v211, v220
  v_mfma_f32_16x16x32_bf16 v[72:75], v[40:43], a[64:67], v[72:75]
  ds_read_b128 a[124:127], v17 offset:14336
  v_fmac_f32 v219, v211, v221
  s_nop 1
  v_mfma_f32_16x16x32_bf16 v[88:91], v[40:43], a[68:71], v[88:91]
  v_add_f32_dpp v212, v212, v212 row_ror:8 row_mask:0xf bank_mask:0xf
  v_add_f32_dpp v213, v213, v213 row_ror:8 row_mask:0xf bank_mask:0xf
  v_add_f32_dpp v214, v214, v214 row_ror:8 row_mask:0xf bank_mask:0xf
  v_mfma_f32_16x16x32_bf16 v[104:107], v[40:43], a[72:75], v[104:107]
  v_add_f32_dpp v215, v215, v215 row_ror:8 row_mask:0xf bank_mask:0xf
  v_add_f32_dpp v216, v216, v216 row_ror:8 row_mask:0xf bank_mask:0xf
  v_add_f32_dpp v217, v217, v217 row_ror:8 row_mask:0xf bank_mask:0xf
  v_mfma_f32_16x16x32_bf16 v[120:123], v[40:43], a[76:79], v[120:123]
  v_add_f32_dpp v218, v218, v218 row_ror:8 row_mask:0xf bank_mask:0xf
  v_add_f32_dpp v219, v219, v219 row_ror:8 row_mask:0xf bank_mask:0xf
  v_add_f32_dpp v212, v212, v212 row_ror:4 row_mask:0xf bank_mask:0xf
  v_mfma_f32_16x16x32_bf16 v[76:79], v[44:47], a[64:67], v[76:79]
  v_add_f32_dpp v213, v213, v213 row_ror:4 row_mask:0xf bank_mask:0xf
  v_add_f32_dpp v214, v214, v214 row_ror:4 row_mask:0xf bank_mask:0xf
  v_add_f32_dpp v215, v215, v215 row_ror:4 row_mask:0xf bank_mask:0xf
  v_mfma_f32_16x16x32_bf16 v[92:95], v[44:47], a[68:71], v[92:95]
  v_add_f32_dpp v216, v216, v216 row_ror:4 row_mask:0xf bank_mask:0xf
  v_add_f32_dpp v217, v217, v217 row_ror:4 row_mask:0xf bank_mask:0xf
  v_add_f32_dpp v218, v218, v218 row_ror:4 row_mask:0xf bank_mask:0xf
  v_mfma_f32_16x16x32_bf16 v[108:111], v[44:47], a[72:75], v[108:111]
  v_add_f32_dpp v219, v219, v219 row_ror:4 row_mask:0xf bank_mask:0xf
  v_add_f32_dpp v212, v212, v212 row_ror:2 row_mask:0xf bank_mask:0xf
  v_add_f32_dpp v213, v213, v213 row_ror:2 row_mask:0xf bank_mask:0xf
  v_mfma_f32_16x16x32_bf16 v[124:127], v[44:47], a[76:79], v[124:127]
  s_waitcnt lgkmcnt(0)
  v_add_f32_dpp v214, v214, v214 row_ror:2 row_mask:0xf bank_mask:0xf
  v_add_f32_dpp v215, v215, v215 row_ror:2 row_mask:0xf bank_mask:0xf
  v_add_f32_dpp v216, v216, v216 row_ror:2 row_mask:0xf bank_mask:0xf
  v_mfma_f32_16x16x32_bf16 v[64:67], v[48:51], a[80:83], v[64:67]
  ds_read_b64_tr_b16 v[32:33], v18 offset:40960
  v_add_f32_dpp v217, v217, v217 row_ror:2 row_mask:0xf bank_mask:0xf
  s_add_u32 m0, s49, 8192
  s_mov_b32 s46, 640
  v_mfma_f32_16x16x32_bf16 v[80:83], v[48:51], a[84:87], v[80:83]
  ds_read_b64_tr_b16 v[34:35], v18 offset:41472
  buffer_load_dwordx4 v4, s[12:15], s46 offen offset:0 lds
  v_add_f32_dpp v218, v218, v218 row_ror:2 row_mask:0xf bank_mask:0xf
  v_mfma_f32_16x16x32_bf16 v[96:99], v[48:51], a[88:91], v[96:99]
  ds_read_b64_tr_b16 v[36:37], v19 offset:40960
  v_add_f32_dpp v219, v219, v219 row_ror:2 row_mask:0xf bank_mask:0xf
  v_lshrrev_b32 v22, 4, v0
  v_lshlrev_b32 v22, 6, v22
  v_mfma_f32_16x16x32_bf16 v[112:115], v[48:51], a[92:95], v[112:115]
  ds_read_b64_tr_b16 v[38:39], v19 offset:41472
  v_lshl_add_u32 v22, v23, 5, v22
  v_add_u32 v22, 0, v22
  v_mfma_f32_16x16x32_bf16 v[68:71], v[52:55], a[80:83], v[68:71]
  ds_read_b64_tr_b16 v[40:41], v20 offset:40960
  buffer_load_dwordx4 v5, s[12:15], s46 offen offset:1024 lds
  ds_write_b128 v22, v[212:215]
  v_mfma_f32_16x16x32_bf16 v[84:87], v[52:55], a[84:87], v[84:87]
  ds_read_b64_tr_b16 v[42:43], v20 offset:41472
  ds_write_b128 v22, v[216:219] offset:16
  v_and_b32 v22, 15, v2
  v_lshrrev_b32 v23, 4, v2
  v_mfma_f32_16x16x32_bf16 v[100:103], v[52:55], a[88:91], v[100:103]
  ds_read_b64_tr_b16 v[44:45], v21 offset:40960
  v_lshlrev_b32 v23, 8, v23
  v_lshl_add_u32 v23, v22, 2, v23
  v_add_u32 v23, 0, v23
  v_mfma_f32_16x16x32_bf16 v[116:119], v[52:55], a[92:95], v[116:119]
  ds_read_b64_tr_b16 v[46:47], v21 offset:41472
  buffer_load_dwordx4 v6, s[12:15], s46 offen offset:2048 lds
  v_lshlrev_b32 v22, 2, v22
  v_mfma_f32_16x16x32_bf16 v[72:75], v[56:59], a[80:83], v[72:75]
  s_waitcnt lgkmcnt(2)
  v_mfma_f32_16x16x32_bf16 v[88:91], v[56:59], a[84:87], v[88:91]
  v_mfma_f32_16x16x32_bf16 v[104:107], v[56:59], a[88:91], v[104:107]
  buffer_load_dwordx4 v7, s[12:15], s46 offen offset:3072 lds
  v_mfma_f32_16x16x32_bf16 v[120:123], v[56:59], a[92:95], v[120:123]
  v_mfma_f32_16x16x32_bf16 v[76:79], v[60:63], a[80:83], v[76:79]
  s_add_u32 m0, s49, 12288
  s_mov_b32 s46, 640
  v_mfma_f32_16x16x32_bf16 v[92:95], v[60:63], a[84:87], v[92:95]
  buffer_load_dwordx4 v8, s[12:15], s46 offen offset:0 lds
  v_mfma_f32_16x16x32_bf16 v[108:111], v[60:63], a[88:91], v[108:111]
  v_mfma_f32_16x16x32_bf16 v[124:127], v[60:63], a[92:95], v[124:127]
  s_waitcnt lgkmcnt(0)
  v_mfma_f32_16x16x32_bf16 v[64:67], v[32:35], a[96:99], v[64:67]
  ds_read_b64_tr_b16 v[48:49], v18 offset:45056
  buffer_load_dwordx4 v9, s[12:15], s46 offen offset:1024 lds
  v_mfma_f32_16x16x32_bf16 v[80:83], v[32:35], a[100:103], v[80:83]
  ds_read_b64_tr_b16 v[50:51], v18 offset:45568
  v_mfma_f32_16x16x32_bf16 v[96:99], v[32:35], a[104:107], v[96:99]
  ds_read_b64_tr_b16 v[52:53], v19 offset:45056
  v_mfma_f32_16x16x32_bf16 v[112:115], v[32:35], a[108:111], v[112:115]
  ds_read_b64_tr_b16 v[54:55], v19 offset:45568
  buffer_load_dwordx4 v10, s[12:15], s46 offen offset:2048 lds
  v_mfma_f32_16x16x32_bf16 v[68:71], v[36:39], a[96:99], v[68:71]
  ds_read_b64_tr_b16 v[56:57], v20 offset:45056
  v_mfma_f32_16x16x32_bf16 v[84:87], v[36:39], a[100:103], v[84:87]
  ds_read_b64_tr_b16 v[58:59], v20 offset:45568
  v_mfma_f32_16x16x32_bf16 v[100:103], v[36:39], a[104:107], v[100:103]
  ds_read_b64_tr_b16 v[60:61], v21 offset:45056
  buffer_load_dwordx4 v11, s[12:15], s46 offen offset:3072 lds
  v_mfma_f32_16x16x32_bf16 v[116:119], v[36:39], a[108:111], v[116:119]
  ds_read_b64_tr_b16 v[62:63], v21 offset:45568
  v_mfma_f32_16x16x32_bf16 v[72:75], v[40:43], a[96:99], v[72:75]
  v_mfma_f32_16x16x32_bf16 v[88:91], v[40:43], a[100:103], v[88:91]
  v_mfma_f32_16x16x32_bf16 v[104:107], v[40:43], a[104:107], v[104:107]
  v_mfma_f32_16x16x32_bf16 v[120:123], v[40:43], a[108:111], v[120:123]
  v_mfma_f32_16x16x32_bf16 v[76:79], v[44:47], a[96:99], v[76:79]
  v_mfma_f32_16x16x32_bf16 v[92:95], v[44:47], a[100:103], v[92:95]
  v_mfma_f32_16x16x32_bf16 v[108:111], v[44:47], a[104:107], v[108:111]
  v_mfma_f32_16x16x32_bf16 v[124:127], v[44:47], a[108:111], v[124:127]
  s_waitcnt vmcnt(20) lgkmcnt(0)
  v_mfma_f32_16x16x32_bf16 v[64:67], v[48:51], a[112:115], v[64:67]
  s_barrier
  v_mfma_f32_16x16x32_bf16 v[80:83], v[48:51], a[116:119], v[80:83]
  ds_read_b64_tr_b16 v[32:33], v18 offset:49152
  ds_read_b32 v220, v23 offset:0
  ds_read_b32 v221, v23 offset:64
  v_mfma_f32_16x16x32_bf16 v[96:99], v[48:51], a[120:123], v[96:99]
  ds_read_b64_tr_b16 v[34:35], v18 offset:49664
  ds_read_b32 v222, v23 offset:128
  ds_read_b32 v223, v23 offset:192
  v_mfma_f32_16x16x32_bf16 v[112:115], v[48:51], a[124:127], v[112:115]
  ds_read_b64_tr_b16 v[36:37], v19 offset:49152
  s_lshl_b32 s53, s52, 1
  v_mfma_f32_16x16x32_bf16 v[68:71], v[52:55], a[112:115], v[68:71]
  ds_read_b64_tr_b16 v[38:39], v19 offset:49664
  s_cmp_eq_u32 s30, 0
  s_cselect_b32 s53, s53, 0x80000000
  v_mfma_f32_16x16x32_bf16 v[84:87], v[52:55], a[116:119], v[84:87]
  ds_read_b64_tr_b16 v[40:41], v20 offset:49152
  s_waitcnt lgkmcnt(3)
  v_add_f32 v220, v220, v221
  v_mfma_f32_16x16x32_bf16 v[100:103], v[52:55], a[120:123], v[100:103]
  ds_read_b64_tr_b16 v[42:43], v20 offset:49664
  v_add_f32 v222, v222, v223
  v_add_f32 v220, v220, v222
  v_mfma_f32_16x16x32_bf16 v[116:119], v[52:55], a[124:127], v[116:119]
  ds_read_b64_tr_b16 v[44:45], v21 offset:49152
  v_mov_b32 v221, v220
  v_mfma_f32_16x16x32_bf16 v[72:75], v[56:59], a[112:115], v[72:75]
  ds_read_b64_tr_b16 v[46:47], v21 offset:49664
  s_nop 1
  v_mfma_f32_16x16x32_bf16 v[88:91], v[56:59], a[116:119], v[88:91]
  v_permlane16_swap_b32 v220, v221
  s_nop 0
  v_mfma_f32_16x16x32_bf16 v[104:107], v[56:59], a[120:123], v[104:107]
  v_add_f32 v220, v220, v221
  v_mov_b32 v221, v220
  v_mfma_f32_16x16x32_bf16 v[120:123], v[56:59], a[124:127], v[120:123]
  s_nop 1
  v_mfma_f32_16x16x32_bf16 v[76:79], v[60:63], a[112:115], v[76:79]
  v_permlane32_swap_b32 v220, v221
  s_nop 0
  v_mfma_f32_16x16x32_bf16 v[92:95], v[60:63], a[116:119], v[92:95]
  v_add_f32 v220, v220, v221
  v_cvt_pk_bf16_f32 v220, v220, v220
  v_mfma_f32_16x16x32_bf16 v[108:111], v[60:63], a[120:123], v[108:111]
  v_lshlrev_b32 v220, 16, v220
  v_add_f32 v220, s44, v220
  v_mfma_f32_16x16x32_bf16 v[124:127], v[60:63], a[124:127], v[124:127]
  s_waitcnt lgkmcnt(0)
  v_cvt_pk_bf16_f32 v220, v220, v220
  s_waitcnt vmcnt(12)
  v_mfma_f32_16x16x32_bf16 v[128:131], v[32:35], a[64:67], v[128:131]
  ds_read_b64_tr_b16 v[48:49], v18 offset:53248
  v_lshlrev_b32 v220, 16, v220
  v_mul_f32 v220, s45, v220
  v_mfma_f32_16x16x32_bf16 v[144:147], v[32:35], a[68:71], v[144:147]
  ds_read_b64_tr_b16 v[50:51], v18 offset:53760
  ds_read_b128 a[128:131], v16 offset:0
  v_mfma_f32_16x16x32_bf16 v[160:163], v[32:35], a[72:75], v[160:163]
  ds_read_b64_tr_b16 v[52:53], v19 offset:53248
  ds_read_b128 a[132:135], v16 offset:2048
  v_mfma_f32_16x16x32_bf16 v[176:179], v[32:35], a[76:79], v[176:179]
  ds_read_b64_tr_b16 v[54:55], v19 offset:53760
  ds_read_b128 a[136:139], v16 offset:4096
  v_mfma_f32_16x16x32_bf16 v[132:135], v[36:39], a[64:67], v[132:135]
  ds_read_b64_tr_b16 v[56:57], v20 offset:53248
  ds_read_b128 a[140:143], v16 offset:6144
  v_mfma_f32_16x16x32_bf16 v[148:151], v[36:39], a[68:71], v[148:151]
  ds_read_b64_tr_b16 v[58:59], v20 offset:53760
  ds_read_b128 a[144:147], v17 offset:0
  v_mfma_f32_16x16x32_bf16 v[164:167], v[36:39], a[72:75], v[164:167]
  ds_read_b64_tr_b16 v[60:61], v21 offset:53248
  ds_read_b128 a[148:151], v17 offset:2048
  v_mfma_f32_16x16x32_bf16 v[180:183], v[36:39], a[76:79], v[180:183]
  ds_read_b64_tr_b16 v[62:63], v21 offset:53760
  ds_read_b128 a[152:155], v17 offset:4096
  v_mfma_f32_16x16x32_bf16 v[136:139], v[40:43], a[64:67], v[136:139]
  ds_read_b128 a[156:159], v17 offset:6144
  v_mfma_f32_16x16x32_bf16 v[152:155], v[40:43], a[68:71], v[152:155]
  buffer_store_dword v220, v22, s[20:23], s53 offen sc1
  v_mfma_f32_16x16x32_bf16 v[168:171], v[40:43], a[72:75], v[168:171]
  s_cmp_lt_u32 s53, 4096
  s_cselect_b32 s54, 0, 0x1000
  v_mfma_f32_16x16x32_bf16 v[184:187], v[40:43], a[76:79], v[184:187]
  v_mfma_f32_16x16x32_bf16 v[140:143], v[44:47], a[64:67], v[140:143]
  v_mfma_f32_16x16x32_bf16 v[156:159], v[44:47], a[68:71], v[156:159]
  v_mfma_f32_16x16x32_bf16 v[172:175], v[44:47], a[72:75], v[172:175]
  v_mfma_f32_16x16x32_bf16 v[188:191], v[44:47], a[76:79], v[188:191]
  s_waitcnt lgkmcnt(0)
  v_mfma_f32_16x16x32_bf16 v[128:131], v[48:51], a[80:83], v[128:131]
  ds_read_b64_tr_b16 v[32:33], v18 offset:57344
  s_add_u32 m0, s49, 0
  s_mov_b32 s46, 768
  v_mfma_f32_16x16x32_bf16 v[144:147], v[48:51], a[84:87], v[144:147]
  ds_read_b64_tr_b16 v[34:35], v18 offset:57856
  buffer_load_dwordx4 v4, s[12:15], s46 offen offset:0 lds
  v_mfma_f32_16x16x32_bf16 v[160:163], v[48:51], a[88:91], v[160:163]
  ds_read_b64_tr_b16 v[36:37], v19 offset:57344
  v_mfma_f32_16x16x32_bf16 v[176:179], v[48:51], a[92:95], v[176:179]
  ds_read_b64_tr_b16 v[38:39], v19 offset:57856
  v_mfma_f32_16x16x32_bf16 v[132:135], v[52:55], a[80:83], v[132:135]
  ds_read_b64_tr_b16 v[40:41], v20 offset:57344
  buffer_load_dwordx4 v5, s[12:15], s46 offen offset:1024 lds
  v_mfma_f32_16x16x32_bf16 v[148:151], v[52:55], a[84:87], v[148:151]
  ds_read_b64_tr_b16 v[42:43], v20 offset:57856
  v_mfma_f32_16x16x32_bf16 v[164:167], v[52:55], a[88:91], v[164:167]
  ds_read_b64_tr_b16 v[44:45], v21 offset:57344
  v_mfma_f32_16x16x32_bf16 v[180:183], v[52:55], a[92:95], v[180:183]
  ds_read_b64_tr_b16 v[46:47], v21 offset:57856
  buffer_load_dwordx4 v6, s[12:15], s46 offen offset:2048 lds
  v_mfma_f32_16x16x32_bf16 v[136:139], v[56:59], a[80:83], v[136:139]
  v_mfma_f32_16x16x32_bf16 v[152:155], v[56:59], a[84:87], v[152:155]
  v_mfma_f32_16x16x32_bf16 v[168:171], v[56:59], a[88:91], v[168:171]
  buffer_load_dwordx4 v7, s[12:15], s46 offen offset:3072 lds
  v_mfma_f32_16x16x32_bf16 v[184:187], v[56:59], a[92:95], v[184:187]
  v_mfma_f32_16x16x32_bf16 v[140:143], v[60:63], a[80:83], v[140:143]
  s_add_u32 m0, s49, 4096
  s_mov_b32 s46, 768
  v_mfma_f32_16x16x32_bf16 v[156:159], v[60:63], a[84:87], v[156:159]
  buffer_load_dwordx4 v8, s[12:15], s46 offen offset:0 lds
  v_mfma_f32_16x16x32_bf16 v[172:175], v[60:63], a[88:91], v[172:175]
  v_mfma_f32_16x16x32_bf16 v[188:191], v[60:63], a[92:95], v[188:191]
  s_waitcnt lgkmcnt(0)
  v_mfma_f32_16x16x32_bf16 v[128:131], v[32:35], a[96:99], v[128:131]
  ds_read_b64_tr_b16 v[48:49], v18 offset:61440
  buffer_load_dwordx4 v9, s[12:15], s46 offen offset:1024 lds
  v_mfma_f32_16x16x32_bf16 v[144:147], v[32:35], a[100:103], v[144:147]
  ds_read_b64_tr_b16 v[50:51], v18 offset:61952
  v_mfma_f32_16x16x32_bf16 v[160:163], v[32:35], a[104:107], v[160:163]
  ds_read_b64_tr_b16 v[52:53], v19 offset:61440
  v_mfma_f32_16x16x32_bf16 v[176:179], v[32:35], a[108:111], v[176:179]
  ds_read_b64_tr_b16 v[54:55], v19 offset:61952
  buffer_load_dwordx4 v10, s[12:15], s46 offen offset:2048 lds
  v_mfma_f32_16x16x32_bf16 v[132:135], v[36:39], a[96:99], v[132:135]
  ds_read_b64_tr_b16 v[56:57], v20 offset:61440
  v_mfma_f32_16x16x32_bf16 v[148:151], v[36:39], a[100:103], v[148:151]
  ds_read_b64_tr_b16 v[58:59], v20 offset:61952
  v_mfma_f32_16x16x32_bf16 v[164:167], v[36:39], a[104:107], v[164:167]
  ds_read_b64_tr_b16 v[60:61], v21 offset:61440
  buffer_load_dwordx4 v11, s[12:15], s46 offen offset:3072 lds
  v_mfma_f32_16x16x32_bf16 v[180:183], v[36:39], a[108:111], v[180:183]
  ds_read_b64_tr_b16 v[62:63], v21 offset:61952
  v_mfma_f32_16x16x32_bf16 v[136:139], v[40:43], a[96:99], v[136:139]
  s_add_u32 m0, s50, 81920
  s_mov_b32 s46, 3145728
  v_mfma_f32_16x16x32_bf16 v[152:155], v[40:43], a[100:103], v[152:155]
  buffer_load_dwordx4 v12, s[16:19], s46 offen offset:0 lds
  v_mfma_f32_16x16x32_bf16 v[168:171], v[40:43], a[104:107], v[168:171]
  v_mfma_f32_16x16x32_bf16 v[184:187], v[40:43], a[108:111], v[184:187]
  v_mfma_f32_16x16x32_bf16 v[140:143], v[44:47], a[96:99], v[140:143]
  buffer_load_dwordx4 v13, s[16:19], s46 offen offset:1024 lds
  v_mfma_f32_16x16x32_bf16 v[156:159], v[44:47], a[100:103], v[156:159]
  v_xor_b32 v18, 0x10000, v18
  v_xor_b32 v19, 0x10000, v19
  v_mfma_f32_16x16x32_bf16 v[172:175], v[44:47], a[104:107], v[172:175]
  v_xor_b32 v20, 0x10000, v20
  v_xor_b32 v21, 0x10000, v21
  v_mfma_f32_16x16x32_bf16 v[188:191], v[44:47], a[108:111], v[188:191]
  s_waitcnt vmcnt(19) lgkmcnt(0)
  buffer_load_dwordx4 v14, s[16:19], s46 offen offset:2048 lds
  s_waitcnt vmcnt(12)
  v_mfma_f32_16x16x32_bf16 v[128:131], v[48:51], a[112:115], v[128:131]
  s_barrier
  v_mfma_f32_16x16x32_bf16 v[144:147], v[48:51], a[116:119], v[144:147]
  ds_read_b64_tr_b16 v[32:33], v18 offset:0
  ds_read_b128 a[160:163], v16 offset:8192
  v_mfma_f32_16x16x32_bf16 v[160:163], v[48:51], a[120:123], v[160:163]
  ds_read_b64_tr_b16 v[34:35], v18 offset:512
  ds_read_b128 a[164:167], v16 offset:10240
  buffer_load_dwordx4 v15, s[16:19], s46 offen offset:3072 lds
  v_mfma_f32_16x16x32_bf16 v[176:179], v[48:51], a[124:127], v[176:179]
  ds_read_b64_tr_b16 v[36:37], v19 offset:0
  ds_read_b128 a[168:171], v16 offset:12288
  v_mfma_f32_16x16x32_bf16 v[132:135], v[52:55], a[112:115], v[132:135]
  ds_read_b64_tr_b16 v[38:39], v19 offset:512
  ds_read_b128 a[172:175], v16 offset:14336
  v_mfma_f32_16x16x32_bf16 v[148:151], v[52:55], a[116:119], v[148:151]
  ds_read_b64_tr_b16 v[40:41], v20 offset:0
  ds_read_b128 a[176:179], v17 offset:8192
  v_mfma_f32_16x16x32_bf16 v[164:167], v[52:55], a[120:123], v[164:167]
  ds_read_b64_tr_b16 v[42:43], v20 offset:512
  ds_read_b128 a[180:183], v17 offset:10240
  v_mfma_f32_16x16x32_bf16 v[180:183], v[52:55], a[124:127], v[180:183]
  ds_read_b64_tr_b16 v[44:45], v21 offset:0
  ds_read_b128 a[184:187], v17 offset:12288
  v_mfma_f32_16x16x32_bf16 v[136:139], v[56:59], a[112:115], v[136:139]
  ds_read_b64_tr_b16 v[46:47], v21 offset:512
  ds_read_b128 a[188:191], v17 offset:14336
  v_mfma_f32_16x16x32_bf16 v[152:155], v[56:59], a[116:119], v[152:155]
  v_mfma_f32_16x16x32_bf16 v[168:171], v[56:59], a[120:123], v[168:171]
  s_waitcnt vmcnt(12)
  v_mfma_f32_16x16x32_bf16 v[184:187], v[56:59], a[124:127], v[184:187]
  buffer_atomic_add v29, v27, s[60:63], s54 offen sc1
  v_mfma_f32_16x16x32_bf16 v[140:143], v[60:63], a[112:115], v[140:143]
  v_mfma_f32_16x16x32_bf16 v[156:159], v[60:63], a[116:119], v[156:159]
  v_mfma_f32_16x16x32_bf16 v[172:175], v[60:63], a[120:123], v[172:175]
  v_mfma_f32_16x16x32_bf16 v[188:191], v[60:63], a[124:127], v[188:191]
  s_waitcnt lgkmcnt(0)
  v_mfma_f32_16x16x32_bf16 v[64:67], v[32:35], a[128:131], v[64:67]
  ds_read_b64_tr_b16 v[48:49], v18 offset:4096
  s_add_u32 m0, s49, 8192
  s_mov_b32 s46, 896
  v_mfma_f32_16x16x32_bf16 v[80:83], v[32:35], a[132:135], v[80:83]
  ds_read_b64_tr_b16 v[50:51], v18 offset:4608
  buffer_load_dwordx4 v4, s[12:15], s46 offen offset:0 lds
  v_mfma_f32_16x16x32_bf16 v[96:99], v[32:35], a[136:139], v[96:99]
  ds_read_b64_tr_b16 v[52:53], v19 offset:4096
  v_mfma_f32_16x16x32_bf16 v[112:115], v[32:35], a[140:143], v[112:115]
  ds_read_b64_tr_b16 v[54:55], v19 offset:4608
  v_mfma_f32_16x16x32_bf16 v[68:71], v[36:39], a[128:131], v[68:71]
  ds_read_b64_tr_b16 v[56:57], v20 offset:4096
  buffer_load_dwordx4 v5, s[12:15], s46 offen offset:1024 lds
  v_mfma_f32_16x16x32_bf16 v[84:87], v[36:39], a[132:135], v[84:87]
  ds_read_b64_tr_b16 v[58:59], v20 offset:4608
  v_mfma_f32_16x16x32_bf16 v[100:103], v[36:39], a[136:139], v[100:103]
  ds_read_b64_tr_b16 v[60:61], v21 offset:4096
  v_mfma_f32_16x16x32_bf16 v[116:119], v[36:39], a[140:143], v[116:119]
  ds_read_b64_tr_b16 v[62:63], v21 offset:4608
  buffer_load_dwordx4 v6, s[12:15], s46 offen offset:2048 lds
  v_mfma_f32_16x16x32_bf16 v[72:75], v[40:43], a[128:131], v[72:75]
  v_mfma_f32_16x16x32_bf16 v[88:91], v[40:43], a[132:135], v[88:91]
  v_mfma_f32_16x16x32_bf16 v[104:107], v[40:43], a[136:139], v[104:107]
  buffer_load_dwordx4 v7, s[12:15], s46 offen offset:3072 lds
  v_mfma_f32_16x16x32_bf16 v[120:123], v[40:43], a[140:143], v[120:123]
  v_mfma_f32_16x16x32_bf16 v[76:79], v[44:47], a[128:131], v[76:79]
  s_add_u32 m0, s49, 12288
  s_mov_b32 s46, 896
  v_mfma_f32_16x16x32_bf16 v[92:95], v[44:47], a[132:135], v[92:95]
  buffer_load_dwordx4 v8, s[12:15], s46 offen offset:0 lds
  v_mfma_f32_16x16x32_bf16 v[108:111], v[44:47], a[136:139], v[108:111]
  v_mfma_f32_16x16x32_bf16 v[124:127], v[44:47], a[140:143], v[124:127]
  s_waitcnt lgkmcnt(0)
  v_mfma_f32_16x16x32_bf16 v[64:67], v[48:51], a[144:147], v[64:67]
  ds_read_b64_tr_b16 v[32:33], v18 offset:8192
  buffer_load_dwordx4 v9, s[12:15], s46 offen offset:1024 lds
  v_mfma_f32_16x16x32_bf16 v[80:83], v[48:51], a[148:151], v[80:83]
  ds_read_b64_tr_b16 v[34:35], v18 offset:8704
  v_mfma_f32_16x16x32_bf16 v[96:99], v[48:51], a[152:155], v[96:99]
  ds_read_b64_tr_b16 v[36:37], v19 offset:8192
  v_mfma_f32_16x16x32_bf16 v[112:115], v[48:51], a[156:159], v[112:115]
  ds_read_b64_tr_b16 v[38:39], v19 offset:8704
  buffer_load_dwordx4 v10, s[12:15], s46 offen offset:2048 lds
  v_mfma_f32_16x16x32_bf16 v[68:71], v[52:55], a[144:147], v[68:71]
  ds_read_b64_tr_b16 v[40:41], v20 offset:8192
  v_mfma_f32_16x16x32_bf16 v[84:87], v[52:55], a[148:151], v[84:87]
  ds_read_b64_tr_b16 v[42:43], v20 offset:8704
  v_mfma_f32_16x16x32_bf16 v[100:103], v[52:55], a[152:155], v[100:103]
  ds_read_b64_tr_b16 v[44:45], v21 offset:8192
  buffer_load_dwordx4 v11, s[12:15], s46 offen offset:3072 lds
  v_mfma_f32_16x16x32_bf16 v[116:119], v[52:55], a[156:159], v[116:119]
  ds_read_b64_tr_b16 v[46:47], v21 offset:8704
  v_mfma_f32_16x16x32_bf16 v[72:75], v[56:59], a[144:147], v[72:75]
  v_mfma_f32_16x16x32_bf16 v[88:91], v[56:59], a[148:151], v[88:91]
  v_mfma_f32_16x16x32_bf16 v[104:107], v[56:59], a[152:155], v[104:107]
  s_add_u32 m0, s50, 0
  s_mov_b32 s46, 2097280
  v_mfma_f32_16x16x32_bf16 v[120:123], v[56:59], a[156:159], v[120:123]
  buffer_load_dwordx4 v12, s[16:19], s46 offen offset:0 lds
  v_mfma_f32_16x16x32_bf16 v[76:79], v[60:63], a[144:147], v[76:79]
  v_mfma_f32_16x16x32_bf16 v[92:95], v[60:63], a[148:151], v[92:95]
  v_mfma_f32_16x16x32_bf16 v[108:111], v[60:63], a[152:155], v[108:111]
  buffer_load_dwordx4 v13, s[16:19], s46 offen offset:1024 lds
  v_mfma_f32_16x16x32_bf16 v[124:127], v[60:63], a[156:159], v[124:127]
  s_waitcnt lgkmcnt(0)
  s_waitcnt vmcnt(15)
  v_mfma_f32_16x16x32_bf16 v[64:67], v[32:35], a[160:163], v[64:67]
  ds_read_b64_tr_b16 v[48:49], v18 offset:12288
  v_mfma_f32_16x16x32_bf16 v[80:83], v[32:35], a[164:167], v[80:83]
  ds_read_b64_tr_b16 v[50:51], v18 offset:12800
  ds_read_b128 a[192:195], v16 offset:0
  buffer_load_dwordx4 v14, s[16:19], s46 offen offset:2048 lds
  v_mfma_f32_16x16x32_bf16 v[96:99], v[32:35], a[168:171], v[96:99]
  ds_read_b64_tr_b16 v[52:53], v19 offset:12288
  ds_read_b128 a[196:199], v16 offset:2048
  v_mfma_f32_16x16x32_bf16 v[112:115], v[32:35], a[172:175], v[112:115]
  ds_read_b64_tr_b16 v[54:55], v19 offset:12800
  ds_read_b128 a[200:203], v16 offset:4096
  v_mfma_f32_16x16x32_bf16 v[68:71], v[36:39], a[160:163], v[68:71]
  ds_read_b64_tr_b16 v[56:57], v20 offset:12288
  ds_read_b128 a[204:207], v16 offset:6144
  buffer_load_dwordx4 v15, s[16:19], s46 offen offset:3072 lds
  v_mfma_f32_16x16x32_bf16 v[84:87], v[36:39], a[164:167], v[84:87]
  ds_read_b64_tr_b16 v[58:59], v20 offset:12800
  ds_read_b128 a[208:211], v17 offset:0
  v_mfma_f32_16x16x32_bf16 v[100:103], v[36:39], a[168:171], v[100:103]
  ds_read_b64_tr_b16 v[60:61], v21 offset:12288
  ds_read_b128 a[212:215], v17 offset:2048
  s_add_u32 m0, s50, 16384
  s_mov_b32 s46, 3145856
  v_mfma_f32_16x16x32_bf16 v[116:119], v[36:39], a[172:175], v[116:119]
  ds_read_b64_tr_b16 v[62:63], v21 offset:12800
  ds_read_b128 a[216:219], v17 offset:4096
  buffer_load_dwordx4 v12, s[16:19], s46 offen offset:0 lds
  v_mfma_f32_16x16x32_bf16 v[72:75], v[40:43], a[160:163], v[72:75]
  ds_read_b128 a[220:223], v17 offset:6144
  v_mfma_f32_16x16x32_bf16 v[88:91], v[40:43], a[164:167], v[88:91]
  v_mfma_f32_16x16x32_bf16 v[104:107], v[40:43], a[168:171], v[104:107]
  buffer_load_dwordx4 v13, s[16:19], s46 offen offset:1024 lds
  v_mfma_f32_16x16x32_bf16 v[120:123], v[40:43], a[172:175], v[120:123]
  v_mfma_f32_16x16x32_bf16 v[76:79], v[44:47], a[160:163], v[76:79]
  v_mfma_f32_16x16x32_bf16 v[92:95], v[44:47], a[164:167], v[92:95]
  buffer_load_dwordx4 v14, s[16:19], s46 offen offset:2048 lds
  v_mfma_f32_16x16x32_bf16 v[108:111], v[44:47], a[168:171], v[108:111]
  v_mfma_f32_16x16x32_bf16 v[124:127], v[44:47], a[172:175], v[124:127]
  s_waitcnt vmcnt(16) lgkmcnt(0)
  v_mfma_f32_16x16x32_bf16 v[64:67], v[48:51], a[176:179], v[64:67]
  s_barrier
  buffer_load_dwordx4 v15, s[16:19], s46 offen offset:3072 lds
  v_mfma_f32_16x16x32_bf16 v[80:83], v[48:51], a[180:183], v[80:83]
  ds_read_b64_tr_b16 v[32:33], v18 offset:16384
  v_mfma_f32_16x16x32_bf16 v[96:99], v[48:51], a[184:187], v[96:99]
  ds_read_b64_tr_b16 v[34:35], v18 offset:16896
  v_mfma_f32_16x16x32_bf16 v[112:115], v[48:51], a[188:191], v[112:115]
  ds_read_b64_tr_b16 v[36:37], v19 offset:16384
  v_mfma_f32_16x16x32_bf16 v[68:71], v[52:55], a[176:179], v[68:71]
  ds_read_b64_tr_b16 v[38:39], v19 offset:16896
  v_mfma_f32_16x16x32_bf16 v[84:87], v[52:55], a[180:183], v[84:87]
  ds_read_b64_tr_b16 v[40:41], v20 offset:16384
  v_mfma_f32_16x16x32_bf16 v[100:103], v[52:55], a[184:187], v[100:103]
  ds_read_b64_tr_b16 v[42:43], v20 offset:16896
  v_mfma_f32_16x16x32_bf16 v[116:119], v[52:55], a[188:191], v[116:119]
  ds_read_b64_tr_b16 v[44:45], v21 offset:16384
  v_mfma_f32_16x16x32_bf16 v[72:75], v[56:59], a[176:179], v[72:75]
  ds_read_b64_tr_b16 v[46:47], v21 offset:16896
  v_mfma_f32_16x16x32_bf16 v[88:91], v[56:59], a[180:183], v[88:91]
  buffer_load_dword v26, v28, s[24:27], s48 offen
  v_mfma_f32_16x16x32_bf16 v[104:107], v[56:59], a[184:187], v[104:107]
  v_mfma_f32_16x16x32_bf16 v[120:123], v[56:59], a[188:191], v[120:123]
  v_mfma_f32_16x16x32_bf16 v[76:79], v[60:63], a[176:179], v[76:79]
  v_mfma_f32_16x16x32_bf16 v[92:95], v[60:63], a[180:183], v[92:95]
  v_mfma_f32_16x16x32_bf16 v[108:111], v[60:63], a[184:187], v[108:111]
  v_mfma_f32_16x16x32_bf16 v[124:127], v[60:63], a[188:191], v[124:127]
  s_waitcnt lgkmcnt(0)
  v_mfma_f32_16x16x32_bf16 v[64:67], v[32:35], a[192:195], v[64:67]
  ds_read_b64_tr_b16 v[48:49], v18 offset:20480
  s_nop 0
  v_lshlrev_b32 v232, 16, v224
  v_mfma_f32_16x16x32_bf16 v[80:83], v[32:35], a[196:199], v[80:83]
  ds_read_b64_tr_b16 v[50:51], v18 offset:20992
  v_and_b32 v233, 0xffff0000, v224
  v_lshlrev_b32 v234, 16, v225
  v_mfma_f32_16x16x32_bf16 v[96:99], v[32:35], a[200:203], v[96:99]
  ds_read_b64_tr_b16 v[52:53], v19 offset:20480
  v_and_b32 v235, 0xffff0000, v225
  v_lshlrev_b32 v236, 16, v226
  v_mfma_f32_16x16x32_bf16 v[112:115], v[32:35], a[204:207], v[112:115]
  ds_read_b64_tr_b16 v[54:55], v19 offset:20992
  v_and_b32 v237, 0xffff0000, v226
  v_lshlrev_b32 v238, 16, v227
  v_mfma_f32_16x16x32_bf16 v[68:71], v[36:39], a[192:195], v[68:71]
  ds_read_b64_tr_b16 v[56:57], v20 offset:20480
  v_and_b32 v239, 0xffff0000, v227
  v_lshlrev_b32 v240, 16, v228
  v_mfma_f32_16x16x32_bf16 v[84:87], v[36:39], a[196:199], v[84:87]
  ds_read_b64_tr_b16 v[58:59], v20 offset:20992
  v_and_b32 v241, 0xffff0000, v228
  v_lshlrev_b32 v242, 16, v229
  v_mfma_f32_16x16x32_bf16 v[100:103], v[36:39], a[200:203], v[100:103]
  ds_read_b64_tr_b16 v[60:61], v21 offset:20480
  v_and_b32 v243, 0xffff0000, v229
  v_lshlrev_b32 v244, 16, v230
  v_mfma_f32_16x16x32_bf16 v[116:119], v[36:39], a[204:207], v[116:119]
  ds_read_b64_tr_b16 v[62:63], v21 offset:20992
  v_and_b32 v245, 0xffff0000, v230
  v_lshlrev_b32 v246, 16, v231
  v_mfma_f32_16x16x32_bf16 v[72:75], v[40:43], a[192:195], v[72:75]
  v_and_b32 v247, 0xffff0000, v231
  v_add_f32 v248, v232, v233
  v_mfma_f32_16x16x32_bf16 v[88:91], v[40:43], a[196:199], v[88:91]
  v_add_f32 v248, v248, v234
  v_add_f32 v248, v248, v235
  v_mfma_f32_16x16x32_bf16 v[104:107], v[40:43], a[200:203], v[104:107]
  v_add_f32 v248, v248, v236
  v_add_f32 v248, v248, v237
  v_mfma_f32_16x16x32_bf16 v[120:123], v[40:43], a[204:207], v[120:123]
  v_add_f32 v248, v248, v238
  v_add_f32 v248, v248, v239
  v_mfma_f32_16x16x32_bf16 v[76:79], v[44:47], a[192:195], v[76:79]
  v_add_f32 v248, v248, v240
  v_add_f32 v248, v248, v241
  v_mfma_f32_16x16x32_bf16 v[92:95], v[44:47], a[196:199], v[92:95]
  v_add_f32 v248, v248, v242
  v_add_f32 v248, v248, v243
  v_mfma_f32_16x16x32_bf16 v[108:111], v[44:47], a[200:203], v[108:111]
  v_add_f32 v248, v248, v244
  v_add_f32 v248, v248, v245
  v_mfma_f32_16x16x32_bf16 v[124:127], v[44:47], a[204:207], v[124:127]
  s_waitcnt lgkmcnt(0)
  v_add_f32 v248, v248, v246
  s_waitcnt vmcnt(9)
  v_mfma_f32_16x16x32_bf16 v[64:67], v[48:51], a[208:211], v[64:67]
  ds_read_b64_tr_b16 v[32:33], v18 offset:24576
  v_add_f32 v248, v248, v247
  v_mfma_f32_16x16x32_bf16 v[80:83], v[48:51], a[212:215], v[80:83]
  ds_read_b64_tr_b16 v[34:35], v18 offset:25088
  ds_read_b128 a[224:227], v16 offset:8192
  v_mfma_f32_16x16x32_bf16 v[96:99], v[48:51], a[216:219], v[96:99]
  ds_read_b64_tr_b16 v[36:37], v19 offset:24576
  ds_read_b128 a[228:231], v16 offset:10240
  v_mfma_f32_16x16x32_bf16 v[112:115], v[48:51], a[220:223], v[112:115]
  ds_read_b64_tr_b16 v[38:39], v19 offset:25088
  ds_read_b128 a[232:235], v16 offset:12288
  v_mfma_f32_16x16x32_bf16 v[68:71], v[52:55], a[208:211], v[68:71]
  ds_read_b64_tr_b16 v[40:41], v20 offset:24576
  ds_read_b128 a[236:239], v16 offset:14336
  v_mfma_f32_16x16x32_bf16 v[84:87], v[52:55], a[212:215], v[84:87]
  ds_read_b64_tr_b16 v[42:43], v20 offset:25088
  ds_read_b128 a[240:243], v17 offset:8192
  v_mfma_f32_16x16x32_bf16 v[100:103], v[52:55], a[216:219], v[100:103]
  ds_read_b64_tr_b16 v[44:45], v21 offset:24576
  ds_read_b128 a[244:247], v17 offset:10240
  v_mfma_f32_16x16x32_bf16 v[116:119], v[52:55], a[220:223], v[116:119]
  ds_read_b64_tr_b16 v[46:47], v21 offset:25088
  ds_read_b128 a[248:251], v17 offset:12288
  v_mfma_f32_16x16x32_bf16 v[72:75], v[56:59], a[208:211], v[72:75]
  ds_read_b128 a[252:255], v17 offset:14336
  s_nop 1
  v_mfma_f32_16x16x32_bf16 v[88:91], v[56:59], a[212:215], v[88:91]
  v_add_f32_dpp v248, v248, v248 row_ror:8 row_mask:0xf bank_mask:0xf
  v_mov_b32 v250, v248
  v_mfma_f32_16x16x32_bf16 v[104:107], v[56:59], a[216:219], v[104:107]
  s_nop 1
  v_mfma_f32_16x16x32_bf16 v[120:123], v[56:59], a[220:223], v[120:123]
  v_permlane16_swap_b32 v248, v250
  s_nop 0
  v_mfma_f32_16x16x32_bf16 v[76:79], v[60:63], a[208:211], v[76:79]
  v_add_f32 v248, v248, v250
  v_mov_b32 v250, v248
  v_mfma_f32_16x16x32_bf16 v[92:95], v[60:63], a[212:215], v[92:95]
  s_nop 1
  v_mfma_f32_16x16x32_bf16 v[108:111], v[60:63], a[216:219], v[108:111]
  v_permlane32_swap_b32 v248, v250
  s_nop 0
  v_mfma_f32_16x16x32_bf16 v[124:127], v[60:63], a[220:223], v[124:127]
  s_waitcnt lgkmcnt(0)
  v_add_f32 v248, v248, v250
  v_mul_f32 v248, 0x3c000000, v248
  v_mfma_f32_16x16x32_bf16 v[64:67], v[32:35], a[224:227], v[64:67]
  ds_read_b64_tr_b16 v[48:49], v18 offset:28672
  v_sub_f32 v192, v232, v248
  v_sub_f32 v193, v233, v248
  v_mfma_f32_16x16x32_bf16 v[80:83], v[32:35], a[228:231], v[80:83]
  ds_read_b64_tr_b16 v[50:51], v18 offset:29184
  v_sub_f32 v194, v234, v248
  v_sub_f32 v195, v235, v248
  v_mfma_f32_16x16x32_bf16 v[96:99], v[32:35], a[232:235], v[96:99]
  ds_read_b64_tr_b16 v[52:53], v19 offset:28672
  v_sub_f32 v196, v236, v248
  v_sub_f32 v197, v237, v248
  v_mfma_f32_16x16x32_bf16 v[112:115], v[32:35], a[236:239], v[112:115]
  ds_read_b64_tr_b16 v[54:55], v19 offset:29184
  v_sub_f32 v198, v238, v248
  v_sub_f32 v199, v239, v248
  v_mfma_f32_16x16x32_bf16 v[68:71], v[36:39], a[224:227], v[68:71]
  ds_read_b64_tr_b16 v[56:57], v20 offset:28672
  v_sub_f32 v200, v240, v248
  v_sub_f32 v201, v241, v248
  v_mfma_f32_16x16x32_bf16 v[84:87], v[36:39], a[228:231], v[84:87]
  ds_read_b64_tr_b16 v[58:59], v20 offset:29184
  v_sub_f32 v202, v242, v248
  v_sub_f32 v203, v243, v248
  v_mfma_f32_16x16x32_bf16 v[100:103], v[36:39], a[232:235], v[100:103]
  ds_read_b64_tr_b16 v[60:61], v21 offset:28672
  v_sub_f32 v204, v244, v248
  v_sub_f32 v205, v245, v248
  v_mfma_f32_16x16x32_bf16 v[116:119], v[36:39], a[236:239], v[116:119]
  ds_read_b64_tr_b16 v[62:63], v21 offset:29184
  v_sub_f32 v206, v246, v248
  v_sub_f32 v207, v247, v248
  v_mfma_f32_16x16x32_bf16 v[72:75], v[40:43], a[224:227], v[72:75]
  v_mul_f32 v249, v192, v192
  v_fmac_f32 v249, v193, v193
  v_mfma_f32_16x16x32_bf16 v[88:91], v[40:43], a[228:231], v[88:91]
  v_fmac_f32 v249, v194, v194
  v_fmac_f32 v249, v195, v195
  v_mfma_f32_16x16x32_bf16 v[104:107], v[40:43], a[232:235], v[104:107]
  v_fmac_f32 v249, v196, v196
  v_fmac_f32 v249, v197, v197
  v_mfma_f32_16x16x32_bf16 v[120:123], v[40:43], a[236:239], v[120:123]
  v_fmac_f32 v249, v198, v198
  v_fmac_f32 v249, v199, v199
  v_mfma_f32_16x16x32_bf16 v[76:79], v[44:47], a[224:227], v[76:79]
  v_fmac_f32 v249, v200, v200
  v_fmac_f32 v249, v201, v201
  v_mfma_f32_16x16x32_bf16 v[92:95], v[44:47], a[228:231], v[92:95]
  v_xor_b32 v18, 0x10000, v18
  v_xor_b32 v19, 0x10000, v19
  v_mfma_f32_16x16x32_bf16 v[108:111], v[44:47], a[232:235], v[108:111]
  v_xor_b32 v20, 0x10000, v20
  v_xor_b32 v21, 0x10000, v21
  v_mfma_f32_16x16x32_bf16 v[124:127], v[44:47], a[236:239], v[124:127]
  s_waitcnt vmcnt(5) lgkmcnt(0)
  v_fmac_f32 v249, v202, v202
  v_fmac_f32 v249, v203, v203
  v_mfma_f32_16x16x32_bf16 v[64:67], v[48:51], a[240:243], v[64:67]
  s_barrier
  v_fmac_f32 v249, v204, v204
  v_fmac_f32 v249, v205, v205
  v_mfma_f32_16x16x32_bf16 v[80:83], v[48:51], a[244:247], v[80:83]
  ds_read_b64_tr_b16 v[32:33], v18 offset:0
  v_fmac_f32 v249, v206, v206
  v_fmac_f32 v249, v207, v207
  v_mfma_f32_16x16x32_bf16 v[96:99], v[48:51], a[248:251], v[96:99]
  ds_read_b64_tr_b16 v[34:35], v18 offset:512
  s_nop 1
  v_mfma_f32_16x16x32_bf16 v[112:115], v[48:51], a[252:255], v[112:115]
  ds_read_b64_tr_b16 v[36:37], v19 offset:0
  v_add_f32_dpp v249, v249, v249 row_ror:8 row_mask:0xf bank_mask:0xf
  v_mov_b32 v250, v249
  v_mfma_f32_16x16x32_bf16 v[68:71], v[52:55], a[240:243], v[68:71]
  ds_read_b64_tr_b16 v[38:39], v19 offset:512
  s_nop 1
  v_mfma_f32_16x16x32_bf16 v[84:87], v[52:55], a[244:247], v[84:87]
  ds_read_b64_tr_b16 v[40:41], v20 offset:0
  v_permlane16_swap_b32 v249, v250
  s_nop 0
  v_mfma_f32_16x16x32_bf16 v[100:103], v[52:55], a[248:251], v[100:103]
  ds_read_b64_tr_b16 v[42:43], v20 offset:512
  v_add_f32 v249, v249, v250
  v_mov_b32 v250, v249
  v_mfma_f32_16x16x32_bf16 v[116:119], v[52:55], a[252:255], v[116:119]
  ds_read_b64_tr_b16 v[44:45], v21 offset:0
  s_nop 1
  v_mfma_f32_16x16x32_bf16 v[72:75], v[56:59], a[240:243], v[72:75]
  ds_read_b64_tr_b16 v[46:47], v21 offset:512
  v_permlane32_swap_b32 v249, v250
  s_nop 0
  v_mfma_f32_16x16x32_bf16 v[88:91], v[56:59], a[244:247], v[88:91]
  v_add_f32 v249, v249, v250
  v_lshlrev_b32 v255, 5, v252
  v_mfma_f32_16x16x32_bf16 v[104:107], v[56:59], a[248:251], v[104:107]
  v_add_u32 v255, 0x20000, v255
  s_lshl_b32 s52, s30, 3
  v_mfma_f32_16x16x32_bf16 v[120:123], v[56:59], a[252:255], v[120:123]
  v_add_u32 v250, s52, v255
  v_mfma_f32_16x16x32_bf16 v[76:79], v[60:63], a[240:243], v[76:79]
  ds_write_b64 v250, v[248:249]
  v_mov_b32 v251, 0
  v_lshlrev_b32 v254, 5, v253
  v_mfma_f32_16x16x32_bf16 v[92:95], v[60:63], a[244:247], v[92:95]
  s_nop 1
  v_mfma_f32_16x16x32_bf16 v[108:111], v[60:63], a[248:251], v[108:111]
  s_nop 1
  v_mfma_f32_16x16x32_bf16 v[124:127], v[60:63], a[252:255], v[124:127]
  s_waitcnt lgkmcnt(1)
  s_nop 1
  v_mfma_f32_16x16x32_bf16 v[128:131], v[32:35], a[128:131], v[128:131]
  ds_read_b64_tr_b16 v[48:49], v18 offset:4096
  s_waitcnt lgkmcnt(1)
  v_mfma_f32_16x16x32_bf16 v[144:147], v[32:35], a[132:135], v[144:147]
  ds_read_b64_tr_b16 v[50:51], v18 offset:4608
  v_mfma_f32_16x16x32_bf16 v[160:163], v[32:35], a[136:139], v[160:163]
  ds_read_b64_tr_b16 v[52:53], v19 offset:4096
  v_mfma_f32_16x16x32_bf16 v[176:179], v[32:35], a[140:143], v[176:179]
  ds_read_b64_tr_b16 v[54:55], v19 offset:4608
  v_mfma_f32_16x16x32_bf16 v[132:135], v[36:39], a[128:131], v[132:135]
  ds_read_b64_tr_b16 v[56:57], v20 offset:4096
  v_mfma_f32_16x16x32_bf16 v[148:151], v[36:39], a[132:135], v[148:151]
  ds_read_b64_tr_b16 v[58:59], v20 offset:4608
  v_mfma_f32_16x16x32_bf16 v[164:167], v[36:39], a[136:139], v[164:167]
  ds_read_b64_tr_b16 v[60:61], v21 offset:4096
  v_mfma_f32_16x16x32_bf16 v[180:183], v[36:39], a[140:143], v[180:183]
  ds_read_b64_tr_b16 v[62:63], v21 offset:4608
  v_mfma_f32_16x16x32_bf16 v[136:139], v[40:43], a[128:131], v[136:139]
  v_mfma_f32_16x16x32_bf16 v[152:155], v[40:43], a[132:135], v[152:155]
  v_mfma_f32_16x16x32_bf16 v[168:171], v[40:43], a[136:139], v[168:171]
  v_cvt_pk_bf16_f32 v64, v64, v65
  v_cvt_pk_bf16_f32 v65, v66, v67
  v_mfma_f32_16x16x32_bf16 v[184:187], v[40:43], a[140:143], v[184:187]
  v_cvt_pk_bf16_f32 v66, v68, v69
  v_cvt_pk_bf16_f32 v67, v70, v71
  v_mfma_f32_16x16x32_bf16 v[140:143], v[44:47], a[128:131], v[140:143]
  s_add_u32 s47, s51, 16777216
  v_mfma_f32_16x16x32_bf16 v[156:159], v[44:47], a[132:135], v[156:159]
  buffer_store_dwordx4 v[64:67], v1, s[20:23], s47 offen offset:0 sc1
  v_mfma_f32_16x16x32_bf16 v[172:175], v[44:47], a[136:139], v[172:175]
  v_mfma_f32_16x16x32_bf16 v[188:191], v[44:47], a[140:143], v[188:191]
  s_waitcnt lgkmcnt(0)
  v_mfma_f32_16x16x32_bf16 v[128:131], v[48:51], a[144:147], v[128:131]
  ds_read_b64_tr_b16 v[32:33], v18 offset:8192
  v_mfma_f32_16x16x32_bf16 v[144:147], v[48:51], a[148:151], v[144:147]
  ds_read_b64_tr_b16 v[34:35], v18 offset:8704
  v_mfma_f32_16x16x32_bf16 v[160:163], v[48:51], a[152:155], v[160:163]
  ds_read_b64_tr_b16 v[36:37], v19 offset:8192
  v_mfma_f32_16x16x32_bf16 v[176:179], v[48:51], a[156:159], v[176:179]
  ds_read_b64_tr_b16 v[38:39], v19 offset:8704
  v_mfma_f32_16x16x32_bf16 v[132:135], v[52:55], a[144:147], v[132:135]
  ds_read_b64_tr_b16 v[40:41], v20 offset:8192
  v_mfma_f32_16x16x32_bf16 v[148:151], v[52:55], a[148:151], v[148:151]
  ds_read_b64_tr_b16 v[42:43], v20 offset:8704
  v_mfma_f32_16x16x32_bf16 v[164:167], v[52:55], a[152:155], v[164:167]
  ds_read_b64_tr_b16 v[44:45], v21 offset:8192
  v_mfma_f32_16x16x32_bf16 v[180:183], v[52:55], a[156:159], v[180:183]
  ds_read_b64_tr_b16 v[46:47], v21 offset:8704
  v_cvt_pk_bf16_f32 v72, v72, v73
  v_cvt_pk_bf16_f32 v73, v74, v75
  v_mfma_f32_16x16x32_bf16 v[136:139], v[56:59], a[144:147], v[136:139]
  v_cvt_pk_bf16_f32 v74, v76, v77
  v_cvt_pk_bf16_f32 v75, v78, v79
  v_mfma_f32_16x16x32_bf16 v[152:155], v[56:59], a[148:151], v[152:155]
  s_add_u32 s47, s51, 16777216
  v_mfma_f32_16x16x32_bf16 v[168:171], v[56:59], a[152:155], v[168:171]
  buffer_store_dwordx4 v[72:75], v1, s[20:23], s47 offen offset:2048 sc1
  v_mfma_f32_16x16x32_bf16 v[184:187], v[56:59], a[156:159], v[184:187]
  v_mfma_f32_16x16x32_bf16 v[140:143], v[60:63], a[144:147], v[140:143]
  v_mfma_f32_16x16x32_bf16 v[156:159], v[60:63], a[148:151], v[156:159]
  v_mfma_f32_16x16x32_bf16 v[172:175], v[60:63], a[152:155], v[172:175]
  v_mfma_f32_16x16x32_bf16 v[188:191], v[60:63], a[156:159], v[188:191]
  s_waitcnt lgkmcnt(0)
  v_mfma_f32_16x16x32_bf16 v[128:131], v[32:35], a[160:163], v[128:131]
  ds_read_b64_tr_b16 v[48:49], v18 offset:12288
  v_mfma_f32_16x16x32_bf16 v[144:147], v[32:35], a[164:167], v[144:147]
  ds_read_b64_tr_b16 v[50:51], v18 offset:12800
  v_mfma_f32_16x16x32_bf16 v[160:163], v[32:35], a[168:171], v[160:163]
  ds_read_b64_tr_b16 v[52:53], v19 offset:12288
  v_mfma_f32_16x16x32_bf16 v[176:179], v[32:35], a[172:175], v[176:179]
  ds_read_b64_tr_b16 v[54:55], v19 offset:12800
  v_mfma_f32_16x16x32_bf16 v[132:135], v[36:39], a[160:163], v[132:135]
  ds_read_b64_tr_b16 v[56:57], v20 offset:12288
  v_cvt_pk_bf16_f32 v80, v80, v81
  v_cvt_pk_bf16_f32 v81, v82, v83
  v_mfma_f32_16x16x32_bf16 v[148:151], v[36:39], a[164:167], v[148:151]
  ds_read_b64_tr_b16 v[58:59], v20 offset:12800
  v_cvt_pk_bf16_f32 v82, v84, v85
  v_cvt_pk_bf16_f32 v83, v86, v87
  v_mfma_f32_16x16x32_bf16 v[164:167], v[36:39], a[168:171], v[164:167]
  ds_read_b64_tr_b16 v[60:61], v21 offset:12288
  s_add_u32 s47, s51, 16777216
  s_add_u32 m0, s50, 98304
  v_mfma_f32_16x16x32_bf16 v[180:183], v[36:39], a[172:175], v[180:183]
  ds_read_b64_tr_b16 v[62:63], v21 offset:12800
  s_mov_b32 s46, 0
  v_mfma_f32_16x16x32_bf16 v[136:139], v[40:43], a[160:163], v[136:139]
  buffer_load_dwordx4 v12, s[24:27], s46 offen offset:0 lds
  v_mfma_f32_16x16x32_bf16 v[152:155], v[40:43], a[164:167], v[152:155]
  buffer_store_dwordx4 v[80:83], v1, s[20:23], s47 offen offset:1024 sc1
  v_mfma_f32_16x16x32_bf16 v[168:171], v[40:43], a[168:171], v[168:171]
  v_mfma_f32_16x16x32_bf16 v[184:187], v[40:43], a[172:175], v[184:187]
  v_mfma_f32_16x16x32_bf16 v[140:143], v[44:47], a[160:163], v[140:143]
  buffer_load_dwordx4 v13, s[24:27], s46 offen offset:1024 lds
  v_mfma_f32_16x16x32_bf16 v[156:159], v[44:47], a[164:167], v[156:159]
  v_mfma_f32_16x16x32_bf16 v[172:175], v[44:47], a[168:171], v[172:175]
  v_mfma_f32_16x16x32_bf16 v[188:191], v[44:47], a[172:175], v[188:191]
  s_waitcnt vmcnt(6) lgkmcnt(0)
  v_mfma_f32_16x16x32_bf16 v[128:131], v[48:51], a[176:179], v[128:131]
  s_barrier
  v_mfma_f32_16x16x32_bf16 v[144:147], v[48:51], a[180:183], v[144:147]
  ds_read_b64_tr_b16 v[32:33], v18 offset:16384
  v_cvt_pk_bf16_f32 v88, v88, v89
  v_cvt_pk_bf16_f32 v89, v90, v91
  v_mfma_f32_16x16x32_bf16 v[160:163], v[48:51], a[184:187], v[160:163]
  ds_read_b64_tr_b16 v[34:35], v18 offset:16896
  v_cvt_pk_bf16_f32 v90, v92, v93
  v_cvt_pk_bf16_f32 v91, v94, v95
  v_mfma_f32_16x16x32_bf16 v[176:179], v[48:51], a[188:191], v[176:179]
  ds_read_b64_tr_b16 v[36:37], v19 offset:16384
  ds_read_b128 v[224:227], v255
  s_add_u32 s47, s51, 16777216
  v_mfma_f32_16x16x32_bf16 v[132:135], v[52:55], a[176:179], v[132:135]
  ds_read_b64_tr_b16 v[38:39], v19 offset:16896
  ds_read_b128 v[228:231], v255 offset:16
  s_mov_b32 s52, 0x43000000
  v_mfma_f32_16x16x32_bf16 v[148:151], v[52:55], a[180:183], v[148:151]
  ds_read_b64_tr_b16 v[40:41], v20 offset:16384
  s_nop 1
  v_mfma_f32_16x16x32_bf16 v[164:167], v[52:55], a[184:187], v[164:167]
  ds_read_b64_tr_b16 v[42:43], v20 offset:16896
  s_nop 1
  v_mfma_f32_16x16x32_bf16 v[180:183], v[52:55], a[188:191], v[180:183]
  ds_read_b64_tr_b16 v[44:45], v21 offset:16384
  s_nop 1
  v_mfma_f32_16x16x32_bf16 v[136:139], v[56:59], a[176:179], v[136:139]
  ds_read_b64_tr_b16 v[46:47], v21 offset:16896
  s_waitcnt lgkmcnt(4)
  v_add_f32 v248, v224, v226
  v_mfma_f32_16x16x32_bf16 v[152:155], v[56:59], a[180:183], v[152:155]
  buffer_load_dwordx4 v14, s[24:27], s46 offen offset:2048 lds
  v_add_f32 v249, v228, v230
  v_mfma_f32_16x16x32_bf16 v[168:171], v[56:59], a[184:187], v[168:171]
  buffer_store_dwordx4 v[88:91], v1, s[20:23], s47 offen offset:3072 sc1
  v_mfma_f32_16x16x32_bf16 v[184:187], v[56:59], a[188:191], v[184:187]
  v_add_f32 v248, v248, v249
  v_mul_f32 v248, 0x3e800000, v248
  v_mfma_f32_16x16x32_bf16 v[140:143], v[60:63], a[176:179], v[140:143]
  v_sub_f32 v224, v224, v248
  v_sub_f32 v226, v226, v248
  v_mfma_f32_16x16x32_bf16 v[156:159], v[60:63], a[180:183], v[156:159]
  buffer_load_dwordx4 v15, s[24:27], s46 offen offset:3072 lds
  v_sub_f32 v228, v228, v248
  v_mfma_f32_16x16x32_bf16 v[172:175], v[60:63], a[184:187], v[172:175]
  v_cvt_pk_bf16_f32 v96, v96, v97
  v_cvt_pk_bf16_f32 v97, v98, v99
  v_mfma_f32_16x16x32_bf16 v[188:191], v[60:63], a[188:191], v[188:191]
  s_waitcnt lgkmcnt(0)
  v_cvt_pk_bf16_f32 v98, v100, v101
  v_cvt_pk_bf16_f32 v99, v102, v103
  v_mfma_f32_16x16x32_bf16 v[128:131], v[32:35], a[192:195], v[128:131]
  ds_read_b64_tr_b16 v[48:49], v18 offset:20480
  s_add_u32 s47, s51, 16785408
  v_sub_f32 v230, v230, v248
  v_mfma_f32_16x16x32_bf16 v[144:147], v[32:35], a[196:199], v[144:147]
  ds_read_b64_tr_b16 v[50:51], v18 offset:20992
  v_mul_f32 v224, v224, v224
  v_fmac_f32 v224, v226, v226
  v_mfma_f32_16x16x32_bf16 v[160:163], v[32:35], a[200:203], v[160:163]
  ds_read_b64_tr_b16 v[52:53], v19 offset:20480
  v_fmac_f32 v224, v228, v228
  v_fmac_f32 v224, v230, v230
  v_mfma_f32_16x16x32_bf16 v[176:179], v[32:35], a[204:207], v[176:179]
  ds_read_b64_tr_b16 v[54:55], v19 offset:20992
  v_add_f32 v225, v225, v227
  v_add_f32 v229, v229, v231
  v_mfma_f32_16x16x32_bf16 v[132:135], v[36:39], a[192:195], v[132:135]
  ds_read_b64_tr_b16 v[56:57], v20 offset:20480
  v_add_f32 v225, v225, v229
  v_fma_f32 v224, v224, s52, v225
  v_mfma_f32_16x16x32_bf16 v[148:151], v[36:39], a[196:199], v[148:151]
  ds_read_b64_tr_b16 v[58:59], v20 offset:20992
  v_mov_b32 v249, 0x3727c5ac
  v_fmac_f32 v249, 0x3b000000, v224
  v_mfma_f32_16x16x32_bf16 v[164:167], v[36:39], a[200:203], v[164:167]
  ds_read_b64_tr_b16 v[60:61], v21 offset:20480
  s_add_u32 m0, s50, 114688
  v_mfma_f32_16x16x32_bf16 v[180:183], v[36:39], a[204:207], v[180:183]
  ds_read_b64_tr_b16 v[62:63], v21 offset:20992
  s_mov_b32 s46, 1048576
  v_mfma_f32_16x16x32_bf16 v[136:139], v[40:43], a[192:195], v[136:139]
  buffer_load_dwordx4 v12, s[24:27], s46 offen offset:0 lds
  v_mfma_f32_16x16x32_bf16 v[152:155], v[40:43], a[196:199], v[152:155]
  buffer_store_dwordx4 v[96:99], v1, s[20:23], s47 offen offset:0 sc1
  v_mfma_f32_16x16x32_bf16 v[168:171], v[40:43], a[200:203], v[168:171]
  buffer_load_dword v24, v251, s[60:63], 0 offen sc1
  v_mfma_f32_16x16x32_bf16 v[184:187], v[40:43], a[204:207], v[184:187]
  v_cvt_pk_bf16_f32 v104, v104, v105
  v_cvt_pk_bf16_f32 v105, v106, v107
  v_mfma_f32_16x16x32_bf16 v[140:143], v[44:47], a[192:195], v[140:143]
  buffer_load_dwordx4 v13, s[24:27], s46 offen offset:1024 lds
  v_cvt_pk_bf16_f32 v106, v108, v109
  v_mfma_f32_16x16x32_bf16 v[156:159], v[44:47], a[196:199], v[156:159]
  v_cvt_pk_bf16_f32 v107, v110, v111
  s_add_u32 s47, s51, 16785408
  v_mfma_f32_16x16x32_bf16 v[172:175], v[44:47], a[200:203], v[172:175]
  buffer_store_dwordx4 v[104:107], v1, s[20:23], s47 offen offset:2048 sc1
  v_mfma_f32_16x16x32_bf16 v[188:191], v[44:47], a[204:207], v[188:191]
  s_waitcnt lgkmcnt(0)
  v_rsq_f32 v249, v249
  v_mfma_f32_16x16x32_bf16 v[128:131], v[48:51], a[208:211], v[128:131]
  ds_read_b64_tr_b16 v[32:33], v18 offset:24576
  s_nop 0
  v_mul_f32 v249, 0x3e0293ee, v249
  v_mfma_f32_16x16x32_bf16 v[144:147], v[48:51], a[212:215], v[144:147]
  ds_read_b64_tr_b16 v[34:35], v18 offset:25088
  v_sub_f32 v232, v232, v248
  v_sub_f32 v233, v233, v248
  v_mfma_f32_16x16x32_bf16 v[160:163], v[48:51], a[216:219], v[160:163]
  ds_read_b64_tr_b16 v[36:37], v19 offset:24576
  v_sub_f32 v234, v234, v248
  v_sub_f32 v235, v235, v248
  v_mfma_f32_16x16x32_bf16 v[176:179], v[48:51], a[220:223], v[176:179]
  ds_read_b64_tr_b16 v[38:39], v19 offset:25088
  v_sub_f32 v236, v236, v248
  v_sub_f32 v237, v237, v248
  v_mfma_f32_16x16x32_bf16 v[132:135], v[52:55], a[208:211], v[132:135]
  ds_read_b64_tr_b16 v[40:41], v20 offset:24576
  v_sub_f32 v238, v238, v248
  v_sub_f32 v239, v239, v248
  v_mfma_f32_16x16x32_bf16 v[148:151], v[52:55], a[212:215], v[148:151]
  ds_read_b64_tr_b16 v[42:43], v20 offset:25088
  v_sub_f32 v240, v240, v248
  v_sub_f32 v241, v241, v248
  v_mfma_f32_16x16x32_bf16 v[164:167], v[52:55], a[216:219], v[164:167]
  ds_read_b64_tr_b16 v[44:45], v21 offset:24576
  v_sub_f32 v242, v242, v248
  v_sub_f32 v243, v243, v248
  v_mfma_f32_16x16x32_bf16 v[180:183], v[52:55], a[220:223], v[180:183]
  ds_read_b64_tr_b16 v[46:47], v21 offset:25088
  v_sub_f32 v244, v244, v248
  v_sub_f32 v245, v245, v248
  v_mfma_f32_16x16x32_bf16 v[136:139], v[56:59], a[208:211], v[136:139]
  buffer_load_dwordx4 v14, s[24:27], s46 offen offset:2048 lds
  v_cvt_pk_bf16_f32 v112, v112, v113
  v_mfma_f32_16x16x32_bf16 v[152:155], v[56:59], a[212:215], v[152:155]
  v_cvt_pk_bf16_f32 v113, v114, v115
  v_cvt_pk_bf16_f32 v114, v116, v117
  v_mfma_f32_16x16x32_bf16 v[168:171], v[56:59], a[216:219], v[168:171]
  v_cvt_pk_bf16_f32 v115, v118, v119
  s_add_u32 s47, s51, 16785408
  v_mfma_f32_16x16x32_bf16 v[184:187], v[56:59], a[220:223], v[184:187]
  buffer_store_dwordx4 v[112:115], v1, s[20:23], s47 offen offset:1024 sc1
  v_mfma_f32_16x16x32_bf16 v[140:143], v[60:63], a[208:211], v[140:143]
  buffer_load_dwordx4 v15, s[24:27], s46 offen offset:3072 lds
  v_sub_f32 v246, v246, v248
  v_mfma_f32_16x16x32_bf16 v[156:159], v[60:63], a[212:215], v[156:159]
  v_sub_f32 v247, v247, v248
  v_mul_f32 v232, v232, v249
  v_mfma_f32_16x16x32_bf16 v[172:175], v[60:63], a[216:219], v[172:175]
  v_mul_f32 v233, v233, v249
  v_mul_f32 v234, v234, v249
  v_mfma_f32_16x16x32_bf16 v[188:191], v[60:63], a[220:223], v[188:191]
  s_waitcnt lgkmcnt(0)
  v_mul_f32 v235, v235, v249
  v_mul_f32 v236, v236, v249
  v_mfma_f32_16x16x32_bf16 v[128:131], v[32:35], a[224:227], v[128:131]
  ds_read_b64_tr_b16 v[48:49], v18 offset:28672
  v_mul_f32 v237, v237, v249
  v_mul_f32 v238, v238, v249
  v_mfma_f32_16x16x32_bf16 v[144:147], v[32:35], a[228:231], v[144:147]
  ds_read_b64_tr_b16 v[50:51], v18 offset:29184
  v_mul_f32 v239, v239, v249
  v_mul_f32 v240, v240, v249
  v_mfma_f32_16x16x32_bf16 v[160:163], v[32:35], a[232:235], v[160:163]
  ds_read_b64_tr_b16 v[52:53], v19 offset:28672
  v_mul_f32 v241, v241, v249
  v_mul_f32 v242, v242, v249
  v_mfma_f32_16x16x32_bf16 v[176:179], v[32:35], a[236:239], v[176:179]
  ds_read_b64_tr_b16 v[54:55], v19 offset:29184
  v_mul_f32 v243, v243, v249
  v_mul_f32 v244, v244, v249
  v_mfma_f32_16x16x32_bf16 v[132:135], v[36:39], a[224:227], v[132:135]
  ds_read_b64_tr_b16 v[56:57], v20 offset:28672
  v_mul_f32 v245, v245, v249
  v_mul_f32 v246, v246, v249
  v_mfma_f32_16x16x32_bf16 v[148:151], v[36:39], a[228:231], v[148:151]
  ds_read_b64_tr_b16 v[58:59], v20 offset:29184
  v_cvt_pk_bf16_f32 v120, v120, v121
  v_cvt_pk_bf16_f32 v121, v122, v123
  v_mfma_f32_16x16x32_bf16 v[164:167], v[36:39], a[232:235], v[164:167]
  ds_read_b64_tr_b16 v[60:61], v21 offset:28672
  v_cvt_pk_bf16_f32 v122, v124, v125
  s_add_u32 m0, s50, 65536
  v_mfma_f32_16x16x32_bf16 v[180:183], v[36:39], a[236:239], v[180:183]
  ds_read_b64_tr_b16 v[62:63], v21 offset:29184
  v_cvt_pk_bf16_f32 v123, v126, v127
  s_mov_b32 s46, 2097152
  v_mfma_f32_16x16x32_bf16 v[136:139], v[40:43], a[224:227], v[136:139]
  buffer_load_dwordx4 v12, s[24:27], s46 offen offset:0 lds
  s_add_u32 s47, s51, 16785408
  v_mfma_f32_16x16x32_bf16 v[152:155], v[40:43], a[228:231], v[152:155]
  buffer_store_dwordx4 v[120:123], v1, s[20:23], s47 offen offset:3072 sc1
  v_mfma_f32_16x16x32_bf16 v[168:171], v[40:43], a[232:235], v[168:171]
  v_mul_f32 v247, v247, v249
  v_and_b32 v250, 3, v253
  v_mfma_f32_16x16x32_bf16 v[184:187], v[40:43], a[236:239], v[184:187]
  v_lshlrev_b32 v250, 8, v250
  v_lshl_add_u32 v250, v252, 4, v250
  v_mfma_f32_16x16x32_bf16 v[140:143], v[44:47], a[224:227], v[140:143]
  buffer_load_dwordx4 v13, s[24:27], s46 offen offset:1024 lds
  v_lshrrev_b32 v23, 5, v2
  v_mfma_f32_16x16x32_bf16 v[156:159], v[44:47], a[228:231], v[156:159]
  v_xor_b32 v18, 0x10000, v18
  v_xor_b32 v19, 0x10000, v19
  v_mfma_f32_16x16x32_bf16 v[172:175], v[44:47], a[232:235], v[172:175]
  v_xor_b32 v20, 0x10000, v20
  v_xor_b32 v21, 0x10000, v21
  v_mfma_f32_16x16x32_bf16 v[188:191], v[44:47], a[236:239], v[188:191]
  s_waitcnt vmcnt(11) lgkmcnt(0)
  v_lshl_add_u32 v250, v23, 11, v250
  s_lshr_b32 s52, s2, 2
  v_mfma_f32_16x16x32_bf16 v[128:131], v[48:51], a[240:243], v[128:131]
  s_barrier
  s_lshl_b32 s52, s52, 15
  s_and_b32 s55, s2, 1
  v_mfma_f32_16x16x32_bf16 v[144:147], v[48:51], a[244:247], v[144:147]
  ds_read_b64_tr_b16 v[32:33], v18 offset:32768
  s_lshl_b32 s55, s55, 7
  s_add_u32 s52, s52, s55
  v_mfma_f32_16x16x32_bf16 v[160:163], v[48:51], a[248:251], v[160:163]
  ds_read_b64_tr_b16 v[34:35], v18 offset:33280
  s_bfe_u32 s55, s2, 0x10001
  s_lshl_b32 s55, s55, 10
  v_mfma_f32_16x16x32_bf16 v[176:179], v[48:51], a[252:255], v[176:179]
  ds_read_b64_tr_b16 v[36:37], v19 offset:32768
  s_add_u32 s52, s52, s55
  s_lshl_b32 s55, s30, 13
  v_mfma_f32_16x16x32_bf16 v[132:135], v[52:55], a[240:243], v[132:135]
  ds_read_b64_tr_b16 v[38:39], v19 offset:33280
  s_add_u32 s52, s52, s55
  s_add_u32 s52, s52, 1048576
  v_mfma_f32_16x16x32_bf16 v[148:151], v[52:55], a[244:247], v[148:151]
  ds_read_b64_tr_b16 v[40:41], v20 offset:32768
  s_add_u32 s55, s52, 4096
  v_mfma_f32_16x16x32_bf16 v[164:167], v[52:55], a[248:251], v[164:167]
  ds_read_b64_tr_b16 v[42:43], v20 offset:33280
  v_mfma_f32_16x16x32_bf16 v[180:183], v[52:55], a[252:255], v[180:183]
  ds_read_b64_tr_b16 v[44:45], v21 offset:32768
  v_mfma_f32_16x16x32_bf16 v[136:139], v[56:59], a[240:243], v[136:139]
  ds_read_b64_tr_b16 v[46:47], v21 offset:33280
  v_mfma_f32_16x16x32_bf16 v[152:155], v[56:59], a[244:247], v[152:155]
  buffer_load_dwordx4 v14, s[24:27], s46 offen offset:2048 lds
  v_mfma_f32_16x16x32_bf16 v[168:171], v[56:59], a[248:251], v[168:171]
  s_waitcnt vmcnt(9)
  v_readfirstlane_b32 s53, v24
  v_mfma_f32_16x16x32_bf16 v[184:187], v[56:59], a[252:255], v[184:187]
  s_cmp_lt_u32 s53, 64
  s_cbranch_scc1 KA_SPIN
KA_SPIN_RET:
  v_mfma_f32_16x16x32_bf16 v[140:143], v[60:63], a[240:243], v[140:143]
  s_lshl_b32 s53, s30, 9
  v_mfma_f32_16x16x32_bf16 v[156:159], v[60:63], a[244:247], v[156:159]
  buffer_load_dwordx4 v15, s[24:27], s46 offen offset:3072 lds
  v_mfma_f32_16x16x32_bf16 v[172:175], v[60:63], a[248:251], v[172:175]
  buffer_load_dwordx4 v[208:211], v254, s[20:23], s53 offen offset:0 sc1
  v_mfma_f32_16x16x32_bf16 v[188:191], v[60:63], a[252:255], v[188:191]
  s_waitcnt lgkmcnt(0)
  v_mfma_f32_16x16x32_bf16 v[64:67], a[0:3], v[32:35], 0
  ds_read_b64_tr_b16 v[48:49], v18 offset:36864
  v_mfma_f32_16x16x32_bf16 v[68:71], a[4:7], v[32:35], 0
  ds_read_b64_tr_b16 v[50:51], v18 offset:37376
  v_mfma_f32_16x16x32_bf16 v[96:99], a[8:11], v[32:35], 0
  ds_read_b64_tr_b16 v[52:53], v19 offset:36864
  v_mfma_f32_16x16x32_bf16 v[100:103], a[12:15], v[32:35], 0
  ds_read_b64_tr_b16 v[54:55], v19 offset:37376
  v_mfma_f32_16x16x32_bf16 v[72:75], a[0:3], v[36:39], 0
  ds_read_b64_tr_b16 v[56:57], v20 offset:36864
  v_mfma_f32_16x16x32_bf16 v[76:79], a[4:7], v[36:39], 0
  ds_read_b64_tr_b16 v[58:59], v20 offset:37376
  v_mfma_f32_16x16x32_bf16 v[104:107], a[8:11], v[36:39], 0
  ds_read_b64_tr_b16 v[60:61], v21 offset:36864
  s_add_u32 m0, s50, 81920
  v_mfma_f32_16x16x32_bf16 v[108:111], a[12:15], v[36:39], 0
  ds_read_b64_tr_b16 v[62:63], v21 offset:37376
  s_mov_b32 s46, 3145728
  v_mfma_f32_16x16x32_bf16 v[80:83], a[0:3], v[40:43], 0
  buffer_load_dwordx4 v12, s[24:27], s46 offen offset:0 lds
  v_mfma_f32_16x16x32_bf16 v[84:87], a[4:7], v[40:43], 0
  buffer_load_dwordx4 v[212:215], v254, s[20:23], s53 offen offset:16 sc1
  v_mfma_f32_16x16x32_bf16 v[112:115], a[8:11], v[40:43], 0
  buffer_load_dwordx4 v[216:219], v254, s[20:23], s53 offen offset:256 sc1
  v_mfma_f32_16x16x32_bf16 v[116:119], a[12:15], v[40:43], 0
  buffer_load_dwordx4 v[220:223], v254, s[20:23], s53 offen offset:272 sc1
  v_mfma_f32_16x16x32_bf16 v[88:91], a[0:3], v[44:47], 0
  buffer_load_dwordx4 v13, s[24:27], s46 offen offset:1024 lds
  v_cvt_pk_bf16_f32 v128, v128, v129
  v_mfma_f32_16x16x32_bf16 v[92:95], a[4:7], v[44:47], 0
  v_cvt_pk_bf16_f32 v129, v130, v131
  v_cvt_pk_bf16_f32 v130, v132, v133
  v_mfma_f32_16x16x32_bf16 v[120:123], a[8:11], v[44:47], 0
  v_cvt_pk_bf16_f32 v131, v134, v135
  s_add_u32 s47, s51, 16781312
  v_mfma_f32_16x16x32_bf16 v[124:127], a[12:15], v[44:47], 0
  s_waitcnt lgkmcnt(0)
  v_mfma_f32_16x16x32_bf16 v[64:67], a[16:19], v[48:51], v[64:67]
  ds_read_b64_tr_b16 v[32:33], v18 offset:40960
  v_mfma_f32_16x16x32_bf16 v[68:71], a[20:23], v[48:51], v[68:71]
  ds_read_b64_tr_b16 v[34:35], v18 offset:41472
  v_mfma_f32_16x16x32_bf16 v[96:99], a[24:27], v[48:51], v[96:99]
  ds_read_b64_tr_b16 v[36:37], v19 offset:40960
  v_mfma_f32_16x16x32_bf16 v[100:103], a[28:31], v[48:51], v[100:103]
  ds_read_b64_tr_b16 v[38:39], v19 offset:41472
  v_mfma_f32_16x16x32_bf16 v[72:75], a[16:19], v[52:55], v[72:75]
  ds_read_b64_tr_b16 v[40:41], v20 offset:40960
  v_mfma_f32_16x16x32_bf16 v[76:79], a[20:23], v[52:55], v[76:79]
  ds_read_b64_tr_b16 v[42:43], v20 offset:41472
  v_mfma_f32_16x16x32_bf16 v[104:107], a[24:27], v[52:55], v[104:107]
  ds_read_b64_tr_b16 v[44:45], v21 offset:40960
  v_mfma_f32_16x16x32_bf16 v[108:111], a[28:31], v[52:55], v[108:111]
  ds_read_b64_tr_b16 v[46:47], v21 offset:41472
  v_mfma_f32_16x16x32_bf16 v[80:83], a[16:19], v[56:59], v[80:83]
  buffer_load_dwordx4 v14, s[24:27], s46 offen offset:2048 lds
  v_mfma_f32_16x16x32_bf16 v[84:87], a[20:23], v[56:59], v[84:87]
  buffer_store_dwordx4 v[128:131], v1, s[20:23], s47 offen offset:0 sc1
  v_mfma_f32_16x16x32_bf16 v[112:115], a[24:27], v[56:59], v[112:115]
  buffer_load_dwordx4 v[192:195], v254, s[20:23], s53 offen offset:2048 sc1
  v_mfma_f32_16x16x32_bf16 v[116:119], a[28:31], v[56:59], v[116:119]
  buffer_load_dwordx4 v[196:199], v254, s[20:23], s53 offen offset:2064 sc1
  v_mfma_f32_16x16x32_bf16 v[88:91], a[16:19], v[60:63], v[88:91]
  buffer_load_dwordx4 v15, s[24:27], s46 offen offset:3072 lds
  v_mfma_f32_16x16x32_bf16 v[92:95], a[20:23], v[60:63], v[92:95]
  buffer_load_dwordx4 v[200:203], v254, s[20:23], s53 offen offset:2304 sc1
  v_mfma_f32_16x16x32_bf16 v[120:123], a[24:27], v[60:63], v[120:123]
  buffer_load_dwordx4 v[204:207], v254, s[20:23], s53 offen offset:2320 sc1
  v_mfma_f32_16x16x32_bf16 v[124:127], a[28:31], v[60:63], v[124:127]
  s_waitcnt lgkmcnt(0)
  v_mfma_f32_16x16x32_bf16 v[64:67], a[32:35], v[32:35], v[64:67]
  ds_read_b64_tr_b16 v[48:49], v18 offset:45056
  v_mfma_f32_16x16x32_bf16 v[68:71], a[36:39], v[32:35], v[68:71]
  ds_read_b64_tr_b16 v[50:51], v18 offset:45568
  v_mfma_f32_16x16x32_bf16 v[96:99], a[40:43], v[32:35], v[96:99]
  ds_read_b64_tr_b16 v[52:53], v19 offset:45056
  v_mfma_f32_16x16x32_bf16 v[100:103], a[44:47], v[32:35], v[100:103]
  ds_read_b64_tr_b16 v[54:55], v19 offset:45568
  v_mfma_f32_16x16x32_bf16 v[72:75], a[32:35], v[36:39], v[72:75]
  ds_read_b64_tr_b16 v[56:57], v20 offset:45056
  v_cvt_pk_bf16_f32 v136, v136, v137
  v_cvt_pk_bf16_f32 v137, v138, v139
  v_mfma_f32_16x16x32_bf16 v[76:79], a[36:39], v[36:39], v[76:79]
  ds_read_b64_tr_b16 v[58:59], v20 offset:45568
  v_cvt_pk_bf16_f32 v138, v140, v141
  v_cvt_pk_bf16_f32 v139, v142, v143
  v_mfma_f32_16x16x32_bf16 v[104:107], a[40:43], v[36:39], v[104:107]
  ds_read_b64_tr_b16 v[60:61], v21 offset:45056
  s_add_u32 s47, s51, 16781312
  s_add_u32 m0, s50, 32768
  v_mfma_f32_16x16x32_bf16 v[108:111], a[44:47], v[36:39], v[108:111]
  ds_read_b64_tr_b16 v[62:63], v21 offset:45568
  s_mov_b32 s46, 128
  v_mfma_f32_16x16x32_bf16 v[80:83], a[32:35], v[40:43], v[80:83]
  buffer_load_dwordx4 v12, s[24:27], s46 offen offset:0 lds
  v_mfma_f32_16x16x32_bf16 v[84:87], a[36:39], v[40:43], v[84:87]
  buffer_store_dwordx4 v[136:139], v1, s[20:23], s47 offen offset:2048 sc1
  v_mfma_f32_16x16x32_bf16 v[112:115], a[40:43], v[40:43], v[112:115]
  v_mfma_f32_16x16x32_bf16 v[116:119], a[44:47], v[40:43], v[116:119]
  v_mfma_f32_16x16x32_bf16 v[88:91], a[32:35], v[44:47], v[88:91]
  buffer_load_dwordx4 v13, s[24:27], s46 offen offset:1024 lds
  v_mfma_f32_16x16x32_bf16 v[92:95], a[36:39], v[44:47], v[92:95]
  v_mfma_f32_16x16x32_bf16 v[120:123], a[40:43], v[44:47], v[120:123]
  v_mfma_f32_16x16x32_bf16 v[124:127], a[44:47], v[44:47], v[124:127]
  s_waitcnt vmcnt(21) lgkmcnt(0)
  v_mfma_f32_16x16x32_bf16 v[64:67], a[48:51], v[48:51], v[64:67]
  s_barrier
  v_mfma_f32_16x16x32_bf16 v[68:71], a[52:55], v[48:51], v[68:71]
  ds_read_b64_tr_b16 v[32:33], v18 offset:49152
  v_mfma_f32_16x16x32_bf16 v[96:99], a[56:59], v[48:51], v[96:99]
  ds_read_b64_tr_b16 v[34:35], v18 offset:49664
  v_mfma_f32_16x16x32_bf16 v[100:103], a[60:63], v[48:51], v[100:103]
  ds_read_b64_tr_b16 v[36:37], v19 offset:49152
  v_mfma_f32_16x16x32_bf16 v[72:75], a[48:51], v[52:55], v[72:75]
  ds_read_b64_tr_b16 v[38:39], v19 offset:49664
  v_mfma_f32_16x16x32_bf16 v[76:79], a[52:55], v[52:55], v[76:79]
  ds_read_b64_tr_b16 v[40:41], v20 offset:49152
  v_mfma_f32_16x16x32_bf16 v[104:107], a[56:59], v[52:55], v[104:107]
  ds_read_b64_tr_b16 v[42:43], v20 offset:49664
  v_mfma_f32_16x16x32_bf16 v[108:111], a[60:63], v[52:55], v[108:111]
  ds_read_b64_tr_b16 v[44:45], v21 offset:49152
  v_mfma_f32_16x16x32_bf16 v[80:83], a[48:51], v[56:59], v[80:83]
  ds_read_b64_tr_b16 v[46:47], v21 offset:49664
  v_mfma_f32_16x16x32_bf16 v[84:87], a[52:55], v[56:59], v[84:87]
  buffer_load_dwordx4 v14, s[24:27], s46 offen offset:2048 lds
  v_mfma_f32_16x16x32_bf16 v[112:115], a[56:59], v[56:59], v[112:115]
  v_mfma_f32_16x16x32_bf16 v[116:119], a[60:63], v[56:59], v[116:119]
  v_mfma_f32_16x16x32_bf16 v[88:91], a[48:51], v[60:63], v[88:91]
  v_cvt_pk_bf16_f32 v144, v144, v145
  v_cvt_pk_bf16_f32 v145, v146, v147
  v_mfma_f32_16x16x32_bf16 v[92:95], a[52:55], v[60:63], v[92:95]
  buffer_load_dwordx4 v15, s[24:27], s46 offen offset:3072 lds
  v_cvt_pk_bf16_f32 v146, v148, v149
  v_mfma_f32_16x16x32_bf16 v[120:123], a[56:59], v[60:63], v[120:123]
  v_cvt_pk_bf16_f32 v147, v150, v151
  s_add_u32 s47, s51, 16781312
  v_mfma_f32_16x16x32_bf16 v[124:127], a[60:63], v[60:63], v[124:127]
  s_waitcnt lgkmcnt(0)
  v_mfma_f32_16x16x32_bf16 v[64:67], a[64:67], v[32:35], v[64:67]
  ds_read_b64_tr_b16 v[48:49], v18 offset:53248
  v_mfma_f32_16x16x32_bf16 v[68:71], a[68:71], v[32:35], v[68:71]
  ds_read_b64_tr_b16 v[50:51], v18 offset:53760
  v_mfma_f32_16x16x32_bf16 v[96:99], a[72:75], v[32:35], v[96:99]
  ds_read_b64_tr_b16 v[52:53], v19 offset:53248
  v_mfma_f32_16x16x32_bf16 v[100:103], a[76:79], v[32:35], v[100:103]
  ds_read_b64_tr_b16 v[54:55], v19 offset:53760
  v_mfma_f32_16x16x32_bf16 v[72:75], a[64:67], v[36:39], v[72:75]
  ds_read_b64_tr_b16 v[56:57], v20 offset:53248
  v_mfma_f32_16x16x32_bf16 v[76:79], a[68:71], v[36:39], v[76:79]
  ds_read_b64_tr_b16 v[58:59], v20 offset:53760
  v_mfma_f32_16x16x32_bf16 v[104:107], a[72:75], v[36:39], v[104:107]
  ds_read_b64_tr_b16 v[60:61], v21 offset:53248
  s_add_u32 m0, s50, 49152
  v_mfma_f32_16x16x32_bf16 v[108:111], a[76:79], v[36:39], v[108:111]
  ds_read_b64_tr_b16 v[62:63], v21 offset:53760
  s_waitcnt vmcnt(5)
  s_mov_b32 s46, 1048704
  v_mfma_f32_16x16x32_bf16 v[80:83], a[64:67], v[40:43], v[80:83]
  buffer_load_dwordx4 v12, s[24:27], s46 offen offset:0 lds
  v_fma_f32 v232, v232, v192, v208
  v_mfma_f32_16x16x32_bf16 v[84:87], a[68:71], v[40:43], v[84:87]
  buffer_store_dwordx4 v[144:147], v1, s[20:23], s47 offen offset:1024 sc1
  v_mfma_f32_16x16x32_bf16 v[112:115], a[72:75], v[40:43], v[112:115]
  v_fma_f32 v233, v233, v193, v209
  v_fma_f32 v234, v234, v194, v210
  v_mfma_f32_16x16x32_bf16 v[116:119], a[76:79], v[40:43], v[116:119]
  v_fma_f32 v235, v235, v195, v211
  v_fma_f32 v236, v236, v196, v212
  v_mfma_f32_16x16x32_bf16 v[88:91], a[64:67], v[44:47], v[88:91]
  buffer_load_dwordx4 v13, s[24:27], s46 offen offset:1024 lds
  v_fma_f32 v237, v237, v197, v213
  v_mfma_f32_16x16x32_bf16 v[92:95], a[68:71], v[44:47], v[92:95]
  v_fma_f32 v238, v238, v198, v214
  v_fma_f32 v239, v239, v199, v215
  v_mfma_f32_16x16x32_bf16 v[120:123], a[72:75], v[44:47], v[120:123]
  v_fma_f32 v240, v240, v200, v216
  v_fma_f32 v241, v241, v201, v217
  v_mfma_f32_16x16x32_bf16 v[124:127], a[76:79], v[44:47], v[124:127]
  s_waitcnt lgkmcnt(0)
  v_fma_f32 v242, v242, v202, v218
  v_fma_f32 v243, v243, v203, v219
  v_mfma_f32_16x16x32_bf16 v[64:67], a[80:83], v[48:51], v[64:67]
  ds_read_b64_tr_b16 v[32:33], v18 offset:57344
  v_fma_f32 v244, v244, v204, v220
  v_fma_f32 v245, v245, v205, v221
  v_mfma_f32_16x16x32_bf16 v[68:71], a[84:87], v[48:51], v[68:71]
  ds_read_b64_tr_b16 v[34:35], v18 offset:57856
  v_fma_f32 v246, v246, v206, v222
  v_fma_f32 v247, v247, v207, v223
  v_mfma_f32_16x16x32_bf16 v[96:99], a[88:91], v[48:51], v[96:99]
  ds_read_b64_tr_b16 v[36:37], v19 offset:57344
  v_cvt_pk_bf16_f32 v224, v232, v233
  v_cvt_pk_bf16_f32 v225, v234, v235
  v_mfma_f32_16x16x32_bf16 v[100:103], a[92:95], v[48:51], v[100:103]
  ds_read_b64_tr_b16 v[38:39], v19 offset:57856
  v_cvt_pk_bf16_f32 v226, v236, v237
  v_cvt_pk_bf16_f32 v227, v238, v239
  v_mfma_f32_16x16x32_bf16 v[72:75], a[80:83], v[52:55], v[72:75]
  ds_read_b64_tr_b16 v[40:41], v20 offset:57344
  v_cvt_pk_bf16_f32 v152, v152, v153
  v_cvt_pk_bf16_f32 v153, v154, v155
  v_mfma_f32_16x16x32_bf16 v[76:79], a[84:87], v[52:55], v[76:79]
  ds_read_b64_tr_b16 v[42:43], v20 offset:57856
  v_cvt_pk_bf16_f32 v154, v156, v157
  v_cvt_pk_bf16_f32 v155, v158, v159
  v_mfma_f32_16x16x32_bf16 v[104:107], a[88:91], v[52:55], v[104:107]
  ds_read_b64_tr_b16 v[44:45], v21 offset:57344
  s_add_u32 s47, s51, 16781312
  v_cvt_pk_bf16_f32 v228, v240, v241
  v_mfma_f32_16x16x32_bf16 v[108:111], a[92:95], v[52:55], v[108:111]
  ds_read_b64_tr_b16 v[46:47], v21 offset:57856
  v_cvt_pk_bf16_f32 v229, v242, v243
  v_cvt_pk_bf16_f32 v230, v244, v245
  v_mfma_f32_16x16x32_bf16 v[80:83], a[80:83], v[56:59], v[80:83]
  buffer_load_dwordx4 v14, s[24:27], s46 offen offset:2048 lds
  v_cvt_pk_bf16_f32 v231, v246, v247
  v_mfma_f32_16x16x32_bf16 v[84:87], a[84:87], v[56:59], v[84:87]
  buffer_store_dwordx4 v[152:155], v1, s[20:23], s47 offen offset:3072 sc1
  v_mfma_f32_16x16x32_bf16 v[112:115], a[88:91], v[56:59], v[112:115]
  buffer_store_dwordx4 v[224:227], v250, s[20:23], s52 offen sc1
  v_mfma_f32_16x16x32_bf16 v[116:119], a[92:95], v[56:59], v[116:119]
  buffer_store_dwordx4 v[228:231], v250, s[20:23], s55 offen sc1
  v_mfma_f32_16x16x32_bf16 v[88:91], a[80:83], v[60:63], v[88:91]
  buffer_load_dwordx4 v15, s[24:27], s46 offen offset:3072 lds
  v_mov_b32 v25, 23063
  v_mfma_f32_16x16x32_bf16 v[92:95], a[84:87], v[60:63], v[92:95]
  v_min_u32 v27, 1, v2
  v_lshlrev_b32 v27, 30, v27
  v_mfma_f32_16x16x32_bf16 v[120:123], a[88:91], v[60:63], v[120:123]
  s_add_u32 s52, s3, 131072
  v_mfma_f32_16x16x32_bf16 v[124:127], a[92:95], v[60:63], v[124:127]
  s_waitcnt lgkmcnt(0)
  v_mfma_f32_16x16x32_bf16 v[64:67], a[96:99], v[32:35], v[64:67]
  ds_read_b64_tr_b16 v[48:49], v18 offset:61440
  v_mfma_f32_16x16x32_bf16 v[68:71], a[100:103], v[32:35], v[68:71]
  ds_read_b64_tr_b16 v[50:51], v18 offset:61952
  v_mfma_f32_16x16x32_bf16 v[96:99], a[104:107], v[32:35], v[96:99]
  ds_read_b64_tr_b16 v[52:53], v19 offset:61440
  v_mfma_f32_16x16x32_bf16 v[100:103], a[108:111], v[32:35], v[100:103]
  ds_read_b64_tr_b16 v[54:55], v19 offset:61952
  v_mfma_f32_16x16x32_bf16 v[72:75], a[96:99], v[36:39], v[72:75]
  ds_read_b64_tr_b16 v[56:57], v20 offset:61440
  v_mfma_f32_16x16x32_bf16 v[76:79], a[100:103], v[36:39], v[76:79]
  ds_read_b64_tr_b16 v[58:59], v20 offset:61952
  v_mfma_f32_16x16x32_bf16 v[104:107], a[104:107], v[36:39], v[104:107]
  ds_read_b64_tr_b16 v[60:61], v21 offset:61440
  s_add_u32 m0, s50, 0
  v_mfma_f32_16x16x32_bf16 v[108:111], a[108:111], v[36:39], v[108:111]
  ds_read_b64_tr_b16 v[62:63], v21 offset:61952
  s_mov_b32 s46, 2097280
  v_mfma_f32_16x16x32_bf16 v[80:83], a[96:99], v[40:43], v[80:83]
  buffer_load_dwordx4 v12, s[24:27], s46 offen offset:0 lds
  v_mfma_f32_16x16x32_bf16 v[84:87], a[100:103], v[40:43], v[84:87]
  v_mfma_f32_16x16x32_bf16 v[112:115], a[104:107], v[40:43], v[112:115]
  v_mfma_f32_16x16x32_bf16 v[116:119], a[108:111], v[40:43], v[116:119]
  v_mfma_f32_16x16x32_bf16 v[88:91], a[96:99], v[44:47], v[88:91]
  buffer_load_dwordx4 v13, s[24:27], s46 offen offset:1024 lds
  v_cvt_pk_bf16_f32 v160, v160, v161
  v_mfma_f32_16x16x32_bf16 v[92:95], a[100:103], v[44:47], v[92:95]
  v_cvt_pk_bf16_f32 v161, v162, v163
  v_cvt_pk_bf16_f32 v162, v164, v165
  v_mfma_f32_16x16x32_bf16 v[120:123], a[104:107], v[44:47], v[120:123]
  v_cvt_pk_bf16_f32 v163, v166, v167
  s_add_u32 s47, s51, 16789504
  v_mfma_f32_16x16x32_bf16 v[124:127], a[108:111], v[44:47], v[124:127]
  s_waitcnt lgkmcnt(0)
  v_mfma_f32_16x16x32_bf16 v[64:67], a[112:115], v[48:51], v[64:67]
  s_barrier
  v_mfma_f32_16x16x32_bf16 v[68:71], a[116:119], v[48:51], v[68:71]
  ds_read_b64_tr_b16 v[32:33], v18 offset:0
  v_mfma_f32_16x16x32_bf16 v[96:99], a[120:123], v[48:51], v[96:99]
  ds_read_b64_tr_b16 v[34:35], v18 offset:512
  v_mfma_f32_16x16x32_bf16 v[100:103], a[124:127], v[48:51], v[100:103]
  ds_read_b64_tr_b16 v[36:37], v19 offset:0
  v_mfma_f32_16x16x32_bf16 v[72:75], a[112:115], v[52:55], v[72:75]
  ds_read_b64_tr_b16 v[38:39], v19 offset:512
  v_mfma_f32_16x16x32_bf16 v[76:79], a[116:119], v[52:55], v[76:79]
  ds_read_b64_tr_b16 v[40:41], v20 offset:0
  v_mfma_f32_16x16x32_bf16 v[104:107], a[120:123], v[52:55], v[104:107]
  ds_read_b64_tr_b16 v[42:43], v20 offset:512
  v_mfma_f32_16x16x32_bf16 v[108:111], a[124:127], v[52:55], v[108:111]
  ds_read_b64_tr_b16 v[44:45], v21 offset:0
  v_mfma_f32_16x16x32_bf16 v[80:83], a[112:115], v[56:59], v[80:83]
  ds_read_b64_tr_b16 v[46:47], v21 offset:512
  v_mfma_f32_16x16x32_bf16 v[84:87], a[116:119], v[56:59], v[84:87]
  buffer_load_dwordx4 v14, s[24:27], s46 offen offset:2048 lds
  v_mfma_f32_16x16x32_bf16 v[112:115], a[120:123], v[56:59], v[112:115]
  buffer_store_dwordx4 v[160:163], v1, s[20:23], s47 offen offset:0 sc1
  v_mfma_f32_16x16x32_bf16 v[116:119], a[124:127], v[56:59], v[116:119]
  v_mfma_f32_16x16x32_bf16 v[88:91], a[112:115], v[60:63], v[88:91]
  v_mfma_f32_16x16x32_bf16 v[92:95], a[116:119], v[60:63], v[92:95]
  buffer_load_dwordx4 v15, s[24:27], s46 offen offset:3072 lds
  v_mfma_f32_16x16x32_bf16 v[120:123], a[120:123], v[60:63], v[120:123]
  v_mfma_f32_16x16x32_bf16 v[124:127], a[124:127], v[60:63], v[124:127]
  s_waitcnt lgkmcnt(0)
  v_mfma_f32_16x16x32_bf16 v[64:67], a[128:131], v[32:35], v[64:67]
  ds_read_b64_tr_b16 v[48:49], v18 offset:4096
  v_mfma_f32_16x16x32_bf16 v[68:71], a[132:135], v[32:35], v[68:71]
  ds_read_b64_tr_b16 v[50:51], v18 offset:4608
  v_mfma_f32_16x16x32_bf16 v[96:99], a[136:139], v[32:35], v[96:99]
  ds_read_b64_tr_b16 v[52:53], v19 offset:4096
  v_mfma_f32_16x16x32_bf16 v[100:103], a[140:143], v[32:35], v[100:103]
  ds_read_b64_tr_b16 v[54:55], v19 offset:4608
  v_mfma_f32_16x16x32_bf16 v[72:75], a[128:131], v[36:39], v[72:75]
  ds_read_b64_tr_b16 v[56:57], v20 offset:4096
  v_cvt_pk_bf16_f32 v168, v168, v169
  v_cvt_pk_bf16_f32 v169, v170, v171
  v_mfma_f32_16x16x32_bf16 v[76:79], a[132:135], v[36:39], v[76:79]
  ds_read_b64_tr_b16 v[58:59], v20 offset:4608
  v_cvt_pk_bf16_f32 v170, v172, v173
  v_cvt_pk_bf16_f32 v171, v174, v175
  v_mfma_f32_16x16x32_bf16 v[104:107], a[136:139], v[36:39], v[104:107]
  ds_read_b64_tr_b16 v[60:61], v21 offset:4096
  s_add_u32 s47, s51, 16789504
  s_add_u32 m0, s50, 16384
  v_mfma_f32_16x16x32_bf16 v[108:111], a[140:143], v[36:39], v[108:111]
  ds_read_b64_tr_b16 v[62:63], v21 offset:4608
  s_mov_b32 s46, 3145856
  v_mfma_f32_16x16x32_bf16 v[80:83], a[128:131], v[40:43], v[80:83]
  buffer_load_dwordx4 v12, s[24:27], s46 offen offset:0 lds
  v_mfma_f32_16x16x32_bf16 v[84:87], a[132:135], v[40:43], v[84:87]
  buffer_store_dwordx4 v[168:171], v1, s[20:23], s47 offen offset:2048 sc1
  v_mfma_f32_16x16x32_bf16 v[112:115], a[136:139], v[40:43], v[112:115]
  v_mfma_f32_16x16x32_bf16 v[116:119], a[140:143], v[40:43], v[116:119]
  v_mfma_f32_16x16x32_bf16 v[88:91], a[128:131], v[44:47], v[88:91]
  buffer_load_dwordx4 v13, s[24:27], s46 offen offset:1024 lds
  v_mfma_f32_16x16x32_bf16 v[92:95], a[132:135], v[44:47], v[92:95]
  v_mfma_f32_16x16x32_bf16 v[120:123], a[136:139], v[44:47], v[120:123]
  v_mfma_f32_16x16x32_bf16 v[124:127], a[140:143], v[44:47], v[124:127]
  s_waitcnt lgkmcnt(0)
  v_mfma_f32_16x16x32_bf16 v[64:67], a[144:147], v[48:51], v[64:67]
  ds_read_b64_tr_b16 v[32:33], v18 offset:8192
  v_mfma_f32_16x16x32_bf16 v[68:71], a[148:151], v[48:51], v[68:71]
  ds_read_b64_tr_b16 v[34:35], v18 offset:8704
  v_mfma_f32_16x16x32_bf16 v[96:99], a[152:155], v[48:51], v[96:99]
  ds_read_b64_tr_b16 v[36:37], v19 offset:8192
  v_mfma_f32_16x16x32_bf16 v[100:103], a[156:159], v[48:51], v[100:103]
  ds_read_b64_tr_b16 v[38:39], v19 offset:8704
  v_mfma_f32_16x16x32_bf16 v[72:75], a[144:147], v[52:55], v[72:75]
  ds_read_b64_tr_b16 v[40:41], v20 offset:8192
  v_mfma_f32_16x16x32_bf16 v[76:79], a[148:151], v[52:55], v[76:79]
  ds_read_b64_tr_b16 v[42:43], v20 offset:8704
  v_mfma_f32_16x16x32_bf16 v[104:107], a[152:155], v[52:55], v[104:107]
  ds_read_b64_tr_b16 v[44:45], v21 offset:8192
  v_mfma_f32_16x16x32_bf16 v[108:111], a[156:159], v[52:55], v[108:111]
  ds_read_b64_tr_b16 v[46:47], v21 offset:8704
  v_mfma_f32_16x16x32_bf16 v[80:83], a[144:147], v[56:59], v[80:83]
  buffer_load_dwordx4 v14, s[24:27], s46 offen offset:2048 lds
  v_mfma_f32_16x16x32_bf16 v[84:87], a[148:151], v[56:59], v[84:87]
  v_mfma_f32_16x16x32_bf16 v[112:115], a[152:155], v[56:59], v[112:115]
  v_mfma_f32_16x16x32_bf16 v[116:119], a[156:159], v[56:59], v[116:119]
  v_mfma_f32_16x16x32_bf16 v[88:91], a[144:147], v[60:63], v[88:91]
  buffer_load_dwordx4 v15, s[24:27], s46 offen offset:3072 lds
  v_cvt_pk_bf16_f32 v176, v176, v177
  v_mfma_f32_16x16x32_bf16 v[92:95], a[148:151], v[60:63], v[92:95]
  v_cvt_pk_bf16_f32 v177, v178, v179
  v_cvt_pk_bf16_f32 v178, v180, v181
  v_mfma_f32_16x16x32_bf16 v[120:123], a[152:155], v[60:63], v[120:123]
  v_cvt_pk_bf16_f32 v179, v182, v183
  s_add_u32 s47, s51, 16789504
  v_mfma_f32_16x16x32_bf16 v[124:127], a[156:159], v[60:63], v[124:127]
  s_waitcnt lgkmcnt(0)
  v_mfma_f32_16x16x32_bf16 v[64:67], a[160:163], v[32:35], v[64:67]
  ds_read_b64_tr_b16 v[48:49], v18 offset:12288
  v_mfma_f32_16x16x32_bf16 v[68:71], a[164:167], v[32:35], v[68:71]
  ds_read_b64_tr_b16 v[50:51], v18 offset:12800
  s_mov_b32 s24, s8
  s_mov_b32 s25, s9
  v_mfma_f32_16x16x32_bf16 v[96:99], a[168:171], v[32:35], v[96:99]
  ds_read_b64_tr_b16 v[52:53], v19 offset:12288
  v_mfma_f32_16x16x32_bf16 v[100:103], a[172:175], v[32:35], v[100:103]
  ds_read_b64_tr_b16 v[54:55], v19 offset:12800
  v_mfma_f32_16x16x32_bf16 v[72:75], a[160:163], v[36:39], v[72:75]
  ds_read_b64_tr_b16 v[56:57], v20 offset:12288
  v_mfma_f32_16x16x32_bf16 v[76:79], a[164:167], v[36:39], v[76:79]
  ds_read_b64_tr_b16 v[58:59], v20 offset:12800
  v_mfma_f32_16x16x32_bf16 v[104:107], a[168:171], v[36:39], v[104:107]
  ds_read_b64_tr_b16 v[60:61], v21 offset:12288
  v_mfma_f32_16x16x32_bf16 v[108:111], a[172:175], v[36:39], v[108:111]
  ds_read_b64_tr_b16 v[62:63], v21 offset:12800
  v_mfma_f32_16x16x32_bf16 v[80:83], a[160:163], v[40:43], v[80:83]
  buffer_store_dwordx4 v[176:179], v1, s[20:23], s47 offen offset:1024 sc1
  v_mfma_f32_16x16x32_bf16 v[84:87], a[164:167], v[40:43], v[84:87]
  buffer_load_dword v26, v28, s[24:27], s48 offen
  v_lshrrev_b32 v22, 4, v2
  v_mfma_f32_16x16x32_bf16 v[112:115], a[168:171], v[40:43], v[112:115]
  v_and_b32 v23, 15, v2
  v_lshlrev_b32 v24, 1, v22
  v_mfma_f32_16x16x32_bf16 v[116:119], a[172:175], v[40:43], v[116:119]
  v_xor_b32 v23, v23, v24
  s_lshl_b32 s53, s32, 3
  v_mfma_f32_16x16x32_bf16 v[88:91], a[160:163], v[44:47], v[88:91]
  v_xor_b32 v23, s53, v23
  v_lshlrev_b32 v23, 4, v23
  v_mfma_f32_16x16x32_bf16 v[92:95], a[164:167], v[44:47], v[92:95]
  v_lshl_add_u32 v23, v22, 13, v23
  s_lshl_b32 s53, s30, 15
  v_mfma_f32_16x16x32_bf16 v[120:123], a[168:171], v[44:47], v[120:123]
  v_add_u32 v12, s53, v23
  s_sub_u32 s53, 15, s34
  v_mfma_f32_16x16x32_bf16 v[124:127], a[172:175], v[44:47], v[124:127]
  s_waitcnt lgkmcnt(0)
  s_waitcnt vmcnt(13)
  v_mfma_f32_16x16x32_bf16 v[64:67], a[176:179], v[48:51], v[64:67]
  s_barrier
  s_cmp_eq_u32 s32, 0
  s_cselect_b32 s53, s53, s34
  v_mfma_f32_16x16x32_bf16 v[68:71], a[180:183], v[48:51], v[68:71]
  ds_read_b64_tr_b16 v[32:33], v18 offset:16384
  s_lshl_b32 s54, s53, 11
  s_add_u32 s54, s54, 196608
  v_mfma_f32_16x16x32_bf16 v[96:99], a[184:187], v[48:51], v[96:99]
  ds_read_b64_tr_b16 v[34:35], v18 offset:16896
  s_lshl_b32 s53, s53, 17
  s_add_u32 s53, s53, 1048576
  v_mfma_f32_16x16x32_bf16 v[100:103], a[188:191], v[48:51], v[100:103]
  ds_read_b64_tr_b16 v[36:37], v19 offset:16384
  v_add_u32 v14, s53, v1
  s_lshl_b32 s53, s31, 15
  v_mfma_f32_16x16x32_bf16 v[72:75], a[176:179], v[52:55], v[72:75]
  ds_read_b64_tr_b16 v[38:39], v19 offset:16896
  v_cvt_pk_bf16_f32 v184, v184, v185
  v_cvt_pk_bf16_f32 v185, v186, v187
  v_mfma_f32_16x16x32_bf16 v[76:79], a[180:183], v[52:55], v[76:79]
  ds_read_b64_tr_b16 v[40:41], v20 offset:16384
  v_cvt_pk_bf16_f32 v186, v188, v189
  v_cvt_pk_bf16_f32 v187, v190, v191
  v_mfma_f32_16x16x32_bf16 v[104:107], a[184:187], v[52:55], v[104:107]
  ds_read_b64_tr_b16 v[42:43], v20 offset:16896
  s_add_u32 s47, s51, 16789504
  v_add_u32 v13, s53, v14
  v_mfma_f32_16x16x32_bf16 v[108:111], a[188:191], v[52:55], v[108:111]
  ds_read_b64_tr_b16 v[44:45], v21 offset:16384
  v_subrev_u32 v14, s53, v14
  v_add_u32 v14, 98304, v14
  v_mfma_f32_16x16x32_bf16 v[80:83], a[176:179], v[56:59], v[80:83]
  ds_read_b64_tr_b16 v[46:47], v21 offset:16896
  v_and_b32 v15, 15, v2
  v_lshlrev_b32 v15, 7, v15
  v_mfma_f32_16x16x32_bf16 v[84:87], a[180:183], v[56:59], v[84:87]
  buffer_store_dwordx4 v[184:187], v1, s[20:23], s47 offen offset:3072 sc1
  buffer_store_dword v25, v27, s[20:23], s52 offen sc1
  v_mfma_f32_16x16x32_bf16 v[112:115], a[184:187], v[56:59], v[112:115]
  s_lshl_b32 s49, s30, 10
  v_mfma_f32_16x16x32_bf16 v[116:119], a[188:191], v[56:59], v[116:119]
  v_mfma_f32_16x16x32_bf16 v[88:91], a[176:179], v[60:63], v[88:91]
  v_bfe_u32 v22, v2, 2, 2
  v_lshrrev_b32 v24, 4, v2
  v_mfma_f32_16x16x32_bf16 v[92:95], a[180:183], v[60:63], v[92:95]
  v_lshl_add_u32 v23, v24, 3, v22
  v_lshlrev_b32 v23, 8, v23
  v_mfma_f32_16x16x32_bf16 v[120:123], a[184:187], v[60:63], v[120:123]
  v_and_b32 v24, 1, v24
  v_lshl_add_u32 v22, v24, 2, v22
  v_mfma_f32_16x16x32_bf16 v[124:127], a[188:191], v[60:63], v[124:127]
  s_waitcnt lgkmcnt(0)
  v_lshl_add_u32 v23, v22, 5, v23
  v_and_b32 v24, 3, v2
  v_mfma_f32_16x16x32_bf16 v[64:67], a[192:195], v[32:35], v[64:67]
  ds_read_b64_tr_b16 v[48:49], v18 offset:20480
  v_lshl_add_u32 v23, v24, 3, v23
  v_add_u32 v4, 0x20000, v23
  v_mfma_f32_16x16x32_bf16 v[68:71], a[196:199], v[32:35], v[68:71]
  ds_read_b64_tr_b16 v[50:51], v18 offset:20992
  v_xor_b32 v5, 32, v4
  v_xor_b32 v6, 64, v4
  v_mfma_f32_16x16x32_bf16 v[96:99], a[200:203], v[32:35], v[96:99]
  ds_read_b64_tr_b16 v[52:53], v19 offset:20480
  v_xor_b32 v7, 96, v4
  v_xor_b32 v8, 128, v4
  v_mfma_f32_16x16x32_bf16 v[100:103], a[204:207], v[32:35], v[100:103]
  ds_read_b64_tr_b16 v[54:55], v19 offset:20992
  v_xor_b32 v9, 160, v4
  v_xor_b32 v10, 192, v4
  v_mfma_f32_16x16x32_bf16 v[72:75], a[192:195], v[36:39], v[72:75]
  ds_read_b64_tr_b16 v[56:57], v20 offset:20480
  v_xor_b32 v11, 224, v4
  v_mfma_f32_16x16x32_bf16 v[76:79], a[196:199], v[36:39], v[76:79]
  ds_read_b64_tr_b16 v[58:59], v20 offset:20992
  v_mfma_f32_16x16x32_bf16 v[104:107], a[200:203], v[36:39], v[104:107]
  ds_read_b64_tr_b16 v[60:61], v21 offset:20480
  v_mfma_f32_16x16x32_bf16 v[108:111], a[204:207], v[36:39], v[108:111]
  ds_read_b64_tr_b16 v[62:63], v21 offset:20992
  v_mfma_f32_16x16x32_bf16 v[80:83], a[192:195], v[40:43], v[80:83]
  v_mfma_f32_16x16x32_bf16 v[84:87], a[196:199], v[40:43], v[84:87]
  v_mfma_f32_16x16x32_bf16 v[112:115], a[200:203], v[40:43], v[112:115]
  v_mfma_f32_16x16x32_bf16 v[116:119], a[204:207], v[40:43], v[116:119]
  v_mfma_f32_16x16x32_bf16 v[88:91], a[192:195], v[44:47], v[88:91]
  v_mfma_f32_16x16x32_bf16 v[92:95], a[196:199], v[44:47], v[92:95]
  v_mfma_f32_16x16x32_bf16 v[120:123], a[200:203], v[44:47], v[120:123]
  v_mfma_f32_16x16x32_bf16 v[124:127], a[204:207], v[44:47], v[124:127]
  s_waitcnt lgkmcnt(0)
  v_mfma_f32_16x16x32_bf16 v[64:67], a[208:211], v[48:51], v[64:67]
  ds_read_b64_tr_b16 v[32:33], v18 offset:24576
  v_mfma_f32_16x16x32_bf16 v[68:71], a[212:215], v[48:51], v[68:71]
  ds_read_b64_tr_b16 v[34:35], v18 offset:25088
  v_mfma_f32_16x16x32_bf16 v[96:99], a[216:219], v[48:51], v[96:99]
  ds_read_b64_tr_b16 v[36:37], v19 offset:24576
  v_mfma_f32_16x16x32_bf16 v[100:103], a[220:223], v[48:51], v[100:103]
  ds_read_b64_tr_b16 v[38:39], v19 offset:25088
  v_mfma_f32_16x16x32_bf16 v[72:75], a[208:211], v[52:55], v[72:75]
  ds_read_b64_tr_b16 v[40:41], v20 offset:24576
  v_mfma_f32_16x16x32_bf16 v[76:79], a[212:215], v[52:55], v[76:79]
  ds_read_b64_tr_b16 v[42:43], v20 offset:25088
  v_mfma_f32_16x16x32_bf16 v[104:107], a[216:219], v[52:55], v[104:107]
  ds_read_b64_tr_b16 v[44:45], v21 offset:24576
  v_mfma_f32_16x16x32_bf16 v[108:111], a[220:223], v[52:55], v[108:111]
  ds_read_b64_tr_b16 v[46:47], v21 offset:25088
  v_mfma_f32_16x16x32_bf16 v[80:83], a[208:211], v[56:59], v[80:83]
  v_mfma_f32_16x16x32_bf16 v[84:87], a[212:215], v[56:59], v[84:87]
  v_mfma_f32_16x16x32_bf16 v[112:115], a[216:219], v[56:59], v[112:115]
  s_add_u32 m0, s49, 131072
  v_mfma_f32_16x16x32_bf16 v[116:119], a[220:223], v[56:59], v[116:119]
  s_mov_b32 s46, 0
  v_mfma_f32_16x16x32_bf16 v[88:91], a[208:211], v[60:63], v[88:91]
  buffer_load_dwordx4 v12, s[24:27], s46 offen lds
  v_mfma_f32_16x16x32_bf16 v[92:95], a[212:215], v[60:63], v[92:95]
  v_mfma_f32_16x16x32_bf16 v[120:123], a[216:219], v[60:63], v[120:123]
  v_mfma_f32_16x16x32_bf16 v[124:127], a[220:223], v[60:63], v[124:127]
  s_waitcnt lgkmcnt(0)
  v_mfma_f32_16x16x32_bf16 v[64:67], a[224:227], v[32:35], v[64:67]
  ds_read_b64_tr_b16 v[48:49], v18 offset:28672
  v_mfma_f32_16x16x32_bf16 v[68:71], a[228:231], v[32:35], v[68:71]
  ds_read_b64_tr_b16 v[50:51], v18 offset:29184
  v_mfma_f32_16x16x32_bf16 v[96:99], a[232:235], v[32:35], v[96:99]
  ds_read_b64_tr_b16 v[52:53], v19 offset:28672
  v_mfma_f32_16x16x32_bf16 v[100:103], a[236:239], v[32:35], v[100:103]
  ds_read_b64_tr_b16 v[54:55], v19 offset:29184
  v_mfma_f32_16x16x32_bf16 v[72:75], a[224:227], v[36:39], v[72:75]
  ds_read_b64_tr_b16 v[56:57], v20 offset:28672
  v_mfma_f32_16x16x32_bf16 v[76:79], a[228:231], v[36:39], v[76:79]
  ds_read_b64_tr_b16 v[58:59], v20 offset:29184
  v_mfma_f32_16x16x32_bf16 v[104:107], a[232:235], v[36:39], v[104:107]
  ds_read_b64_tr_b16 v[60:61], v21 offset:28672
  s_add_u32 m0, s49, 135168
  v_mfma_f32_16x16x32_bf16 v[108:111], a[236:239], v[36:39], v[108:111]
  ds_read_b64_tr_b16 v[62:63], v21 offset:29184
  s_mov_b32 s46, 131072
  v_mfma_f32_16x16x32_bf16 v[80:83], a[224:227], v[40:43], v[80:83]
  buffer_load_dwordx4 v12, s[24:27], s46 offen lds
  v_mfma_f32_16x16x32_bf16 v[84:87], a[228:231], v[40:43], v[84:87]
  v_mfma_f32_16x16x32_bf16 v[112:115], a[232:235], v[40:43], v[112:115]
  v_mfma_f32_16x16x32_bf16 v[116:119], a[236:239], v[40:43], v[116:119]
  v_mfma_f32_16x16x32_bf16 v[88:91], a[224:227], v[44:47], v[88:91]
  v_mfma_f32_16x16x32_bf16 v[92:95], a[228:231], v[44:47], v[92:95]
  v_xor_b32 v18, 0x10000, v18
  v_xor_b32 v19, 0x10000, v19
  v_mfma_f32_16x16x32_bf16 v[120:123], a[232:235], v[44:47], v[120:123]
  v_xor_b32 v20, 0x10000, v20
  v_xor_b32 v21, 0x10000, v21
  v_mfma_f32_16x16x32_bf16 v[124:127], a[236:239], v[44:47], v[124:127]
  s_waitcnt lgkmcnt(0)
  v_mfma_f32_16x16x32_bf16 v[64:67], a[240:243], v[48:51], v[64:67]
  s_barrier
  v_mfma_f32_16x16x32_bf16 v[68:71], a[244:247], v[48:51], v[68:71]
  ds_read_b64_tr_b16 v[32:33], v18 offset:32768
  v_mfma_f32_16x16x32_bf16 v[96:99], a[248:251], v[48:51], v[96:99]
  ds_read_b64_tr_b16 v[34:35], v18 offset:33280
  v_mfma_f32_16x16x32_bf16 v[100:103], a[252:255], v[48:51], v[100:103]
  ds_read_b64_tr_b16 v[36:37], v19 offset:32768
  v_mfma_f32_16x16x32_bf16 v[72:75], a[240:243], v[52:55], v[72:75]
  ds_read_b64_tr_b16 v[38:39], v19 offset:33280
  v_mfma_f32_16x16x32_bf16 v[76:79], a[244:247], v[52:55], v[76:79]
  ds_read_b64_tr_b16 v[40:41], v20 offset:32768
  v_mfma_f32_16x16x32_bf16 v[104:107], a[248:251], v[52:55], v[104:107]
  ds_read_b64_tr_b16 v[42:43], v20 offset:33280
  v_mfma_f32_16x16x32_bf16 v[108:111], a[252:255], v[52:55], v[108:111]
  ds_read_b64_tr_b16 v[44:45], v21 offset:32768
  s_add_u32 m0, s49, 139264
  v_mfma_f32_16x16x32_bf16 v[80:83], a[240:243], v[56:59], v[80:83]
  ds_read_b64_tr_b16 v[46:47], v21 offset:33280
  s_mov_b32 s46, 262144
  v_mfma_f32_16x16x32_bf16 v[84:87], a[244:247], v[56:59], v[84:87]
  buffer_load_dwordx4 v12, s[24:27], s46 offen lds
  v_mfma_f32_16x16x32_bf16 v[112:115], a[248:251], v[56:59], v[112:115]
  v_mfma_f32_16x16x32_bf16 v[116:119], a[252:255], v[56:59], v[116:119]
  s_add_u32 m0, s49, 143360
  v_mfma_f32_16x16x32_bf16 v[88:91], a[240:243], v[60:63], v[88:91]
  s_mov_b32 s46, 393216
  v_mfma_f32_16x16x32_bf16 v[92:95], a[244:247], v[60:63], v[92:95]
  buffer_load_dwordx4 v12, s[24:27], s46 offen lds
  v_mfma_f32_16x16x32_bf16 v[120:123], a[248:251], v[60:63], v[120:123]
  v_mfma_f32_16x16x32_bf16 v[124:127], a[252:255], v[60:63], v[124:127]
  s_waitcnt lgkmcnt(0)
  v_mfma_f32_16x16x32_bf16 v[128:131], a[0:3], v[32:35], 0
  ds_read_b64_tr_b16 v[48:49], v18 offset:36864
  v_mfma_f32_16x16x32_bf16 v[132:135], a[4:7], v[32:35], 0
  ds_read_b64_tr_b16 v[50:51], v18 offset:37376
  v_mfma_f32_16x16x32_bf16 v[160:163], a[8:11], v[32:35], 0
  ds_read_b64_tr_b16 v[52:53], v19 offset:36864
  v_mfma_f32_16x16x32_bf16 v[164:167], a[12:15], v[32:35], 0
  ds_read_b64_tr_b16 v[54:55], v19 offset:37376
  v_mfma_f32_16x16x32_bf16 v[136:139], a[0:3], v[36:39], 0
  ds_read_b64_tr_b16 v[56:57], v20 offset:36864
  v_mfma_f32_16x16x32_bf16 v[140:143], a[4:7], v[36:39], 0
  ds_read_b64_tr_b16 v[58:59], v20 offset:37376
  v_mfma_f32_16x16x32_bf16 v[168:171], a[8:11], v[36:39], 0
  ds_read_b64_tr_b16 v[60:61], v21 offset:36864
  s_add_u32 m0, s49, 147456
  v_mfma_f32_16x16x32_bf16 v[172:175], a[12:15], v[36:39], 0
  ds_read_b64_tr_b16 v[62:63], v21 offset:37376
  s_mov_b32 s46, 524288
  v_mfma_f32_16x16x32_bf16 v[144:147], a[0:3], v[40:43], 0
  buffer_load_dwordx4 v12, s[24:27], s46 offen lds
  v_mfma_f32_16x16x32_bf16 v[148:151], a[4:7], v[40:43], 0
  v_mfma_f32_16x16x32_bf16 v[176:179], a[8:11], v[40:43], 0
  v_mfma_f32_16x16x32_bf16 v[180:183], a[12:15], v[40:43], 0
  v_mfma_f32_16x16x32_bf16 v[152:155], a[0:3], v[44:47], 0
  v_cvt_pk_bf16_f32 v64, v64, v65
  v_cvt_pk_bf16_f32 v65, v66, v67
  v_mfma_f32_16x16x32_bf16 v[156:159], a[4:7], v[44:47], 0
  v_cvt_pk_bf16_f32 v66, v68, v69
  v_cvt_pk_bf16_f32 v67, v70, v71
  v_mfma_f32_16x16x32_bf16 v[184:187], a[8:11], v[44:47], 0
  s_add_u32 s47, s51, 33554432
  v_mfma_f32_16x16x32_bf16 v[188:191], a[12:15], v[44:47], 0
  s_waitcnt lgkmcnt(0)
  v_mfma_f32_16x16x32_bf16 v[128:131], a[16:19], v[48:51], v[128:131]
  ds_read_b64_tr_b16 v[32:33], v18 offset:40960
  v_mfma_f32_16x16x32_bf16 v[132:135], a[20:23], v[48:51], v[132:135]
  ds_read_b64_tr_b16 v[34:35], v18 offset:41472
  v_mfma_f32_16x16x32_bf16 v[160:163], a[24:27], v[48:51], v[160:163]
  ds_read_b64_tr_b16 v[36:37], v19 offset:40960
  v_mfma_f32_16x16x32_bf16 v[164:167], a[28:31], v[48:51], v[164:167]
  ds_read_b64_tr_b16 v[38:39], v19 offset:41472
  v_mfma_f32_16x16x32_bf16 v[136:139], a[16:19], v[52:55], v[136:139]
  ds_read_b64_tr_b16 v[40:41], v20 offset:40960
  v_mfma_f32_16x16x32_bf16 v[140:143], a[20:23], v[52:55], v[140:143]
  ds_read_b64_tr_b16 v[42:43], v20 offset:41472
  v_mfma_f32_16x16x32_bf16 v[168:171], a[24:27], v[52:55], v[168:171]
  ds_read_b64_tr_b16 v[44:45], v21 offset:40960
  v_mfma_f32_16x16x32_bf16 v[172:175], a[28:31], v[52:55], v[172:175]
  ds_read_b64_tr_b16 v[46:47], v21 offset:41472
  s_add_u32 m0, s49, 151552
  v_mfma_f32_16x16x32_bf16 v[144:147], a[16:19], v[56:59], v[144:147]
  buffer_store_dwordx4 v[64:67], v1, s[20:23], s47 offen offset:0 sc1
  s_mov_b32 s46, 655360
  v_mfma_f32_16x16x32_bf16 v[148:151], a[20:23], v[56:59], v[148:151]
  buffer_load_dwordx4 v12, s[24:27], s46 offen lds
  v_mfma_f32_16x16x32_bf16 v[176:179], a[24:27], v[56:59], v[176:179]
  v_mfma_f32_16x16x32_bf16 v[180:183], a[28:31], v[56:59], v[180:183]
  v_mfma_f32_16x16x32_bf16 v[152:155], a[16:19], v[60:63], v[152:155]
  v_mfma_f32_16x16x32_bf16 v[156:159], a[20:23], v[60:63], v[156:159]
  v_mfma_f32_16x16x32_bf16 v[184:187], a[24:27], v[60:63], v[184:187]
  v_mfma_f32_16x16x32_bf16 v[188:191], a[28:31], v[60:63], v[188:191]
  s_waitcnt lgkmcnt(0)
  v_mfma_f32_16x16x32_bf16 v[128:131], a[32:35], v[32:35], v[128:131]
  ds_read_b64_tr_b16 v[48:49], v18 offset:45056
  v_mfma_f32_16x16x32_bf16 v[132:135], a[36:39], v[32:35], v[132:135]
  ds_read_b64_tr_b16 v[50:51], v18 offset:45568
  v_mfma_f32_16x16x32_bf16 v[160:163], a[40:43], v[32:35], v[160:163]
  ds_read_b64_tr_b16 v[52:53], v19 offset:45056
  v_mfma_f32_16x16x32_bf16 v[164:167], a[44:47], v[32:35], v[164:167]
  ds_read_b64_tr_b16 v[54:55], v19 offset:45568
  v_mfma_f32_16x16x32_bf16 v[136:139], a[32:35], v[36:39], v[136:139]
  ds_read_b64_tr_b16 v[56:57], v20 offset:45056
  v_cvt_pk_bf16_f32 v72, v72, v73
  v_cvt_pk_bf16_f32 v73, v74, v75
  v_mfma_f32_16x16x32_bf16 v[140:143], a[36:39], v[36:39], v[140:143]
  ds_read_b64_tr_b16 v[58:59], v20 offset:45568
  v_cvt_pk_bf16_f32 v74, v76, v77
  v_cvt_pk_bf16_f32 v75, v78, v79
  v_mfma_f32_16x16x32_bf16 v[168:171], a[40:43], v[36:39], v[168:171]
  ds_read_b64_tr_b16 v[60:61], v21 offset:45056
  s_add_u32 s47, s51, 33554432
  v_mfma_f32_16x16x32_bf16 v[172:175], a[44:47], v[36:39], v[172:175]
  ds_read_b64_tr_b16 v[62:63], v21 offset:45568
  s_add_u32 m0, s49, 155648
  v_mfma_f32_16x16x32_bf16 v[144:147], a[32:35], v[40:43], v[144:147]
  buffer_store_dwordx4 v[72:75], v1, s[20:23], s47 offen offset:1024 sc1
  s_mov_b32 s46, 786432
  v_mfma_f32_16x16x32_bf16 v[148:151], a[36:39], v[40:43], v[148:151]
  buffer_load_dwordx4 v12, s[24:27], s46 offen lds
  v_mfma_f32_16x16x32_bf16 v[176:179], a[40:43], v[40:43], v[176:179]
  v_mfma_f32_16x16x32_bf16 v[180:183], a[44:47], v[40:43], v[180:183]
  s_add_u32 m0, s49, 159744
  v_mfma_f32_16x16x32_bf16 v[152:155], a[32:35], v[44:47], v[152:155]
  s_mov_b32 s46, 917504
  v_mfma_f32_16x16x32_bf16 v[156:159], a[36:39], v[44:47], v[156:159]
  buffer_load_dwordx4 v12, s[24:27], s46 offen lds
  v_mfma_f32_16x16x32_bf16 v[184:187], a[40:43], v[44:47], v[184:187]
  v_mfma_f32_16x16x32_bf16 v[188:191], a[44:47], v[44:47], v[188:191]
  s_waitcnt vmcnt(24) lgkmcnt(0)
  v_mfma_f32_16x16x32_bf16 v[128:131], a[48:51], v[48:51], v[128:131]
  s_barrier
  v_mfma_f32_16x16x32_bf16 v[132:135], a[52:55], v[48:51], v[132:135]
  ds_read_b64_tr_b16 v[32:33], v18 offset:49152
  v_mfma_f32_16x16x32_bf16 v[160:163], a[56:59], v[48:51], v[160:163]
  ds_read_b64_tr_b16 v[34:35], v18 offset:49664
  v_mfma_f32_16x16x32_bf16 v[164:167], a[60:63], v[48:51], v[164:167]
  ds_read_b64_tr_b16 v[36:37], v19 offset:49152
  v_mfma_f32_16x16x32_bf16 v[136:139], a[48:51], v[52:55], v[136:139]
  ds_read_b64_tr_b16 v[38:39], v19 offset:49664
  v_mfma_f32_16x16x32_bf16 v[140:143], a[52:55], v[52:55], v[140:143]
  ds_read_b64_tr_b16 v[40:41], v20 offset:49152
  v_mfma_f32_16x16x32_bf16 v[168:171], a[56:59], v[52:55], v[168:171]
  ds_read_b64_tr_b16 v[42:43], v20 offset:49664
  v_mfma_f32_16x16x32_bf16 v[172:175], a[60:63], v[52:55], v[172:175]
  ds_read_b64_tr_b16 v[44:45], v21 offset:49152
  s_add_u32 m0, s49, 98304
  v_mfma_f32_16x16x32_bf16 v[144:147], a[48:51], v[56:59], v[144:147]
  ds_read_b64_tr_b16 v[46:47], v21 offset:49664
  s_mov_b32 s46, 1048576
  v_mfma_f32_16x16x32_bf16 v[148:151], a[52:55], v[56:59], v[148:151]
  buffer_load_dwordx4 v12, s[24:27], s46 offen lds
  v_mfma_f32_16x16x32_bf16 v[176:179], a[56:59], v[56:59], v[176:179]
  v_mfma_f32_16x16x32_bf16 v[180:183], a[60:63], v[56:59], v[180:183]
  v_mfma_f32_16x16x32_bf16 v[152:155], a[48:51], v[60:63], v[152:155]
  v_cvt_pk_bf16_f32 v80, v80, v81
  v_cvt_pk_bf16_f32 v81, v82, v83
  v_mfma_f32_16x16x32_bf16 v[156:159], a[52:55], v[60:63], v[156:159]
  v_cvt_pk_bf16_f32 v82, v84, v85
  v_cvt_pk_bf16_f32 v83, v86, v87
  v_mfma_f32_16x16x32_bf16 v[184:187], a[56:59], v[60:63], v[184:187]
  s_add_u32 s47, s51, 33558528
  v_mfma_f32_16x16x32_bf16 v[188:191], a[60:63], v[60:63], v[188:191]
  s_waitcnt lgkmcnt(0)
  v_mfma_f32_16x16x32_bf16 v[128:131], a[64:67], v[32:35], v[128:131]
  ds_read_b64_tr_b16 v[48:49], v18 offset:53248
  v_mfma_f32_16x16x32_bf16 v[132:135], a[68:71], v[32:35], v[132:135]
  ds_read_b64_tr_b16 v[50:51], v18 offset:53760
  v_mfma_f32_16x16x32_bf16 v[160:163], a[72:75], v[32:35], v[160:163]
  ds_read_b64_tr_b16 v[52:53], v19 offset:53248
  v_mfma_f32_16x16x32_bf16 v[164:167], a[76:79], v[32:35], v[164:167]
  ds_read_b64_tr_b16 v[54:55], v19 offset:53760
  v_mfma_f32_16x16x32_bf16 v[136:139], a[64:67], v[36:39], v[136:139]
  ds_read_b64_tr_b16 v[56:57], v20 offset:53248
  v_mfma_f32_16x16x32_bf16 v[140:143], a[68:71], v[36:39], v[140:143]
  ds_read_b64_tr_b16 v[58:59], v20 offset:53760
  v_mfma_f32_16x16x32_bf16 v[168:171], a[72:75], v[36:39], v[168:171]
  ds_read_b64_tr_b16 v[60:61], v21 offset:53248
  v_mfma_f32_16x16x32_bf16 v[172:175], a[76:79], v[36:39], v[172:175]
  ds_read_b64_tr_b16 v[62:63], v21 offset:53760
  s_add_u32 m0, s49, 102400
  v_mfma_f32_16x16x32_bf16 v[144:147], a[64:67], v[40:43], v[144:147]
  buffer_store_dwordx4 v[80:83], v1, s[20:23], s47 offen offset:0 sc1
  s_mov_b32 s46, 1179648
  v_mfma_f32_16x16x32_bf16 v[148:151], a[68:71], v[40:43], v[148:151]
  buffer_load_dwordx4 v12, s[24:27], s46 offen lds
  v_mfma_f32_16x16x32_bf16 v[176:179], a[72:75], v[40:43], v[176:179]
  buffer_load_dword v22, v15, s[20:23], s54 offen sc1
  v_mfma_f32_16x16x32_bf16 v[180:183], a[76:79], v[40:43], v[180:183]
  v_mfma_f32_16x16x32_bf16 v[152:155], a[64:67], v[44:47], v[152:155]
  v_mfma_f32_16x16x32_bf16 v[156:159], a[68:71], v[44:47], v[156:159]
  v_mfma_f32_16x16x32_bf16 v[184:187], a[72:75], v[44:47], v[184:187]
  v_mfma_f32_16x16x32_bf16 v[188:191], a[76:79], v[44:47], v[188:191]
  s_waitcnt lgkmcnt(0)
  v_mfma_f32_16x16x32_bf16 v[128:131], a[80:83], v[48:51], v[128:131]
  ds_read_b64_tr_b16 v[32:33], v18 offset:57344
  v_mfma_f32_16x16x32_bf16 v[132:135], a[84:87], v[48:51], v[132:135]
  ds_read_b64_tr_b16 v[34:35], v18 offset:57856
  v_mfma_f32_16x16x32_bf16 v[160:163], a[88:91], v[48:51], v[160:163]
  ds_read_b64_tr_b16 v[36:37], v19 offset:57344
  v_mfma_f32_16x16x32_bf16 v[164:167], a[92:95], v[48:51], v[164:167]
  ds_read_b64_tr_b16 v[38:39], v19 offset:57856
  v_mfma_f32_16x16x32_bf16 v[136:139], a[80:83], v[52:55], v[136:139]
  ds_read_b64_tr_b16 v[40:41], v20 offset:57344
  v_cvt_pk_bf16_f32 v88, v88, v89
  v_cvt_pk_bf16_f32 v89, v90, v91
  v_mfma_f32_16x16x32_bf16 v[140:143], a[84:87], v[52:55], v[140:143]
  ds_read_b64_tr_b16 v[42:43], v20 offset:57856
  v_cvt_pk_bf16_f32 v90, v92, v93
  v_cvt_pk_bf16_f32 v91, v94, v95
  v_mfma_f32_16x16x32_bf16 v[168:171], a[88:91], v[52:55], v[168:171]
  ds_read_b64_tr_b16 v[44:45], v21 offset:57344
  s_add_u32 s47, s51, 33558528
  v_mfma_f32_16x16x32_bf16 v[172:175], a[92:95], v[52:55], v[172:175]
  ds_read_b64_tr_b16 v[46:47], v21 offset:57856
  s_add_u32 m0, s49, 106496
  v_mfma_f32_16x16x32_bf16 v[144:147], a[80:83], v[56:59], v[144:147]
  buffer_store_dwordx4 v[88:91], v1, s[20:23], s47 offen offset:1024 sc1
  s_mov_b32 s46, 1310720
  v_mfma_f32_16x16x32_bf16 v[148:151], a[84:87], v[56:59], v[148:151]
  buffer_load_dwordx4 v12, s[24:27], s46 offen lds
  v_mfma_f32_16x16x32_bf16 v[176:179], a[88:91], v[56:59], v[176:179]
  v_mfma_f32_16x16x32_bf16 v[180:183], a[92:95], v[56:59], v[180:183]
  s_add_u32 m0, s49, 110592
  v_mfma_f32_16x16x32_bf16 v[152:155], a[80:83], v[60:63], v[152:155]
  s_mov_b32 s46, 1441792
  v_mfma_f32_16x16x32_bf16 v[156:159], a[84:87], v[60:63], v[156:159]
  buffer_load_dwordx4 v12, s[24:27], s46 offen lds
  v_mfma_f32_16x16x32_bf16 v[184:187], a[88:91], v[60:63], v[184:187]
  v_mfma_f32_16x16x32_bf16 v[188:191], a[92:95], v[60:63], v[188:191]
  s_waitcnt lgkmcnt(0)
  v_mfma_f32_16x16x32_bf16 v[128:131], a[96:99], v[32:35], v[128:131]
  ds_read_b64_tr_b16 v[48:49], v18 offset:61440
  v_mfma_f32_16x16x32_bf16 v[132:135], a[100:103], v[32:35], v[132:135]
  ds_read_b64_tr_b16 v[50:51], v18 offset:61952
  v_mfma_f32_16x16x32_bf16 v[160:163], a[104:107], v[32:35], v[160:163]
  ds_read_b64_tr_b16 v[52:53], v19 offset:61440
  v_mfma_f32_16x16x32_bf16 v[164:167], a[108:111], v[32:35], v[164:167]
  ds_read_b64_tr_b16 v[54:55], v19 offset:61952
  v_mfma_f32_16x16x32_bf16 v[136:139], a[96:99], v[36:39], v[136:139]
  ds_read_b64_tr_b16 v[56:57], v20 offset:61440
  v_mfma_f32_16x16x32_bf16 v[140:143], a[100:103], v[36:39], v[140:143]
  ds_read_b64_tr_b16 v[58:59], v20 offset:61952
  v_mfma_f32_16x16x32_bf16 v[168:171], a[104:107], v[36:39], v[168:171]
  ds_read_b64_tr_b16 v[60:61], v21 offset:61440
  s_add_u32 m0, s49, 114688
  v_mfma_f32_16x16x32_bf16 v[172:175], a[108:111], v[36:39], v[172:175]
  ds_read_b64_tr_b16 v[62:63], v21 offset:61952
  s_mov_b32 s46, 1572864
  v_mfma_f32_16x16x32_bf16 v[144:147], a[96:99], v[40:43], v[144:147]
  buffer_load_dwordx4 v12, s[24:27], s46 offen lds
  v_mfma_f32_16x16x32_bf16 v[148:151], a[100:103], v[40:43], v[148:151]
  v_mfma_f32_16x16x32_bf16 v[176:179], a[104:107], v[40:43], v[176:179]
  v_mfma_f32_16x16x32_bf16 v[180:183], a[108:111], v[40:43], v[180:183]
  v_mfma_f32_16x16x32_bf16 v[152:155], a[96:99], v[44:47], v[152:155]
  v_cvt_pk_bf16_f32 v96, v96, v97
  v_cvt_pk_bf16_f32 v97, v98, v99
  v_mfma_f32_16x16x32_bf16 v[156:159], a[100:103], v[44:47], v[156:159]
  v_cvt_pk_bf16_f32 v98, v100, v101
  v_cvt_pk_bf16_f32 v99, v102, v103
  v_mfma_f32_16x16x32_bf16 v[184:187], a[104:107], v[44:47], v[184:187]
  s_add_u32 s47, s51, 33562624
  v_mfma_f32_16x16x32_bf16 v[188:191], a[108:111], v[44:47], v[188:191]
  s_waitcnt vmcnt(27) lgkmcnt(0)
  v_mfma_f32_16x16x32_bf16 v[128:131], a[112:115], v[48:51], v[128:131]
  s_barrier
  v_mfma_f32_16x16x32_bf16 v[132:135], a[116:119], v[48:51], v[132:135]
  ds_read_b64_tr_b16 v[32:33], v18 offset:0
  v_mfma_f32_16x16x32_bf16 v[160:163], a[120:123], v[48:51], v[160:163]
  ds_read_b64_tr_b16 v[34:35], v18 offset:512
  v_mfma_f32_16x16x32_bf16 v[164:167], a[124:127], v[48:51], v[164:167]
  ds_read_b64_tr_b16 v[36:37], v19 offset:0
  v_mfma_f32_16x16x32_bf16 v[136:139], a[112:115], v[52:55], v[136:139]
  ds_read_b64_tr_b16 v[38:39], v19 offset:512
  v_mfma_f32_16x16x32_bf16 v[140:143], a[116:119], v[52:55], v[140:143]
  ds_read_b64_tr_b16 v[40:41], v20 offset:0
  v_mfma_f32_16x16x32_bf16 v[168:171], a[120:123], v[52:55], v[168:171]
  ds_read_b64_tr_b16 v[42:43], v20 offset:512
  v_mfma_f32_16x16x32_bf16 v[172:175], a[124:127], v[52:55], v[172:175]
  ds_read_b64_tr_b16 v[44:45], v21 offset:0
  v_mfma_f32_16x16x32_bf16 v[144:147], a[112:115], v[56:59], v[144:147]
  ds_read_b64_tr_b16 v[46:47], v21 offset:512
  s_add_u32 m0, s49, 118784
  v_mfma_f32_16x16x32_bf16 v[148:151], a[116:119], v[56:59], v[148:151]
  buffer_store_dwordx4 v[96:99], v1, s[20:23], s47 offen offset:2048 sc1
  s_mov_b32 s46, 1703936
  v_mfma_f32_16x16x32_bf16 v[176:179], a[120:123], v[56:59], v[176:179]
  buffer_load_dwordx4 v12, s[24:27], s46 offen lds
  v_mfma_f32_16x16x32_bf16 v[180:183], a[124:127], v[56:59], v[180:183]
  s_waitcnt vmcnt(6)
  v_cmp_ne_u32 vcc, v25, v22
  v_mfma_f32_16x16x32_bf16 v[152:155], a[112:115], v[60:63], v[152:155]
  s_cbranch_vccnz KA_HSPIN
KA_HSPIN_RET:
  v_mfma_f32_16x16x32_bf16 v[156:159], a[116:119], v[60:63], v[156:159]
  s_mov_b32 s53, 0
  v_mfma_f32_16x16x32_bf16 v[184:187], a[120:123], v[60:63], v[184:187]
  buffer_load_dwordx4 a[0:3], v13, s[20:23], s53 offen offset:0 sc1
  v_mfma_f32_16x16x32_bf16 v[188:191], a[124:127], v[60:63], v[188:191]
  s_waitcnt lgkmcnt(0)
  v_mfma_f32_16x16x32_bf16 v[128:131], a[128:131], v[32:35], v[128:131]
  ds_read_b64_tr_b16 v[48:49], v18 offset:4096
  v_mfma_f32_16x16x32_bf16 v[132:135], a[132:135], v[32:35], v[132:135]
  ds_read_b64_tr_b16 v[50:51], v18 offset:4608
  v_mfma_f32_16x16x32_bf16 v[160:163], a[136:139], v[32:35], v[160:163]
  ds_read_b64_tr_b16 v[52:53], v19 offset:4096
  v_mfma_f32_16x16x32_bf16 v[164:167], a[140:143], v[32:35], v[164:167]
  ds_read_b64_tr_b16 v[54:55], v19 offset:4608
  v_mfma_f32_16x16x32_bf16 v[136:139], a[128:131], v[36:39], v[136:139]
  ds_read_b64_tr_b16 v[56:57], v20 offset:4096
  v_cvt_pk_bf16_f32 v104, v104, v105
  v_cvt_pk_bf16_f32 v105, v106, v107
  v_mfma_f32_16x16x32_bf16 v[140:143], a[132:135], v[36:39], v[140:143]
  ds_read_b64_tr_b16 v[58:59], v20 offset:4608
  v_cvt_pk_bf16_f32 v106, v108, v109
  v_cvt_pk_bf16_f32 v107, v110, v111
  v_mfma_f32_16x16x32_bf16 v[168:171], a[136:139], v[36:39], v[168:171]
  ds_read_b64_tr_b16 v[60:61], v21 offset:4096
  s_add_u32 s47, s51, 33562624
  v_mfma_f32_16x16x32_bf16 v[172:175], a[140:143], v[36:39], v[172:175]
  ds_read_b64_tr_b16 v[62:63], v21 offset:4608
  s_add_u32 m0, s49, 122880
  v_mfma_f32_16x16x32_bf16 v[144:147], a[128:131], v[40:43], v[144:147]
  buffer_store_dwordx4 v[104:107], v1, s[20:23], s47 offen offset:3072 sc1
  s_mov_b32 s46, 1835008
  v_mfma_f32_16x16x32_bf16 v[148:151], a[132:135], v[40:43], v[148:151]
  buffer_load_dwordx4 v12, s[24:27], s46 offen lds
  v_mfma_f32_16x16x32_bf16 v[176:179], a[136:139], v[40:43], v[176:179]
  buffer_load_dwordx4 a[4:7], v13, s[20:23], s53 offen offset:1024 sc1
  v_mfma_f32_16x16x32_bf16 v[180:183], a[140:143], v[40:43], v[180:183]
  s_add_u32 m0, s49, 126976
  v_mfma_f32_16x16x32_bf16 v[152:155], a[128:131], v[44:47], v[152:155]
  s_mov_b32 s46, 1966080
  v_mfma_f32_16x16x32_bf16 v[156:159], a[132:135], v[44:47], v[156:159]
  buffer_load_dwordx4 v12, s[24:27], s46 offen lds
  v_mfma_f32_16x16x32_bf16 v[184:187], a[136:139], v[44:47], v[184:187]
  buffer_load_dwordx4 a[8:11], v14, s[20:23], s53 offen offset:0 sc1
  v_mfma_f32_16x16x32_bf16 v[188:191], a[140:143], v[44:47], v[188:191]
  s_waitcnt lgkmcnt(0)
  v_mfma_f32_16x16x32_bf16 v[128:131], a[144:147], v[48:51], v[128:131]
  ds_read_b64_tr_b16 v[32:33], v18 offset:8192
  v_mfma_f32_16x16x32_bf16 v[132:135], a[148:151], v[48:51], v[132:135]
  ds_read_b64_tr_b16 v[34:35], v18 offset:8704
  v_mfma_f32_16x16x32_bf16 v[160:163], a[152:155], v[48:51], v[160:163]
  ds_read_b64_tr_b16 v[36:37], v19 offset:8192
  v_mfma_f32_16x16x32_bf16 v[164:167], a[156:159], v[48:51], v[164:167]
  ds_read_b64_tr_b16 v[38:39], v19 offset:8704
  v_mfma_f32_16x16x32_bf16 v[136:139], a[144:147], v[52:55], v[136:139]
  ds_read_b64_tr_b16 v[40:41], v20 offset:8192
  v_mfma_f32_16x16x32_bf16 v[140:143], a[148:151], v[52:55], v[140:143]
  ds_read_b64_tr_b16 v[42:43], v20 offset:8704
  v_mfma_f32_16x16x32_bf16 v[168:171], a[152:155], v[52:55], v[168:171]
  ds_read_b64_tr_b16 v[44:45], v21 offset:8192
  s_add_u32 m0, s49, 65536
  v_mfma_f32_16x16x32_bf16 v[172:175], a[156:159], v[52:55], v[172:175]
  ds_read_b64_tr_b16 v[46:47], v21 offset:8704
  s_mov_b32 s46, 2097152
  v_mfma_f32_16x16x32_bf16 v[144:147], a[144:147], v[56:59], v[144:147]
  buffer_load_dwordx4 v12, s[24:27], s46 offen lds
  v_mfma_f32_16x16x32_bf16 v[148:151], a[148:151], v[56:59], v[148:151]
  buffer_load_dwordx4 a[12:15], v14, s[20:23], s53 offen offset:1024 sc1
  v_mfma_f32_16x16x32_bf16 v[176:179], a[152:155], v[56:59], v[176:179]
  v_mfma_f32_16x16x32_bf16 v[180:183], a[156:159], v[56:59], v[180:183]
  v_mfma_f32_16x16x32_bf16 v[152:155], a[144:147], v[60:63], v[152:155]
  v_cvt_pk_bf16_f32 v112, v112, v113
  v_cvt_pk_bf16_f32 v113, v114, v115
  v_mfma_f32_16x16x32_bf16 v[156:159], a[148:151], v[60:63], v[156:159]
  v_cvt_pk_bf16_f32 v114, v116, v117
  v_cvt_pk_bf16_f32 v115, v118, v119
  v_mfma_f32_16x16x32_bf16 v[184:187], a[152:155], v[60:63], v[184:187]
  s_add_u32 s47, s51, 33566720
  v_mfma_f32_16x16x32_bf16 v[188:191], a[156:159], v[60:63], v[188:191]
  s_waitcnt lgkmcnt(0)
  v_mfma_f32_16x16x32_bf16 v[128:131], a[160:163], v[32:35], v[128:131]
  ds_read_b64_tr_b16 v[48:49], v18 offset:12288
  v_mfma_f32_16x16x32_bf16 v[132:135], a[164:167], v[32:35], v[132:135]
  ds_read_b64_tr_b16 v[50:51], v18 offset:12800
  v_mfma_f32_16x16x32_bf16 v[160:163], a[168:171], v[32:35], v[160:163]
  ds_read_b64_tr_b16 v[52:53], v19 offset:12288
  v_mfma_f32_16x16x32_bf16 v[164:167], a[172:175], v[32:35], v[164:167]
  ds_read_b64_tr_b16 v[54:55], v19 offset:12800
  v_mfma_f32_16x16x32_bf16 v[136:139], a[160:163], v[36:39], v[136:139]
  ds_read_b64_tr_b16 v[56:57], v20 offset:12288
  v_mfma_f32_16x16x32_bf16 v[140:143], a[164:167], v[36:39], v[140:143]
  ds_read_b64_tr_b16 v[58:59], v20 offset:12800
  v_mfma_f32_16x16x32_bf16 v[168:171], a[168:171], v[36:39], v[168:171]
  ds_read_b64_tr_b16 v[60:61], v21 offset:12288
  v_mfma_f32_16x16x32_bf16 v[172:175], a[172:175], v[36:39], v[172:175]
  ds_read_b64_tr_b16 v[62:63], v21 offset:12800
  s_add_u32 m0, s49, 69632
  v_mfma_f32_16x16x32_bf16 v[144:147], a[160:163], v[40:43], v[144:147]
  buffer_store_dwordx4 v[112:115], v1, s[20:23], s47 offen offset:2048 sc1
  s_mov_b32 s46, 2228224
  v_mfma_f32_16x16x32_bf16 v[148:151], a[164:167], v[40:43], v[148:151]
  buffer_load_dwordx4 v12, s[24:27], s46 offen lds
  v_mfma_f32_16x16x32_bf16 v[176:179], a[168:171], v[40:43], v[176:179]
  buffer_load_dwordx4 a[16:19], v13, s[20:23], s53 offen offset:2048 sc1
  v_mfma_f32_16x16x32_bf16 v[180:183], a[172:175], v[40:43], v[180:183]
  v_mfma_f32_16x16x32_bf16 v[152:155], a[160:163], v[44:47], v[152:155]
  v_lshrrev_b32 v24, 4, v2
  v_mul_lo_u32 v29, v24, s11
  v_mfma_f32_16x16x32_bf16 v[156:159], a[164:167], v[44:47], v[156:159]
  buffer_load_dwordx4 a[20:23], v13, s[20:23], s53 offen offset:3072 sc1
  v_and_b32 v23, 15, v2
  v_mfma_f32_16x16x32_bf16 v[184:187], a[168:171], v[44:47], v[184:187]
  v_lshlrev_b32 v16, 1, v24
  v_xor_b32 v23, v23, v16
  v_mfma_f32_16x16x32_bf16 v[188:191], a[172:175], v[44:47], v[188:191]
  s_waitcnt lgkmcnt(0)
  v_lshl_add_u32 v29, v23, 4, v29
  v_xor_b32 v17, 0x80, v29
  v_mfma_f32_16x16x32_bf16 v[128:131], a[176:179], v[48:51], v[128:131]
  s_barrier
  s_lshl_b32 s11, s11, 2
  v_bfe_u32 v23, v2, 2, 2
  v_mfma_f32_16x16x32_bf16 v[132:135], a[180:183], v[48:51], v[132:135]
  ds_read_b64_tr_b16 v[32:33], v18 offset:16384
  v_lshl_add_u32 v23, v24, 2, v23
  v_and_b32 v16, 7, v23
  v_mfma_f32_16x16x32_bf16 v[160:163], a[184:187], v[48:51], v[160:163]
  ds_read_b64_tr_b16 v[34:35], v18 offset:16896
  v_lshlrev_b32 v23, 8, v23
  v_lshl_add_u32 v23, v16, 5, v23
  v_mfma_f32_16x16x32_bf16 v[164:167], a[188:191], v[48:51], v[164:167]
  ds_read_b64_tr_b16 v[36:37], v19 offset:16384
  v_and_b32 v24, 3, v2
  v_lshl_add_u32 v23, v24, 3, v23
  v_mfma_f32_16x16x32_bf16 v[136:139], a[176:179], v[52:55], v[136:139]
  ds_read_b64_tr_b16 v[38:39], v19 offset:16896
  v_cvt_pk_bf16_f32 v120, v120, v121
  v_cvt_pk_bf16_f32 v121, v122, v123
  v_mfma_f32_16x16x32_bf16 v[140:143], a[180:183], v[52:55], v[140:143]
  ds_read_b64_tr_b16 v[40:41], v20 offset:16384
  v_cvt_pk_bf16_f32 v122, v124, v125
  v_cvt_pk_bf16_f32 v123, v126, v127
  v_mfma_f32_16x16x32_bf16 v[168:171], a[184:187], v[52:55], v[168:171]
  ds_read_b64_tr_b16 v[42:43], v20 offset:16896
  s_add_u32 s47, s51, 33566720
  v_add_u32 v23, s35, v23
  v_mfma_f32_16x16x32_bf16 v[172:175], a[188:191], v[52:55], v[172:175]
  ds_read_b64_tr_b16 v[44:45], v21 offset:16384
  v_lshrrev_b32 v24, 5, v2
  v_mfma_f32_16x16x32_bf16 v[144:147], a[176:179], v[56:59], v[144:147]
  ds_read_b64_tr_b16 v[46:47], v21 offset:16896
  s_add_u32 m0, s49, 73728
  v_mfma_f32_16x16x32_bf16 v[148:151], a[180:183], v[56:59], v[148:151]
  buffer_store_dwordx4 v[120:123], v1, s[20:23], s47 offen offset:3072 sc1
  s_mov_b32 s46, 2359296
  v_mfma_f32_16x16x32_bf16 v[176:179], a[184:187], v[56:59], v[176:179]
  buffer_load_dwordx4 v12, s[24:27], s46 offen lds
  v_mfma_f32_16x16x32_bf16 v[180:183], a[188:191], v[56:59], v[180:183]
  buffer_load_dwordx4 a[24:27], v14, s[20:23], s53 offen offset:2048 sc1
  v_mfma_f32_16x16x32_bf16 v[152:155], a[176:179], v[60:63], v[152:155]
  s_add_u32 m0, s49, 77824
  v_mfma_f32_16x16x32_bf16 v[156:159], a[180:183], v[60:63], v[156:159]
  s_mov_b32 s46, 2490368
  v_mfma_f32_16x16x32_bf16 v[184:187], a[184:187], v[60:63], v[184:187]
  buffer_load_dwordx4 v12, s[24:27], s46 offen lds
  v_mfma_f32_16x16x32_bf16 v[188:191], a[188:191], v[60:63], v[188:191]
  s_waitcnt lgkmcnt(0)
  s_cmp_lt_u32 s2, 128
  s_cselect_b32 s52, 0, 0
  v_mfma_f32_16x16x32_bf16 v[128:131], a[192:195], v[32:35], v[128:131]
  ds_read_b64_tr_b16 v[48:49], v18 offset:20480
  v_mul_u32_u24 v24, s52, v24
  v_add_u32 v26, v23, v24
  v_mfma_f32_16x16x32_bf16 v[132:135], a[196:199], v[32:35], v[132:135]
  ds_read_b64_tr_b16 v[50:51], v18 offset:20992
  s_sub_u32 s52, 4096, s52
  v_add_u32 v3, s52, v26
  v_mfma_f32_16x16x32_bf16 v[160:163], a[200:203], v[32:35], v[160:163]
  ds_read_b64_tr_b16 v[52:53], v19 offset:20480
  v_mfma_f32_16x16x32_bf16 v[164:167], a[204:207], v[32:35], v[164:167]
  ds_read_b64_tr_b16 v[54:55], v19 offset:20992
  v_mfma_f32_16x16x32_bf16 v[136:139], a[192:195], v[36:39], v[136:139]
  ds_read_b64_tr_b16 v[56:57], v20 offset:20480
  v_mfma_f32_16x16x32_bf16 v[140:143], a[196:199], v[36:39], v[140:143]
  ds_read_b64_tr_b16 v[58:59], v20 offset:20992
  v_mfma_f32_16x16x32_bf16 v[168:171], a[200:203], v[36:39], v[168:171]
  ds_read_b64_tr_b16 v[60:61], v21 offset:20480
  s_add_u32 m0, s49, 81920
  v_mfma_f32_16x16x32_bf16 v[172:175], a[204:207], v[36:39], v[172:175]
  ds_read_b64_tr_b16 v[62:63], v21 offset:20992
  s_mov_b32 s46, 2621440
  v_mfma_f32_16x16x32_bf16 v[144:147], a[192:195], v[40:43], v[144:147]
  buffer_load_dwordx4 v12, s[24:27], s46 offen lds
  v_mfma_f32_16x16x32_bf16 v[148:151], a[196:199], v[40:43], v[148:151]
  buffer_load_dwordx4 a[28:31], v14, s[20:23], s53 offen offset:3072 sc1
  v_mfma_f32_16x16x32_bf16 v[176:179], a[200:203], v[40:43], v[176:179]
  s_add_u32 m0, s49, 86016
  v_mfma_f32_16x16x32_bf16 v[180:183], a[204:207], v[40:43], v[180:183]
  s_mov_b32 s46, 2752512
  v_mfma_f32_16x16x32_bf16 v[152:155], a[192:195], v[44:47], v[152:155]
  buffer_load_dwordx4 v12, s[24:27], s46 offen lds
  s_mov_b32 s53, 4096
  v_mfma_f32_16x16x32_bf16 v[156:159], a[196:199], v[44:47], v[156:159]
  buffer_load_dwordx4 a[32:35], v13, s[20:23], s53 offen offset:0 sc1
  v_mfma_f32_16x16x32_bf16 v[184:187], a[200:203], v[44:47], v[184:187]
  v_mfma_f32_16x16x32_bf16 v[188:191], a[204:207], v[44:47], v[188:191]
  s_waitcnt lgkmcnt(0)
  v_mfma_f32_16x16x32_bf16 v[128:131], a[208:211], v[48:51], v[128:131]
  ds_read_b64_tr_b16 v[32:33], v18 offset:24576
  v_mfma_f32_16x16x32_bf16 v[132:135], a[212:215], v[48:51], v[132:135]
  ds_read_b64_tr_b16 v[34:35], v18 offset:25088
  v_mfma_f32_16x16x32_bf16 v[160:163], a[216:219], v[48:51], v[160:163]
  ds_read_b64_tr_b16 v[36:37], v19 offset:24576
  v_mfma_f32_16x16x32_bf16 v[164:167], a[220:223], v[48:51], v[164:167]
  ds_read_b64_tr_b16 v[38:39], v19 offset:25088
  v_mfma_f32_16x16x32_bf16 v[136:139], a[208:211], v[52:55], v[136:139]
  ds_read_b64_tr_b16 v[40:41], v20 offset:24576
  v_mfma_f32_16x16x32_bf16 v[140:143], a[212:215], v[52:55], v[140:143]
  ds_read_b64_tr_b16 v[42:43], v20 offset:25088
  v_mfma_f32_16x16x32_bf16 v[168:171], a[216:219], v[52:55], v[168:171]
  ds_read_b64_tr_b16 v[44:45], v21 offset:24576
  s_add_u32 m0, s49, 90112
  v_mfma_f32_16x16x32_bf16 v[172:175], a[220:223], v[52:55], v[172:175]
  ds_read_b64_tr_b16 v[46:47], v21 offset:25088
  s_mov_b32 s46, 2883584
  v_mfma_f32_16x16x32_bf16 v[144:147], a[208:211], v[56:59], v[144:147]
  buffer_load_dwordx4 v12, s[24:27], s46 offen lds
  v_mfma_f32_16x16x32_bf16 v[148:151], a[212:215], v[56:59], v[148:151]
  buffer_load_dwordx4 a[36:39], v13, s[20:23], s53 offen offset:1024 sc1
  v_mfma_f32_16x16x32_bf16 v[176:179], a[216:219], v[56:59], v[176:179]
  s_add_u32 m0, s49, 94208
  v_mfma_f32_16x16x32_bf16 v[180:183], a[220:223], v[56:59], v[180:183]
  s_mov_b32 s46, 3014656
  v_mfma_f32_16x16x32_bf16 v[152:155], a[208:211], v[60:63], v[152:155]
  buffer_load_dwordx4 v12, s[24:27], s46 offen lds
  v_mfma_f32_16x16x32_bf16 v[156:159], a[212:215], v[60:63], v[156:159]
  buffer_load_dwordx4 a[40:43], v14, s[20:23], s53 offen offset:0 sc1
  v_mfma_f32_16x16x32_bf16 v[184:187], a[216:219], v[60:63], v[184:187]
  v_mfma_f32_16x16x32_bf16 v[188:191], a[220:223], v[60:63], v[188:191]
  s_waitcnt lgkmcnt(0)
  v_mfma_f32_16x16x32_bf16 v[128:131], a[224:227], v[32:35], v[128:131]
  ds_read_b64_tr_b16 v[48:49], v18 offset:28672
  v_mfma_f32_16x16x32_bf16 v[132:135], a[228:231], v[32:35], v[132:135]
  ds_read_b64_tr_b16 v[50:51], v18 offset:29184
  v_mfma_f32_16x16x32_bf16 v[160:163], a[232:235], v[32:35], v[160:163]
  ds_read_b64_tr_b16 v[52:53], v19 offset:28672
  v_mfma_f32_16x16x32_bf16 v[164:167], a[236:239], v[32:35], v[164:167]
  ds_read_b64_tr_b16 v[54:55], v19 offset:29184
  v_mfma_f32_16x16x32_bf16 v[136:139], a[224:227], v[36:39], v[136:139]
  ds_read_b64_tr_b16 v[56:57], v20 offset:28672
  v_mfma_f32_16x16x32_bf16 v[140:143], a[228:231], v[36:39], v[140:143]
  ds_read_b64_tr_b16 v[58:59], v20 offset:29184
  v_mfma_f32_16x16x32_bf16 v[168:171], a[232:235], v[36:39], v[168:171]
  ds_read_b64_tr_b16 v[60:61], v21 offset:28672
  s_add_u32 m0, s49, 32768
  v_mfma_f32_16x16x32_bf16 v[172:175], a[236:239], v[36:39], v[172:175]
  ds_read_b64_tr_b16 v[62:63], v21 offset:29184
  s_mov_b32 s46, 3145728
  v_mfma_f32_16x16x32_bf16 v[144:147], a[224:227], v[40:43], v[144:147]
  buffer_load_dwordx4 v12, s[24:27], s46 offen lds
  v_mfma_f32_16x16x32_bf16 v[148:151], a[228:231], v[40:43], v[148:151]
  buffer_load_dwordx4 a[44:47], v14, s[20:23], s53 offen offset:1024 sc1
  v_mfma_f32_16x16x32_bf16 v[176:179], a[232:235], v[40:43], v[176:179]
  s_add_u32 m0, s49, 36864
  v_mfma_f32_16x16x32_bf16 v[180:183], a[236:239], v[40:43], v[180:183]
  s_mov_b32 s46, 3276800
  v_mfma_f32_16x16x32_bf16 v[152:155], a[224:227], v[44:47], v[152:155]
  buffer_load_dwordx4 v12, s[24:27], s46 offen lds
  v_mfma_f32_16x16x32_bf16 v[156:159], a[228:231], v[44:47], v[156:159]
  buffer_load_dwordx4 a[48:51], v13, s[20:23], s53 offen offset:2048 sc1
  v_mfma_f32_16x16x32_bf16 v[184:187], a[232:235], v[44:47], v[184:187]
  v_mfma_f32_16x16x32_bf16 v[188:191], a[236:239], v[44:47], v[188:191]
  s_waitcnt lgkmcnt(0)
  s_nop 0
  v_mfma_f32_16x16x32_bf16 v[128:131], a[240:243], v[48:51], v[128:131]
  s_barrier
  v_mfma_f32_16x16x32_bf16 v[132:135], a[244:247], v[48:51], v[132:135]
  ds_read_b64_tr_b16 v[32:33], v4 offset:0
  v_mfma_f32_16x16x32_bf16 v[160:163], a[248:251], v[48:51], v[160:163]
  ds_read_b64_tr_b16 v[34:35], v4 offset:1024
  v_mfma_f32_16x16x32_bf16 v[164:167], a[252:255], v[48:51], v[164:167]
  buffer_load_dwordx4 a[52:55], v13, s[20:23], s53 offen offset:3072 sc1
  v_mfma_f32_16x16x32_bf16 v[136:139], a[240:243], v[52:55], v[136:139]
  ds_read_b64_tr_b16 v[36:37], v5 offset:0
  s_add_u32 m0, s49, 40960
  v_mfma_f32_16x16x32_bf16 v[140:143], a[244:247], v[52:55], v[140:143]
  ds_read_b64_tr_b16 v[38:39], v5 offset:1024
  s_mov_b32 s46, 3407872
  v_mfma_f32_16x16x32_bf16 v[168:171], a[248:251], v[52:55], v[168:171]
  buffer_load_dwordx4 v12, s[24:27], s46 offen lds
  v_mfma_f32_16x16x32_bf16 v[172:175], a[252:255], v[52:55], v[172:175]
  buffer_load_dwordx4 a[56:59], v14, s[20:23], s53 offen offset:2048 sc1
  v_mfma_f32_16x16x32_bf16 v[144:147], a[240:243], v[56:59], v[144:147]
  ds_read_b64_tr_b16 v[40:41], v6 offset:0
  s_add_u32 m0, s49, 45056
  v_mfma_f32_16x16x32_bf16 v[148:151], a[244:247], v[56:59], v[148:151]
  ds_read_b64_tr_b16 v[42:43], v6 offset:1024
  s_mov_b32 s46, 3538944
  v_mfma_f32_16x16x32_bf16 v[176:179], a[248:251], v[56:59], v[176:179]
  buffer_load_dwordx4 v12, s[24:27], s46 offen lds
  v_mfma_f32_16x16x32_bf16 v[180:183], a[252:255], v[56:59], v[180:183]
  buffer_load_dwordx4 a[60:63], v14, s[20:23], s53 offen offset:3072 sc1
  v_mfma_f32_16x16x32_bf16 v[152:155], a[240:243], v[60:63], v[152:155]
  ds_read_b64_tr_b16 v[44:45], v7 offset:0
  v_mfma_f32_16x16x32_bf16 v[156:159], a[244:247], v[60:63], v[156:159]
  ds_read_b64_tr_b16 v[46:47], v7 offset:1024
  s_mov_b32 s53, 8192
  v_mfma_f32_16x16x32_bf16 v[184:187], a[248:251], v[60:63], v[184:187]
  buffer_load_dwordx4 a[64:67], v13, s[20:23], s53 offen offset:0 sc1
  v_mfma_f32_16x16x32_bf16 v[188:191], a[252:255], v[60:63], v[188:191]
  s_waitcnt vmcnt(26) lgkmcnt(4)
  v_mfma_f32_16x16x32_bf16 v[64:67], v[32:35], a[0:3], 0
  ds_read_b64_tr_b16 v[48:49], v8 offset:0
  s_add_u32 m0, s49, 49152
  v_mfma_f32_16x16x32_bf16 v[96:99], v[32:35], a[4:7], 0
  ds_read_b64_tr_b16 v[50:51], v8 offset:1024
  s_mov_b32 s46, 3670016
  v_mfma_f32_16x16x32_bf16 v[192:195], v[32:35], a[8:11], 0
  buffer_load_dwordx4 v12, s[24:27], s46 offen lds
  v_mfma_f32_16x16x32_bf16 v[224:227], v[32:35], a[12:15], 0
  buffer_load_dwordx4 a[68:71], v13, s[20:23], s53 offen offset:1024 sc1
  v_mfma_f32_16x16x32_bf16 v[68:71], v[36:39], a[0:3], 0
  ds_read_b64_tr_b16 v[52:53], v9 offset:0
  s_add_u32 m0, s49, 53248
  v_mfma_f32_16x16x32_bf16 v[100:103], v[36:39], a[4:7], 0
  ds_read_b64_tr_b16 v[54:55], v9 offset:1024
  s_mov_b32 s46, 3801088
  v_mfma_f32_16x16x32_bf16 v[196:199], v[36:39], a[8:11], 0
  buffer_load_dwordx4 v12, s[24:27], s46 offen lds
  v_mfma_f32_16x16x32_bf16 v[228:231], v[36:39], a[12:15], 0
  s_waitcnt lgkmcnt(4)
  v_mfma_f32_16x16x32_bf16 v[72:75], v[40:43], a[0:3], 0
  ds_read_b64_tr_b16 v[56:57], v10 offset:0
  v_mfma_f32_16x16x32_bf16 v[104:107], v[40:43], a[4:7], 0
  ds_read_b64_tr_b16 v[58:59], v10 offset:1024
  v_mfma_f32_16x16x32_bf16 v[200:203], v[40:43], a[8:11], 0
  buffer_load_dwordx4 a[72:75], v14, s[20:23], s53 offen offset:0 sc1
  v_mfma_f32_16x16x32_bf16 v[232:235], v[40:43], a[12:15], 0
  v_mfma_f32_16x16x32_bf16 v[76:79], v[44:47], a[0:3], 0
  ds_read_b64_tr_b16 v[60:61], v11 offset:0
  v_cvt_pk_bf16_f32 v128, v128, v129
  v_cvt_pk_bf16_f32 v129, v130, v131
  v_mfma_f32_16x16x32_bf16 v[108:111], v[44:47], a[4:7], 0
  ds_read_b64_tr_b16 v[62:63], v11 offset:1024
  v_cvt_pk_bf16_f32 v130, v132, v133
  v_cvt_pk_bf16_f32 v131, v134, v135
  v_mfma_f32_16x16x32_bf16 v[204:207], v[44:47], a[8:11], 0
  s_add_u32 s47, s51, 33554432
  v_mfma_f32_16x16x32_bf16 v[236:239], v[44:47], a[12:15], 0
  s_waitcnt lgkmcnt(4)
  v_mfma_f32_16x16x32_bf16 v[80:83], v[48:51], a[0:3], 0
  ds_read_b64_tr_b16 v[32:33], v4 offset:8192
  v_mfma_f32_16x16x32_bf16 v[112:115], v[48:51], a[4:7], 0
  ds_read_b64_tr_b16 v[34:35], v4 offset:9216
  s_add_u32 m0, s49, 57344
  v_mfma_f32_16x16x32_bf16 v[208:211], v[48:51], a[8:11], 0
  buffer_store_dwordx4 v[128:131], v1, s[20:23], s47 offen offset:2048 sc1
  s_mov_b32 s46, 3932160
  v_mfma_f32_16x16x32_bf16 v[240:243], v[48:51], a[12:15], 0
  buffer_load_dwordx4 v12, s[24:27], s46 offen lds
  v_mfma_f32_16x16x32_bf16 v[84:87], v[52:55], a[0:3], 0
  ds_read_b64_tr_b16 v[36:37], v5 offset:8192
  v_mfma_f32_16x16x32_bf16 v[116:119], v[52:55], a[4:7], 0
  ds_read_b64_tr_b16 v[38:39], v5 offset:9216
  v_mfma_f32_16x16x32_bf16 v[212:215], v[52:55], a[8:11], 0
  buffer_load_dwordx4 a[76:79], v14, s[20:23], s53 offen offset:1024 sc1
  v_mfma_f32_16x16x32_bf16 v[244:247], v[52:55], a[12:15], 0
  s_waitcnt lgkmcnt(4)
  v_mfma_f32_16x16x32_bf16 v[88:91], v[56:59], a[0:3], 0
  ds_read_b64_tr_b16 v[40:41], v6 offset:8192
  s_add_u32 m0, s49, 61440
  v_mfma_f32_16x16x32_bf16 v[120:123], v[56:59], a[4:7], 0
  ds_read_b64_tr_b16 v[42:43], v6 offset:9216
  s_mov_b32 s46, 4063232
  v_mfma_f32_16x16x32_bf16 v[216:219], v[56:59], a[8:11], 0
  buffer_load_dwordx4 v12, s[24:27], s46 offen lds
  v_mfma_f32_16x16x32_bf16 v[248:251], v[56:59], a[12:15], 0
  buffer_load_dwordx4 a[80:83], v13, s[20:23], s53 offen offset:2048 sc1
  v_mfma_f32_16x16x32_bf16 v[92:95], v[60:63], a[0:3], 0
  ds_read_b64_tr_b16 v[44:45], v7 offset:8192
  v_cvt_pk_bf16_f32 v136, v136, v137
  v_cvt_pk_bf16_f32 v137, v138, v139
  v_mfma_f32_16x16x32_bf16 v[124:127], v[60:63], a[4:7], 0
  ds_read_b64_tr_b16 v[46:47], v7 offset:9216
  v_cvt_pk_bf16_f32 v138, v140, v141
  v_cvt_pk_bf16_f32 v139, v142, v143
  v_mfma_f32_16x16x32_bf16 v[220:223], v[60:63], a[8:11], 0
  s_add_u32 s47, s51, 33554432
  v_mfma_f32_16x16x32_bf16 v[252:255], v[60:63], a[12:15], 0
  s_waitcnt vmcnt(25) lgkmcnt(4)
  v_mfma_f32_16x16x32_bf16 v[64:67], v[32:35], a[16:19], v[64:67]
  ds_read_b64_tr_b16 v[48:49], v8 offset:8192
  v_mfma_f32_16x16x32_bf16 v[96:99], v[32:35], a[20:23], v[96:99]
  ds_read_b64_tr_b16 v[50:51], v8 offset:9216
  v_mfma_f32_16x16x32_bf16 v[192:195], v[32:35], a[24:27], v[192:195]
  buffer_store_dwordx4 v[136:139], v1, s[20:23], s47 offen offset:3072 sc1
  v_mfma_f32_16x16x32_bf16 v[224:227], v[32:35], a[28:31], v[224:227]
  buffer_load_dwordx4 a[84:87], v13, s[20:23], s53 offen offset:3072 sc1
  v_mfma_f32_16x16x32_bf16 v[68:71], v[36:39], a[16:19], v[68:71]
  ds_read_b64_tr_b16 v[52:53], v9 offset:8192
  v_mfma_f32_16x16x32_bf16 v[100:103], v[36:39], a[20:23], v[100:103]
  ds_read_b64_tr_b16 v[54:55], v9 offset:9216
  v_mfma_f32_16x16x32_bf16 v[196:199], v[36:39], a[24:27], v[196:199]
  v_mfma_f32_16x16x32_bf16 v[228:231], v[36:39], a[28:31], v[228:231]
  s_waitcnt lgkmcnt(4)
  v_mfma_f32_16x16x32_bf16 v[72:75], v[40:43], a[16:19], v[72:75]
  ds_read_b64_tr_b16 v[56:57], v10 offset:8192
  v_mfma_f32_16x16x32_bf16 v[104:107], v[40:43], a[20:23], v[104:107]
  ds_read_b64_tr_b16 v[58:59], v10 offset:9216
  v_mfma_f32_16x16x32_bf16 v[200:203], v[40:43], a[24:27], v[200:203]
  buffer_load_dwordx4 a[88:91], v14, s[20:23], s53 offen offset:2048 sc1
  v_mfma_f32_16x16x32_bf16 v[232:235], v[40:43], a[28:31], v[232:235]
  v_mfma_f32_16x16x32_bf16 v[76:79], v[44:47], a[16:19], v[76:79]
  ds_read_b64_tr_b16 v[60:61], v11 offset:8192
  v_cvt_pk_bf16_f32 v144, v144, v145
  v_cvt_pk_bf16_f32 v145, v146, v147
  v_mfma_f32_16x16x32_bf16 v[108:111], v[44:47], a[20:23], v[108:111]
  ds_read_b64_tr_b16 v[62:63], v11 offset:9216
  v_cvt_pk_bf16_f32 v146, v148, v149
  v_cvt_pk_bf16_f32 v147, v150, v151
  v_mfma_f32_16x16x32_bf16 v[204:207], v[44:47], a[24:27], v[204:207]
  s_add_u32 s47, s51, 33558528
  v_mfma_f32_16x16x32_bf16 v[236:239], v[44:47], a[28:31], v[236:239]
  s_waitcnt lgkmcnt(4)
  v_mfma_f32_16x16x32_bf16 v[80:83], v[48:51], a[16:19], v[80:83]
  ds_read_b64_tr_b16 v[32:33], v4 offset:16384
  v_mfma_f32_16x16x32_bf16 v[112:115], v[48:51], a[20:23], v[112:115]
  ds_read_b64_tr_b16 v[34:35], v4 offset:17408
  v_mfma_f32_16x16x32_bf16 v[208:211], v[48:51], a[24:27], v[208:211]
  buffer_store_dwordx4 v[144:147], v1, s[20:23], s47 offen offset:2048 sc1
  v_mfma_f32_16x16x32_bf16 v[240:243], v[48:51], a[28:31], v[240:243]
  buffer_load_dwordx4 a[92:95], v14, s[20:23], s53 offen offset:3072 sc1
  v_mfma_f32_16x16x32_bf16 v[84:87], v[52:55], a[16:19], v[84:87]
  ds_read_b64_tr_b16 v[36:37], v5 offset:16384
  v_mfma_f32_16x16x32_bf16 v[116:119], v[52:55], a[20:23], v[116:119]
  ds_read_b64_tr_b16 v[38:39], v5 offset:17408
  v_mfma_f32_16x16x32_bf16 v[212:215], v[52:55], a[24:27], v[212:215]
  v_mfma_f32_16x16x32_bf16 v[244:247], v[52:55], a[28:31], v[244:247]
  s_waitcnt lgkmcnt(4)
  v_mfma_f32_16x16x32_bf16 v[88:91], v[56:59], a[16:19], v[88:91]
  ds_read_b64_tr_b16 v[40:41], v6 offset:16384
  v_mfma_f32_16x16x32_bf16 v[120:123], v[56:59], a[20:23], v[120:123]
  ds_read_b64_tr_b16 v[42:43], v6 offset:17408
  s_mov_b32 s53, 12288
  v_mfma_f32_16x16x32_bf16 v[216:219], v[56:59], a[24:27], v[216:219]
  buffer_load_dwordx4 a[96:99], v13, s[20:23], s53 offen offset:0 sc1
  v_mfma_f32_16x16x32_bf16 v[248:251], v[56:59], a[28:31], v[248:251]
  v_mfma_f32_16x16x32_bf16 v[92:95], v[60:63], a[16:19], v[92:95]
  ds_read_b64_tr_b16 v[44:45], v7 offset:16384
  v_cvt_pk_bf16_f32 v152, v152, v153
  v_cvt_pk_bf16_f32 v153, v154, v155
  v_mfma_f32_16x16x32_bf16 v[124:127], v[60:63], a[20:23], v[124:127]
  ds_read_b64_tr_b16 v[46:47], v7 offset:17408
  v_cvt_pk_bf16_f32 v154, v156, v157
  v_cvt_pk_bf16_f32 v155, v158, v159
  v_mfma_f32_16x16x32_bf16 v[220:223], v[60:63], a[24:27], v[220:223]
  s_add_u32 s47, s51, 33558528
  v_mfma_f32_16x16x32_bf16 v[252:255], v[60:63], a[28:31], v[252:255]
  s_waitcnt vmcnt(23) lgkmcnt(4)
  v_mfma_f32_16x16x32_bf16 v[64:67], v[32:35], a[32:35], v[64:67]
  ds_read_b64_tr_b16 v[48:49], v8 offset:16384
  v_mfma_f32_16x16x32_bf16 v[96:99], v[32:35], a[36:39], v[96:99]
  ds_read_b64_tr_b16 v[50:51], v8 offset:17408
  v_mfma_f32_16x16x32_bf16 v[192:195], v[32:35], a[40:43], v[192:195]
  buffer_store_dwordx4 v[152:155], v1, s[20:23], s47 offen offset:3072 sc1
  v_mfma_f32_16x16x32_bf16 v[224:227], v[32:35], a[44:47], v[224:227]
  buffer_load_dwordx4 a[100:103], v13, s[20:23], s53 offen offset:1024 sc1
  v_mfma_f32_16x16x32_bf16 v[68:71], v[36:39], a[32:35], v[68:71]
  ds_read_b64_tr_b16 v[52:53], v9 offset:16384
  v_mfma_f32_16x16x32_bf16 v[100:103], v[36:39], a[36:39], v[100:103]
  ds_read_b64_tr_b16 v[54:55], v9 offset:17408
  v_mfma_f32_16x16x32_bf16 v[196:199], v[36:39], a[40:43], v[196:199]
  v_mfma_f32_16x16x32_bf16 v[228:231], v[36:39], a[44:47], v[228:231]
  s_waitcnt lgkmcnt(4)
  v_mfma_f32_16x16x32_bf16 v[72:75], v[40:43], a[32:35], v[72:75]
  ds_read_b64_tr_b16 v[56:57], v10 offset:16384
  v_mfma_f32_16x16x32_bf16 v[104:107], v[40:43], a[36:39], v[104:107]
  ds_read_b64_tr_b16 v[58:59], v10 offset:17408
  v_mfma_f32_16x16x32_bf16 v[200:203], v[40:43], a[40:43], v[200:203]
  buffer_load_dwordx4 a[104:107], v14, s[20:23], s53 offen offset:0 sc1
  v_mfma_f32_16x16x32_bf16 v[232:235], v[40:43], a[44:47], v[232:235]
  v_mfma_f32_16x16x32_bf16 v[76:79], v[44:47], a[32:35], v[76:79]
  ds_read_b64_tr_b16 v[60:61], v11 offset:16384
  v_cvt_pk_bf16_f32 v160, v160, v161
  v_cvt_pk_bf16_f32 v161, v162, v163
  v_mfma_f32_16x16x32_bf16 v[108:111], v[44:47], a[36:39], v[108:111]
  ds_read_b64_tr_b16 v[62:63], v11 offset:17408
  v_cvt_pk_bf16_f32 v162, v164, v165
  v_cvt_pk_bf16_f32 v163, v166, v167
  v_mfma_f32_16x16x32_bf16 v[204:207], v[44:47], a[40:43], v[204:207]
  s_add_u32 s47, s51, 33562624
  v_mfma_f32_16x16x32_bf16 v[236:239], v[44:47], a[44:47], v[236:239]
  s_waitcnt lgkmcnt(4)
  v_mfma_f32_16x16x32_bf16 v[80:83], v[48:51], a[32:35], v[80:83]
  ds_read_b64_tr_b16 v[32:33], v4 offset:24576
  v_mfma_f32_16x16x32_bf16 v[112:115], v[48:51], a[36:39], v[112:115]
  ds_read_b64_tr_b16 v[34:35], v4 offset:25600
  v_mfma_f32_16x16x32_bf16 v[208:211], v[48:51], a[40:43], v[208:211]
  buffer_store_dwordx4 v[160:163], v1, s[20:23], s47 offen offset:0 sc1
  v_mfma_f32_16x16x32_bf16 v[240:243], v[48:51], a[44:47], v[240:243]
  buffer_load_dwordx4 a[108:111], v14, s[20:23], s53 offen offset:1024 sc1
  v_mfma_f32_16x16x32_bf16 v[84:87], v[52:55], a[32:35], v[84:87]
  ds_read_b64_tr_b16 v[36:37], v5 offset:24576
  v_mfma_f32_16x16x32_bf16 v[116:119], v[52:55], a[36:39], v[116:119]
  ds_read_b64_tr_b16 v[38:39], v5 offset:25600
  v_mfma_f32_16x16x32_bf16 v[212:215], v[52:55], a[40:43], v[212:215]
  v_mfma_f32_16x16x32_bf16 v[244:247], v[52:55], a[44:47], v[244:247]
  s_waitcnt lgkmcnt(4)
  v_mfma_f32_16x16x32_bf16 v[88:91], v[56:59], a[32:35], v[88:91]
  ds_read_b64_tr_b16 v[40:41], v6 offset:24576
  v_mfma_f32_16x16x32_bf16 v[120:123], v[56:59], a[36:39], v[120:123]
  ds_read_b64_tr_b16 v[42:43], v6 offset:25600
  v_mfma_f32_16x16x32_bf16 v[216:219], v[56:59], a[40:43], v[216:219]
  buffer_load_dwordx4 a[112:115], v13, s[20:23], s53 offen offset:2048 sc1
  v_mfma_f32_16x16x32_bf16 v[248:251], v[56:59], a[44:47], v[248:251]
  v_mfma_f32_16x16x32_bf16 v[92:95], v[60:63], a[32:35], v[92:95]
  ds_read_b64_tr_b16 v[44:45], v7 offset:24576
  v_cvt_pk_bf16_f32 v168, v168, v169
  v_cvt_pk_bf16_f32 v169, v170, v171
  v_mfma_f32_16x16x32_bf16 v[124:127], v[60:63], a[36:39], v[124:127]
  ds_read_b64_tr_b16 v[46:47], v7 offset:25600
  v_cvt_pk_bf16_f32 v170, v172, v173
  v_cvt_pk_bf16_f32 v171, v174, v175
  v_mfma_f32_16x16x32_bf16 v[220:223], v[60:63], a[40:43], v[220:223]
  s_add_u32 s47, s51, 33562624
  v_mfma_f32_16x16x32_bf16 v[252:255], v[60:63], a[44:47], v[252:255]
  s_waitcnt vmcnt(22) lgkmcnt(4)
  v_mfma_f32_16x16x32_bf16 v[64:67], v[32:35], a[48:51], v[64:67]
  ds_read_b64_tr_b16 v[48:49], v8 offset:24576
  v_mfma_f32_16x16x32_bf16 v[96:99], v[32:35], a[52:55], v[96:99]
  ds_read_b64_tr_b16 v[50:51], v8 offset:25600
  v_mfma_f32_16x16x32_bf16 v[192:195], v[32:35], a[56:59], v[192:195]
  buffer_store_dwordx4 v[168:171], v1, s[20:23], s47 offen offset:1024 sc1
  v_mfma_f32_16x16x32_bf16 v[224:227], v[32:35], a[60:63], v[224:227]
  buffer_load_dwordx4 a[116:119], v13, s[20:23], s53 offen offset:3072 sc1
  v_mfma_f32_16x16x32_bf16 v[68:71], v[36:39], a[48:51], v[68:71]
  ds_read_b64_tr_b16 v[52:53], v9 offset:24576
  v_mfma_f32_16x16x32_bf16 v[100:103], v[36:39], a[52:55], v[100:103]
  ds_read_b64_tr_b16 v[54:55], v9 offset:25600
  v_mfma_f32_16x16x32_bf16 v[196:199], v[36:39], a[56:59], v[196:199]
  v_mfma_f32_16x16x32_bf16 v[228:231], v[36:39], a[60:63], v[228:231]
  s_waitcnt lgkmcnt(4)
  v_mfma_f32_16x16x32_bf16 v[72:75], v[40:43], a[48:51], v[72:75]
  ds_read_b64_tr_b16 v[56:57], v10 offset:24576
  v_mfma_f32_16x16x32_bf16 v[104:107], v[40:43], a[52:55], v[104:107]
  ds_read_b64_tr_b16 v[58:59], v10 offset:25600
  v_mfma_f32_16x16x32_bf16 v[200:203], v[40:43], a[56:59], v[200:203]
  buffer_load_dwordx4 a[120:123], v14, s[20:23], s53 offen offset:2048 sc1
  v_mfma_f32_16x16x32_bf16 v[232:235], v[40:43], a[60:63], v[232:235]
  v_mfma_f32_16x16x32_bf16 v[76:79], v[44:47], a[48:51], v[76:79]
  ds_read_b64_tr_b16 v[60:61], v11 offset:24576
  v_cvt_pk_bf16_f32 v176, v176, v177
  v_subrev_u32 v4, 0x8000, v4
  v_mfma_f32_16x16x32_bf16 v[108:111], v[44:47], a[52:55], v[108:111]
  ds_read_b64_tr_b16 v[62:63], v11 offset:25600
  v_cvt_pk_bf16_f32 v177, v178, v179
  v_cvt_pk_bf16_f32 v178, v180, v181
  v_mfma_f32_16x16x32_bf16 v[204:207], v[44:47], a[56:59], v[204:207]
  v_cvt_pk_bf16_f32 v179, v182, v183
  s_add_u32 s47, s51, 33566720
  v_mfma_f32_16x16x32_bf16 v[236:239], v[44:47], a[60:63], v[236:239]
  s_waitcnt lgkmcnt(4)
  s_nop 0
  v_mfma_f32_16x16x32_bf16 v[80:83], v[48:51], a[48:51], v[80:83]
  s_barrier
  v_subrev_u32 v5, 0x8000, v5
  v_mfma_f32_16x16x32_bf16 v[112:115], v[48:51], a[52:55], v[112:115]
  ds_read_b64_tr_b16 v[32:33], v4 offset:0
  v_mfma_f32_16x16x32_bf16 v[208:211], v[48:51], a[56:59], v[208:211]
  ds_read_b64_tr_b16 v[34:35], v4 offset:1024
  v_mfma_f32_16x16x32_bf16 v[240:243], v[48:51], a[60:63], v[240:243]
  buffer_store_dwordx4 v[176:179], v1, s[20:23], s47 offen offset:0 sc1
  v_mfma_f32_16x16x32_bf16 v[84:87], v[52:55], a[48:51], v[84:87]
  ds_read_b64_tr_b16 v[36:37], v5 offset:0
  v_subrev_u32 v6, 0x8000, v6
  v_mfma_f32_16x16x32_bf16 v[116:119], v[52:55], a[52:55], v[116:119]
  ds_read_b64_tr_b16 v[38:39], v5 offset:1024
  v_mfma_f32_16x16x32_bf16 v[212:215], v[52:55], a[56:59], v[212:215]
  buffer_load_dwordx4 a[124:127], v14, s[20:23], s53 offen offset:3072 sc1
  v_mfma_f32_16x16x32_bf16 v[244:247], v[52:55], a[60:63], v[244:247]
  s_waitcnt lgkmcnt(4)
  v_mfma_f32_16x16x32_bf16 v[88:91], v[56:59], a[48:51], v[88:91]
  ds_read_b64_tr_b16 v[40:41], v6 offset:0
  v_subrev_u32 v7, 0x8000, v7
  v_mfma_f32_16x16x32_bf16 v[120:123], v[56:59], a[52:55], v[120:123]
  ds_read_b64_tr_b16 v[42:43], v6 offset:1024
  s_mov_b32 s53, 16384
  v_mfma_f32_16x16x32_bf16 v[216:219], v[56:59], a[56:59], v[216:219]
  buffer_load_dwordx4 a[128:131], v13, s[20:23], s53 offen offset:0 sc1
  v_mfma_f32_16x16x32_bf16 v[248:251], v[56:59], a[60:63], v[248:251]
  v_mfma_f32_16x16x32_bf16 v[92:95], v[60:63], a[48:51], v[92:95]
  ds_read_b64_tr_b16 v[44:45], v7 offset:0
  v_cvt_pk_bf16_f32 v184, v184, v185
  v_subrev_u32 v8, 0x8000, v8
  v_mfma_f32_16x16x32_bf16 v[124:127], v[60:63], a[52:55], v[124:127]
  ds_read_b64_tr_b16 v[46:47], v7 offset:1024
  v_cvt_pk_bf16_f32 v185, v186, v187
  v_cvt_pk_bf16_f32 v186, v188, v189
  v_mfma_f32_16x16x32_bf16 v[220:223], v[60:63], a[56:59], v[220:223]
  v_cvt_pk_bf16_f32 v187, v190, v191
  s_add_u32 s47, s51, 33566720
  v_mfma_f32_16x16x32_bf16 v[252:255], v[60:63], a[60:63], v[252:255]
  s_waitcnt vmcnt(20) lgkmcnt(4)
  v_mfma_f32_16x16x32_bf16 v[64:67], v[32:35], a[64:67], v[64:67]
  ds_read_b64_tr_b16 v[48:49], v8 offset:0
  v_subrev_u32 v9, 0x8000, v9
  v_mfma_f32_16x16x32_bf16 v[96:99], v[32:35], a[68:71], v[96:99]
  ds_read_b64_tr_b16 v[50:51], v8 offset:1024
  v_mfma_f32_16x16x32_bf16 v[192:195], v[32:35], a[72:75], v[192:195]
  buffer_store_dwordx4 v[184:187], v1, s[20:23], s47 offen offset:1024 sc1
  v_mfma_f32_16x16x32_bf16 v[224:227], v[32:35], a[76:79], v[224:227]
  buffer_load_dwordx4 a[132:135], v13, s[20:23], s53 offen offset:1024 sc1
  v_mfma_f32_16x16x32_bf16 v[68:71], v[36:39], a[64:67], v[68:71]
  ds_read_b64_tr_b16 v[52:53], v9 offset:0
  v_subrev_u32 v10, 0x8000, v10
  v_mfma_f32_16x16x32_bf16 v[100:103], v[36:39], a[68:71], v[100:103]
  ds_read_b64_tr_b16 v[54:55], v9 offset:1024
  v_mfma_f32_16x16x32_bf16 v[196:199], v[36:39], a[72:75], v[196:199]
  s_and_b32 s54, s2, 31
  s_lshl_b32 s54, s54, 7
  s_add_u32 s54, s54, 229376
  v_mfma_f32_16x16x32_bf16 v[228:231], v[36:39], a[76:79], v[228:231]
  s_waitcnt lgkmcnt(4)
  v_and_b32 v15, 0x380, v15
  v_lshlrev_b32 v15, 5, v15
  v_mfma_f32_16x16x32_bf16 v[72:75], v[40:43], a[64:67], v[72:75]
  ds_read_b64_tr_b16 v[56:57], v10 offset:0
  v_mov_b32 v28, v2
  v_subrev_u32 v11, 0x8000, v11
  v_mfma_f32_16x16x32_bf16 v[104:107], v[40:43], a[68:71], v[104:107]
  ds_read_b64_tr_b16 v[58:59], v10 offset:1024
  s_lshl_b32 s55, s33, 19
  s_add_u32 s48, s55, 16777216
  v_mfma_f32_16x16x32_bf16 v[200:203], v[40:43], a[72:75], v[200:203]
  buffer_load_dwordx4 a[136:139], v14, s[20:23], s53 offen offset:0 sc1
  v_mfma_f32_16x16x32_bf16 v[232:235], v[40:43], a[76:79], v[232:235]
  s_add_u32 s12, s20, s48
  s_addc_u32 s13, s21, 0
  v_mfma_f32_16x16x32_bf16 v[76:79], v[44:47], a[64:67], v[76:79]
  ds_read_b64_tr_b16 v[60:61], v11 offset:0
  s_add_u32 s48, s55, 33554432
  v_mfma_f32_16x16x32_bf16 v[108:111], v[44:47], a[68:71], v[108:111]
  ds_read_b64_tr_b16 v[62:63], v11 offset:1024
  s_add_u32 s16, s20, s48
  s_addc_u32 s17, s21, 0
  v_mfma_f32_16x16x32_bf16 v[204:207], v[44:47], a[72:75], v[204:207]
  s_mov_b32 s18, 0x80000
  s_lshl_b32 s55, s34, 1
  s_sub_u32 s45, 32, s55
  v_mfma_f32_16x16x32_bf16 v[236:239], v[44:47], a[76:79], v[236:239]
  s_waitcnt lgkmcnt(4)
  s_lshl_b32 s37, s45, 14
  s_mov_b32 s14, s37
  v_mfma_f32_16x16x32_bf16 v[80:83], v[48:51], a[64:67], v[80:83]
  ds_read_b64_tr_b16 v[32:33], v4 offset:8192
  s_add_u32 s38, s55, 2
  s_lshl_b32 s38, s38, 14
  v_mfma_f32_16x16x32_bf16 v[112:115], v[48:51], a[68:71], v[112:115]
  ds_read_b64_tr_b16 v[34:35], v4 offset:9216
  s_mov_b32 s36, 0
  s_lshl_b32 s39, s30, 12
  v_mfma_f32_16x16x32_bf16 v[208:211], v[48:51], a[72:75], v[208:211]
  buffer_load_dwordx4 a[140:143], v14, s[20:23], s53 offen offset:1024 sc1
  s_mov_b32 s43, 0
  v_mfma_f32_16x16x32_bf16 v[240:243], v[48:51], a[76:79], v[240:243]
  s_sub_u32 s44, 15, s34
  v_add_u32 v132, s39, v1
  s_lshl_b32 s55, s32, 13
  v_mfma_f32_16x16x32_bf16 v[84:87], v[52:55], a[64:67], v[84:87]
  ds_read_b64_tr_b16 v[36:37], v5 offset:8192
  v_add_u32 v2, s55, v1
  v_mov_b32 v133, 0xff800000
  v_mfma_f32_16x16x32_bf16 v[116:119], v[52:55], a[68:71], v[116:119]
  ds_read_b64_tr_b16 v[38:39], v5 offset:9216
  s_lshl_b32 s48, s31, 14
  v_add_u32 v138, s48, v1
  v_mfma_f32_16x16x32_bf16 v[212:215], v[52:55], a[72:75], v[212:215]
  buffer_load_dwordx4 a[144:147], v13, s[20:23], s53 offen offset:2048 sc1
  v_xor_b32 v139, 0x2000, v138
  v_mfma_f32_16x16x32_bf16 v[244:247], v[52:55], a[76:79], v[244:247]
  s_waitcnt lgkmcnt(4)
  v_and_b32 v23, 15, v28
  v_lshrrev_b32 v24, 4, v28
  v_mfma_f32_16x16x32_bf16 v[88:91], v[56:59], a[64:67], v[88:91]
  ds_read_b64_tr_b16 v[40:41], v6 offset:8192
  v_lshlrev_b32 v24, 2, v24
  v_sub_u32 v23, v23, v24
  v_mfma_f32_16x16x32_bf16 v[120:123], v[56:59], a[68:71], v[120:123]
  ds_read_b64_tr_b16 v[42:43], v6 offset:9216
  v_bfe_u32 v24, v28, 4, 1
  v_lshlrev_b32 v136, 10, v24
  v_mfma_f32_16x16x32_bf16 v[216:219], v[56:59], a[72:75], v[216:219]
  v_lshrrev_b32 v24, 5, v28
  v_lshl_add_u32 v136, v24, 8, v136
  v_mfma_f32_16x16x32_bf16 v[248:251], v[56:59], a[76:79], v[248:251]
  v_and_b32 v24, 15, v28
  v_lshl_add_u32 v136, v24, 4, v136
  v_mfma_f32_16x16x32_bf16 v[92:95], v[60:63], a[64:67], v[92:95]
  ds_read_b64_tr_b16 v[44:45], v7 offset:8192
  s_mov_b32 s55, s31
  s_sub_u32 s55, s55, s32
  v_mfma_f32_16x16x32_bf16 v[124:127], v[60:63], a[68:71], v[124:127]
  ds_read_b64_tr_b16 v[46:47], v7 offset:9216
  s_lshl_b32 s55, s55, 5
  v_add_u32 v134, s55, v23
  v_mfma_f32_16x16x32_bf16 v[220:223], v[60:63], a[72:75], v[220:223]
  buffer_load_dwordx4 a[148:151], v13, s[20:23], s53 offen offset:3072 sc1
  s_sub_u32 s55, 3, s31
  v_mfma_f32_16x16x32_bf16 v[252:255], v[60:63], a[76:79], v[252:255]
  s_waitcnt vmcnt(19) lgkmcnt(4)
  s_sub_u32 s55, s55, s32
  s_lshl_b32 s55, s55, 5
  v_mfma_f32_16x16x32_bf16 v[64:67], v[32:35], a[80:83], v[64:67]
  ds_read_b64_tr_b16 v[48:49], v8 offset:8192
  v_add_u32 v135, s55, v23
  s_sub_u32 s55, 1, s31
  v_mfma_f32_16x16x32_bf16 v[96:99], v[32:35], a[84:87], v[96:99]
  ds_read_b64_tr_b16 v[50:51], v8 offset:9216
  s_sub_u32 s55, s55, s32
  s_lshl_b32 s55, s55, 5
  v_mfma_f32_16x16x32_bf16 v[192:195], v[32:35], a[88:91], v[192:195]
  buffer_load_dwordx4 a[152:155], v14, s[20:23], s53 offen offset:2048 sc1
  v_add_u32 v137, s55, v23
  v_mfma_f32_16x16x32_bf16 v[224:227], v[32:35], a[92:95], v[224:227]
  v_lshrrev_b32 v24, 4, v28
  v_lshlrev_b32 v128, 9, v24
  v_mfma_f32_16x16x32_bf16 v[68:71], v[36:39], a[80:83], v[68:71]
  ds_read_b64_tr_b16 v[52:53], v9 offset:8192
  v_and_b32 v24, 15, v28
  v_lshl_add_u32 v128, v24, 4, v128
  v_mfma_f32_16x16x32_bf16 v[100:103], v[36:39], a[84:87], v[100:103]
  ds_read_b64_tr_b16 v[54:55], v9 offset:9216
  v_mfma_f32_16x16x32_bf16 v[196:199], v[36:39], a[88:91], v[196:199]
  v_mfma_f32_16x16x32_bf16 v[228:231], v[36:39], a[92:95], v[228:231]
  s_waitcnt lgkmcnt(4)
  v_mfma_f32_16x16x32_bf16 v[72:75], v[40:43], a[80:83], v[72:75]
  ds_read_b64_tr_b16 v[56:57], v10 offset:8192
  v_mfma_f32_16x16x32_bf16 v[104:107], v[40:43], a[84:87], v[104:107]
  ds_read_b64_tr_b16 v[58:59], v10 offset:9216
  v_mfma_f32_16x16x32_bf16 v[200:203], v[40:43], a[88:91], v[200:203]
  buffer_load_dwordx4 a[156:159], v14, s[20:23], s53 offen offset:3072 sc1
  v_mfma_f32_16x16x32_bf16 v[232:235], v[40:43], a[92:95], v[232:235]
  v_mfma_f32_16x16x32_bf16 v[76:79], v[44:47], a[80:83], v[76:79]
  ds_read_b64_tr_b16 v[60:61], v11 offset:8192
  v_mfma_f32_16x16x32_bf16 v[108:111], v[44:47], a[84:87], v[108:111]
  ds_read_b64_tr_b16 v[62:63], v11 offset:9216
  s_mov_b32 s53, 20480
  v_mfma_f32_16x16x32_bf16 v[204:207], v[44:47], a[88:91], v[204:207]
  buffer_load_dwordx4 a[160:163], v13, s[20:23], s53 offen offset:0 sc1
  v_mfma_f32_16x16x32_bf16 v[236:239], v[44:47], a[92:95], v[236:239]
  s_waitcnt lgkmcnt(4)
  v_mfma_f32_16x16x32_bf16 v[80:83], v[48:51], a[80:83], v[80:83]
  ds_read_b64_tr_b16 v[32:33], v4 offset:16384
  v_mfma_f32_16x16x32_bf16 v[112:115], v[48:51], a[84:87], v[112:115]
  ds_read_b64_tr_b16 v[34:35], v4 offset:17408
  v_mfma_f32_16x16x32_bf16 v[208:211], v[48:51], a[88:91], v[208:211]
  v_mfma_f32_16x16x32_bf16 v[240:243], v[48:51], a[92:95], v[240:243]
  v_mfma_f32_16x16x32_bf16 v[84:87], v[52:55], a[80:83], v[84:87]
  ds_read_b64_tr_b16 v[36:37], v5 offset:16384
  v_mfma_f32_16x16x32_bf16 v[116:119], v[52:55], a[84:87], v[116:119]
  ds_read_b64_tr_b16 v[38:39], v5 offset:17408
  v_mfma_f32_16x16x32_bf16 v[212:215], v[52:55], a[88:91], v[212:215]
  buffer_load_dwordx4 a[164:167], v13, s[20:23], s53 offen offset:1024 sc1
  v_mfma_f32_16x16x32_bf16 v[244:247], v[52:55], a[92:95], v[244:247]
  s_waitcnt lgkmcnt(4)
  v_mfma_f32_16x16x32_bf16 v[88:91], v[56:59], a[80:83], v[88:91]
  ds_read_b64_tr_b16 v[40:41], v6 offset:16384
  v_mfma_f32_16x16x32_bf16 v[120:123], v[56:59], a[84:87], v[120:123]
  ds_read_b64_tr_b16 v[42:43], v6 offset:17408
  v_mfma_f32_16x16x32_bf16 v[216:219], v[56:59], a[88:91], v[216:219]
  buffer_load_dwordx4 a[168:171], v14, s[20:23], s53 offen offset:0 sc1
  v_mfma_f32_16x16x32_bf16 v[248:251], v[56:59], a[92:95], v[248:251]
  v_mfma_f32_16x16x32_bf16 v[92:95], v[60:63], a[80:83], v[92:95]
  ds_read_b64_tr_b16 v[44:45], v7 offset:16384
  v_mfma_f32_16x16x32_bf16 v[124:127], v[60:63], a[84:87], v[124:127]
  ds_read_b64_tr_b16 v[46:47], v7 offset:17408
  v_mfma_f32_16x16x32_bf16 v[220:223], v[60:63], a[88:91], v[220:223]
  v_mfma_f32_16x16x32_bf16 v[252:255], v[60:63], a[92:95], v[252:255]
  s_waitcnt vmcnt(18) lgkmcnt(4)
  v_mfma_f32_16x16x32_bf16 v[64:67], v[32:35], a[96:99], v[64:67]
  ds_read_b64_tr_b16 v[48:49], v8 offset:16384
  v_mfma_f32_16x16x32_bf16 v[96:99], v[32:35], a[100:103], v[96:99]
  ds_read_b64_tr_b16 v[50:51], v8 offset:17408
  v_mfma_f32_16x16x32_bf16 v[192:195], v[32:35], a[104:107], v[192:195]
  buffer_load_dwordx4 a[172:175], v14, s[20:23], s53 offen offset:1024 sc1
  v_mfma_f32_16x16x32_bf16 v[224:227], v[32:35], a[108:111], v[224:227]
  v_mfma_f32_16x16x32_bf16 v[68:71], v[36:39], a[96:99], v[68:71]
  ds_read_b64_tr_b16 v[52:53], v9 offset:16384
  v_mfma_f32_16x16x32_bf16 v[100:103], v[36:39], a[100:103], v[100:103]
  ds_read_b64_tr_b16 v[54:55], v9 offset:17408
  v_mfma_f32_16x16x32_bf16 v[196:199], v[36:39], a[104:107], v[196:199]
  buffer_load_dwordx4 a[176:179], v13, s[20:23], s53 offen offset:2048 sc1
  v_mfma_f32_16x16x32_bf16 v[228:231], v[36:39], a[108:111], v[228:231]
  s_waitcnt lgkmcnt(4)
  v_mfma_f32_16x16x32_bf16 v[72:75], v[40:43], a[96:99], v[72:75]
  ds_read_b64_tr_b16 v[56:57], v10 offset:16384
  v_mfma_f32_16x16x32_bf16 v[104:107], v[40:43], a[100:103], v[104:107]
  ds_read_b64_tr_b16 v[58:59], v10 offset:17408
  v_mfma_f32_16x16x32_bf16 v[200:203], v[40:43], a[104:107], v[200:203]
  v_mfma_f32_16x16x32_bf16 v[232:235], v[40:43], a[108:111], v[232:235]
  v_mfma_f32_16x16x32_bf16 v[76:79], v[44:47], a[96:99], v[76:79]
  ds_read_b64_tr_b16 v[60:61], v11 offset:16384
  v_mfma_f32_16x16x32_bf16 v[108:111], v[44:47], a[100:103], v[108:111]
  ds_read_b64_tr_b16 v[62:63], v11 offset:17408
  v_mfma_f32_16x16x32_bf16 v[204:207], v[44:47], a[104:107], v[204:207]
  buffer_load_dwordx4 a[180:183], v13, s[20:23], s53 offen offset:3072 sc1
  v_mfma_f32_16x16x32_bf16 v[236:239], v[44:47], a[108:111], v[236:239]
  s_waitcnt lgkmcnt(4)
  v_mfma_f32_16x16x32_bf16 v[80:83], v[48:51], a[96:99], v[80:83]
  ds_read_b64_tr_b16 v[32:33], v4 offset:24576
  v_mfma_f32_16x16x32_bf16 v[112:115], v[48:51], a[100:103], v[112:115]
  ds_read_b64_tr_b16 v[34:35], v4 offset:25600
  v_mfma_f32_16x16x32_bf16 v[208:211], v[48:51], a[104:107], v[208:211]
  buffer_load_dwordx4 a[184:187], v14, s[20:23], s53 offen offset:2048 sc1
  v_mfma_f32_16x16x32_bf16 v[240:243], v[48:51], a[108:111], v[240:243]
  v_mfma_f32_16x16x32_bf16 v[84:87], v[52:55], a[96:99], v[84:87]
  ds_read_b64_tr_b16 v[36:37], v5 offset:24576
  v_mfma_f32_16x16x32_bf16 v[116:119], v[52:55], a[100:103], v[116:119]
  ds_read_b64_tr_b16 v[38:39], v5 offset:25600
  v_mfma_f32_16x16x32_bf16 v[212:215], v[52:55], a[104:107], v[212:215]
  v_mfma_f32_16x16x32_bf16 v[244:247], v[52:55], a[108:111], v[244:247]
  s_waitcnt lgkmcnt(4)
  v_mfma_f32_16x16x32_bf16 v[88:91], v[56:59], a[96:99], v[88:91]
  ds_read_b64_tr_b16 v[40:41], v6 offset:24576
  v_mfma_f32_16x16x32_bf16 v[120:123], v[56:59], a[100:103], v[120:123]
  ds_read_b64_tr_b16 v[42:43], v6 offset:25600
  v_mfma_f32_16x16x32_bf16 v[216:219], v[56:59], a[104:107], v[216:219]
  buffer_load_dwordx4 a[188:191], v14, s[20:23], s53 offen offset:3072 sc1
  v_mfma_f32_16x16x32_bf16 v[248:251], v[56:59], a[108:111], v[248:251]
  v_mfma_f32_16x16x32_bf16 v[92:95], v[60:63], a[96:99], v[92:95]
  ds_read_b64_tr_b16 v[44:45], v7 offset:24576
  v_mfma_f32_16x16x32_bf16 v[124:127], v[60:63], a[100:103], v[124:127]
  ds_read_b64_tr_b16 v[46:47], v7 offset:25600
  s_mov_b32 s53, 24576
  v_mfma_f32_16x16x32_bf16 v[220:223], v[60:63], a[104:107], v[220:223]
  buffer_load_dwordx4 a[192:195], v13, s[20:23], s53 offen offset:0 sc1
  v_mfma_f32_16x16x32_bf16 v[252:255], v[60:63], a[108:111], v[252:255]
  s_waitcnt vmcnt(18) lgkmcnt(4)
  v_mfma_f32_16x16x32_bf16 v[64:67], v[32:35], a[112:115], v[64:67]
  ds_read_b64_tr_b16 v[48:49], v8 offset:24576
  v_mfma_f32_16x16x32_bf16 v[96:99], v[32:35], a[116:119], v[96:99]
  ds_read_b64_tr_b16 v[50:51], v8 offset:25600
  v_mfma_f32_16x16x32_bf16 v[192:195], v[32:35], a[120:123], v[192:195]
  v_mfma_f32_16x16x32_bf16 v[224:227], v[32:35], a[124:127], v[224:227]
  v_mfma_f32_16x16x32_bf16 v[68:71], v[36:39], a[112:115], v[68:71]
  ds_read_b64_tr_b16 v[52:53], v9 offset:24576
  v_mfma_f32_16x16x32_bf16 v[100:103], v[36:39], a[116:119], v[100:103]
  ds_read_b64_tr_b16 v[54:55], v9 offset:25600
  v_mfma_f32_16x16x32_bf16 v[196:199], v[36:39], a[120:123], v[196:199]
  buffer_load_dwordx4 a[196:199], v13, s[20:23], s53 offen offset:1024 sc1
  v_mfma_f32_16x16x32_bf16 v[228:231], v[36:39], a[124:127], v[228:231]
  s_waitcnt lgkmcnt(4)
  v_mfma_f32_16x16x32_bf16 v[72:75], v[40:43], a[112:115], v[72:75]
  ds_read_b64_tr_b16 v[56:57], v10 offset:24576
  v_mfma_f32_16x16x32_bf16 v[104:107], v[40:43], a[116:119], v[104:107]
  ds_read_b64_tr_b16 v[58:59], v10 offset:25600
  v_mfma_f32_16x16x32_bf16 v[200:203], v[40:43], a[120:123], v[200:203]
  buffer_load_dwordx4 a[200:203], v14, s[20:23], s53 offen offset:0 sc1
  v_mfma_f32_16x16x32_bf16 v[232:235], v[40:43], a[124:127], v[232:235]
  v_mfma_f32_16x16x32_bf16 v[76:79], v[44:47], a[112:115], v[76:79]
  ds_read_b64_tr_b16 v[60:61], v11 offset:24576
  v_subrev_u32 v4, 0x8000, v4
  v_mfma_f32_16x16x32_bf16 v[108:111], v[44:47], a[116:119], v[108:111]
  ds_read_b64_tr_b16 v[62:63], v11 offset:25600
  v_mfma_f32_16x16x32_bf16 v[204:207], v[44:47], a[120:123], v[204:207]
  s_waitcnt vmcnt(18)
  s_add_u32 s52, s3, 163840
  v_mfma_f32_16x16x32_bf16 v[236:239], v[44:47], a[124:127], v[236:239]
  s_waitcnt lgkmcnt(4)
  s_nop 0
  v_mfma_f32_16x16x32_bf16 v[80:83], v[48:51], a[112:115], v[80:83]
  s_barrier
  v_subrev_u32 v5, 0x8000, v5
  v_mfma_f32_16x16x32_bf16 v[112:115], v[48:51], a[116:119], v[112:115]
  ds_read_b64_tr_b16 v[32:33], v4 offset:0
  v_mfma_f32_16x16x32_bf16 v[208:211], v[48:51], a[120:123], v[208:211]
  ds_read_b64_tr_b16 v[34:35], v4 offset:1024
  v_mfma_f32_16x16x32_bf16 v[240:243], v[48:51], a[124:127], v[240:243]
  buffer_load_dwordx4 a[204:207], v14, s[20:23], s53 offen offset:1024 sc1
  v_mfma_f32_16x16x32_bf16 v[84:87], v[52:55], a[112:115], v[84:87]
  ds_read_b64_tr_b16 v[36:37], v5 offset:0
  v_subrev_u32 v6, 0x8000, v6
  v_mfma_f32_16x16x32_bf16 v[116:119], v[52:55], a[116:119], v[116:119]
  ds_read_b64_tr_b16 v[38:39], v5 offset:1024
  v_mfma_f32_16x16x32_bf16 v[212:215], v[52:55], a[120:123], v[212:215]
  buffer_store_dword v25, v27, s[20:23], s52 offen sc1
  v_mfma_f32_16x16x32_bf16 v[244:247], v[52:55], a[124:127], v[244:247]
  s_waitcnt lgkmcnt(4)
  v_mfma_f32_16x16x32_bf16 v[88:91], v[56:59], a[112:115], v[88:91]
  ds_read_b64_tr_b16 v[40:41], v6 offset:0
  v_subrev_u32 v7, 0x8000, v7
  v_mfma_f32_16x16x32_bf16 v[120:123], v[56:59], a[116:119], v[120:123]
  ds_read_b64_tr_b16 v[42:43], v6 offset:1024
  v_mfma_f32_16x16x32_bf16 v[216:219], v[56:59], a[120:123], v[216:219]
  buffer_load_dwordx4 a[208:211], v13, s[20:23], s53 offen offset:2048 sc1
  v_mfma_f32_16x16x32_bf16 v[248:251], v[56:59], a[124:127], v[248:251]
  v_mfma_f32_16x16x32_bf16 v[92:95], v[60:63], a[112:115], v[92:95]
  ds_read_b64_tr_b16 v[44:45], v7 offset:0
  v_subrev_u32 v8, 0x8000, v8
  v_mfma_f32_16x16x32_bf16 v[124:127], v[60:63], a[116:119], v[124:127]
  ds_read_b64_tr_b16 v[46:47], v7 offset:1024
  v_mfma_f32_16x16x32_bf16 v[220:223], v[60:63], a[120:123], v[220:223]
  v_mfma_f32_16x16x32_bf16 v[252:255], v[60:63], a[124:127], v[252:255]
  s_waitcnt vmcnt(18) lgkmcnt(4)
  v_mfma_f32_16x16x32_bf16 v[64:67], v[32:35], a[128:131], v[64:67]
  ds_read_b64_tr_b16 v[48:49], v8 offset:0
  v_subrev_u32 v9, 0x8000, v9
  v_mfma_f32_16x16x32_bf16 v[96:99], v[32:35], a[132:135], v[96:99]
  ds_read_b64_tr_b16 v[50:51], v8 offset:1024
  v_mfma_f32_16x16x32_bf16 v[192:195], v[32:35], a[136:139], v[192:195]
  buffer_load_dwordx4 a[212:215], v13, s[20:23], s53 offen offset:3072 sc1
  v_mfma_f32_16x16x32_bf16 v[224:227], v[32:35], a[140:143], v[224:227]
  v_mfma_f32_16x16x32_bf16 v[68:71], v[36:39], a[128:131], v[68:71]
  ds_read_b64_tr_b16 v[52:53], v9 offset:0
  v_subrev_u32 v10, 0x8000, v10
  v_mfma_f32_16x16x32_bf16 v[100:103], v[36:39], a[132:135], v[100:103]
  ds_read_b64_tr_b16 v[54:55], v9 offset:1024
  v_mfma_f32_16x16x32_bf16 v[196:199], v[36:39], a[136:139], v[196:199]
  buffer_load_dwordx4 a[216:219], v14, s[20:23], s53 offen offset:2048 sc1
  v_mfma_f32_16x16x32_bf16 v[228:231], v[36:39], a[140:143], v[228:231]
  s_waitcnt lgkmcnt(4)
  v_mfma_f32_16x16x32_bf16 v[72:75], v[40:43], a[128:131], v[72:75]
  ds_read_b64_tr_b16 v[56:57], v10 offset:0
  v_subrev_u32 v11, 0x8000, v11
  v_mfma_f32_16x16x32_bf16 v[104:107], v[40:43], a[132:135], v[104:107]
  ds_read_b64_tr_b16 v[58:59], v10 offset:1024
  v_mfma_f32_16x16x32_bf16 v[200:203], v[40:43], a[136:139], v[200:203]
  v_mfma_f32_16x16x32_bf16 v[232:235], v[40:43], a[140:143], v[232:235]
  v_mfma_f32_16x16x32_bf16 v[76:79], v[44:47], a[128:131], v[76:79]
  ds_read_b64_tr_b16 v[60:61], v11 offset:0
  v_mfma_f32_16x16x32_bf16 v[108:111], v[44:47], a[132:135], v[108:111]
  ds_read_b64_tr_b16 v[62:63], v11 offset:1024
  v_mfma_f32_16x16x32_bf16 v[204:207], v[44:47], a[136:139], v[204:207]
  buffer_load_dwordx4 a[220:223], v14, s[20:23], s53 offen offset:3072 sc1
  v_mfma_f32_16x16x32_bf16 v[236:239], v[44:47], a[140:143], v[236:239]
  s_waitcnt lgkmcnt(4)
  v_mfma_f32_16x16x32_bf16 v[80:83], v[48:51], a[128:131], v[80:83]
  ds_read_b64_tr_b16 v[32:33], v4 offset:8192
  v_mfma_f32_16x16x32_bf16 v[112:115], v[48:51], a[132:135], v[112:115]
  ds_read_b64_tr_b16 v[34:35], v4 offset:9216
  s_mov_b32 s53, 28672
  v_mfma_f32_16x16x32_bf16 v[208:211], v[48:51], a[136:139], v[208:211]
  buffer_load_dwordx4 a[224:227], v13, s[20:23], s53 offen offset:0 sc1
  v_mfma_f32_16x16x32_bf16 v[240:243], v[48:51], a[140:143], v[240:243]
  v_mfma_f32_16x16x32_bf16 v[84:87], v[52:55], a[128:131], v[84:87]
  ds_read_b64_tr_b16 v[36:37], v5 offset:8192
  v_mfma_f32_16x16x32_bf16 v[116:119], v[52:55], a[132:135], v[116:119]
  ds_read_b64_tr_b16 v[38:39], v5 offset:9216
  v_mfma_f32_16x16x32_bf16 v[212:215], v[52:55], a[136:139], v[212:215]
  v_mfma_f32_16x16x32_bf16 v[244:247], v[52:55], a[140:143], v[244:247]
  s_waitcnt lgkmcnt(4)
  v_mfma_f32_16x16x32_bf16 v[88:91], v[56:59], a[128:131], v[88:91]
  ds_read_b64_tr_b16 v[40:41], v6 offset:8192
  v_mfma_f32_16x16x32_bf16 v[120:123], v[56:59], a[132:135], v[120:123]
  ds_read_b64_tr_b16 v[42:43], v6 offset:9216
  v_mfma_f32_16x16x32_bf16 v[216:219], v[56:59], a[136:139], v[216:219]
  buffer_load_dwordx4 a[228:231], v13, s[20:23], s53 offen offset:1024 sc1
  v_mfma_f32_16x16x32_bf16 v[248:251], v[56:59], a[140:143], v[248:251]
  v_mfma_f32_16x16x32_bf16 v[92:95], v[60:63], a[128:131], v[92:95]
  ds_read_b64_tr_b16 v[44:45], v7 offset:8192
  v_mfma_f32_16x16x32_bf16 v[124:127], v[60:63], a[132:135], v[124:127]
  ds_read_b64_tr_b16 v[46:47], v7 offset:9216
  v_mfma_f32_16x16x32_bf16 v[220:223], v[60:63], a[136:139], v[220:223]
  buffer_load_dwordx4 a[232:235], v14, s[20:23], s53 offen offset:0 sc1
  v_mfma_f32_16x16x32_bf16 v[252:255], v[60:63], a[140:143], v[252:255]
  s_waitcnt vmcnt(20) lgkmcnt(4)
  v_mfma_f32_16x16x32_bf16 v[64:67], v[32:35], a[144:147], v[64:67]
  ds_read_b64_tr_b16 v[48:49], v8 offset:8192
  v_mfma_f32_16x16x32_bf16 v[96:99], v[32:35], a[148:151], v[96:99]
  ds_read_b64_tr_b16 v[50:51], v8 offset:9216
  v_mfma_f32_16x16x32_bf16 v[192:195], v[32:35], a[152:155], v[192:195]
  v_mfma_f32_16x16x32_bf16 v[224:227], v[32:35], a[156:159], v[224:227]
  v_mfma_f32_16x16x32_bf16 v[68:71], v[36:39], a[144:147], v[68:71]
  ds_read_b64_tr_b16 v[52:53], v9 offset:8192
  v_mfma_f32_16x16x32_bf16 v[100:103], v[36:39], a[148:151], v[100:103]
  ds_read_b64_tr_b16 v[54:55], v9 offset:9216
  v_mfma_f32_16x16x32_bf16 v[196:199], v[36:39], a[152:155], v[196:199]
  buffer_load_dwordx4 a[236:239], v14, s[20:23], s53 offen offset:1024 sc1
  v_mfma_f32_16x16x32_bf16 v[228:231], v[36:39], a[156:159], v[228:231]
  s_waitcnt lgkmcnt(4)
  v_mfma_f32_16x16x32_bf16 v[72:75], v[40:43], a[144:147], v[72:75]
  ds_read_b64_tr_b16 v[56:57], v10 offset:8192
  v_mfma_f32_16x16x32_bf16 v[104:107], v[40:43], a[148:151], v[104:107]
  ds_read_b64_tr_b16 v[58:59], v10 offset:9216
  v_mfma_f32_16x16x32_bf16 v[200:203], v[40:43], a[152:155], v[200:203]
  buffer_load_dwordx4 a[240:243], v13, s[20:23], s53 offen offset:2048 sc1
  v_mfma_f32_16x16x32_bf16 v[232:235], v[40:43], a[156:159], v[232:235]
  v_mfma_f32_16x16x32_bf16 v[76:79], v[44:47], a[144:147], v[76:79]
  ds_read_b64_tr_b16 v[60:61], v11 offset:8192
  v_mfma_f32_16x16x32_bf16 v[108:111], v[44:47], a[148:151], v[108:111]
  ds_read_b64_tr_b16 v[62:63], v11 offset:9216
  v_mfma_f32_16x16x32_bf16 v[204:207], v[44:47], a[152:155], v[204:207]
  v_mfma_f32_16x16x32_bf16 v[236:239], v[44:47], a[156:159], v[236:239]
  s_waitcnt lgkmcnt(4)
  v_mfma_f32_16x16x32_bf16 v[80:83], v[48:51], a[144:147], v[80:83]
  ds_read_b64_tr_b16 v[32:33], v4 offset:16384
  v_mfma_f32_16x16x32_bf16 v[112:115], v[48:51], a[148:151], v[112:115]
  ds_read_b64_tr_b16 v[34:35], v4 offset:17408
  v_mfma_f32_16x16x32_bf16 v[208:211], v[48:51], a[152:155], v[208:211]
  buffer_load_dwordx4 a[244:247], v13, s[20:23], s53 offen offset:3072 sc1
  v_mfma_f32_16x16x32_bf16 v[240:243], v[48:51], a[156:159], v[240:243]
  v_mfma_f32_16x16x32_bf16 v[84:87], v[52:55], a[144:147], v[84:87]
  ds_read_b64_tr_b16 v[36:37], v5 offset:16384
  v_mfma_f32_16x16x32_bf16 v[116:119], v[52:55], a[148:151], v[116:119]
  ds_read_b64_tr_b16 v[38:39], v5 offset:17408
  v_mfma_f32_16x16x32_bf16 v[212:215], v[52:55], a[152:155], v[212:215]
  buffer_load_dwordx4 a[248:251], v14, s[20:23], s53 offen offset:2048 sc1
  v_mfma_f32_16x16x32_bf16 v[244:247], v[52:55], a[156:159], v[244:247]
  s_waitcnt lgkmcnt(4)
  v_mfma_f32_16x16x32_bf16 v[88:91], v[56:59], a[144:147], v[88:91]
  ds_read_b64_tr_b16 v[40:41], v6 offset:16384
  v_mfma_f32_16x16x32_bf16 v[120:123], v[56:59], a[148:151], v[120:123]
  ds_read_b64_tr_b16 v[42:43], v6 offset:17408
  v_mfma_f32_16x16x32_bf16 v[216:219], v[56:59], a[152:155], v[216:219]
  v_mfma_f32_16x16x32_bf16 v[248:251], v[56:59], a[156:159], v[248:251]
  v_mfma_f32_16x16x32_bf16 v[92:95], v[60:63], a[144:147], v[92:95]
  ds_read_b64_tr_b16 v[44:45], v7 offset:16384
  v_mfma_f32_16x16x32_bf16 v[124:127], v[60:63], a[148:151], v[124:127]
  ds_read_b64_tr_b16 v[46:47], v7 offset:17408
  v_mfma_f32_16x16x32_bf16 v[220:223], v[60:63], a[152:155], v[220:223]
  buffer_load_dwordx4 a[252:255], v14, s[20:23], s53 offen offset:3072 sc1
  v_mfma_f32_16x16x32_bf16 v[252:255], v[60:63], a[156:159], v[252:255]
  s_waitcnt vmcnt(21) lgkmcnt(4)
  v_mfma_f32_16x16x32_bf16 v[64:67], v[32:35], a[160:163], v[64:67]
  ds_read_b64_tr_b16 v[48:49], v8 offset:16384
  s_add_u32 m0, s35, 0
  v_mfma_f32_16x16x32_bf16 v[96:99], v[32:35], a[164:167], v[96:99]
  ds_read_b64_tr_b16 v[50:51], v8 offset:17408
  s_nop 0
  v_mfma_f32_16x16x32_bf16 v[192:195], v[32:35], a[168:171], v[192:195]
  buffer_load_dwordx4 v29, s[4:7], s10 offen nt lds
  v_mfma_f32_16x16x32_bf16 v[224:227], v[32:35], a[172:175], v[224:227]
  v_mfma_f32_16x16x32_bf16 v[68:71], v[36:39], a[160:163], v[68:71]
  ds_read_b64_tr_b16 v[52:53], v9 offset:16384
  s_add_u32 m0, s35, 1024
  v_mfma_f32_16x16x32_bf16 v[100:103], v[36:39], a[164:167], v[100:103]
  ds_read_b64_tr_b16 v[54:55], v9 offset:17408
  s_add_u32 s10, s10, s11
  v_mfma_f32_16x16x32_bf16 v[196:199], v[36:39], a[168:171], v[196:199]
  buffer_load_dwordx4 v17, s[4:7], s10 offen nt lds
  v_mfma_f32_16x16x32_bf16 v[228:231], v[36:39], a[172:175], v[228:231]
  s_waitcnt lgkmcnt(4)
  v_mfma_f32_16x16x32_bf16 v[72:75], v[40:43], a[160:163], v[72:75]
  ds_read_b64_tr_b16 v[56:57], v10 offset:16384
  s_add_u32 m0, s35, 2048
  v_mfma_f32_16x16x32_bf16 v[104:107], v[40:43], a[164:167], v[104:107]
  ds_read_b64_tr_b16 v[58:59], v10 offset:17408
  s_add_u32 s10, s10, s11
  v_mfma_f32_16x16x32_bf16 v[200:203], v[40:43], a[168:171], v[200:203]
  buffer_load_dwordx4 v29, s[4:7], s10 offen nt lds
  v_mfma_f32_16x16x32_bf16 v[232:235], v[40:43], a[172:175], v[232:235]
  v_mfma_f32_16x16x32_bf16 v[76:79], v[44:47], a[160:163], v[76:79]
  ds_read_b64_tr_b16 v[60:61], v11 offset:16384
  s_add_u32 m0, s35, 3072
  v_mfma_f32_16x16x32_bf16 v[108:111], v[44:47], a[164:167], v[108:111]
  ds_read_b64_tr_b16 v[62:63], v11 offset:17408
  s_add_u32 s10, s10, s11
  v_mfma_f32_16x16x32_bf16 v[204:207], v[44:47], a[168:171], v[204:207]
  buffer_load_dwordx4 v17, s[4:7], s10 offen nt lds
  v_mfma_f32_16x16x32_bf16 v[236:239], v[44:47], a[172:175], v[236:239]
  s_waitcnt lgkmcnt(4)
  v_mfma_f32_16x16x32_bf16 v[80:83], v[48:51], a[160:163], v[80:83]
  ds_read_b64_tr_b16 v[32:33], v4 offset:24576
  s_add_u32 m0, s35, 4096
  v_mfma_f32_16x16x32_bf16 v[112:115], v[48:51], a[164:167], v[112:115]
  ds_read_b64_tr_b16 v[34:35], v4 offset:25600
  s_add_u32 s10, s10, s11
  v_mfma_f32_16x16x32_bf16 v[208:211], v[48:51], a[168:171], v[208:211]
  buffer_load_dwordx4 v29, s[4:7], s10 offen nt lds
  v_mfma_f32_16x16x32_bf16 v[240:243], v[48:51], a[172:175], v[240:243]
  v_mfma_f32_16x16x32_bf16 v[84:87], v[52:55], a[160:163], v[84:87]
  ds_read_b64_tr_b16 v[36:37], v5 offset:24576
  s_add_u32 m0, s35, 5120
  v_mfma_f32_16x16x32_bf16 v[116:119], v[52:55], a[164:167], v[116:119]
  ds_read_b64_tr_b16 v[38:39], v5 offset:25600
  s_add_u32 s10, s10, s11
  v_mfma_f32_16x16x32_bf16 v[212:215], v[52:55], a[168:171], v[212:215]
  buffer_load_dwordx4 v17, s[4:7], s10 offen nt lds
  v_mfma_f32_16x16x32_bf16 v[244:247], v[52:55], a[172:175], v[244:247]
  s_waitcnt lgkmcnt(4)
  v_mfma_f32_16x16x32_bf16 v[88:91], v[56:59], a[160:163], v[88:91]
  ds_read_b64_tr_b16 v[40:41], v6 offset:24576
  s_add_u32 m0, s35, 6144
  v_mfma_f32_16x16x32_bf16 v[120:123], v[56:59], a[164:167], v[120:123]
  ds_read_b64_tr_b16 v[42:43], v6 offset:25600
  s_add_u32 s10, s10, s11
  v_mfma_f32_16x16x32_bf16 v[216:219], v[56:59], a[168:171], v[216:219]
  buffer_load_dwordx4 v29, s[4:7], s10 offen nt lds
  v_mfma_f32_16x16x32_bf16 v[248:251], v[56:59], a[172:175], v[248:251]
  v_mfma_f32_16x16x32_bf16 v[92:95], v[60:63], a[160:163], v[92:95]
  ds_read_b64_tr_b16 v[44:45], v7 offset:24576
  s_add_u32 m0, s35, 7168
  v_mfma_f32_16x16x32_bf16 v[124:127], v[60:63], a[164:167], v[124:127]
  ds_read_b64_tr_b16 v[46:47], v7 offset:25600
  s_add_u32 s10, s10, s11
  v_mfma_f32_16x16x32_bf16 v[220:223], v[60:63], a[168:171], v[220:223]
  buffer_load_dwordx4 v17, s[4:7], s10 offen nt lds
  v_mfma_f32_16x16x32_bf16 v[252:255], v[60:63], a[172:175], v[252:255]
  s_waitcnt vmcnt(25) lgkmcnt(4)
  v_mfma_f32_16x16x32_bf16 v[64:67], v[32:35], a[176:179], v[64:67]
  ds_read_b64_tr_b16 v[48:49], v8 offset:24576
  v_mfma_f32_16x16x32_bf16 v[96:99], v[32:35], a[180:183], v[96:99]
  ds_read_b64_tr_b16 v[50:51], v8 offset:25600
  v_mfma_f32_16x16x32_bf16 v[192:195], v[32:35], a[184:187], v[192:195]
  v_mfma_f32_16x16x32_bf16 v[224:227], v[32:35], a[188:191], v[224:227]
  v_mfma_f32_16x16x32_bf16 v[68:71], v[36:39], a[176:179], v[68:71]
  ds_read_b64_tr_b16 v[52:53], v9 offset:24576
  v_mfma_f32_16x16x32_bf16 v[100:103], v[36:39], a[180:183], v[100:103]
  ds_read_b64_tr_b16 v[54:55], v9 offset:25600
  v_mfma_f32_16x16x32_bf16 v[196:199], v[36:39], a[184:187], v[196:199]
  v_mfma_f32_16x16x32_bf16 v[228:231], v[36:39], a[188:191], v[228:231]
  s_waitcnt lgkmcnt(4)
  v_mfma_f32_16x16x32_bf16 v[72:75], v[40:43], a[176:179], v[72:75]
  ds_read_b64_tr_b16 v[56:57], v10 offset:24576
  v_mfma_f32_16x16x32_bf16 v[104:107], v[40:43], a[180:183], v[104:107]
  ds_read_b64_tr_b16 v[58:59], v10 offset:25600
  v_mfma_f32_16x16x32_bf16 v[200:203], v[40:43], a[184:187], v[200:203]
  v_mfma_f32_16x16x32_bf16 v[232:235], v[40:43], a[188:191], v[232:235]
  v_mfma_f32_16x16x32_bf16 v[76:79], v[44:47], a[176:179], v[76:79]
  ds_read_b64_tr_b16 v[60:61], v11 offset:24576
  v_subrev_u32 v4, 0x8000, v4
  v_mfma_f32_16x16x32_bf16 v[108:111], v[44:47], a[180:183], v[108:111]
  ds_read_b64_tr_b16 v[62:63], v11 offset:25600
  v_mfma_f32_16x16x32_bf16 v[204:207], v[44:47], a[184:187], v[204:207]
  v_mfma_f32_16x16x32_bf16 v[236:239], v[44:47], a[188:191], v[236:239]
  s_waitcnt lgkmcnt(4)
  s_nop 0
  v_mfma_f32_16x16x32_bf16 v[80:83], v[48:51], a[176:179], v[80:83]
  s_barrier
  v_subrev_u32 v5, 0x8000, v5
  v_mfma_f32_16x16x32_bf16 v[112:115], v[48:51], a[180:183], v[112:115]
  ds_read_b64_tr_b16 v[32:33], v4 offset:0
  v_mfma_f32_16x16x32_bf16 v[208:211], v[48:51], a[184:187], v[208:211]
  ds_read_b64_tr_b16 v[34:35], v4 offset:1024
  v_mfma_f32_16x16x32_bf16 v[240:243], v[48:51], a[188:191], v[240:243]
  v_mfma_f32_16x16x32_bf16 v[84:87], v[52:55], a[176:179], v[84:87]
  ds_read_b64_tr_b16 v[36:37], v5 offset:0
  v_subrev_u32 v6, 0x8000, v6
  v_mfma_f32_16x16x32_bf16 v[116:119], v[52:55], a[180:183], v[116:119]
  ds_read_b64_tr_b16 v[38:39], v5 offset:1024
  v_mfma_f32_16x16x32_bf16 v[212:215], v[52:55], a[184:187], v[212:215]
  v_mfma_f32_16x16x32_bf16 v[244:247], v[52:55], a[188:191], v[244:247]
  s_waitcnt lgkmcnt(4)
  v_mfma_f32_16x16x32_bf16 v[88:91], v[56:59], a[176:179], v[88:91]
  ds_read_b64_tr_b16 v[40:41], v6 offset:0
  v_subrev_u32 v7, 0x8000, v7
  v_mfma_f32_16x16x32_bf16 v[120:123], v[56:59], a[180:183], v[120:123]
  ds_read_b64_tr_b16 v[42:43], v6 offset:1024
  v_mfma_f32_16x16x32_bf16 v[216:219], v[56:59], a[184:187], v[216:219]
  v_mfma_f32_16x16x32_bf16 v[248:251], v[56:59], a[188:191], v[248:251]
  v_mfma_f32_16x16x32_bf16 v[92:95], v[60:63], a[176:179], v[92:95]
  ds_read_b64_tr_b16 v[44:45], v7 offset:0
  v_subrev_u32 v8, 0x8000, v8
  v_mfma_f32_16x16x32_bf16 v[124:127], v[60:63], a[180:183], v[124:127]
  ds_read_b64_tr_b16 v[46:47], v7 offset:1024
  v_mfma_f32_16x16x32_bf16 v[220:223], v[60:63], a[184:187], v[220:223]
  v_mfma_f32_16x16x32_bf16 v[252:255], v[60:63], a[188:191], v[252:255]
  s_waitcnt vmcnt(21) lgkmcnt(4)
  v_mfma_f32_16x16x32_bf16 v[64:67], v[32:35], a[192:195], v[64:67]
  ds_read_b64_tr_b16 v[48:49], v8 offset:0
  v_subrev_u32 v9, 0x8000, v9
  v_mfma_f32_16x16x32_bf16 v[96:99], v[32:35], a[196:199], v[96:99]
  ds_read_b64_tr_b16 v[50:51], v8 offset:1024
  v_mfma_f32_16x16x32_bf16 v[192:195], v[32:35], a[200:203], v[192:195]
  v_mfma_f32_16x16x32_bf16 v[224:227], v[32:35], a[204:207], v[224:227]
  v_mfma_f32_16x16x32_bf16 v[68:71], v[36:39], a[192:195], v[68:71]
  ds_read_b64_tr_b16 v[52:53], v9 offset:0
  v_subrev_u32 v10, 0x8000, v10
  v_mfma_f32_16x16x32_bf16 v[100:103], v[36:39], a[196:199], v[100:103]
  ds_read_b64_tr_b16 v[54:55], v9 offset:1024
  v_mfma_f32_16x16x32_bf16 v[196:199], v[36:39], a[200:203], v[196:199]
  v_mfma_f32_16x16x32_bf16 v[228:231], v[36:39], a[204:207], v[228:231]
  s_waitcnt lgkmcnt(4)
  v_mfma_f32_16x16x32_bf16 v[72:75], v[40:43], a[192:195], v[72:75]
  ds_read_b64_tr_b16 v[56:57], v10 offset:0
  v_subrev_u32 v11, 0x8000, v11
  v_mfma_f32_16x16x32_bf16 v[104:107], v[40:43], a[196:199], v[104:107]
  ds_read_b64_tr_b16 v[58:59], v10 offset:1024
  v_mfma_f32_16x16x32_bf16 v[200:203], v[40:43], a[200:203], v[200:203]
  v_mfma_f32_16x16x32_bf16 v[232:235], v[40:43], a[204:207], v[232:235]
  v_mfma_f32_16x16x32_bf16 v[76:79], v[44:47], a[192:195], v[76:79]
  ds_read_b64_tr_b16 v[60:61], v11 offset:0
  v_mfma_f32_16x16x32_bf16 v[108:111], v[44:47], a[196:199], v[108:111]
  ds_read_b64_tr_b16 v[62:63], v11 offset:1024
  v_mfma_f32_16x16x32_bf16 v[204:207], v[44:47], a[200:203], v[204:207]
  v_mfma_f32_16x16x32_bf16 v[236:239], v[44:47], a[204:207], v[236:239]
  s_waitcnt lgkmcnt(4)
  v_mfma_f32_16x16x32_bf16 v[80:83], v[48:51], a[192:195], v[80:83]
  ds_read_b64_tr_b16 v[32:33], v4 offset:8192
  v_mfma_f32_16x16x32_bf16 v[112:115], v[48:51], a[196:199], v[112:115]
  ds_read_b64_tr_b16 v[34:35], v4 offset:9216
  v_mfma_f32_16x16x32_bf16 v[208:211], v[48:51], a[200:203], v[208:211]
  v_mfma_f32_16x16x32_bf16 v[240:243], v[48:51], a[204:207], v[240:243]
  v_mfma_f32_16x16x32_bf16 v[84:87], v[52:55], a[192:195], v[84:87]
  ds_read_b64_tr_b16 v[36:37], v5 offset:8192
  v_mfma_f32_16x16x32_bf16 v[116:119], v[52:55], a[196:199], v[116:119]
  ds_read_b64_tr_b16 v[38:39], v5 offset:9216
  v_mfma_f32_16x16x32_bf16 v[212:215], v[52:55], a[200:203], v[212:215]
  v_mfma_f32_16x16x32_bf16 v[244:247], v[52:55], a[204:207], v[244:247]
  s_waitcnt lgkmcnt(4)
  v_mfma_f32_16x16x32_bf16 v[88:91], v[56:59], a[192:195], v[88:91]
  ds_read_b64_tr_b16 v[40:41], v6 offset:8192
  v_mfma_f32_16x16x32_bf16 v[120:123], v[56:59], a[196:199], v[120:123]
  ds_read_b64_tr_b16 v[42:43], v6 offset:9216
  v_mfma_f32_16x16x32_bf16 v[216:219], v[56:59], a[200:203], v[216:219]
  v_mfma_f32_16x16x32_bf16 v[248:251], v[56:59], a[204:207], v[248:251]
  v_mfma_f32_16x16x32_bf16 v[92:95], v[60:63], a[192:195], v[92:95]
  ds_read_b64_tr_b16 v[44:45], v7 offset:8192
  v_mfma_f32_16x16x32_bf16 v[124:127], v[60:63], a[196:199], v[124:127]
  ds_read_b64_tr_b16 v[46:47], v7 offset:9216
  v_mfma_f32_16x16x32_bf16 v[220:223], v[60:63], a[200:203], v[220:223]
  v_mfma_f32_16x16x32_bf16 v[252:255], v[60:63], a[204:207], v[252:255]
  s_waitcnt vmcnt(16) lgkmcnt(4)
  v_mfma_f32_16x16x32_bf16 v[64:67], v[32:35], a[208:211], v[64:67]
  ds_read_b64_tr_b16 v[48:49], v8 offset:8192
  v_mfma_f32_16x16x32_bf16 v[96:99], v[32:35], a[212:215], v[96:99]
  ds_read_b64_tr_b16 v[50:51], v8 offset:9216
  v_mfma_f32_16x16x32_bf16 v[192:195], v[32:35], a[216:219], v[192:195]
  v_mfma_f32_16x16x32_bf16 v[224:227], v[32:35], a[220:223], v[224:227]
  v_mfma_f32_16x16x32_bf16 v[68:71], v[36:39], a[208:211], v[68:71]
  ds_read_b64_tr_b16 v[52:53], v9 offset:8192
  v_mfma_f32_16x16x32_bf16 v[100:103], v[36:39], a[212:215], v[100:103]
  ds_read_b64_tr_b16 v[54:55], v9 offset:9216
  v_mfma_f32_16x16x32_bf16 v[196:199], v[36:39], a[216:219], v[196:199]
  v_mfma_f32_16x16x32_bf16 v[228:231], v[36:39], a[220:223], v[228:231]
  s_waitcnt lgkmcnt(4)
  v_mfma_f32_16x16x32_bf16 v[72:75], v[40:43], a[208:211], v[72:75]
  ds_read_b64_tr_b16 v[56:57], v10 offset:8192
  v_mfma_f32_16x16x32_bf16 v[104:107], v[40:43], a[212:215], v[104:107]
  ds_read_b64_tr_b16 v[58:59], v10 offset:9216
  v_mfma_f32_16x16x32_bf16 v[200:203], v[40:43], a[216:219], v[200:203]
  v_mfma_f32_16x16x32_bf16 v[232:235], v[40:43], a[220:223], v[232:235]
  v_mfma_f32_16x16x32_bf16 v[76:79], v[44:47], a[208:211], v[76:79]
  ds_read_b64_tr_b16 v[60:61], v11 offset:8192
  v_mfma_f32_16x16x32_bf16 v[108:111], v[44:47], a[212:215], v[108:111]
  ds_read_b64_tr_b16 v[62:63], v11 offset:9216
  v_mfma_f32_16x16x32_bf16 v[204:207], v[44:47], a[216:219], v[204:207]
  v_mfma_f32_16x16x32_bf16 v[236:239], v[44:47], a[220:223], v[236:239]
  s_waitcnt lgkmcnt(4)
  v_mfma_f32_16x16x32_bf16 v[80:83], v[48:51], a[208:211], v[80:83]
  ds_read_b64_tr_b16 v[32:33], v4 offset:16384
  v_mfma_f32_16x16x32_bf16 v[112:115], v[48:51], a[212:215], v[112:115]
  ds_read_b64_tr_b16 v[34:35], v4 offset:17408
  v_mfma_f32_16x16x32_bf16 v[208:211], v[48:51], a[216:219], v[208:211]
  v_mfma_f32_16x16x32_bf16 v[240:243], v[48:51], a[220:223], v[240:243]
  v_mfma_f32_16x16x32_bf16 v[84:87], v[52:55], a[208:211], v[84:87]
  ds_read_b64_tr_b16 v[36:37], v5 offset:16384
  v_mfma_f32_16x16x32_bf16 v[116:119], v[52:55], a[212:215], v[116:119]
  ds_read_b64_tr_b16 v[38:39], v5 offset:17408
  v_mfma_f32_16x16x32_bf16 v[212:215], v[52:55], a[216:219], v[212:215]
  v_mfma_f32_16x16x32_bf16 v[244:247], v[52:55], a[220:223], v[244:247]
  s_waitcnt lgkmcnt(4)
  v_mfma_f32_16x16x32_bf16 v[88:91], v[56:59], a[208:211], v[88:91]
  ds_read_b64_tr_b16 v[40:41], v6 offset:16384
  v_mfma_f32_16x16x32_bf16 v[120:123], v[56:59], a[212:215], v[120:123]
  ds_read_b64_tr_b16 v[42:43], v6 offset:17408
  v_mfma_f32_16x16x32_bf16 v[216:219], v[56:59], a[216:219], v[216:219]
  v_mfma_f32_16x16x32_bf16 v[248:251], v[56:59], a[220:223], v[248:251]
  v_mfma_f32_16x16x32_bf16 v[92:95], v[60:63], a[208:211], v[92:95]
  ds_read_b64_tr_b16 v[44:45], v7 offset:16384
  v_mfma_f32_16x16x32_bf16 v[124:127], v[60:63], a[212:215], v[124:127]
  ds_read_b64_tr_b16 v[46:47], v7 offset:17408
  v_mfma_f32_16x16x32_bf16 v[220:223], v[60:63], a[216:219], v[220:223]
  v_mfma_f32_16x16x32_bf16 v[252:255], v[60:63], a[220:223], v[252:255]
  s_waitcnt vmcnt(12) lgkmcnt(4)
  v_mfma_f32_16x16x32_bf16 v[64:67], v[32:35], a[224:227], v[64:67]
  ds_read_b64_tr_b16 v[48:49], v8 offset:16384
  v_mfma_f32_16x16x32_bf16 v[96:99], v[32:35], a[228:231], v[96:99]
  ds_read_b64_tr_b16 v[50:51], v8 offset:17408
  v_mfma_f32_16x16x32_bf16 v[192:195], v[32:35], a[232:235], v[192:195]
  buffer_load_dword v22, v15, s[20:23], s54 offen sc1
  v_mfma_f32_16x16x32_bf16 v[224:227], v[32:35], a[236:239], v[224:227]
  v_mfma_f32_16x16x32_bf16 v[68:71], v[36:39], a[224:227], v[68:71]
  ds_read_b64_tr_b16 v[52:53], v9 offset:16384
  v_mfma_f32_16x16x32_bf16 v[100:103], v[36:39], a[228:231], v[100:103]
  ds_read_b64_tr_b16 v[54:55], v9 offset:17408
  v_mfma_f32_16x16x32_bf16 v[196:199], v[36:39], a[232:235], v[196:199]
  v_mfma_f32_16x16x32_bf16 v[228:231], v[36:39], a[236:239], v[228:231]
  s_waitcnt lgkmcnt(4)
  v_mfma_f32_16x16x32_bf16 v[72:75], v[40:43], a[224:227], v[72:75]
  ds_read_b64_tr_b16 v[56:57], v10 offset:16384
  v_mfma_f32_16x16x32_bf16 v[104:107], v[40:43], a[228:231], v[104:107]
  ds_read_b64_tr_b16 v[58:59], v10 offset:17408
  v_mfma_f32_16x16x32_bf16 v[200:203], v[40:43], a[232:235], v[200:203]
  v_mfma_f32_16x16x32_bf16 v[232:235], v[40:43], a[236:239], v[232:235]
  v_mfma_f32_16x16x32_bf16 v[76:79], v[44:47], a[224:227], v[76:79]
  ds_read_b64_tr_b16 v[60:61], v11 offset:16384
  v_mfma_f32_16x16x32_bf16 v[108:111], v[44:47], a[228:231], v[108:111]
  ds_read_b64_tr_b16 v[62:63], v11 offset:17408
  v_mfma_f32_16x16x32_bf16 v[204:207], v[44:47], a[232:235], v[204:207]
  v_mfma_f32_16x16x32_bf16 v[236:239], v[44:47], a[236:239], v[236:239]
  s_waitcnt lgkmcnt(4)
  v_mfma_f32_16x16x32_bf16 v[80:83], v[48:51], a[224:227], v[80:83]
  ds_read_b64_tr_b16 v[32:33], v4 offset:24576
  v_mfma_f32_16x16x32_bf16 v[112:115], v[48:51], a[228:231], v[112:115]
  ds_read_b64_tr_b16 v[34:35], v4 offset:25600
  v_mfma_f32_16x16x32_bf16 v[208:211], v[48:51], a[232:235], v[208:211]
  v_mfma_f32_16x16x32_bf16 v[240:243], v[48:51], a[236:239], v[240:243]
  v_mfma_f32_16x16x32_bf16 v[84:87], v[52:55], a[224:227], v[84:87]
  ds_read_b64_tr_b16 v[36:37], v5 offset:24576
  s_waitcnt vmcnt(1)
  v_mfma_f32_16x16x32_bf16 v[116:119], v[52:55], a[228:231], v[116:119]
  ds_read_b64_tr_b16 v[38:39], v5 offset:25600
  ds_read_b64_tr_b16 v[160:161], v26
  ds_read_b64_tr_b16 v[162:163], v3
  v_mfma_f32_16x16x32_bf16 v[212:215], v[52:55], a[232:235], v[212:215]
  v_xor_b32 v26, 32, v26
  v_xor_b32 v3, 32, v3
  v_mfma_f32_16x16x32_bf16 v[244:247], v[52:55], a[236:239], v[244:247]
  s_waitcnt lgkmcnt(6)
  ds_read_b64_tr_b16 v[164:165], v26
  ds_read_b64_tr_b16 v[166:167], v3
  v_mfma_f32_16x16x32_bf16 v[88:91], v[56:59], a[224:227], v[88:91]
  ds_read_b64_tr_b16 v[40:41], v6 offset:24576
  v_xor_b32 v26, 64, v26
  v_xor_b32 v3, 64, v3
  v_mfma_f32_16x16x32_bf16 v[120:123], v[56:59], a[228:231], v[120:123]
  ds_read_b64_tr_b16 v[42:43], v6 offset:25600
  ds_read_b64_tr_b16 v[172:173], v26
  ds_read_b64_tr_b16 v[174:175], v3
  v_mfma_f32_16x16x32_bf16 v[216:219], v[56:59], a[232:235], v[216:219]
  v_xor_b32 v26, 32, v26
  v_xor_b32 v3, 32, v3
  v_mfma_f32_16x16x32_bf16 v[248:251], v[56:59], a[236:239], v[248:251]
  ds_read_b64_tr_b16 v[168:169], v26
  ds_read_b64_tr_b16 v[170:171], v3
  v_mfma_f32_16x16x32_bf16 v[92:95], v[60:63], a[224:227], v[92:95]
  ds_read_b64_tr_b16 v[44:45], v7 offset:24576
  v_xor_b32 v26, 128, v26
  v_xor_b32 v3, 128, v3
  v_mfma_f32_16x16x32_bf16 v[124:127], v[60:63], a[228:231], v[124:127]
  ds_read_b64_tr_b16 v[46:47], v7 offset:25600
  ds_read_b64_tr_b16 v[184:185], v26
  ds_read_b64_tr_b16 v[186:187], v3
  v_mfma_f32_16x16x32_bf16 v[220:223], v[60:63], a[232:235], v[220:223]
  v_xor_b32 v26, 32, v26
  v_xor_b32 v3, 32, v3
  v_mfma_f32_16x16x32_bf16 v[252:255], v[60:63], a[236:239], v[252:255]
  s_waitcnt lgkmcnt(14)
  ds_read_b64_tr_b16 v[188:189], v26
  ds_read_b64_tr_b16 v[190:191], v3
  v_mfma_f32_16x16x32_bf16 v[64:67], v[32:35], a[240:243], v[64:67]
  ds_read_b64_tr_b16 v[48:49], v8 offset:24576
  v_xor_b32 v26, 64, v26
  v_xor_b32 v3, 64, v3
  v_mfma_f32_16x16x32_bf16 v[96:99], v[32:35], a[244:247], v[96:99]
  ds_read_b64_tr_b16 v[50:51], v8 offset:25600
  ds_read_b64_tr_b16 v[180:181], v26
  ds_read_b64_tr_b16 v[182:183], v3
  v_mfma_f32_16x16x32_bf16 v[192:195], v[32:35], a[248:251], v[192:195]
  v_xor_b32 v26, 32, v26
  v_xor_b32 v3, 32, v3
  v_mfma_f32_16x16x32_bf16 v[224:227], v[32:35], a[252:255], v[224:227]
  ds_read_b64_tr_b16 v[176:177], v26
  ds_read_b64_tr_b16 v[178:179], v3
  v_mfma_f32_16x16x32_bf16 v[68:71], v[36:39], a[240:243], v[68:71]
  ds_read_b64_tr_b16 v[52:53], v9 offset:24576
  v_mfma_f32_16x16x32_bf16 v[100:103], v[36:39], a[244:247], v[100:103]
  ds_read_b64_tr_b16 v[54:55], v9 offset:25600
  v_mfma_f32_16x16x32_bf16 v[196:199], v[36:39], a[248:251], v[196:199]
  v_mfma_f32_16x16x32_bf16 v[228:231], v[36:39], a[252:255], v[228:231]
  s_waitcnt lgkmcnt(12)
  v_mfma_f32_16x16x32_bf16 v[72:75], v[40:43], a[240:243], v[72:75]
  ds_read_b64_tr_b16 v[56:57], v10 offset:24576
  v_mfma_f32_16x16x32_bf16 v[104:107], v[40:43], a[244:247], v[104:107]
  ds_read_b64_tr_b16 v[58:59], v10 offset:25600
  v_mfma_f32_16x16x32_bf16 v[200:203], v[40:43], a[248:251], v[200:203]
  v_mfma_f32_16x16x32_bf16 v[232:235], v[40:43], a[252:255], v[232:235]
  v_mfma_f32_16x16x32_bf16 v[76:79], v[44:47], a[240:243], v[76:79]
  ds_read_b64_tr_b16 v[60:61], v11 offset:24576
  v_mfma_f32_16x16x32_bf16 v[108:111], v[44:47], a[244:247], v[108:111]
  ds_read_b64_tr_b16 v[62:63], v11 offset:25600
  v_mfma_f32_16x16x32_bf16 v[204:207], v[44:47], a[248:251], v[204:207]
  s_waitcnt vmcnt(0)
  v_cmp_ne_u32 vcc, v25, v22
  v_mfma_f32_16x16x32_bf16 v[236:239], v[44:47], a[252:255], v[236:239]
  s_waitcnt lgkmcnt(4)
  s_cbranch_vccnz KA_KSPIN
KA_KSPIN_RET:
  v_mfma_f32_16x16x32_bf16 v[80:83], v[48:51], a[240:243], v[80:83]
  v_mfma_f32_16x16x32_bf16 v[112:115], v[48:51], a[244:247], v[112:115]
  v_mfma_f32_16x16x32_bf16 v[208:211], v[48:51], a[248:251], v[208:211]
  v_mfma_f32_16x16x32_bf16 v[240:243], v[48:51], a[252:255], v[240:243]
  v_mfma_f32_16x16x32_bf16 v[84:87], v[52:55], a[240:243], v[84:87]
  v_mfma_f32_16x16x32_bf16 v[116:119], v[52:55], a[244:247], v[116:119]
  v_mfma_f32_16x16x32_bf16 v[212:215], v[52:55], a[248:251], v[212:215]
  v_mfma_f32_16x16x32_bf16 v[244:247], v[52:55], a[252:255], v[244:247]
  s_waitcnt lgkmcnt(0)
  s_nop 0
  v_mfma_f32_16x16x32_bf16 v[88:91], v[56:59], a[240:243], v[88:91]
  s_barrier
  v_mfma_f32_16x16x32_bf16 v[120:123], v[56:59], a[244:247], v[120:123]
  v_mov_b32 v4, v132
  v_mov_b32 v5, v133
  v_mfma_f32_16x16x32_bf16 v[216:219], v[56:59], a[248:251], v[216:219]
  v_mov_b32 v6, v134
  v_mov_b32 v7, v135
  v_mfma_f32_16x16x32_bf16 v[248:251], v[56:59], a[252:255], v[248:251]
  v_mov_b32 v8, v136
  v_mov_b32 v9, v137
  v_mfma_f32_16x16x32_bf16 v[92:95], v[60:63], a[240:243], v[92:95]
  v_mov_b32 v10, v138
  v_mov_b32 v11, v139
  v_mfma_f32_16x16x32_bf16 v[124:127], v[60:63], a[244:247], v[124:127]
  v_mfma_f32_16x16x32_bf16 v[220:223], v[60:63], a[248:251], v[220:223]
  v_mfma_f32_16x16x32_bf16 v[252:255], v[60:63], a[252:255], v[252:255]
  s_lshl_b32 s47, s32, 15
  s_lshl_b32 s46, s31, 14
  s_add_u32 s47, s47, s46
  s_add_u32 s47, s47, 98304
  v_add_u32 v12, s47, v1
  s_lshl_b32 s40, s30, 12
  s_and_b32 m0, s39, 0xffff
  v_cvt_pk_bf16_f32 v64, v64, v65
  v_cvt_pk_bf16_f32 v65, v66, v67
  v_cvt_pk_bf16_f32 v66, v68, v69
  v_cvt_pk_bf16_f32 v67, v70, v71
  ds_write_b128 v12, v[64:67] offset:0
  buffer_load_dwordx4 v4, s[12:15], s36 offen offset:0 lds
  buffer_load_dwordx4 v4, s[12:15], s36 offen offset:1024 lds
  v_cvt_pk_bf16_f32 v96, v96, v97
  v_cvt_pk_bf16_f32 v97, v98, v99
  v_cvt_pk_bf16_f32 v98, v100, v101
  v_cvt_pk_bf16_f32 v99, v102, v103
  ds_write_b128 v12, v[96:99] offset:4096
  buffer_load_dwordx4 v4, s[12:15], s36 offen offset:2048 lds
  buffer_load_dwordx4 v4, s[12:15], s36 offen offset:3072 lds
  s_add_u32 s39, s39, 16384
  s_add_u32 s36, s36, 16384
  s_cmp_eq_u32 s36, s37
  s_cselect_b32 s36, 0, s36
  s_cselect_b32 s14, s38, s14
  s_and_b32 m0, s39, 0xffff
  v_cvt_pk_bf16_f32 v192, v192, v193
  v_cvt_pk_bf16_f32 v193, v194, v195
  v_cvt_pk_bf16_f32 v194, v196, v197
  v_cvt_pk_bf16_f32 v195, v198, v199
  ds_write_b128 v12, v[192:195] offset:8192
  buffer_load_dwordx4 v4, s[12:15], s36 offen offset:0 lds
  buffer_load_dwordx4 v4, s[12:15], s36 offen offset:1024 lds
  v_cvt_pk_bf16_f32 v224, v224, v225
  v_cvt_pk_bf16_f32 v225, v226, v227
  v_cvt_pk_bf16_f32 v226, v228, v229
  v_cvt_pk_bf16_f32 v227, v230, v231
  ds_write_b128 v12, v[224:227] offset:12288
  buffer_load_dwordx4 v4, s[12:15], s36 offen offset:2048 lds
  buffer_load_dwordx4 v4, s[12:15], s36 offen offset:3072 lds
  s_add_u32 s39, s39, 16384
  s_add_u32 s36, s36, 16384
  s_cmp_eq_u32 s36, s37
  s_cselect_b32 s36, 0, s36
  s_cselect_b32 s14, s38, s14
  v_cvt_pk_bf16_f32 v72, v72, v73
  v_cvt_pk_bf16_f32 v73, v74, v75
  v_cvt_pk_bf16_f32 v74, v76, v77
  v_cvt_pk_bf16_f32 v75, v78, v79
  ds_write_b128 v12, v[72:75] offset:1024
  v_cvt_pk_bf16_f32 v104, v104, v105
  v_cvt_pk_bf16_f32 v105, v106, v107
  v_cvt_pk_bf16_f32 v106, v108, v109
  v_cvt_pk_bf16_f32 v107, v110, v111
  ds_write_b128 v12, v[104:107] offset:5120
  v_cvt_pk_bf16_f32 v200, v200, v201
  v_cvt_pk_bf16_f32 v201, v202, v203
  v_cvt_pk_bf16_f32 v202, v204, v205
  v_cvt_pk_bf16_f32 v203, v206, v207
  ds_write_b128 v12, v[200:203] offset:9216
  v_cvt_pk_bf16_f32 v232, v232, v233
  v_cvt_pk_bf16_f32 v233, v234, v235
  v_cvt_pk_bf16_f32 v234, v236, v237
  v_cvt_pk_bf16_f32 v235, v238, v239
  ds_write_b128 v12, v[232:235] offset:13312
  s_and_b32 m0, s39, 0xffff
  v_cvt_pk_bf16_f32 v80, v80, v81
  v_cvt_pk_bf16_f32 v81, v82, v83
  v_cvt_pk_bf16_f32 v82, v84, v85
  v_cvt_pk_bf16_f32 v83, v86, v87
  ds_write_b128 v12, v[80:83] offset:2048
  buffer_load_dwordx4 v4, s[12:15], s36 offen offset:0 lds
  v_cvt_pk_bf16_f32 v112, v112, v113
  v_cvt_pk_bf16_f32 v113, v114, v115
  v_cvt_pk_bf16_f32 v114, v116, v117
  v_cvt_pk_bf16_f32 v115, v118, v119
  ds_write_b128 v12, v[112:115] offset:6144
  buffer_load_dwordx4 v4, s[12:15], s36 offen offset:1024 lds
  v_cvt_pk_bf16_f32 v208, v208, v209
  v_cvt_pk_bf16_f32 v209, v210, v211
  v_cvt_pk_bf16_f32 v210, v212, v213
  v_cvt_pk_bf16_f32 v211, v214, v215
  ds_write_b128 v12, v[208:211] offset:10240
  buffer_load_dwordx4 v4, s[12:15], s36 offen offset:2048 lds
  v_cvt_pk_bf16_f32 v240, v240, v241
  v_cvt_pk_bf16_f32 v241, v242, v243
  v_cvt_pk_bf16_f32 v242, v244, v245
  v_cvt_pk_bf16_f32 v243, v246, v247
  ds_write_b128 v12, v[240:243] offset:14336
  buffer_load_dwordx4 v4, s[12:15], s36 offen offset:3072 lds
  s_add_u32 s39, s39, 16384
  s_add_u32 s36, s36, 16384
  s_cmp_eq_u32 s36, s37
  s_cselect_b32 s36, 0, s36
  s_cselect_b32 s14, s38, s14
  v_cvt_pk_bf16_f32 v88, v88, v89
  v_cvt_pk_bf16_f32 v89, v90, v91
  v_cvt_pk_bf16_f32 v90, v92, v93
  v_cvt_pk_bf16_f32 v91, v94, v95
  ds_write_b128 v12, v[88:91] offset:3072
  v_cvt_pk_bf16_f32 v120, v120, v121
  v_cvt_pk_bf16_f32 v121, v122, v123
  v_cvt_pk_bf16_f32 v122, v124, v125
  v_cvt_pk_bf16_f32 v123, v126, v127
  ds_write_b128 v12, v[120:123] offset:7168
  v_cvt_pk_bf16_f32 v216, v216, v217
  v_cvt_pk_bf16_f32 v217, v218, v219
  v_cvt_pk_bf16_f32 v218, v220, v221
  v_cvt_pk_bf16_f32 v219, v222, v223
  ds_write_b128 v12, v[216:219] offset:11264
  v_cvt_pk_bf16_f32 v248, v248, v249
  v_cvt_pk_bf16_f32 v249, v250, v251
  v_cvt_pk_bf16_f32 v250, v252, v253
  v_cvt_pk_bf16_f32 v251, v254, v255
  ds_write_b128 v12, v[248:251] offset:15360
  v_add_u32 v12, 98304, v10
  v_add_u32 v13, 98304, v11
  v_add_u32 v10, 0x20000, v10
  v_add_u32 v11, 0x20000, v11
  s_waitcnt vmcnt(4) lgkmcnt(0)
  s_barrier
  v_mov_b32 v14, v25
  v_mov_b32 v15, v27
  ds_read_b128 a[192:195], v2 offset:0
  ds_read_b128 a[128:131], v12 offset:0
  ds_read_b128 a[196:199], v2 offset:1024
  ds_read_b128 a[144:147], v12 offset:4096
  ds_read_b128 a[200:203], v2 offset:2048
  ds_read_b128 a[132:135], v12 offset:1024
  ds_read_b128 a[204:207], v2 offset:3072
  ds_read_b128 a[148:151], v12 offset:5120
  ds_read_b128 a[208:211], v2 offset:4096
  ds_read_b128 a[136:139], v12 offset:2048
  ds_read_b128 a[212:215], v2 offset:5120
  ds_read_b128 a[152:155], v12 offset:6144
  ds_read_b128 a[216:219], v2 offset:6144
  ds_read_b128 a[140:143], v12 offset:3072
  ds_read_b128 a[220:223], v2 offset:7168
  ds_read_b128 a[156:159], v12 offset:7168
  ds_read_b128 a[160:163], v13 offset:0
  ds_read_b128 a[164:167], v13 offset:1024
  ds_read_b128 a[168:171], v13 offset:2048
  ds_read_b128 a[172:175], v13 offset:3072
  ds_read_b128 a[176:179], v13 offset:4096
  ds_read_b128 a[180:183], v13 offset:5120
  ds_read_b128 a[184:187], v13 offset:6144
  ds_read_b128 a[188:191], v13 offset:7168
  s_lshl_b32 s46, s32, 13
  s_add_u32 s46, s46, 0x18000
  v_add_u32 v3, s46, v1
  v_mov_b32 v244, 0x3f803f80
  v_mov_b32 v245, 0x3f803f80
  v_mov_b32 v246, 0x3f803f80
  v_mov_b32 v247, 0x3f803f80
  s_lshr_b32 s41, s45, 1
  s_sub_u32 s41, s41, 1
  v_mov_b32 v96, 0
  v_mov_b32 v97, 0
  v_mov_b32 v98, 0
  v_mov_b32 v99, 0
  s_mov_b32 s42, 4048155338
  s_waitcnt lgkmcnt(15)
  v_mfma_f32_16x16x32_bf16 v[16:19], a[192:195], a[128:131], 0
  v_mfma_f32_16x16x32_bf16 v[24:27], a[192:195], a[144:147], 0
  v_mov_b32 v13, 1400897536
  s_and_b32 m0, s39, 0xffff
  v_mfma_f32_16x16x32_bf16 v[20:23], a[196:199], a[128:131], 0
  buffer_load_dwordx4 v4, s[12:15], s36 offen offset:0 lds
  v_mfma_f32_16x16x32_bf16 v[28:31], a[196:199], a[144:147], 0
  s_nop 0
  v_mfma_f32_16x16x32_bf16 v[16:19], a[200:203], a[132:135], v[16:19]
  v_mfma_f32_16x16x32_bf16 v[24:27], a[200:203], a[148:151], v[24:27]
  buffer_load_dwordx4 v4, s[12:15], s36 offen offset:1024 lds
  v_mfma_f32_16x16x32_bf16 v[20:23], a[204:207], a[132:135], v[20:23]
  buffer_load_dwordx4 v4, s[12:15], s36 offen offset:2048 lds
  v_mfma_f32_16x16x32_bf16 v[28:31], a[204:207], a[148:151], v[28:31]
  s_waitcnt lgkmcnt(12)
  v_mfma_f32_16x16x32_bf16 v[16:19], a[208:211], a[136:139], v[16:19]
  buffer_load_dwordx4 v4, s[12:15], s36 offen offset:3072 lds
  v_mfma_f32_16x16x32_bf16 v[24:27], a[208:211], a[152:155], v[24:27]
  s_add_u32 s39, s39, 16384
  s_add_u32 s36, s36, 16384
  s_cmp_eq_u32 s36, s37
  s_cselect_b32 s36, 0, s36
  s_cselect_b32 s14, s38, s14
  v_mfma_f32_16x16x32_bf16 v[20:23], a[212:215], a[136:139], v[20:23]
  v_mfma_f32_16x16x32_bf16 v[28:31], a[212:215], a[152:155], v[28:31]
  s_waitcnt lgkmcnt(8)
  s_and_b32 s48, s40, 0xffff
  s_or_b32 m0, s48, 0x10000
  v_mfma_f32_16x16x32_bf16 v[16:19], a[216:219], a[140:143], v[16:19]
  v_mfma_f32_16x16x32_bf16 v[24:27], a[216:219], a[156:159], v[24:27]
  buffer_load_dwordx4 v1, s[16:19], s40 offen offset:0 lds
  v_mfma_f32_16x16x32_bf16 v[20:23], a[220:223], a[140:143], v[20:23]
  buffer_load_dwordx4 v1, s[16:19], s40 offen offset:1024 lds
  v_mfma_f32_16x16x32_bf16 v[28:31], a[220:223], a[156:159], v[28:31]
  s_waitcnt lgkmcnt(0)
  v_mfma_f32_16x16x32_bf16 v[32:35], a[192:195], a[160:163], 0
  v_mfma_f32_16x16x32_bf16 v[40:43], a[192:195], a[176:179], 0
  ds_read_b128 a[192:195], v2 offset:16384
  s_nop 0
  v_mfma_f32_16x16x32_bf16 v[36:39], a[196:199], a[160:163], 0
  v_mfma_f32_16x16x32_bf16 v[44:47], a[196:199], a[176:179], 0
  ds_read_b128 a[196:199], v2 offset:17408
  buffer_load_dwordx4 v1, s[16:19], s40 offen offset:2048 lds
  s_nop 0
  v_mfma_f32_16x16x32_bf16 v[32:35], a[200:203], a[164:167], v[32:35]
  v_mfma_f32_16x16x32_bf16 v[40:43], a[200:203], a[180:183], v[40:43]
  ds_read_b128 a[200:203], v2 offset:18432
  s_nop 0
  v_mfma_f32_16x16x32_bf16 v[36:39], a[204:207], a[164:167], v[36:39]
  v_mfma_f32_16x16x32_bf16 v[44:47], a[204:207], a[180:183], v[44:47]
  ds_read_b128 a[204:207], v2 offset:19456
  buffer_load_dwordx4 v1, s[16:19], s40 offen offset:3072 lds
  s_add_u32 s40, s40, 16384
  s_nop 0
  v_mfma_f32_16x16x32_bf16 v[32:35], a[208:211], a[168:171], v[32:35]
  v_mfma_f32_16x16x32_bf16 v[40:43], a[208:211], a[184:187], v[40:43]
  ds_read_b128 a[208:211], v2 offset:20480
  v_max3_f32 v144, v16, v17, v18
  v_max3_f32 v145, v24, v25, v26
  v_max3_f32 v144, v144, v19, v20
  v_max3_f32 v145, v145, v27, v28
  v_max3_f32 v144, v144, v21, v22
  v_max3_f32 v145, v145, v29, v30
  v_mfma_f32_16x16x32_bf16 v[36:39], a[212:215], a[168:171], v[36:39]
  v_mfma_f32_16x16x32_bf16 v[44:47], a[212:215], a[184:187], v[44:47]
  ds_read_b128 a[212:215], v2 offset:21504
  v_max3_f32 v144, v144, v23, s42
  v_max3_f32 v145, v145, v31, s42
  v_mov_b32 v156, v144
  v_mov_b32 v157, v145
  s_nop 0
  v_permlane16_swap_b32 v144, v156
  v_mfma_f32_16x16x32_bf16 v[32:35], a[216:219], a[172:175], v[32:35]
  v_mfma_f32_16x16x32_bf16 v[40:43], a[216:219], a[188:191], v[40:43]
  ds_read_b128 a[216:219], v2 offset:22528
  v_permlane16_swap_b32 v145, v157
  v_max_f32 v144, v144, v156
  v_max_f32 v145, v145, v157
  v_mov_b32 v156, v144
  v_mov_b32 v157, v145
  s_nop 0
  v_mfma_f32_16x16x32_bf16 v[36:39], a[220:223], a[172:175], v[36:39]
  v_mfma_f32_16x16x32_bf16 v[44:47], a[220:223], a[188:191], v[44:47]
  ds_read_b128 a[220:223], v2 offset:23552
  v_permlane32_swap_b32 v144, v156
  v_permlane32_swap_b32 v145, v157
  v_max_f32 v144, v144, v156
  v_max_f32 v145, v145, v157
  s_and_b32 s48, s40, 0xffff
  s_or_b32 m0, s48, 0x10000
  v_mfma_f32_32x32x16_bf16 a[0:15], v[96:99], v[96:99], 0
  buffer_load_dwordx4 v1, s[16:19], s40 offen offset:0 lds
  v_sub_f32 v112, 0, v144
  v_sub_f32 v113, 0, v144
  v_sub_f32 v114, 0, v144
  v_sub_f32 v115, 0, v144
  v_sub_f32 v116, 0, v145
  v_mfma_f32_32x32x16_bf16 a[16:31], v[96:99], v[96:99], 0
  buffer_load_dwordx4 v1, s[16:19], s40 offen offset:1024 lds
  v_sub_f32 v117, 0, v145
  v_sub_f32 v118, 0, v145
  v_sub_f32 v119, 0, v145
  v_mfma_f32_32x32x16_bf16 a[32:47], v[96:99], v[96:99], 0
  buffer_load_dwordx4 v1, s[16:19], s40 offen offset:2048 lds
  v_mfma_f32_32x32x16_bf16 a[48:63], v[96:99], v[96:99], 0
  buffer_load_dwordx4 v1, s[16:19], s40 offen offset:3072 lds
  v_max3_f32 v146, v32, v33, v34
  v_max3_f32 v147, v40, v41, v42
  v_max3_f32 v146, v146, v35, v36
  v_max3_f32 v147, v147, v43, v44
  s_add_u32 s40, s40, 16384
  v_mfma_f32_32x32x16_bf16 a[64:79], v[96:99], v[96:99], 0
  v_max3_f32 v146, v146, v37, v38
  v_max3_f32 v147, v147, v45, v46
  v_max3_f32 v146, v146, v39, s42
  v_max3_f32 v147, v147, v47, s42
  v_mov_b32 v158, v146
  v_xor_b32 v2, 0x8000, v2
  v_mfma_f32_32x32x16_bf16 a[80:95], v[96:99], v[96:99], 0
  v_mov_b32 v159, v147
  s_nop 0
  v_permlane16_swap_b32 v146, v158
  v_permlane16_swap_b32 v147, v159
  v_max_f32 v146, v146, v158
  v_max_f32 v147, v147, v159
  v_mfma_f32_32x32x16_bf16 a[96:111], v[96:99], v[96:99], 0
  v_mov_b32 v158, v146
  v_mov_b32 v159, v147
  s_nop 0
  v_permlane32_swap_b32 v146, v158
  v_permlane32_swap_b32 v147, v159
  s_waitcnt vmcnt(12) lgkmcnt(0)
  v_mfma_f32_32x32x16_bf16 a[112:127], v[96:99], v[96:99], 0
  s_barrier
  v_max_f32 v146, v146, v158
  v_max_f32 v147, v147, v159
  v_sub_f32 v120, 0, v146
  v_sub_f32 v121, 0, v146
  v_sub_f32 v122, 0, v146
  s_and_b32 m0, s39, 0xffff
  v_mfma_f32_16x16x32_bf16 v[48:51], a[192:195], a[128:131], v[112:115]
  buffer_load_dwordx4 v4, s[12:15], s36 offen offset:0 lds
  v_sub_f32 v123, 0, v146
  v_sub_f32 v124, 0, v147
  v_sub_f32 v125, 0, v147
  v_sub_f32 v126, 0, v147
  v_mfma_f32_16x16x32_bf16 v[56:59], a[192:195], a[144:147], v[116:119]
  v_sub_f32 v127, 0, v147
  v_sub_f32 v16, v16, v144
  v_sub_f32 v17, v17, v144
  v_exp_f32 v148, v16
  v_sub_f32 v18, v18, v144
  v_mfma_f32_16x16x32_bf16 v[52:55], a[196:199], a[128:131], v[112:115]
  buffer_load_dwordx4 v4, s[12:15], s36 offen offset:1024 lds
  v_exp_f32 v149, v17
  v_sub_f32 v19, v19, v144
  v_mfma_f32_16x16x32_bf16 v[60:63], a[196:199], a[144:147], v[116:119]
  v_exp_f32 v150, v18
  v_sub_f32 v20, v20, v144
  v_cvt_pk_bf16_f32 v80, v148, v149
  v_exp_f32 v151, v19
  v_sub_f32 v21, v21, v144
  v_mfma_f32_16x16x32_bf16 v[48:51], a[200:203], a[132:135], v[48:51]
  buffer_load_dwordx4 v4, s[12:15], s36 offen offset:2048 lds
  v_exp_f32 v152, v20
  v_sub_f32 v22, v22, v144
  v_cvt_pk_bf16_f32 v81, v150, v151
  v_mfma_f32_16x16x32_bf16 v[56:59], a[200:203], a[148:151], v[56:59]
  v_exp_f32 v153, v21
  v_sub_f32 v23, v23, v144
  v_exp_f32 v154, v22
  v_sub_f32 v24, v24, v145
  v_mfma_f32_16x16x32_bf16 v[52:55], a[204:207], a[132:135], v[52:55]
  buffer_load_dwordx4 v4, s[12:15], s36 offen offset:3072 lds
  v_cvt_pk_bf16_f32 v82, v152, v153
  v_mfma_f32_16x16x32_bf16 v[60:63], a[204:207], a[148:151], v[60:63]
  v_exp_f32 v155, v23
  v_sub_f32 v25, v25, v145
  s_add_u32 s39, s39, 16384
  s_add_u32 s36, s36, 16384
  s_cmp_eq_u32 s36, s37
  s_cselect_b32 s36, 0, s36
  s_cselect_b32 s14, s38, s14
  v_mfma_f32_16x16x32_bf16 v[48:51], a[208:211], a[136:139], v[48:51]
  v_exp_f32 v148, v24
  v_sub_f32 v26, v26, v145
  v_cvt_pk_bf16_f32 v83, v154, v155
  v_exp_f32 v149, v25
  v_mfma_f32_16x16x32_bf16 v[56:59], a[208:211], a[152:155], v[56:59]
  v_sub_f32 v27, v27, v145
  v_exp_f32 v150, v26
  v_sub_f32 v28, v28, v145
  s_and_b32 m0, s39, 0xffff
  v_mfma_f32_16x16x32_bf16 v[52:55], a[212:215], a[136:139], v[52:55]
  buffer_load_dwordx4 v4, s[12:15], s36 offen offset:0 lds
  v_cvt_pk_bf16_f32 v84, v148, v149
  v_mfma_f32_16x16x32_bf16 v[128:131], v[244:247], v[80:83], 0
  v_mfma_f32_16x16x32_bf16 v[60:63], a[212:215], a[152:155], v[60:63]
  v_exp_f32 v151, v27
  v_sub_f32 v29, v29, v145
  v_exp_f32 v152, v28
  v_sub_f32 v30, v30, v145
  v_cvt_pk_bf16_f32 v85, v150, v151
  v_mfma_f32_16x16x32_bf16 v[48:51], a[216:219], a[140:143], v[48:51]
  buffer_load_dwordx4 v4, s[12:15], s36 offen offset:1024 lds
  v_exp_f32 v153, v29
  v_sub_f32 v31, v31, v145
  v_mfma_f32_16x16x32_bf16 v[56:59], a[216:219], a[156:159], v[56:59]
  v_exp_f32 v154, v30
  v_sub_f32 v32, v32, v146
  v_cvt_pk_bf16_f32 v86, v152, v153
  v_exp_f32 v155, v31
  v_sub_f32 v33, v33, v146
  v_mfma_f32_16x16x32_bf16 v[52:55], a[220:223], a[140:143], v[52:55]
  buffer_load_dwordx4 v4, s[12:15], s36 offen offset:2048 lds
  v_exp_f32 v148, v32
  v_sub_f32 v34, v34, v146
  v_cvt_pk_bf16_f32 v87, v154, v155
  v_mfma_f32_16x16x32_bf16 v[60:63], a[220:223], a[156:159], v[60:63]
  v_exp_f32 v149, v33
  v_sub_f32 v35, v35, v146
  v_exp_f32 v150, v34
  v_sub_f32 v36, v36, v146
  v_mfma_f32_16x16x32_bf16 v[64:67], a[192:195], a[160:163], v[120:123]
  v_mfma_f32_16x16x32_bf16 v[72:75], a[192:195], a[176:179], v[124:127]
  ds_read_b128 a[192:195], v2 offset:0
  buffer_load_dwordx4 v4, s[12:15], s36 offen offset:3072 lds
  v_cvt_pk_bf16_f32 v88, v148, v149
  v_mfma_f32_16x16x32_bf16 v[132:135], v[244:247], v[84:87], 0
  s_add_u32 s39, s39, 16384
  s_add_u32 s36, s36, 16384
  s_cmp_eq_u32 s36, s37
  s_cselect_b32 s36, 0, s36
  s_cselect_b32 s14, s38, s14
  v_mfma_f32_16x16x32_bf16 v[68:71], a[196:199], a[160:163], v[120:123]
  v_mfma_f32_16x16x32_bf16 v[76:79], a[196:199], a[176:179], v[124:127]
  ds_read_b128 a[196:199], v2 offset:1024
  v_exp_f32 v151, v35
  v_sub_f32 v37, v37, v146
  v_exp_f32 v152, v36
  v_sub_f32 v38, v38, v146
  v_cvt_pk_bf16_f32 v89, v150, v151
  v_exp_f32 v153, v37
  s_and_b32 s48, s40, 0xffff
  s_or_b32 m0, s48, 0x10000
  v_mfma_f32_16x16x32_bf16 v[64:67], a[200:203], a[164:167], v[64:67]
  v_mfma_f32_16x16x32_bf16 v[72:75], a[200:203], a[180:183], v[72:75]
  ds_read_b128 a[200:203], v2 offset:2048
  buffer_load_dwordx4 v1, s[16:19], s40 offen offset:0 lds
  v_sub_f32 v39, v39, v146
  v_exp_f32 v154, v38
  v_sub_f32 v40, v40, v147
  v_cvt_pk_bf16_f32 v90, v152, v153
  v_exp_f32 v155, v39
  v_sub_f32 v41, v41, v147
  v_mfma_f32_16x16x32_bf16 v[68:71], a[204:207], a[164:167], v[68:71]
  v_mfma_f32_16x16x32_bf16 v[76:79], a[204:207], a[180:183], v[76:79]
  ds_read_b128 a[204:207], v2 offset:3072
  buffer_load_dwordx4 v1, s[16:19], s40 offen offset:1024 lds
  v_exp_f32 v148, v40
  v_sub_f32 v42, v42, v147
  v_cvt_pk_bf16_f32 v91, v154, v155
  v_exp_f32 v149, v41
  v_sub_f32 v43, v43, v147
  v_exp_f32 v150, v42
  v_mfma_f32_16x16x32_bf16 v[64:67], a[208:211], a[168:171], v[64:67]
  v_mfma_f32_16x16x32_bf16 v[72:75], a[208:211], a[184:187], v[72:75]
  ds_read_b128 a[208:211], v2 offset:4096
  buffer_load_dwordx4 v1, s[16:19], s40 offen offset:2048 lds
  v_sub_f32 v44, v44, v147
  v_cvt_pk_bf16_f32 v92, v148, v149
  v_mfma_f32_16x16x32_bf16 v[136:139], v[244:247], v[88:91], 0
  v_exp_f32 v151, v43
  v_sub_f32 v45, v45, v147
  v_exp_f32 v152, v44
  v_mfma_f32_16x16x32_bf16 v[68:71], a[212:215], a[168:171], v[68:71]
  v_mfma_f32_16x16x32_bf16 v[76:79], a[212:215], a[184:187], v[76:79]
  ds_read_b128 a[212:215], v2 offset:5120
  buffer_load_dwordx4 v1, s[16:19], s40 offen offset:3072 lds
  v_sub_f32 v46, v46, v147
  v_cvt_pk_bf16_f32 v93, v150, v151
  v_exp_f32 v153, v45
  v_sub_f32 v47, v47, v147
  v_exp_f32 v154, v46
  v_cvt_pk_bf16_f32 v94, v152, v153
  s_add_u32 s40, s40, 16384
  v_mfma_f32_16x16x32_bf16 v[64:67], a[216:219], a[172:175], v[64:67]
  v_mfma_f32_16x16x32_bf16 v[72:75], a[216:219], a[188:191], v[72:75]
  ds_read_b128 a[216:219], v2 offset:6144
  v_exp_f32 v155, v47
  s_nop 0
  v_cvt_pk_bf16_f32 v95, v154, v155
  s_nop 1
  v_mfma_f32_16x16x32_bf16 v[140:143], v[244:247], v[92:95], 0
  v_mfma_f32_16x16x32_bf16 v[68:71], a[220:223], a[172:175], v[68:71]
  v_mfma_f32_16x16x32_bf16 v[76:79], a[220:223], a[188:191], v[76:79]
  ds_read_b128 a[220:223], v2 offset:7168
  s_waitcnt vmcnt(16) lgkmcnt(0)
.p2align 3
K2_LOOP:
  v_mfma_f32_16x16x32_bf16 v[16:19], a[192:195], a[128:131], v[112:115]
  s_barrier
  v_exp_f32 v148, v48
  v_mfma_f32_16x16x32_bf16 v[24:27], a[192:195], a[144:147], v[116:119]
  v_xor_b32 v3, 0x8000, v3
  v_mfma_f32_16x16x32_bf16 v[32:35], a[192:195], a[160:163], v[120:123]
  ds_read_b128 a[224:227], v3 offset:0
  v_mfma_f32_16x16x32_bf16 v[40:43], a[192:195], a[176:179], v[124:127]
  s_and_b32 m0, s39, 0xffff
  v_exp_f32 v149, v49
  v_mfma_f32_16x16x32_bf16 v[20:23], a[196:199], a[128:131], v[112:115]
  buffer_load_dwordx4 v4, s[12:15], s36 offen offset:0 lds
  v_mfma_f32_16x16x32_bf16 v[28:31], a[196:199], a[144:147], v[116:119]
  ds_read_b128 a[228:231], v3 offset:1024
  v_cvt_pk_bf16_f32 v96, v148, v149
  v_mfma_f32_16x16x32_bf16 v[36:39], a[196:199], a[160:163], v[120:123]
  v_exp_f32 v150, v50
  v_mfma_f32_16x16x32_bf16 v[44:47], a[196:199], a[176:179], v[124:127]
  v_exp_f32 v151, v51
  v_mfma_f32_16x16x32_bf16 v[16:19], a[200:203], a[132:135], v[16:19]
  ds_read_b128 a[232:235], v3 offset:2048
  v_cvt_pk_bf16_f32 v97, v150, v151
  v_mfma_f32_16x16x32_bf16 v[24:27], a[200:203], a[148:151], v[24:27]
  v_exp_f32 v152, v52
  v_mfma_f32_16x16x32_bf16 v[32:35], a[200:203], a[164:167], v[32:35]
  buffer_load_dwordx4 v4, s[12:15], s36 offen offset:1024 lds
  v_mfma_f32_16x16x32_bf16 v[40:43], a[200:203], a[180:183], v[40:43]
  ds_read_b128 a[236:239], v3 offset:3072
  v_mfma_f32_16x16x32_bf16 v[20:23], a[204:207], a[132:135], v[20:23]
  v_exp_f32 v153, v53
  v_mfma_f32_16x16x32_bf16 v[28:31], a[204:207], a[148:151], v[28:31]
  v_exp_f32 v154, v54
  v_mfma_f32_16x16x32_bf16 v[36:39], a[204:207], a[164:167], v[36:39]
  ds_read_b128 a[240:243], v3 offset:4096
  v_cvt_pk_bf16_f32 v98, v152, v153
  v_mfma_f32_16x16x32_bf16 v[44:47], a[204:207], a[180:183], v[44:47]
  v_exp_f32 v155, v55
  v_mfma_f32_16x16x32_bf16 v[16:19], a[208:211], a[136:139], v[16:19]
  buffer_load_dwordx4 v4, s[12:15], s36 offen offset:2048 lds
  v_mfma_f32_16x16x32_bf16 v[24:27], a[208:211], a[152:155], v[24:27]
  ds_read_b128 a[244:247], v3 offset:5120
  v_cvt_pk_bf16_f32 v99, v154, v155
  v_mfma_f32_16x16x32_bf16 v[32:35], a[208:211], a[168:171], v[32:35]
  v_exp_f32 v148, v56
  v_mfma_f32_16x16x32_bf16 v[40:43], a[208:211], a[184:187], v[40:43]
  v_exp_f32 v149, v57
  v_mfma_f32_16x16x32_bf16 v[20:23], a[212:215], a[136:139], v[20:23]
  ds_read_b128 a[248:251], v3 offset:6144
  v_cvt_pk_bf16_f32 v100, v148, v149
  v_mfma_f32_16x16x32_bf16 v[224:227], v[244:247], v[96:99], v[128:131]
  v_exp_f32 v150, v58
  v_mfma_f32_16x16x32_bf16 v[28:31], a[212:215], a[152:155], v[28:31]
  buffer_load_dwordx4 v4, s[12:15], s36 offen offset:3072 lds
  v_mfma_f32_16x16x32_bf16 v[36:39], a[212:215], a[168:171], v[36:39]
  ds_read_b128 a[252:255], v3 offset:7168
  v_mfma_f32_16x16x32_bf16 v[44:47], a[212:215], a[184:187], v[44:47]
  s_add_u32 s39, s39, 16384
  v_exp_f32 v151, v59
  v_mfma_f32_16x16x32_bf16 v[16:19], a[216:219], a[140:143], v[16:19]
  s_add_u32 s36, s36, 16384
  v_exp_f32 v152, v60
  v_mfma_f32_16x16x32_bf16 v[24:27], a[216:219], a[156:159], v[24:27]
  s_cmp_eq_u32 s36, s37
  v_exp_f32 v153, v61
  v_mfma_f32_16x16x32_bf16 v[32:35], a[216:219], a[172:175], v[32:35]
  s_cselect_b32 s36, 0, s36
  v_exp_f32 v154, v62
  v_mfma_f32_16x16x32_bf16 v[40:43], a[216:219], a[188:191], v[40:43]
  s_cselect_b32 s14, s38, s14
  v_exp_f32 v155, v63
  v_mfma_f32_16x16x32_bf16 v[20:23], a[220:223], a[140:143], v[20:23]
  s_and_b32 s48, s40, 0xffff
  v_exp_f32 v148, v64
  v_mfma_f32_16x16x32_bf16 v[28:31], a[220:223], a[156:159], v[28:31]
  s_or_b32 m0, s48, 0x10000
  v_exp_f32 v149, v65
  v_mfma_f32_16x16x32_bf16 v[36:39], a[220:223], a[172:175], v[36:39]
  v_cvt_pk_bf16_f32 v101, v150, v151
  v_cvt_pk_bf16_f32 v102, v152, v153
  v_mfma_f32_16x16x32_bf16 v[44:47], a[220:223], a[188:191], v[44:47]
  s_waitcnt lgkmcnt(0)
  v_exp_f32 v150, v66
  v_mfma_f32_16x16x32_bf16 a[0:3], a[224:227], v[80:83], a[0:3]
  ds_read_b128 a[192:195], v2 offset:16384
  v_cvt_pk_bf16_f32 v103, v154, v155
  v_mfma_f32_16x16x32_bf16 a[16:19], a[224:227], v[84:87], a[16:19]
  v_exp_f32 v151, v67
  v_mfma_f32_16x16x32_bf16 a[32:35], a[224:227], v[88:91], a[32:35]
  buffer_load_dwordx4 v1, s[16:19], s40 offen offset:0 lds
  v_mfma_f32_16x16x32_bf16 a[48:51], a[224:227], v[92:95], a[48:51]
  ds_read_b128 a[196:199], v2 offset:17408
  v_cvt_pk_bf16_f32 v104, v148, v149
  v_mfma_f32_16x16x32_bf16 a[4:7], a[228:231], v[80:83], a[4:7]
  v_exp_f32 v152, v68
  v_mfma_f32_16x16x32_bf16 v[228:231], v[244:247], v[100:103], v[132:135]
  v_exp_f32 v153, v69
  v_mfma_f32_16x16x32_bf16 a[20:23], a[228:231], v[84:87], a[20:23]
  ds_read_b128 a[200:203], v2 offset:18432
  v_cvt_pk_bf16_f32 v105, v150, v151
  v_mfma_f32_16x16x32_bf16 a[36:39], a[228:231], v[88:91], a[36:39]
  v_exp_f32 v154, v70
  v_mfma_f32_16x16x32_bf16 a[52:55], a[228:231], v[92:95], a[52:55]
  v_exp_f32 v155, v71
  v_mfma_f32_16x16x32_bf16 a[64:67], a[232:235], v[80:83], a[64:67]
  ds_read_b128 a[204:207], v2 offset:19456
  v_cvt_pk_bf16_f32 v106, v152, v153
  v_mfma_f32_16x16x32_bf16 a[80:83], a[232:235], v[84:87], a[80:83]
  v_exp_f32 v148, v72
  v_mfma_f32_16x16x32_bf16 a[96:99], a[232:235], v[88:91], a[96:99]
  buffer_load_dwordx4 v1, s[16:19], s40 offen offset:1024 lds
  v_mfma_f32_16x16x32_bf16 a[112:115], a[232:235], v[92:95], a[112:115]
  ds_read_b128 a[208:211], v2 offset:20480
  v_cvt_pk_bf16_f32 v107, v154, v155
  v_mfma_f32_16x16x32_bf16 a[68:71], a[236:239], v[80:83], a[68:71]
  v_exp_f32 v149, v73
  v_mfma_f32_16x16x32_bf16 a[84:87], a[236:239], v[84:87], a[84:87]
  v_exp_f32 v150, v74
  v_mfma_f32_16x16x32_bf16 a[100:103], a[236:239], v[88:91], a[100:103]
  ds_read_b128 a[212:215], v2 offset:21504
  v_cvt_pk_bf16_f32 v108, v148, v149
  v_mfma_f32_16x16x32_bf16 a[116:119], a[236:239], v[92:95], a[116:119]
  v_exp_f32 v151, v75
  v_mfma_f32_16x16x32_bf16 v[232:235], v[244:247], v[104:107], v[136:139]
  v_exp_f32 v152, v76
  v_mfma_f32_16x16x32_bf16 a[8:11], a[240:243], v[80:83], a[8:11]
  ds_read_b128 a[216:219], v2 offset:22528
  v_cvt_pk_bf16_f32 v109, v150, v151
  v_mfma_f32_16x16x32_bf16 a[24:27], a[240:243], v[84:87], a[24:27]
  v_exp_f32 v153, v77
  v_mfma_f32_16x16x32_bf16 a[40:43], a[240:243], v[88:91], a[40:43]
  buffer_load_dwordx4 v1, s[16:19], s40 offen offset:2048 lds
  v_mfma_f32_16x16x32_bf16 a[56:59], a[240:243], v[92:95], a[56:59]
  ds_read_b128 a[220:223], v2 offset:23552
  v_cvt_pk_bf16_f32 v110, v152, v153
  v_mfma_f32_16x16x32_bf16 a[12:15], a[244:247], v[80:83], a[12:15]
  v_exp_f32 v154, v78
  v_mfma_f32_16x16x32_bf16 a[28:31], a[244:247], v[84:87], a[28:31]
  v_exp_f32 v155, v79
  v_mfma_f32_16x16x32_bf16 a[44:47], a[244:247], v[88:91], a[44:47]
  v_cvt_pk_bf16_f32 v111, v154, v155
  v_mfma_f32_16x16x32_bf16 a[60:63], a[244:247], v[92:95], a[60:63]
  v_mfma_f32_16x16x32_bf16 a[72:75], a[248:251], v[80:83], a[72:75]
  v_mfma_f32_16x16x32_bf16 v[236:239], v[244:247], v[108:111], v[140:143]
  v_mfma_f32_16x16x32_bf16 a[88:91], a[248:251], v[84:87], a[88:91]
  buffer_load_dwordx4 v1, s[16:19], s40 offen offset:3072 lds
  v_mfma_f32_16x16x32_bf16 a[104:107], a[248:251], v[88:91], a[104:107]
  s_add_u32 s40, s40, 16384
  v_mfma_f32_16x16x32_bf16 a[120:123], a[248:251], v[92:95], a[120:123]
  s_sub_u32 s41, s41, 1
  v_mfma_f32_16x16x32_bf16 a[76:79], a[252:255], v[80:83], a[76:79]
  s_cmp_eq_u32 s41, 0
  v_max3_f32 v12, v224, v228, v232
  v_mfma_f32_16x16x32_bf16 a[92:95], a[252:255], v[84:87], a[92:95]
  s_nop 0
  v_max_f32 v12, v12, v236
  v_mfma_f32_16x16x32_bf16 a[108:111], a[252:255], v[88:91], a[108:111]
  v_cmp_nle_f32 vcc, v12, v13
  v_mfma_f32_16x16x32_bf16 a[124:127], a[252:255], v[92:95], a[124:127]
  s_cbranch_vccnz K2_RARE_O
K2_RARE_O_ret:
  s_waitcnt vmcnt(16) lgkmcnt(0)
  s_cbranch_scc1 K2_X
  v_mfma_f32_16x16x32_bf16 v[48:51], a[192:195], a[128:131], v[112:115]
  s_barrier
  v_exp_f32 v148, v16
  v_mfma_f32_16x16x32_bf16 v[56:59], a[192:195], a[144:147], v[116:119]
  v_exp_f32 v149, v17
  v_mfma_f32_16x16x32_bf16 v[64:67], a[192:195], a[160:163], v[120:123]
  ds_read_b128 a[224:227], v3 offset:16384
  v_xor_b32 v2, 0x8000, v2
  v_mfma_f32_16x16x32_bf16 v[72:75], a[192:195], a[176:179], v[124:127]
  s_and_b32 m0, s39, 0xffff
  v_exp_f32 v150, v18
  v_mfma_f32_16x16x32_bf16 v[52:55], a[196:199], a[128:131], v[112:115]
  buffer_load_dwordx4 v4, s[12:15], s36 offen offset:0 lds
  v_mfma_f32_16x16x32_bf16 v[60:63], a[196:199], a[144:147], v[116:119]
  ds_read_b128 a[228:231], v3 offset:17408
  v_cvt_pk_bf16_f32 v80, v148, v149
  v_mfma_f32_16x16x32_bf16 v[68:71], a[196:199], a[160:163], v[120:123]
  v_exp_f32 v151, v19
  v_mfma_f32_16x16x32_bf16 v[76:79], a[196:199], a[176:179], v[124:127]
  v_exp_f32 v152, v20
  v_mfma_f32_16x16x32_bf16 v[48:51], a[200:203], a[132:135], v[48:51]
  ds_read_b128 a[232:235], v3 offset:18432
  v_cvt_pk_bf16_f32 v81, v150, v151
  v_mfma_f32_16x16x32_bf16 v[56:59], a[200:203], a[148:151], v[56:59]
  v_exp_f32 v153, v21
  v_mfma_f32_16x16x32_bf16 v[64:67], a[200:203], a[164:167], v[64:67]
  buffer_load_dwordx4 v4, s[12:15], s36 offen offset:1024 lds
  v_mfma_f32_16x16x32_bf16 v[72:75], a[200:203], a[180:183], v[72:75]
  ds_read_b128 a[236:239], v3 offset:19456
  v_cvt_pk_bf16_f32 v82, v152, v153
  v_mfma_f32_16x16x32_bf16 v[52:55], a[204:207], a[132:135], v[52:55]
  v_exp_f32 v154, v22
  v_mfma_f32_16x16x32_bf16 v[60:63], a[204:207], a[148:151], v[60:63]
  v_exp_f32 v155, v23
  v_mfma_f32_16x16x32_bf16 v[68:71], a[204:207], a[164:167], v[68:71]
  ds_read_b128 a[240:243], v3 offset:20480
  v_cvt_pk_bf16_f32 v83, v154, v155
  v_mfma_f32_16x16x32_bf16 v[76:79], a[204:207], a[180:183], v[76:79]
  v_exp_f32 v148, v24
  v_mfma_f32_16x16x32_bf16 v[48:51], a[208:211], a[136:139], v[48:51]
  buffer_load_dwordx4 v4, s[12:15], s36 offen offset:2048 lds
  v_mfma_f32_16x16x32_bf16 v[56:59], a[208:211], a[152:155], v[56:59]
  ds_read_b128 a[244:247], v3 offset:21504
  v_mfma_f32_16x16x32_bf16 v[64:67], a[208:211], a[168:171], v[64:67]
  v_exp_f32 v149, v25
  v_mfma_f32_16x16x32_bf16 v[72:75], a[208:211], a[184:187], v[72:75]
  v_exp_f32 v150, v26
  v_mfma_f32_16x16x32_bf16 v[52:55], a[212:215], a[136:139], v[52:55]
  ds_read_b128 a[248:251], v3 offset:22528
  v_cvt_pk_bf16_f32 v84, v148, v149
  v_mfma_f32_16x16x32_bf16 v[128:131], v[244:247], v[80:83], v[224:227]
  v_exp_f32 v151, v27
  v_mfma_f32_16x16x32_bf16 v[60:63], a[212:215], a[152:155], v[60:63]
  buffer_load_dwordx4 v4, s[12:15], s36 offen offset:3072 lds
  v_mfma_f32_16x16x32_bf16 v[68:71], a[212:215], a[168:171], v[68:71]
  ds_read_b128 a[252:255], v3 offset:23552
  v_cvt_pk_bf16_f32 v85, v150, v151
  v_mfma_f32_16x16x32_bf16 v[76:79], a[212:215], a[184:187], v[76:79]
  s_add_u32 s39, s39, 16384
  v_exp_f32 v152, v28
  v_mfma_f32_16x16x32_bf16 v[48:51], a[216:219], a[140:143], v[48:51]
  s_add_u32 s36, s36, 16384
  v_exp_f32 v153, v29
  v_mfma_f32_16x16x32_bf16 v[56:59], a[216:219], a[156:159], v[56:59]
  s_cmp_eq_u32 s36, s37
  v_exp_f32 v154, v30
  v_mfma_f32_16x16x32_bf16 v[64:67], a[216:219], a[172:175], v[64:67]
  s_cselect_b32 s36, 0, s36
  v_exp_f32 v155, v31
  v_mfma_f32_16x16x32_bf16 v[72:75], a[216:219], a[188:191], v[72:75]
  s_cselect_b32 s14, s38, s14
  v_exp_f32 v148, v32
  v_mfma_f32_16x16x32_bf16 v[52:55], a[220:223], a[140:143], v[52:55]
  s_and_b32 s48, s40, 0xffff
  v_exp_f32 v149, v33
  v_mfma_f32_16x16x32_bf16 v[60:63], a[220:223], a[156:159], v[60:63]
  s_or_b32 m0, s48, 0x10000
  v_exp_f32 v150, v34
  v_mfma_f32_16x16x32_bf16 v[68:71], a[220:223], a[172:175], v[68:71]
  v_exp_f32 v151, v35
  v_mfma_f32_16x16x32_bf16 v[76:79], a[220:223], a[188:191], v[76:79]
  s_waitcnt lgkmcnt(0)
  v_cvt_pk_bf16_f32 v86, v152, v153
  v_cvt_pk_bf16_f32 v87, v154, v155
  v_mfma_f32_16x16x32_bf16 a[0:3], a[224:227], v[96:99], a[0:3]
  ds_read_b128 a[192:195], v2 offset:0
  v_cvt_pk_bf16_f32 v88, v148, v149
  v_mfma_f32_16x16x32_bf16 a[16:19], a[224:227], v[100:103], a[16:19]
  v_exp_f32 v152, v36
  v_mfma_f32_16x16x32_bf16 a[32:35], a[224:227], v[104:107], a[32:35]
  buffer_load_dwordx4 v1, s[16:19], s40 offen offset:0 lds
  v_mfma_f32_16x16x32_bf16 a[48:51], a[224:227], v[108:111], a[48:51]
  ds_read_b128 a[196:199], v2 offset:1024
  v_cvt_pk_bf16_f32 v89, v150, v151
  v_mfma_f32_16x16x32_bf16 a[4:7], a[228:231], v[96:99], a[4:7]
  v_exp_f32 v153, v37
  v_mfma_f32_16x16x32_bf16 v[132:135], v[244:247], v[84:87], v[228:231]
  v_exp_f32 v154, v38
  v_mfma_f32_16x16x32_bf16 a[20:23], a[228:231], v[100:103], a[20:23]
  ds_read_b128 a[200:203], v2 offset:2048
  v_cvt_pk_bf16_f32 v90, v152, v153
  v_mfma_f32_16x16x32_bf16 a[36:39], a[228:231], v[104:107], a[36:39]
  v_exp_f32 v155, v39
  v_mfma_f32_16x16x32_bf16 a[52:55], a[228:231], v[108:111], a[52:55]
  v_exp_f32 v148, v40
  v_mfma_f32_16x16x32_bf16 a[64:67], a[232:235], v[96:99], a[64:67]
  ds_read_b128 a[204:207], v2 offset:3072
  v_cvt_pk_bf16_f32 v91, v154, v155
  v_mfma_f32_16x16x32_bf16 a[80:83], a[232:235], v[100:103], a[80:83]
  v_exp_f32 v149, v41
  v_mfma_f32_16x16x32_bf16 a[96:99], a[232:235], v[104:107], a[96:99]
  buffer_load_dwordx4 v1, s[16:19], s40 offen offset:1024 lds
  v_mfma_f32_16x16x32_bf16 a[112:115], a[232:235], v[108:111], a[112:115]
  ds_read_b128 a[208:211], v2 offset:4096
  v_cvt_pk_bf16_f32 v92, v148, v149
  v_mfma_f32_16x16x32_bf16 a[68:71], a[236:239], v[96:99], a[68:71]
  v_exp_f32 v150, v42
  v_mfma_f32_16x16x32_bf16 a[84:87], a[236:239], v[100:103], a[84:87]
  v_exp_f32 v151, v43
  v_mfma_f32_16x16x32_bf16 a[100:103], a[236:239], v[104:107], a[100:103]
  ds_read_b128 a[212:215], v2 offset:5120
  v_cvt_pk_bf16_f32 v93, v150, v151
  v_mfma_f32_16x16x32_bf16 a[116:119], a[236:239], v[108:111], a[116:119]
  v_exp_f32 v152, v44
  v_mfma_f32_16x16x32_bf16 v[136:139], v[244:247], v[88:91], v[232:235]
  v_exp_f32 v153, v45
  v_mfma_f32_16x16x32_bf16 a[8:11], a[240:243], v[96:99], a[8:11]
  ds_read_b128 a[216:219], v2 offset:6144
  v_cvt_pk_bf16_f32 v94, v152, v153
  v_mfma_f32_16x16x32_bf16 a[24:27], a[240:243], v[100:103], a[24:27]
  v_exp_f32 v154, v46
  v_mfma_f32_16x16x32_bf16 a[40:43], a[240:243], v[104:107], a[40:43]
  buffer_load_dwordx4 v1, s[16:19], s40 offen offset:2048 lds
  v_mfma_f32_16x16x32_bf16 a[56:59], a[240:243], v[108:111], a[56:59]
  ds_read_b128 a[220:223], v2 offset:7168
  v_mfma_f32_16x16x32_bf16 a[12:15], a[244:247], v[96:99], a[12:15]
  v_exp_f32 v155, v47
  v_mfma_f32_16x16x32_bf16 a[28:31], a[244:247], v[100:103], a[28:31]
  v_cvt_pk_bf16_f32 v95, v154, v155
  v_mfma_f32_16x16x32_bf16 a[44:47], a[244:247], v[104:107], a[44:47]
  v_mfma_f32_16x16x32_bf16 a[60:63], a[244:247], v[108:111], a[60:63]
  v_mfma_f32_16x16x32_bf16 a[72:75], a[248:251], v[96:99], a[72:75]
  v_mfma_f32_16x16x32_bf16 v[140:143], v[244:247], v[92:95], v[236:239]
  v_mfma_f32_16x16x32_bf16 a[88:91], a[248:251], v[100:103], a[88:91]
  buffer_load_dwordx4 v1, s[16:19], s40 offen offset:3072 lds
  v_mfma_f32_16x16x32_bf16 a[104:107], a[248:251], v[104:107], a[104:107]
  s_add_u32 s40, s40, 16384
  v_mfma_f32_16x16x32_bf16 a[120:123], a[248:251], v[108:111], a[120:123]
  v_mfma_f32_16x16x32_bf16 a[76:79], a[252:255], v[96:99], a[76:79]
  v_max3_f32 v12, v128, v132, v136
  v_mfma_f32_16x16x32_bf16 a[92:95], a[252:255], v[100:103], a[92:95]
  s_nop 0
  v_max_f32 v12, v12, v140
  v_mfma_f32_16x16x32_bf16 a[108:111], a[252:255], v[104:107], a[108:111]
  v_cmp_nle_f32 vcc, v12, v13
  v_mfma_f32_16x16x32_bf16 a[124:127], a[252:255], v[108:111], a[124:127]
  s_cbranch_vccnz K2_RARE_E
K2_RARE_E_ret:
  s_waitcnt vmcnt(16) lgkmcnt(0)
  s_branch K2_LOOP
K2_X:
  s_cmp_eq_u32 s43, 0
  s_cbranch_scc0 K2_NM2
  v_mfma_f32_16x16x32_bf16 v[64:67], a[192:195], a[160:163], v[120:123]
  s_barrier
  v_cmp_le_i32 s[52:53], 0, v6
  v_cmp_le_i32 s[54:55], 1, v6
  v_cmp_le_i32 s[56:57], 2, v6
  v_cndmask_b32 v16, v5, v16, s[52:53]
  v_mfma_f32_16x16x32_bf16 v[72:75], a[192:195], a[176:179], v[124:127]
  v_cmp_le_i32 s[58:59], 3, v6
  v_cndmask_b32 v17, v5, v17, s[54:55]
  v_exp_f32 v148, v16
  v_cmp_le_i32 s[52:53], 16, v6
  v_mfma_f32_16x16x32_bf16 v[68:71], a[196:199], a[160:163], v[120:123]
  ds_read_b128 a[224:227], v3 offset:16384
  ds_read_b128 a[228:231], v3 offset:17408
  v_cndmask_b32 v18, v5, v18, s[56:57]
  v_exp_f32 v149, v17
  v_mfma_f32_16x16x32_bf16 v[76:79], a[196:199], a[176:179], v[124:127]
  v_cmp_le_i32 s[54:55], 17, v6
  v_cndmask_b32 v19, v5, v19, s[58:59]
  v_exp_f32 v150, v18
  s_and_b32 m0, s39, 0xffff
  v_mfma_f32_16x16x32_bf16 v[64:67], a[200:203], a[164:167], v[64:67]
  ds_read_b128 a[232:235], v3 offset:18432
  ds_read_b128 a[236:239], v3 offset:19456
  buffer_load_dwordx4 v4, s[12:15], s36 offen offset:0 lds
  v_cvt_pk_bf16_f32 v80, v148, v149
  v_mfma_f32_16x16x32_bf16 v[72:75], a[200:203], a[180:183], v[72:75]
  v_cmp_le_i32 s[56:57], 18, v6
  v_cndmask_b32 v20, v5, v20, s[52:53]
  v_exp_f32 v151, v19
  v_cmp_le_i32 s[58:59], 19, v6
  v_mfma_f32_16x16x32_bf16 v[68:71], a[204:207], a[164:167], v[68:71]
  ds_read_b128 a[240:243], v3 offset:20480
  ds_read_b128 a[244:247], v3 offset:21504
  v_cndmask_b32 v21, v5, v21, s[54:55]
  v_exp_f32 v152, v20
  v_mfma_f32_16x16x32_bf16 v[76:79], a[204:207], a[180:183], v[76:79]
  v_cvt_pk_bf16_f32 v81, v150, v151
  v_cmp_le_i32 s[52:53], -16, v6
  v_cndmask_b32 v22, v5, v22, s[56:57]
  v_exp_f32 v153, v21
  v_mfma_f32_16x16x32_bf16 v[64:67], a[208:211], a[168:171], v[64:67]
  ds_read_b128 a[248:251], v3 offset:22528
  ds_read_b128 a[252:255], v3 offset:23552
  v_cmp_le_i32 s[54:55], -15, v6
  v_cndmask_b32 v23, v5, v23, s[58:59]
  v_mfma_f32_16x16x32_bf16 v[72:75], a[208:211], a[184:187], v[72:75]
  v_exp_f32 v154, v22
  v_cvt_pk_bf16_f32 v82, v152, v153
  v_cmp_le_i32 s[56:57], -14, v6
  v_cndmask_b32 v24, v5, v24, s[52:53]
  v_mfma_f32_16x16x32_bf16 v[68:71], a[212:215], a[168:171], v[68:71]
  ds_read_b128 a[128:131], v10 offset:0
  buffer_load_dwordx4 v4, s[12:15], s36 offen offset:1024 lds
  v_exp_f32 v155, v23
  v_mfma_f32_16x16x32_bf16 v[76:79], a[212:215], a[184:187], v[76:79]
  v_cmp_le_i32 s[58:59], -13, v6
  v_cndmask_b32 v25, v5, v25, s[54:55]
  v_exp_f32 v148, v24
  v_cvt_pk_bf16_f32 v83, v154, v155
  v_mfma_f32_16x16x32_bf16 v[64:67], a[216:219], a[172:175], v[64:67]
  ds_read_b128 a[132:135], v10 offset:1024
  v_cmp_le_i32 s[52:53], 0, v6
  v_cndmask_b32 v26, v5, v26, s[56:57]
  v_exp_f32 v149, v25
  v_mfma_f32_16x16x32_bf16 v[72:75], a[216:219], a[188:191], v[72:75]
  v_cmp_le_i32 s[54:55], 1, v6
  v_cndmask_b32 v27, v5, v27, s[58:59]
  v_exp_f32 v150, v26
  v_xor_b32 v2, 0x8000, v2
  v_mfma_f32_16x16x32_bf16 v[68:71], a[220:223], a[172:175], v[68:71]
  ds_read_b128 a[136:139], v10 offset:2048
  buffer_load_dwordx4 v4, s[12:15], s36 offen offset:2048 lds
  v_cvt_pk_bf16_f32 v84, v148, v149
  v_mfma_f32_16x16x32_bf16 v[76:79], a[220:223], a[188:191], v[76:79]
  v_mfma_f32_16x16x32_bf16 v[128:131], v[244:247], v[80:83], v[224:227]
  v_cmp_le_i32 s[56:57], 2, v6
  v_cndmask_b32 v28, v5, v28, s[52:53]
  s_waitcnt lgkmcnt(7)
  v_mfma_f32_16x16x32_bf16 a[0:3], a[224:227], v[96:99], a[0:3]
  ds_read_b128 a[192:195], v2 offset:0
  ds_read_b128 a[140:143], v10 offset:3072
  v_exp_f32 v151, v27
  v_cmp_le_i32 s[58:59], 3, v6
  v_mfma_f32_16x16x32_bf16 a[16:19], a[224:227], v[100:103], a[16:19]
  v_cndmask_b32 v29, v5, v29, s[54:55]
  v_exp_f32 v152, v28
  v_cvt_pk_bf16_f32 v85, v150, v151
  v_cmp_le_i32 s[52:53], 0, v7
  v_mfma_f32_16x16x32_bf16 a[32:35], a[224:227], v[104:107], a[32:35]
  ds_read_b128 a[196:199], v2 offset:1024
  ds_read_b128 a[144:147], v10 offset:4096
  v_mfma_f32_16x16x32_bf16 a[48:51], a[224:227], v[108:111], a[48:51]
  buffer_load_dwordx4 v4, s[12:15], s36 offen offset:3072 lds
  v_cndmask_b32 v30, v5, v30, s[56:57]
  s_add_u32 s39, s39, 16384
  s_add_u32 s36, s36, 16384
  s_cmp_eq_u32 s36, s37
  s_cselect_b32 s36, 0, s36
  s_cselect_b32 s14, s38, s14
  v_mfma_f32_16x16x32_bf16 a[4:7], a[228:231], v[96:99], a[4:7]
  ds_read_b128 a[200:203], v2 offset:2048
  ds_read_b128 a[148:151], v10 offset:5120
  v_exp_f32 v153, v29
  v_cmp_le_i32 s[54:55], 1, v7
  v_mfma_f32_16x16x32_bf16 a[20:23], a[228:231], v[100:103], a[20:23]
  v_cndmask_b32 v31, v5, v31, s[58:59]
  v_exp_f32 v154, v30
  v_cvt_pk_bf16_f32 v86, v152, v153
  v_cmp_le_i32 s[56:57], 2, v7
  v_mfma_f32_16x16x32_bf16 a[36:39], a[228:231], v[104:107], a[36:39]
  ds_read_b128 a[204:207], v2 offset:3072
  ds_read_b128 a[152:155], v10 offset:6144
  v_cndmask_b32 v32, v5, v32, s[52:53]
  v_exp_f32 v155, v31
  v_mfma_f32_16x16x32_bf16 a[52:55], a[228:231], v[108:111], a[52:55]
  v_cmp_le_i32 s[58:59], 3, v7
  v_cndmask_b32 v33, v5, v33, s[54:55]
  v_exp_f32 v148, v32
  s_sub_u32 s16, s16, s37
  s_subb_u32 s17, s17, 0
  s_add_u32 s18, s18, s37
  v_mfma_f32_16x16x32_bf16 a[64:67], a[232:235], v[96:99], a[64:67]
  ds_read_b128 a[208:211], v2 offset:4096
  ds_read_b128 a[156:159], v10 offset:7168
  v_cvt_pk_bf16_f32 v87, v154, v155
  v_cmp_le_i32 s[52:53], 16, v7
  v_cndmask_b32 v34, v5, v34, s[56:57]
  v_mfma_f32_16x16x32_bf16 a[80:83], a[232:235], v[100:103], a[80:83]
  v_exp_f32 v149, v33
  v_cmp_le_i32 s[54:55], 17, v7
  s_and_b32 s48, s40, 0xffff
  s_or_b32 m0, s48, 0x10000
  v_mfma_f32_16x16x32_bf16 a[96:99], a[232:235], v[104:107], a[96:99]
  ds_read_b128 a[212:215], v2 offset:5120
  ds_read_b128 a[160:163], v11 offset:0
  buffer_load_dwordx4 v1, s[16:19], s40 offen offset:0 lds
  v_cndmask_b32 v35, v5, v35, s[58:59]
  v_mfma_f32_16x16x32_bf16 a[112:115], a[232:235], v[108:111], a[112:115]
  v_exp_f32 v150, v34
  v_cvt_pk_bf16_f32 v88, v148, v149
  v_mfma_f32_16x16x32_bf16 v[132:135], v[244:247], v[84:87], v[228:231]
  v_mfma_f32_16x16x32_bf16 a[68:71], a[236:239], v[96:99], a[68:71]
  ds_read_b128 a[216:219], v2 offset:6144
  ds_read_b128 a[164:167], v11 offset:1024
  v_cmp_le_i32 s[56:57], 18, v7
  v_cndmask_b32 v36, v5, v36, s[52:53]
  v_mfma_f32_16x16x32_bf16 a[84:87], a[236:239], v[100:103], a[84:87]
  v_exp_f32 v151, v35
  v_cmp_le_i32 s[58:59], 19, v7
  v_cndmask_b32 v37, v5, v37, s[54:55]
  v_exp_f32 v152, v36
  v_mfma_f32_16x16x32_bf16 a[100:103], a[236:239], v[104:107], a[100:103]
  ds_read_b128 a[220:223], v2 offset:7168
  ds_read_b128 a[168:171], v11 offset:2048
  v_cvt_pk_bf16_f32 v89, v150, v151
  v_cmp_le_i32 s[52:53], -16, v7
  v_cndmask_b32 v38, v5, v38, s[56:57]
  v_mfma_f32_16x16x32_bf16 a[116:119], a[236:239], v[108:111], a[116:119]
  v_exp_f32 v153, v37
  v_cmp_le_i32 s[54:55], -15, v7
  v_cndmask_b32 v39, v5, v39, s[58:59]
  s_waitcnt lgkmcnt(15)
  v_mfma_f32_16x16x32_bf16 a[8:11], a[240:243], v[96:99], a[8:11]
  ds_read_b128 a[172:175], v11 offset:3072
  buffer_load_dwordx4 v1, s[16:19], s40 offen offset:1024 lds
  v_exp_f32 v154, v38
  v_mfma_f32_16x16x32_bf16 a[24:27], a[240:243], v[100:103], a[24:27]
  v_cvt_pk_bf16_f32 v90, v152, v153
  v_cmp_le_i32 s[56:57], -14, v7
  v_cndmask_b32 v40, v5, v40, s[52:53]
  v_exp_f32 v155, v39
  v_mfma_f32_16x16x32_bf16 a[40:43], a[240:243], v[104:107], a[40:43]
  ds_read_b128 a[176:179], v11 offset:4096
  v_cmp_le_i32 s[58:59], -13, v7
  v_cndmask_b32 v41, v5, v41, s[54:55]
  v_exp_f32 v148, v40
  v_mfma_f32_16x16x32_bf16 a[56:59], a[240:243], v[108:111], a[56:59]
  v_cvt_pk_bf16_f32 v91, v154, v155
  v_cmp_le_i32 s[52:53], 0, v7
  v_cndmask_b32 v42, v5, v42, s[56:57]
  v_exp_f32 v149, v41
  v_mfma_f32_16x16x32_bf16 a[12:15], a[244:247], v[96:99], a[12:15]
  ds_read_b128 a[180:183], v11 offset:5120
  buffer_load_dwordx4 v1, s[16:19], s40 offen offset:2048 lds
  v_cmp_le_i32 s[54:55], 1, v7
  v_cndmask_b32 v43, v5, v43, s[58:59]
  v_mfma_f32_16x16x32_bf16 a[28:31], a[244:247], v[100:103], a[28:31]
  v_exp_f32 v150, v42
  v_cvt_pk_bf16_f32 v92, v148, v149
  v_mfma_f32_16x16x32_bf16 v[136:139], v[244:247], v[88:91], v[232:235]
  v_mfma_f32_16x16x32_bf16 a[44:47], a[244:247], v[104:107], a[44:47]
  ds_read_b128 a[184:187], v11 offset:6144
  v_cmp_le_i32 s[56:57], 2, v7
  v_cndmask_b32 v44, v5, v44, s[52:53]
  v_exp_f32 v151, v43
  v_mfma_f32_16x16x32_bf16 a[60:63], a[244:247], v[108:111], a[60:63]
  v_cmp_le_i32 s[58:59], 3, v7
  v_cndmask_b32 v45, v5, v45, s[54:55]
  v_exp_f32 v152, v44
  v_cvt_pk_bf16_f32 v93, v150, v151
  v_mfma_f32_16x16x32_bf16 a[72:75], a[248:251], v[96:99], a[72:75]
  ds_read_b128 a[188:191], v11 offset:7168
  v_cndmask_b32 v46, v5, v46, s[56:57]
  v_exp_f32 v153, v45
  v_cndmask_b32 v47, v5, v47, s[58:59]
  v_mfma_f32_16x16x32_bf16 a[88:91], a[248:251], v[100:103], a[88:91]
  v_exp_f32 v154, v46
  v_cvt_pk_bf16_f32 v94, v152, v153
  v_exp_f32 v155, v47
  v_mfma_f32_16x16x32_bf16 a[104:107], a[248:251], v[104:107], a[104:107]
  buffer_load_dwordx4 v1, s[16:19], s40 offen offset:3072 lds
  s_nop 0
  v_cvt_pk_bf16_f32 v95, v154, v155
  v_mfma_f32_16x16x32_bf16 a[120:123], a[248:251], v[108:111], a[120:123]
  s_nop 1
  v_mfma_f32_16x16x32_bf16 v[140:143], v[244:247], v[92:95], v[236:239]
  s_add_u32 s40, s40, 16384
  v_mfma_f32_16x16x32_bf16 a[76:79], a[252:255], v[96:99], a[76:79]
  v_mfma_f32_16x16x32_bf16 a[92:95], a[252:255], v[100:103], a[92:95]
  v_mfma_f32_16x16x32_bf16 a[108:111], a[252:255], v[104:107], a[108:111]
  v_mfma_f32_16x16x32_bf16 a[124:127], a[252:255], v[108:111], a[124:127]
  s_nop 7
  v_max3_f32 v12, v128, v132, v136
  v_max_f32 v12, v12, v140
  v_cmp_nle_f32 vcc, v12, v13
  s_cbranch_vccnz K2_RARE_T1
K2_RARE_T1_ret:
  s_waitcnt vmcnt(8) lgkmcnt(0)
  v_mfma_f32_16x16x32_bf16 v[16:19], a[192:195], a[128:131], 0
  s_barrier
  v_cmp_le_i32 s[52:53], 0, v9
  v_cmp_le_i32 s[54:55], 1, v9
  v_mfma_f32_16x16x32_bf16 v[24:27], a[192:195], a[144:147], 0
  v_cmp_le_i32 s[56:57], 2, v9
  v_xor_b32 v3, 0x8000, v3
  v_mfma_f32_16x16x32_bf16 v[32:35], a[192:195], a[160:163], 0
  ds_read_b128 a[224:227], v3 offset:0
  v_cndmask_b32 v64, v5, v64, s[52:53]
  v_cmp_le_i32 s[58:59], 3, v9
  v_mfma_f32_16x16x32_bf16 v[40:43], a[192:195], a[176:179], 0
  v_cndmask_b32 v65, v5, v65, s[54:55]
  s_and_b32 m0, s39, 0xffff
  v_mfma_f32_16x16x32_bf16 v[20:23], a[196:199], a[128:131], 0
  ds_read_b128 a[228:231], v3 offset:1024
  buffer_load_dwordx4 v4, s[12:15], s36 offen offset:0 lds
  v_mfma_f32_16x16x32_bf16 v[28:31], a[196:199], a[144:147], 0
  v_exp_f32 v148, v64
  v_mfma_f32_16x16x32_bf16 v[36:39], a[196:199], a[160:163], 0
  ds_read_b128 a[232:235], v3 offset:2048
  v_cmp_le_i32 s[52:53], 16, v9
  v_cndmask_b32 v66, v5, v66, s[56:57]
  v_mfma_f32_16x16x32_bf16 v[44:47], a[196:199], a[176:179], 0
  v_exp_f32 v149, v65
  v_mfma_f32_16x16x32_bf16 v[16:19], a[200:203], a[132:135], v[16:19]
  ds_read_b128 a[236:239], v3 offset:3072
  v_cmp_le_i32 s[54:55], 17, v9
  v_cndmask_b32 v67, v5, v67, s[58:59]
  v_mfma_f32_16x16x32_bf16 v[24:27], a[200:203], a[148:151], v[24:27]
  v_exp_f32 v150, v66
  v_mfma_f32_16x16x32_bf16 v[32:35], a[200:203], a[164:167], v[32:35]
  ds_read_b128 a[240:243], v3 offset:4096
  v_cvt_pk_bf16_f32 v104, v148, v149
  v_mfma_f32_16x16x32_bf16 v[40:43], a[200:203], a[180:183], v[40:43]
  v_cmp_le_i32 s[56:57], 18, v9
  v_cndmask_b32 v68, v5, v68, s[52:53]
  v_mfma_f32_16x16x32_bf16 v[20:23], a[204:207], a[132:135], v[20:23]
  ds_read_b128 a[244:247], v3 offset:5120
  buffer_load_dwordx4 v4, s[12:15], s36 offen offset:1024 lds
  v_mfma_f32_16x16x32_bf16 v[28:31], a[204:207], a[148:151], v[28:31]
  v_exp_f32 v151, v67
  v_mfma_f32_16x16x32_bf16 v[36:39], a[204:207], a[164:167], v[36:39]
  ds_read_b128 a[248:251], v3 offset:6144
  v_cmp_le_i32 s[58:59], 19, v9
  v_cndmask_b32 v69, v5, v69, s[54:55]
  v_mfma_f32_16x16x32_bf16 v[44:47], a[204:207], a[180:183], v[44:47]
  v_exp_f32 v152, v68
  v_mfma_f32_16x16x32_bf16 v[16:19], a[208:211], a[136:139], v[16:19]
  ds_read_b128 a[252:255], v3 offset:7168
  v_cvt_pk_bf16_f32 v105, v150, v151
  v_mfma_f32_16x16x32_bf16 v[24:27], a[208:211], a[152:155], v[24:27]
  v_cmp_le_i32 s[52:53], -16, v9
  v_cndmask_b32 v70, v5, v70, s[56:57]
  v_mfma_f32_16x16x32_bf16 v[32:35], a[208:211], a[168:171], v[32:35]
  buffer_store_dwordx4 v[160:163], v1, s[20:23], s28 offen offset:0 sc1
  v_mfma_f32_16x16x32_bf16 v[40:43], a[208:211], a[184:187], v[40:43]
  v_exp_f32 v153, v69
  v_cmp_le_i32 s[54:55], -15, v9
  v_mfma_f32_16x16x32_bf16 v[20:23], a[212:215], a[136:139], v[20:23]
  buffer_load_dwordx4 v4, s[12:15], s36 offen offset:2048 lds
  v_cndmask_b32 v71, v5, v71, s[58:59]
  v_mfma_f32_16x16x32_bf16 v[28:31], a[212:215], a[152:155], v[28:31]
  v_exp_f32 v154, v70
  v_mfma_f32_16x16x32_bf16 v[36:39], a[212:215], a[168:171], v[36:39]
  buffer_store_dwordx4 v[164:167], v1, s[20:23], s28 offen offset:1024 sc1
  v_cvt_pk_bf16_f32 v106, v152, v153
  v_mfma_f32_16x16x32_bf16 v[44:47], a[212:215], a[184:187], v[44:47]
  v_cmp_le_i32 s[56:57], -14, v9
  v_cndmask_b32 v72, v5, v72, s[52:53]
  v_mfma_f32_16x16x32_bf16 v[16:19], a[216:219], a[140:143], v[16:19]
  buffer_store_dwordx4 v[168:171], v1, s[20:23], s28 offen offset:2048 sc1
  v_mfma_f32_16x16x32_bf16 v[24:27], a[216:219], a[156:159], v[24:27]
  v_exp_f32 v155, v71
  v_cmp_le_i32 s[58:59], -13, v9
  v_mfma_f32_16x16x32_bf16 v[32:35], a[216:219], a[172:175], v[32:35]
  buffer_load_dwordx4 v4, s[12:15], s36 offen offset:3072 lds
  v_mfma_f32_16x16x32_bf16 v[40:43], a[216:219], a[188:191], v[40:43]
  s_add_u32 s39, s39, 16384
  s_add_u32 s36, s36, 16384
  s_cmp_eq_u32 s36, s37
  s_cselect_b32 s36, 0, s36
  s_cselect_b32 s14, s38, s14
  v_mfma_f32_16x16x32_bf16 v[20:23], a[220:223], a[140:143], v[20:23]
  buffer_store_dwordx4 v[172:175], v1, s[20:23], s28 offen offset:3072 sc1
  v_mfma_f32_16x16x32_bf16 v[28:31], a[220:223], a[156:159], v[28:31]
  v_cndmask_b32 v73, v5, v73, s[54:55]
  s_add_u32 s28, s28, s29
  v_mfma_f32_16x16x32_bf16 v[36:39], a[220:223], a[172:175], v[36:39]
  v_exp_f32 v148, v72
  v_mfma_f32_16x16x32_bf16 v[44:47], a[220:223], a[188:191], v[44:47]
  v_cvt_pk_bf16_f32 v107, v154, v155
  s_waitcnt lgkmcnt(0)
  v_mfma_f32_16x16x32_bf16 a[0:3], a[224:227], v[80:83], a[0:3]
  ds_read_b128 a[192:195], v2 offset:16384
  v_cmp_le_i32 s[52:53], 0, v9
  v_cndmask_b32 v74, v5, v74, s[56:57]
  v_mfma_f32_16x16x32_bf16 a[16:19], a[224:227], v[84:87], a[16:19]
  v_exp_f32 v149, v73
  v_mfma_f32_16x16x32_bf16 a[32:35], a[224:227], v[88:91], a[32:35]
  v_mfma_f32_16x16x32_bf16 a[48:51], a[224:227], v[92:95], a[48:51]
  ds_read_b128 a[224:227], v3 offset:16384
  v_cmp_le_i32 s[54:55], 1, v9
  v_cndmask_b32 v75, v5, v75, s[58:59]
  s_and_b32 s48, s40, 0xffff
  s_or_b32 m0, s48, 0x10000
  v_mfma_f32_16x16x32_bf16 a[4:7], a[228:231], v[80:83], a[4:7]
  ds_read_b128 a[196:199], v2 offset:17408
  buffer_load_dwordx4 v1, s[16:19], s40 offen offset:0 lds
  v_mfma_f32_16x16x32_bf16 a[20:23], a[228:231], v[84:87], a[20:23]
  v_exp_f32 v150, v74
  v_mfma_f32_16x16x32_bf16 a[36:39], a[228:231], v[88:91], a[36:39]
  v_mfma_f32_16x16x32_bf16 a[52:55], a[228:231], v[92:95], a[52:55]
  ds_read_b128 a[228:231], v3 offset:17408
  v_cvt_pk_bf16_f32 v108, v148, v149
  v_mfma_f32_16x16x32_bf16 v[232:235], v[244:247], v[104:107], v[136:139]
  v_cmp_le_i32 s[56:57], 2, v9
  v_mfma_f32_16x16x32_bf16 a[64:67], a[232:235], v[80:83], a[64:67]
  ds_read_b128 a[200:203], v2 offset:18432
  v_mfma_f32_16x16x32_bf16 a[80:83], a[232:235], v[84:87], a[80:83]
  buffer_store_dwordx4 v[176:179], v1, s[20:23], s28 offen offset:0 sc1
  v_cndmask_b32 v76, v5, v76, s[52:53]
  v_mfma_f32_16x16x32_bf16 a[96:99], a[232:235], v[88:91], a[96:99]
  v_mfma_f32_16x16x32_bf16 a[112:115], a[232:235], v[92:95], a[112:115]
  ds_read_b128 a[232:235], v3 offset:18432
  v_exp_f32 v151, v75
  v_cmp_le_i32 s[58:59], 3, v9
  v_cndmask_b32 v77, v5, v77, s[54:55]
  v_mfma_f32_16x16x32_bf16 a[68:71], a[236:239], v[80:83], a[68:71]
  ds_read_b128 a[204:207], v2 offset:19456
  buffer_load_dwordx4 v1, s[16:19], s40 offen offset:1024 lds
  v_mfma_f32_16x16x32_bf16 a[84:87], a[236:239], v[84:87], a[84:87]
  v_exp_f32 v152, v76
  v_mfma_f32_16x16x32_bf16 a[100:103], a[236:239], v[88:91], a[100:103]
  v_mfma_f32_16x16x32_bf16 a[116:119], a[236:239], v[92:95], a[116:119]
  ds_read_b128 a[236:239], v3 offset:19456
  v_cvt_pk_bf16_f32 v109, v150, v151
  v_cndmask_b32 v78, v5, v78, s[56:57]
  v_exp_f32 v153, v77
  v_mfma_f32_16x16x32_bf16 a[8:11], a[240:243], v[80:83], a[8:11]
  ds_read_b128 a[208:211], v2 offset:20480
  v_mfma_f32_16x16x32_bf16 a[24:27], a[240:243], v[84:87], a[24:27]
  buffer_store_dwordx4 v[180:183], v1, s[20:23], s28 offen offset:1024 sc1
  v_cndmask_b32 v79, v5, v79, s[58:59]
  v_mfma_f32_16x16x32_bf16 a[40:43], a[240:243], v[88:91], a[40:43]
  v_mfma_f32_16x16x32_bf16 a[56:59], a[240:243], v[92:95], a[56:59]
  ds_read_b128 a[240:243], v3 offset:20480
  v_exp_f32 v154, v78
  v_cvt_pk_bf16_f32 v110, v152, v153
  v_mfma_f32_16x16x32_bf16 a[12:15], a[244:247], v[80:83], a[12:15]
  ds_read_b128 a[212:215], v2 offset:21504
  buffer_load_dwordx4 v1, s[16:19], s40 offen offset:2048 lds
  v_mfma_f32_16x16x32_bf16 a[28:31], a[244:247], v[84:87], a[28:31]
  v_exp_f32 v155, v79
  v_mfma_f32_16x16x32_bf16 a[44:47], a[244:247], v[88:91], a[44:47]
  v_mfma_f32_16x16x32_bf16 a[60:63], a[244:247], v[92:95], a[60:63]
  ds_read_b128 a[244:247], v3 offset:21504
  buffer_store_dwordx4 v[184:187], v1, s[20:23], s28 offen offset:2048 sc1
  s_nop 0
  v_cvt_pk_bf16_f32 v111, v154, v155
  v_mfma_f32_16x16x32_bf16 a[72:75], a[248:251], v[80:83], a[72:75]
  ds_read_b128 a[216:219], v2 offset:22528
  v_mfma_f32_16x16x32_bf16 a[88:91], a[248:251], v[84:87], a[88:91]
  buffer_load_dwordx4 v1, s[16:19], s40 offen offset:3072 lds
  s_add_u32 s40, s40, 16384
  v_mfma_f32_16x16x32_bf16 a[104:107], a[248:251], v[88:91], a[104:107]
  v_mfma_f32_16x16x32_bf16 a[120:123], a[248:251], v[92:95], a[120:123]
  ds_read_b128 a[248:251], v3 offset:22528
  buffer_store_dwordx4 v[188:191], v1, s[20:23], s28 offen offset:3072 sc1
  s_nop 1
  v_mfma_f32_16x16x32_bf16 a[76:79], a[252:255], v[80:83], a[76:79]
  ds_read_b128 a[220:223], v2 offset:23552
  v_mfma_f32_16x16x32_bf16 v[236:239], v[244:247], v[108:111], v[140:143]
  v_mfma_f32_16x16x32_bf16 a[92:95], a[252:255], v[84:87], a[92:95]
  s_nop 7
  v_add_f32 v12, v232, v236
  v_cmp_nle_f32 vcc, v12, v13
  v_mfma_f32_16x16x32_bf16 a[108:111], a[252:255], v[88:91], a[108:111]
  v_mfma_f32_16x16x32_bf16 a[124:127], a[252:255], v[92:95], a[124:127]
  ds_read_b128 a[252:255], v3 offset:23552
  s_cbranch_vccnz K2_RARE_T2
K2_RARE_T2_ret:
  s_cmp_lg_u32 s38, 0x8000
  s_cbranch_scc1 K2_NOMASK0
  v_cmp_le_i32 s[52:53], 0, v6
  v_cmp_le_i32 s[54:55], 1, v6
  v_cmp_le_i32 s[56:57], 2, v6
  v_cndmask_b32 v16, v5, v16, s[52:53]
  v_cmp_le_i32 s[58:59], 3, v6
  v_cndmask_b32 v17, v5, v17, s[54:55]
  v_cmp_le_i32 s[52:53], 16, v6
  v_cndmask_b32 v18, v5, v18, s[56:57]
  v_cmp_le_i32 s[54:55], 17, v6
  v_cndmask_b32 v19, v5, v19, s[58:59]
  v_cmp_le_i32 s[56:57], 18, v6
  v_cndmask_b32 v20, v5, v20, s[52:53]
  v_cmp_le_i32 s[58:59], 19, v6
  v_cndmask_b32 v21, v5, v21, s[54:55]
  v_cmp_le_i32 s[52:53], -16, v6
  v_cndmask_b32 v22, v5, v22, s[56:57]
  v_cmp_le_i32 s[54:55], -15, v6
  v_cndmask_b32 v23, v5, v23, s[58:59]
  v_cmp_le_i32 s[56:57], -14, v6
  v_cndmask_b32 v24, v5, v24, s[52:53]
  v_cmp_le_i32 s[58:59], -13, v6
  v_cndmask_b32 v25, v5, v25, s[54:55]
  v_cmp_le_i32 s[52:53], 0, v6
  v_cndmask_b32 v26, v5, v26, s[56:57]
  v_cmp_le_i32 s[54:55], 1, v6
  v_cndmask_b32 v27, v5, v27, s[58:59]
  v_cmp_le_i32 s[56:57], 2, v6
  v_cndmask_b32 v28, v5, v28, s[52:53]
  v_cmp_le_i32 s[58:59], 3, v6
  v_cndmask_b32 v29, v5, v29, s[54:55]
  v_cmp_le_i32 s[52:53], 0, v7
  v_cndmask_b32 v30, v5, v30, s[56:57]
  v_cmp_le_i32 s[54:55], 1, v7
  v_cndmask_b32 v31, v5, v31, s[58:59]
  v_cmp_le_i32 s[56:57], 2, v7
  v_cndmask_b32 v32, v5, v32, s[52:53]
  v_cmp_le_i32 s[58:59], 3, v7
  v_cndmask_b32 v33, v5, v33, s[54:55]
  v_cmp_le_i32 s[52:53], 16, v7
  v_cndmask_b32 v34, v5, v34, s[56:57]
  v_cmp_le_i32 s[54:55], 17, v7
  v_cndmask_b32 v35, v5, v35, s[58:59]
  v_cmp_le_i32 s[56:57], 18, v7
  v_cndmask_b32 v36, v5, v36, s[52:53]
  v_cmp_le_i32 s[58:59], 19, v7
  v_cndmask_b32 v37, v5, v37, s[54:55]
  v_cmp_le_i32 s[52:53], -16, v7
  v_cndmask_b32 v38, v5, v38, s[56:57]
  v_cmp_le_i32 s[54:55], -15, v7
  v_cndmask_b32 v39, v5, v39, s[58:59]
  v_cmp_le_i32 s[56:57], -14, v7
  v_cndmask_b32 v40, v5, v40, s[52:53]
  v_cmp_le_i32 s[58:59], -13, v7
  v_cndmask_b32 v41, v5, v41, s[54:55]
  v_cmp_le_i32 s[52:53], 0, v7
  v_cndmask_b32 v42, v5, v42, s[56:57]
  v_cmp_le_i32 s[54:55], 1, v7
  v_cndmask_b32 v43, v5, v43, s[58:59]
  v_cmp_le_i32 s[56:57], 2, v7
  v_cndmask_b32 v44, v5, v44, s[52:53]
  v_cmp_le_i32 s[58:59], 3, v7
  v_cndmask_b32 v45, v5, v45, s[54:55]
  v_cndmask_b32 v46, v5, v46, s[56:57]
  v_cndmask_b32 v47, v5, v47, s[58:59]
K2_NOMASK0:
  s_waitcnt lgkmcnt(8)
  v_mfma_f32_16x16x32_bf16 a[96:99], a[232:235], v[104:107], a[96:99]
  s_and_b32 s46, s40, 0x8000
  s_or_b32 s46, s46, 0x10000
  s_cmp_eq_u32 s32, 0
  s_cselect_b32 s47, s46, 0x20000
  s_cselect_b32 s46, 0x20000, s46
  s_lshl_b32 s48, s31, 14
  s_add_u32 s47, s47, s48
  v_mfma_f32_16x16x32_bf16 a[112:115], a[232:235], v[108:111], a[112:115]
  s_add_u32 s46, s46, s48
  v_add_u32 v168, s47, v1
  v_add_u32 v169, s46, v1
  s_and_b32 s46, s39, 0xffff
  v_add_u32 v170, s46, v1
  v_xor_b32 v171, 0x2000, v170
  v_mfma_f32_16x16x32_bf16 a[100:103], a[236:239], v[104:107], a[100:103]
  v_mov_b32 v249, v128
  v_mov_b32 v251, v132
  v_mov_b32 v253, v232
  v_mov_b32 v255, v236
  v_mov_b32 v248, v112
  v_mov_b32 v250, v116
  v_mov_b32 v252, v120
  v_mfma_f32_16x16x32_bf16 a[116:119], a[236:239], v[108:111], a[116:119]
  v_mov_b32 v254, v124
  v_max3_f32 v144, v16, v17, v18
  v_max3_f32 v145, v24, v25, v26
  v_max3_f32 v144, v144, v19, v20
  v_max3_f32 v145, v145, v27, v28
  s_waitcnt lgkmcnt(0)
  v_mfma_f32_16x16x32_bf16 a[104:107], a[248:251], v[104:107], a[104:107]
  s_barrier
  v_max3_f32 v144, v144, v21, v22
  v_max3_f32 v145, v145, v29, v30
  v_max3_f32 v144, v144, v23, s42
  v_max3_f32 v145, v145, v31, s42
  v_mov_b32 v156, v144
  v_mov_b32 v157, v145
  v_mfma_f32_16x16x32_bf16 a[120:123], a[248:251], v[108:111], a[120:123]
  s_nop 0
  v_permlane16_swap_b32 v144, v156
  v_permlane16_swap_b32 v145, v157
  v_max_f32 v144, v144, v156
  v_max_f32 v145, v145, v157
  v_mov_b32 v156, v144
  v_mov_b32 v157, v145
  v_mfma_f32_16x16x32_bf16 a[108:111], a[252:255], v[104:107], a[108:111]
  s_nop 0
  v_permlane32_swap_b32 v144, v156
  v_permlane32_swap_b32 v145, v157
  v_max_f32 v144, v144, v156
  v_max_f32 v145, v145, v157
  v_sub_f32 v112, 0, v144
  v_sub_f32 v113, 0, v144
  v_mfma_f32_16x16x32_bf16 a[124:127], a[252:255], v[108:111], a[124:127]
  v_sub_f32 v114, 0, v144
  v_sub_f32 v115, 0, v144
  v_sub_f32 v116, 0, v145
  v_sub_f32 v117, 0, v145
  v_sub_f32 v118, 0, v145
  v_sub_f32 v119, 0, v145
  v_mfma_f32_16x16x32_bf16 a[32:35], a[224:227], v[104:107], a[32:35]
  v_max3_f32 v146, v32, v33, v34
  v_max3_f32 v147, v40, v41, v42
  v_max3_f32 v146, v146, v35, v36
  v_max3_f32 v147, v147, v43, v44
  v_max3_f32 v146, v146, v37, v38
  v_max3_f32 v147, v147, v45, v46
  v_max3_f32 v146, v146, v39, s42
  v_mfma_f32_16x16x32_bf16 a[48:51], a[224:227], v[108:111], a[48:51]
  v_max3_f32 v147, v147, v47, s42
  v_mov_b32 v158, v146
  v_mov_b32 v159, v147
  s_nop 0
  v_permlane16_swap_b32 v146, v158
  v_permlane16_swap_b32 v147, v159
  v_mfma_f32_16x16x32_bf16 a[36:39], a[228:231], v[104:107], a[36:39]
  ds_write_b128 v168, a[64:67] offset:0
  v_max_f32 v146, v146, v158
  v_max_f32 v147, v147, v159
  v_mov_b32 v158, v146
  v_mov_b32 v159, v147
  s_nop 0
  v_permlane32_swap_b32 v146, v158
  v_mfma_f32_16x16x32_bf16 a[52:55], a[228:231], v[108:111], a[52:55]
  v_permlane32_swap_b32 v147, v159
  v_max_f32 v146, v146, v158
  v_max_f32 v147, v147, v159
  v_sub_f32 v120, 0, v146
  v_sub_f32 v121, 0, v146
  v_sub_f32 v122, 0, v146
  v_sub_f32 v123, 0, v146
  v_mfma_f32_16x16x32_bf16 a[40:43], a[240:243], v[104:107], a[40:43]
  ds_write_b128 v168, a[68:71] offset:1024
  v_sub_f32 v124, 0, v147
  v_sub_f32 v125, 0, v147
  v_sub_f32 v126, 0, v147
  v_sub_f32 v127, 0, v147
  v_mfma_f32_16x16x32_bf16 a[56:59], a[240:243], v[108:111], a[56:59]
  v_mov_b32 v156, 0
  v_mov_b32 v157, 0
  v_mov_b32 v158, 0
  v_mov_b32 v159, 0
  v_mfma_f32_16x16x32_bf16 a[44:47], a[244:247], v[104:107], a[44:47]
  ds_write_b128 v168, a[72:75] offset:2048
  v_sub_f32 v16, v16, v144
  v_sub_f32 v17, v17, v144
  v_exp_f32 v148, v16
  v_mfma_f32_16x16x32_bf16 a[60:63], a[244:247], v[108:111], a[60:63]
  v_sub_f32 v18, v18, v144
  v_exp_f32 v149, v17
  v_sub_f32 v19, v19, v144
  v_mfma_f32_16x16x32_bf16 v[48:51], a[192:195], a[128:131], v[112:115]
  ds_write_b128 v168, a[76:79] offset:3072
  v_exp_f32 v150, v18
  v_sub_f32 v20, v20, v144
  v_mfma_f32_16x16x32_bf16 v[56:59], a[192:195], a[144:147], v[116:119]
  v_cvt_pk_bf16_f32 v80, v148, v149
  v_exp_f32 v151, v19
  v_sub_f32 v21, v21, v144
  v_mfma_f32_16x16x32_bf16 v[52:55], a[196:199], a[128:131], v[112:115]
  ds_write_b128 v168, a[80:83] offset:4096
  v_exp_f32 v152, v20
  v_sub_f32 v22, v22, v144
  v_mfma_f32_16x16x32_bf16 v[60:63], a[196:199], a[144:147], v[116:119]
  v_cvt_pk_bf16_f32 v81, v150, v151
  v_exp_f32 v153, v21
  v_sub_f32 v23, v23, v144
  v_mfma_f32_16x16x32_bf16 v[48:51], a[200:203], a[132:135], v[48:51]
  ds_write_b128 v168, a[84:87] offset:5120
  v_exp_f32 v154, v22
  v_sub_f32 v24, v24, v145
  v_mfma_f32_16x16x32_bf16 v[56:59], a[200:203], a[148:151], v[56:59]
  v_cvt_pk_bf16_f32 v82, v152, v153
  v_exp_f32 v155, v23
  v_sub_f32 v25, v25, v145
  v_mfma_f32_16x16x32_bf16 v[52:55], a[204:207], a[132:135], v[52:55]
  ds_write_b128 v168, a[88:91] offset:6144
  v_exp_f32 v148, v24
  v_sub_f32 v26, v26, v145
  v_mfma_f32_16x16x32_bf16 v[60:63], a[204:207], a[148:151], v[60:63]
  v_cvt_pk_bf16_f32 v83, v154, v155
  v_exp_f32 v149, v25
  v_sub_f32 v27, v27, v145
  v_mfma_f32_16x16x32_bf16 v[48:51], a[208:211], a[136:139], v[48:51]
  ds_write_b128 v168, a[92:95] offset:7168
  v_exp_f32 v150, v26
  v_sub_f32 v28, v28, v145
  v_mfma_f32_16x16x32_bf16 v[56:59], a[208:211], a[152:155], v[56:59]
  v_cvt_pk_bf16_f32 v84, v148, v149
  v_mfma_f32_16x16x32_bf16 v[128:131], v[244:247], v[80:83], 0
  v_xor_b32 v2, 0x8000, v2
  v_mfma_f32_16x16x32_bf16 v[52:55], a[212:215], a[136:139], v[52:55]
  ds_write_b128 v168, a[96:99] offset:8192
  v_exp_f32 v151, v27
  v_sub_f32 v29, v29, v145
  v_mfma_f32_16x16x32_bf16 v[60:63], a[212:215], a[152:155], v[60:63]
  v_exp_f32 v152, v28
  v_sub_f32 v30, v30, v145
  v_cvt_pk_bf16_f32 v85, v150, v151
  v_mfma_f32_16x16x32_bf16 v[48:51], a[216:219], a[140:143], v[48:51]
  ds_write_b128 v168, a[100:103] offset:9216
  v_exp_f32 v153, v29
  v_sub_f32 v31, v31, v145
  v_mfma_f32_16x16x32_bf16 v[56:59], a[216:219], a[156:159], v[56:59]
  v_exp_f32 v154, v30
  v_sub_f32 v32, v32, v146
  v_cvt_pk_bf16_f32 v86, v152, v153
  v_mfma_f32_16x16x32_bf16 v[52:55], a[220:223], a[140:143], v[52:55]
  ds_write_b128 v168, a[104:107] offset:10240
  v_exp_f32 v155, v31
  v_sub_f32 v33, v33, v146
  v_mfma_f32_16x16x32_bf16 v[60:63], a[220:223], a[156:159], v[60:63]
  v_exp_f32 v148, v32
  v_sub_f32 v34, v34, v146
  v_cvt_pk_bf16_f32 v87, v154, v155
  v_mfma_f32_16x16x32_bf16 v[64:67], a[192:195], a[160:163], v[120:123]
  ds_write_b128 v168, a[108:111] offset:11264
  v_mfma_f32_16x16x32_bf16 v[72:75], a[192:195], a[176:179], v[124:127]
  ds_read_b128 a[192:195], v2 offset:0
  v_exp_f32 v149, v33
  v_sub_f32 v35, v35, v146
  v_exp_f32 v150, v34
  v_sub_f32 v36, v36, v146
  v_cvt_pk_bf16_f32 v88, v148, v149
  v_mfma_f32_16x16x32_bf16 v[68:71], a[196:199], a[160:163], v[120:123]
  ds_write_b128 v168, a[112:115] offset:12288
  v_mfma_f32_16x16x32_bf16 v[76:79], a[196:199], a[176:179], v[124:127]
  ds_read_b128 a[196:199], v2 offset:1024
  v_mfma_f32_16x16x32_bf16 v[132:135], v[244:247], v[84:87], 0
  v_exp_f32 v151, v35
  v_sub_f32 v37, v37, v146
  v_exp_f32 v152, v36
  v_mfma_f32_16x16x32_bf16 v[64:67], a[200:203], a[164:167], v[64:67]
  ds_write_b128 v168, a[116:119] offset:13312
  v_mfma_f32_16x16x32_bf16 v[72:75], a[200:203], a[180:183], v[72:75]
  ds_read_b128 a[200:203], v2 offset:2048
  v_sub_f32 v38, v38, v146
  v_cvt_pk_bf16_f32 v89, v150, v151
  v_exp_f32 v153, v37
  v_sub_f32 v39, v39, v146
  v_exp_f32 v154, v38
  v_mfma_f32_16x16x32_bf16 v[68:71], a[204:207], a[164:167], v[68:71]
  ds_write_b128 v168, a[120:123] offset:14336
  v_mfma_f32_16x16x32_bf16 v[76:79], a[204:207], a[180:183], v[76:79]
  ds_read_b128 a[204:207], v2 offset:3072
  v_sub_f32 v40, v40, v147
  v_cvt_pk_bf16_f32 v90, v152, v153
  v_exp_f32 v155, v39
  v_sub_f32 v41, v41, v147
  v_exp_f32 v148, v40
  v_mfma_f32_16x16x32_bf16 v[64:67], a[208:211], a[168:171], v[64:67]
  ds_write_b128 v168, a[124:127] offset:15360
  v_mfma_f32_16x16x32_bf16 v[72:75], a[208:211], a[184:187], v[72:75]
  ds_read_b128 a[208:211], v2 offset:4096
  v_sub_f32 v42, v42, v147
  v_cvt_pk_bf16_f32 v91, v154, v155
  v_exp_f32 v149, v41
  v_sub_f32 v43, v43, v147
  v_exp_f32 v150, v42
  v_mfma_f32_16x16x32_bf16 v[68:71], a[212:215], a[168:171], v[68:71]
  ds_write_b128 v170, v[248:251]
  v_mfma_f32_16x16x32_bf16 v[76:79], a[212:215], a[184:187], v[76:79]
  ds_read_b128 a[212:215], v2 offset:5120
  v_sub_f32 v44, v44, v147
  v_cvt_pk_bf16_f32 v92, v148, v149
  v_mfma_f32_16x16x32_bf16 v[136:139], v[244:247], v[88:91], 0
  v_exp_f32 v151, v43
  v_sub_f32 v45, v45, v147
  v_mfma_f32_16x16x32_bf16 v[64:67], a[216:219], a[172:175], v[64:67]
  ds_write_b128 v170, v[252:255] offset:1024
  v_mfma_f32_16x16x32_bf16 v[72:75], a[216:219], a[188:191], v[72:75]
  ds_read_b128 a[216:219], v2 offset:6144
  v_exp_f32 v152, v44
  v_sub_f32 v46, v46, v147
  v_cvt_pk_bf16_f32 v93, v150, v151
  v_exp_f32 v153, v45
  v_sub_f32 v47, v47, v147
  v_mfma_f32_16x16x32_bf16 v[68:71], a[220:223], a[172:175], v[68:71]
  v_mfma_f32_16x16x32_bf16 v[76:79], a[220:223], a[188:191], v[76:79]
  ds_read_b128 a[220:223], v2 offset:7168
  v_exp_f32 v154, v46
  v_cvt_pk_bf16_f32 v94, v152, v153
  v_exp_f32 v155, v47
  s_nop 0
  v_cvt_pk_bf16_f32 v95, v154, v155
  s_waitcnt lgkmcnt(2)
  v_mfma_f32_32x32x16_bf16 a[64:79], v[156:159], v[156:159], 0
  s_barrier
  ds_read_b128 v[160:163], v171
  ds_read_b128 v[164:167], v171 offset:1024
  ds_read_b128 v[176:179], v169 offset:0
  ds_read_b128 v[180:183], v169 offset:1024
  ds_read_b128 v[184:187], v169 offset:2048
  ds_read_b128 v[188:191], v169 offset:3072
  s_nop 1
  v_mfma_f32_32x32x16_bf16 a[80:95], v[156:159], v[156:159], 0
  ds_read_b128 v[192:195], v169 offset:4096
  ds_read_b128 v[196:199], v169 offset:5120
  ds_read_b128 v[200:203], v169 offset:6144
  ds_read_b128 v[204:207], v169 offset:7168
  v_mfma_f32_16x16x32_bf16 v[140:143], v[244:247], v[92:95], 0
  v_mfma_f32_32x32x16_bf16 a[96:111], v[156:159], v[156:159], 0
  ds_read_b128 v[208:211], v169 offset:8192
  ds_read_b128 v[212:215], v169 offset:9216
  ds_read_b128 v[216:219], v169 offset:10240
  ds_read_b128 v[220:223], v169 offset:11264
  v_mfma_f32_32x32x16_bf16 a[112:127], v[156:159], v[156:159], 0
  ds_read_b128 v[224:227], v169 offset:12288
  ds_read_b128 v[228:231], v169 offset:13312
  ds_read_b128 v[232:235], v169 offset:14336
  ds_read_b128 v[236:239], v169 offset:15360
  s_lshl_b32 s46, s44, 20
  s_lshl_b32 s47, s33, 13
  s_add_u32 s46, s46, s47
  s_lshl_b32 s47, s32, 12
  s_add_u32 s46, s46, s47
  s_add_u32 s46, s46, 50331648
  s_lshl_b32 s47, s31, 18
  s_add_u32 s63, s46, s47
  s_sub_u32 s64, s46, s47
  s_add_u32 s64, s64, 786432
  s_add_u32 s46, s3, 262144
  s_waitcnt vmcnt(0) lgkmcnt(0)
  s_barrier
  buffer_store_dword v14, v15, s[20:23], s46 offen sc1
  s_and_b32 m0, s39, 0xffff
  s_nop 0
  buffer_load_dwordx4 v4, s[12:15], s36 offen offset:0 lds
  buffer_load_dwordx4 v4, s[12:15], s36 offen offset:1024 lds
  buffer_load_dwordx4 v4, s[12:15], s36 offen offset:2048 lds
  buffer_load_dwordx4 v4, s[12:15], s36 offen offset:3072 lds
  s_add_u32 s39, s39, 16384
  s_add_u32 s36, s36, 16384
  s_cmp_eq_u32 s36, s37
  s_cselect_b32 s36, 0, s36
  s_cselect_b32 s14, s38, s14
  v_min_f32 v172, v248, v160
  v_min_f32 v173, v250, v162
  v_min_f32 v174, v252, v164
  v_min_f32 v175, v254, v166
  v_sub_f32 v248, v172, v248
  v_sub_f32 v160, v172, v160
  v_sub_f32 v250, v173, v250
  v_sub_f32 v162, v173, v162
  v_sub_f32 v252, v174, v252
  v_sub_f32 v164, v174, v164
  v_sub_f32 v254, v175, v254
  v_sub_f32 v166, v175, v166
  v_exp_f32 v248, v248
  v_exp_f32 v160, v160
  v_exp_f32 v250, v250
  v_exp_f32 v162, v162
  v_exp_f32 v252, v252
  v_exp_f32 v164, v164
  v_exp_f32 v254, v254
  v_exp_f32 v166, v166
  v_mul_f32 v172, v248, v249
  v_mul_f32 v173, v250, v251
  v_mul_f32 v174, v252, v253
  v_mul_f32 v175, v254, v255
  v_fmac_f32 v172, v160, v161
  v_fmac_f32 v173, v162, v163
  v_fmac_f32 v174, v164, v165
  v_fmac_f32 v175, v166, v167
  v_rcp_f32 v172, v172
  v_rcp_f32 v173, v173
  v_rcp_f32 v174, v174
  v_rcp_f32 v175, v175
  v_mul_f32 v248, v248, v172
  v_mul_f32 v160, v160, v172
  v_mul_f32 v250, v250, v173
  v_mul_f32 v162, v162, v173
  v_mul_f32 v252, v252, v174
  v_mul_f32 v164, v164, v174
  v_mul_f32 v254, v254, v175
  v_mul_f32 v166, v166, v175
  v_accvgpr_read_b32 v96, a0
  v_accvgpr_read_b32 v97, a1
  v_accvgpr_read_b32 v98, a2
  v_accvgpr_read_b32 v99, a3
  v_accvgpr_read_b32 v100, a4
  v_accvgpr_read_b32 v101, a5
  v_accvgpr_read_b32 v102, a6
  v_accvgpr_read_b32 v103, a7
  v_mul_f32 v176, v176, v160
  v_mul_f32 v177, v177, v160
  v_mul_f32 v178, v178, v160
  v_mul_f32 v179, v179, v160
  v_mul_f32 v180, v180, v160
  v_mul_f32 v181, v181, v160
  v_mul_f32 v182, v182, v160
  v_mul_f32 v183, v183, v160
  v_fmac_f32 v176, v96, v248
  v_fmac_f32 v177, v97, v248
  v_fmac_f32 v178, v98, v248
  v_fmac_f32 v179, v99, v248
  v_fmac_f32 v180, v100, v248
  v_fmac_f32 v181, v101, v248
  v_fmac_f32 v182, v102, v248
  v_fmac_f32 v183, v103, v248
  v_cvt_pk_bf16_f32 v176, v176, v177
  v_cvt_pk_bf16_f32 v177, v178, v179
  v_cvt_pk_bf16_f32 v178, v180, v181
  v_cvt_pk_bf16_f32 v179, v182, v183
  buffer_store_dwordx4 v[176:179], v1, s[20:23], s63 offen offset:0 sc1
  s_and_b32 s48, s40, 0xffff
  s_or_b32 m0, s48, 0x10000
  s_nop 0
  buffer_load_dwordx4 v1, s[16:19], s40 offen offset:0 lds
  buffer_load_dwordx4 v1, s[16:19], s40 offen offset:1024 lds
  v_accvgpr_read_b32 v104, a8
  v_accvgpr_read_b32 v105, a9
  v_accvgpr_read_b32 v106, a10
  v_accvgpr_read_b32 v107, a11
  v_accvgpr_read_b32 v108, a12
  v_accvgpr_read_b32 v109, a13
  v_accvgpr_read_b32 v110, a14
  v_accvgpr_read_b32 v111, a15
  v_mul_f32 v184, v184, v160
  v_mul_f32 v185, v185, v160
  v_mul_f32 v186, v186, v160
  v_mul_f32 v187, v187, v160
  v_mul_f32 v188, v188, v160
  v_mul_f32 v189, v189, v160
  v_mul_f32 v190, v190, v160
  v_mul_f32 v191, v191, v160
  v_fmac_f32 v184, v104, v248
  v_fmac_f32 v185, v105, v248
  v_fmac_f32 v186, v106, v248
  v_fmac_f32 v187, v107, v248
  v_fmac_f32 v188, v108, v248
  v_fmac_f32 v189, v109, v248
  v_fmac_f32 v190, v110, v248
  v_fmac_f32 v191, v111, v248
  v_cvt_pk_bf16_f32 v184, v184, v185
  v_cvt_pk_bf16_f32 v185, v186, v187
  v_cvt_pk_bf16_f32 v186, v188, v189
  v_cvt_pk_bf16_f32 v187, v190, v191
  buffer_store_dwordx4 v[184:187], v1, s[20:23], s63 offen offset:2048 sc1
  buffer_load_dwordx4 v1, s[16:19], s40 offen offset:2048 lds
  buffer_load_dwordx4 v1, s[16:19], s40 offen offset:3072 lds
  s_add_u32 s40, s40, 16384
  v_mfma_f32_32x32x16_bf16 a[0:15], v[156:159], v[156:159], 0
  v_accvgpr_read_b32 v96, a16
  v_accvgpr_read_b32 v97, a17
  v_accvgpr_read_b32 v98, a18
  v_accvgpr_read_b32 v99, a19
  v_accvgpr_read_b32 v100, a20
  v_accvgpr_read_b32 v101, a21
  v_accvgpr_read_b32 v102, a22
  v_accvgpr_read_b32 v103, a23
  v_mul_f32 v192, v192, v162
  v_mul_f32 v193, v193, v162
  v_mul_f32 v194, v194, v162
  v_mul_f32 v195, v195, v162
  v_mul_f32 v196, v196, v162
  v_mul_f32 v197, v197, v162
  v_mul_f32 v198, v198, v162
  v_mul_f32 v199, v199, v162
  v_fmac_f32 v192, v96, v250
  v_fmac_f32 v193, v97, v250
  v_fmac_f32 v194, v98, v250
  v_fmac_f32 v195, v99, v250
  v_fmac_f32 v196, v100, v250
  v_fmac_f32 v197, v101, v250
  v_fmac_f32 v198, v102, v250
  v_fmac_f32 v199, v103, v250
  v_cvt_pk_bf16_f32 v192, v192, v193
  v_cvt_pk_bf16_f32 v193, v194, v195
  v_cvt_pk_bf16_f32 v194, v196, v197
  v_cvt_pk_bf16_f32 v195, v198, v199
  buffer_store_dwordx4 v[192:195], v1, s[20:23], s63 offen offset:1024 sc1
  v_accvgpr_read_b32 v104, a24
  v_accvgpr_read_b32 v105, a25
  v_accvgpr_read_b32 v106, a26
  v_accvgpr_read_b32 v107, a27
  v_accvgpr_read_b32 v108, a28
  v_accvgpr_read_b32 v109, a29
  v_accvgpr_read_b32 v110, a30
  v_accvgpr_read_b32 v111, a31
  v_mul_f32 v200, v200, v162
  v_mul_f32 v201, v201, v162
  v_mul_f32 v202, v202, v162
  v_mul_f32 v203, v203, v162
  v_mul_f32 v204, v204, v162
  v_mul_f32 v205, v205, v162
  v_mul_f32 v206, v206, v162
  v_mul_f32 v207, v207, v162
  v_fmac_f32 v200, v104, v250
  v_fmac_f32 v201, v105, v250
  v_fmac_f32 v202, v106, v250
  v_fmac_f32 v203, v107, v250
  v_fmac_f32 v204, v108, v250
  v_fmac_f32 v205, v109, v250
  v_fmac_f32 v206, v110, v250
  v_fmac_f32 v207, v111, v250
  v_cvt_pk_bf16_f32 v200, v200, v201
  v_cvt_pk_bf16_f32 v201, v202, v203
  v_cvt_pk_bf16_f32 v202, v204, v205
  v_cvt_pk_bf16_f32 v203, v206, v207
  buffer_store_dwordx4 v[200:203], v1, s[20:23], s63 offen offset:3072 sc1
  v_mfma_f32_32x32x16_bf16 a[16:31], v[156:159], v[156:159], 0
  v_accvgpr_read_b32 v96, a32
  v_accvgpr_read_b32 v97, a33
  v_accvgpr_read_b32 v98, a34
  v_accvgpr_read_b32 v99, a35
  v_accvgpr_read_b32 v100, a36
  v_accvgpr_read_b32 v101, a37
  v_accvgpr_read_b32 v102, a38
  v_accvgpr_read_b32 v103, a39
  v_mul_f32 v208, v208, v164
  v_mul_f32 v209, v209, v164
  v_mul_f32 v210, v210, v164
  v_mul_f32 v211, v211, v164
  v_mul_f32 v212, v212, v164
  v_mul_f32 v213, v213, v164
  v_mul_f32 v214, v214, v164
  v_mul_f32 v215, v215, v164
  v_fmac_f32 v208, v96, v252
  v_fmac_f32 v209, v97, v252
  v_fmac_f32 v210, v98, v252
  v_fmac_f32 v211, v99, v252
  v_fmac_f32 v212, v100, v252
  v_fmac_f32 v213, v101, v252
  v_fmac_f32 v214, v102, v252
  v_fmac_f32 v215, v103, v252
  v_cvt_pk_bf16_f32 v208, v208, v209
  v_cvt_pk_bf16_f32 v209, v210, v211
  v_cvt_pk_bf16_f32 v210, v212, v213
  v_cvt_pk_bf16_f32 v211, v214, v215
  buffer_store_dwordx4 v[208:211], v1, s[20:23], s64 offen offset:0 sc1
  v_accvgpr_read_b32 v104, a40
  v_accvgpr_read_b32 v105, a41
  v_accvgpr_read_b32 v106, a42
  v_accvgpr_read_b32 v107, a43
  v_accvgpr_read_b32 v108, a44
  v_accvgpr_read_b32 v109, a45
  v_accvgpr_read_b32 v110, a46
  v_accvgpr_read_b32 v111, a47
  v_mul_f32 v216, v216, v164
  v_mul_f32 v217, v217, v164
  v_mul_f32 v218, v218, v164
  v_mul_f32 v219, v219, v164
  v_mul_f32 v220, v220, v164
  v_mul_f32 v221, v221, v164
  v_mul_f32 v222, v222, v164
  v_mul_f32 v223, v223, v164
  v_fmac_f32 v216, v104, v252
  v_fmac_f32 v217, v105, v252
  v_fmac_f32 v218, v106, v252
  v_fmac_f32 v219, v107, v252
  v_fmac_f32 v220, v108, v252
  v_fmac_f32 v221, v109, v252
  v_fmac_f32 v222, v110, v252
  v_fmac_f32 v223, v111, v252
  v_cvt_pk_bf16_f32 v216, v216, v217
  v_cvt_pk_bf16_f32 v217, v218, v219
  v_cvt_pk_bf16_f32 v218, v220, v221
  v_cvt_pk_bf16_f32 v219, v222, v223
  buffer_store_dwordx4 v[216:219], v1, s[20:23], s64 offen offset:2048 sc1
  v_mfma_f32_32x32x16_bf16 a[32:47], v[156:159], v[156:159], 0
  v_accvgpr_read_b32 v96, a48
  v_accvgpr_read_b32 v97, a49
  v_accvgpr_read_b32 v98, a50
  v_accvgpr_read_b32 v99, a51
  v_accvgpr_read_b32 v100, a52
  v_accvgpr_read_b32 v101, a53
  v_accvgpr_read_b32 v102, a54
  v_accvgpr_read_b32 v103, a55
  v_mul_f32 v224, v224, v166
  v_mul_f32 v225, v225, v166
  v_mul_f32 v226, v226, v166
  v_mul_f32 v227, v227, v166
  v_mul_f32 v228, v228, v166
  v_mul_f32 v229, v229, v166
  v_mul_f32 v230, v230, v166
  v_mul_f32 v231, v231, v166
  v_fmac_f32 v224, v96, v254
  v_fmac_f32 v225, v97, v254
  v_fmac_f32 v226, v98, v254
  v_fmac_f32 v227, v99, v254
  v_fmac_f32 v228, v100, v254
  v_fmac_f32 v229, v101, v254
  v_fmac_f32 v230, v102, v254
  v_fmac_f32 v231, v103, v254
  v_cvt_pk_bf16_f32 v224, v224, v225
  v_cvt_pk_bf16_f32 v225, v226, v227
  v_cvt_pk_bf16_f32 v226, v228, v229
  v_cvt_pk_bf16_f32 v227, v230, v231
  buffer_store_dwordx4 v[224:227], v1, s[20:23], s64 offen offset:1024 sc1
  v_accvgpr_read_b32 v104, a56
  v_accvgpr_read_b32 v105, a57
  v_accvgpr_read_b32 v106, a58
  v_accvgpr_read_b32 v107, a59
  v_accvgpr_read_b32 v108, a60
  v_accvgpr_read_b32 v109, a61
  v_accvgpr_read_b32 v110, a62
  v_accvgpr_read_b32 v111, a63
  v_mul_f32 v232, v232, v166
  v_mul_f32 v233, v233, v166
  v_mul_f32 v234, v234, v166
  v_mul_f32 v235, v235, v166
  v_mul_f32 v236, v236, v166
  v_mul_f32 v237, v237, v166
  v_mul_f32 v238, v238, v166
  v_mul_f32 v239, v239, v166
  v_fmac_f32 v232, v104, v254
  v_fmac_f32 v233, v105, v254
  v_fmac_f32 v234, v106, v254
  v_fmac_f32 v235, v107, v254
  v_fmac_f32 v236, v108, v254
  v_fmac_f32 v237, v109, v254
  v_fmac_f32 v238, v110, v254
  v_fmac_f32 v239, v111, v254
  v_cvt_pk_bf16_f32 v232, v232, v233
  v_cvt_pk_bf16_f32 v233, v234, v235
  v_cvt_pk_bf16_f32 v234, v236, v237
  v_cvt_pk_bf16_f32 v235, v238, v239
  buffer_store_dwordx4 v[232:235], v1, s[20:23], s64 offen offset:3072 sc1
  v_mfma_f32_32x32x16_bf16 a[48:63], v[156:159], v[156:159], 0
  s_getpc_b64 s[52:53]
  s_add_u32 s52, s52, KC_START-.
  s_addc_u32 s53, s53, 0
  v_lshlrev_b32 v240, 6, v0
  global_load_dword v241, v240, s[52:53]
  s_mov_b32 s43, 1
  s_mov_b32 s44, s34
  s_mov_b32 s41, s34
  s_cmp_eq_u32 s34, 0
  s_nop 0
  s_cbranch_scc0 K2_LOOP
  s_waitcnt vmcnt(7)
  s_branch K2_LAST
K2_NM2:
  v_mfma_f32_16x16x32_bf16 v[64:67], a[192:195], a[160:163], v[120:123]
  s_barrier
  v_cmp_le_i32 s[52:53], 0, v6
  v_cmp_le_i32 s[54:55], 1, v6
  v_cmp_le_i32 s[56:57], 2, v6
  v_cndmask_b32 v16, v5, v16, s[52:53]
  v_mfma_f32_16x16x32_bf16 v[72:75], a[192:195], a[176:179], v[124:127]
  v_cmp_le_i32 s[58:59], 3, v6
  v_cndmask_b32 v17, v5, v17, s[54:55]
  v_exp_f32 v148, v16
  v_mfma_f32_16x16x32_bf16 v[68:71], a[196:199], a[160:163], v[120:123]
  ds_read_b128 a[224:227], v3 offset:16384
  ds_read_b128 a[228:231], v3 offset:17408
  v_cmp_le_i32 s[52:53], 16, v6
  v_cndmask_b32 v18, v5, v18, s[56:57]
  v_mfma_f32_16x16x32_bf16 v[76:79], a[196:199], a[176:179], v[124:127]
  v_exp_f32 v149, v17
  v_cmp_le_i32 s[54:55], 17, v6
  v_cndmask_b32 v19, v5, v19, s[58:59]
  v_mfma_f32_16x16x32_bf16 v[64:67], a[200:203], a[164:167], v[64:67]
  ds_read_b128 a[232:235], v3 offset:18432
  ds_read_b128 a[236:239], v3 offset:19456
  v_exp_f32 v150, v18
  v_cvt_pk_bf16_f32 v80, v148, v149
  v_mfma_f32_16x16x32_bf16 v[72:75], a[200:203], a[180:183], v[72:75]
  v_cmp_le_i32 s[56:57], 18, v6
  v_cndmask_b32 v20, v5, v20, s[52:53]
  v_exp_f32 v151, v19
  v_mfma_f32_16x16x32_bf16 v[68:71], a[204:207], a[164:167], v[68:71]
  ds_read_b128 a[240:243], v3 offset:20480
  ds_read_b128 a[244:247], v3 offset:21504
  v_cmp_le_i32 s[58:59], 19, v6
  v_cndmask_b32 v21, v5, v21, s[54:55]
  v_mfma_f32_16x16x32_bf16 v[76:79], a[204:207], a[180:183], v[76:79]
  v_exp_f32 v152, v20
  v_cvt_pk_bf16_f32 v81, v150, v151
  v_cmp_le_i32 s[52:53], -16, v6
  v_cndmask_b32 v22, v5, v22, s[56:57]
  v_mfma_f32_16x16x32_bf16 v[64:67], a[208:211], a[168:171], v[64:67]
  ds_read_b128 a[248:251], v3 offset:22528
  ds_read_b128 a[252:255], v3 offset:23552
  v_exp_f32 v153, v21
  v_cmp_le_i32 s[54:55], -15, v6
  v_mfma_f32_16x16x32_bf16 v[72:75], a[208:211], a[184:187], v[72:75]
  v_cndmask_b32 v23, v5, v23, s[58:59]
  v_exp_f32 v154, v22
  v_cvt_pk_bf16_f32 v82, v152, v153
  v_mfma_f32_16x16x32_bf16 v[68:71], a[212:215], a[168:171], v[68:71]
  v_cmp_le_i32 s[56:57], -14, v6
  v_cndmask_b32 v24, v5, v24, s[52:53]
  v_exp_f32 v155, v23
  v_mfma_f32_16x16x32_bf16 v[76:79], a[212:215], a[184:187], v[76:79]
  v_cmp_le_i32 s[58:59], -13, v6
  v_cndmask_b32 v25, v5, v25, s[54:55]
  v_exp_f32 v148, v24
  v_mfma_f32_16x16x32_bf16 v[64:67], a[216:219], a[172:175], v[64:67]
  v_cvt_pk_bf16_f32 v83, v154, v155
  v_cmp_le_i32 s[52:53], 0, v6
  v_cndmask_b32 v26, v5, v26, s[56:57]
  v_mfma_f32_16x16x32_bf16 v[72:75], a[216:219], a[188:191], v[72:75]
  v_exp_f32 v149, v25
  v_cmp_le_i32 s[54:55], 1, v6
  v_cndmask_b32 v27, v5, v27, s[58:59]
  v_mfma_f32_16x16x32_bf16 v[68:71], a[220:223], a[172:175], v[68:71]
  v_exp_f32 v150, v26
  v_cvt_pk_bf16_f32 v84, v148, v149
  v_mfma_f32_16x16x32_bf16 v[76:79], a[220:223], a[188:191], v[76:79]
  v_mfma_f32_16x16x32_bf16 v[128:131], v[244:247], v[80:83], v[224:227]
  v_cmp_le_i32 s[56:57], 2, v6
  v_cndmask_b32 v28, v5, v28, s[52:53]
  s_waitcnt lgkmcnt(4)
  v_mfma_f32_16x16x32_bf16 a[0:3], a[224:227], v[96:99], a[0:3]
  v_exp_f32 v151, v27
  v_cmp_le_i32 s[58:59], 3, v6
  v_cndmask_b32 v29, v5, v29, s[54:55]
  v_mfma_f32_16x16x32_bf16 a[16:19], a[224:227], v[100:103], a[16:19]
  v_exp_f32 v152, v28
  v_cvt_pk_bf16_f32 v85, v150, v151
  v_cmp_le_i32 s[52:53], 0, v7
  v_mfma_f32_16x16x32_bf16 a[32:35], a[224:227], v[104:107], a[32:35]
  v_cndmask_b32 v30, v5, v30, s[56:57]
  v_exp_f32 v153, v29
  v_cmp_le_i32 s[54:55], 1, v7
  v_mfma_f32_16x16x32_bf16 a[48:51], a[224:227], v[108:111], a[48:51]
  v_cndmask_b32 v31, v5, v31, s[58:59]
  v_exp_f32 v154, v30
  v_cvt_pk_bf16_f32 v86, v152, v153
  v_mfma_f32_16x16x32_bf16 a[4:7], a[228:231], v[96:99], a[4:7]
  v_cmp_le_i32 s[56:57], 2, v7
  v_cndmask_b32 v32, v5, v32, s[52:53]
  v_exp_f32 v155, v31
  v_mfma_f32_16x16x32_bf16 a[20:23], a[228:231], v[100:103], a[20:23]
  v_cmp_le_i32 s[58:59], 3, v7
  v_cndmask_b32 v33, v5, v33, s[54:55]
  v_exp_f32 v148, v32
  v_mfma_f32_16x16x32_bf16 a[36:39], a[228:231], v[104:107], a[36:39]
  v_cvt_pk_bf16_f32 v87, v154, v155
  v_cmp_le_i32 s[52:53], 16, v7
  v_cndmask_b32 v34, v5, v34, s[56:57]
  v_mfma_f32_16x16x32_bf16 a[52:55], a[228:231], v[108:111], a[52:55]
  v_exp_f32 v149, v33
  v_cmp_le_i32 s[54:55], 17, v7
  v_cndmask_b32 v35, v5, v35, s[58:59]
  v_mfma_f32_16x16x32_bf16 a[64:67], a[232:235], v[96:99], a[64:67]
  v_exp_f32 v150, v34
  v_cvt_pk_bf16_f32 v88, v148, v149
  v_mfma_f32_16x16x32_bf16 a[80:83], a[232:235], v[100:103], a[80:83]
  v_mfma_f32_16x16x32_bf16 v[132:135], v[244:247], v[84:87], v[228:231]
  v_cmp_le_i32 s[56:57], 18, v7
  v_cndmask_b32 v36, v5, v36, s[52:53]
  v_mfma_f32_16x16x32_bf16 a[96:99], a[232:235], v[104:107], a[96:99]
  v_exp_f32 v151, v35
  v_cmp_le_i32 s[58:59], 19, v7
  v_cndmask_b32 v37, v5, v37, s[54:55]
  v_mfma_f32_16x16x32_bf16 a[112:115], a[232:235], v[108:111], a[112:115]
  v_exp_f32 v152, v36
  v_cvt_pk_bf16_f32 v89, v150, v151
  v_cmp_le_i32 s[52:53], -16, v7
  v_mfma_f32_16x16x32_bf16 a[68:71], a[236:239], v[96:99], a[68:71]
  v_cndmask_b32 v38, v5, v38, s[56:57]
  v_exp_f32 v153, v37
  v_cmp_le_i32 s[54:55], -15, v7
  v_mfma_f32_16x16x32_bf16 a[84:87], a[236:239], v[100:103], a[84:87]
  v_cndmask_b32 v39, v5, v39, s[58:59]
  v_exp_f32 v154, v38
  v_cvt_pk_bf16_f32 v90, v152, v153
  v_mfma_f32_16x16x32_bf16 a[100:103], a[236:239], v[104:107], a[100:103]
  v_cmp_le_i32 s[56:57], -14, v7
  v_cndmask_b32 v40, v5, v40, s[52:53]
  v_exp_f32 v155, v39
  v_mfma_f32_16x16x32_bf16 a[116:119], a[236:239], v[108:111], a[116:119]
  v_cmp_le_i32 s[58:59], -13, v7
  v_cndmask_b32 v41, v5, v41, s[54:55]
  s_waitcnt lgkmcnt(0)
  v_mfma_f32_16x16x32_bf16 a[8:11], a[240:243], v[96:99], a[8:11]
  v_exp_f32 v148, v40
  v_cvt_pk_bf16_f32 v91, v154, v155
  v_cmp_le_i32 s[52:53], 0, v7
  v_mfma_f32_16x16x32_bf16 a[24:27], a[240:243], v[100:103], a[24:27]
  v_cndmask_b32 v42, v5, v42, s[56:57]
  v_exp_f32 v149, v41
  v_cmp_le_i32 s[54:55], 1, v7
  v_mfma_f32_16x16x32_bf16 a[40:43], a[240:243], v[104:107], a[40:43]
  v_cndmask_b32 v43, v5, v43, s[58:59]
  v_exp_f32 v150, v42
  v_cvt_pk_bf16_f32 v92, v148, v149
  v_mfma_f32_16x16x32_bf16 a[56:59], a[240:243], v[108:111], a[56:59]
  v_mfma_f32_16x16x32_bf16 v[136:139], v[244:247], v[88:91], v[232:235]
  v_cmp_le_i32 s[56:57], 2, v7
  v_cndmask_b32 v44, v5, v44, s[52:53]
  v_mfma_f32_16x16x32_bf16 a[12:15], a[244:247], v[96:99], a[12:15]
  v_exp_f32 v151, v43
  v_cmp_le_i32 s[58:59], 3, v7
  v_cndmask_b32 v45, v5, v45, s[54:55]
  v_mfma_f32_16x16x32_bf16 a[28:31], a[244:247], v[100:103], a[28:31]
  v_exp_f32 v152, v44
  v_cvt_pk_bf16_f32 v93, v150, v151
  v_cndmask_b32 v46, v5, v46, s[56:57]
  v_mfma_f32_16x16x32_bf16 a[44:47], a[244:247], v[104:107], a[44:47]
  v_exp_f32 v153, v45
  v_cndmask_b32 v47, v5, v47, s[58:59]
  v_mfma_f32_16x16x32_bf16 a[60:63], a[244:247], v[108:111], a[60:63]
  v_exp_f32 v154, v46
  v_cvt_pk_bf16_f32 v94, v152, v153
  v_exp_f32 v155, v47
  v_mfma_f32_16x16x32_bf16 a[72:75], a[248:251], v[96:99], a[72:75]
  s_nop 0
  v_cvt_pk_bf16_f32 v95, v154, v155
  v_mfma_f32_16x16x32_bf16 a[88:91], a[248:251], v[100:103], a[88:91]
  s_nop 1
  v_mfma_f32_16x16x32_bf16 v[140:143], v[244:247], v[92:95], v[236:239]
  v_mfma_f32_16x16x32_bf16 a[104:107], a[248:251], v[104:107], a[104:107]
  v_mfma_f32_16x16x32_bf16 a[120:123], a[248:251], v[108:111], a[120:123]
  v_mfma_f32_16x16x32_bf16 a[76:79], a[252:255], v[96:99], a[76:79]
  v_mfma_f32_16x16x32_bf16 a[92:95], a[252:255], v[100:103], a[92:95]
  v_mfma_f32_16x16x32_bf16 a[108:111], a[252:255], v[104:107], a[108:111]
  v_mfma_f32_16x16x32_bf16 a[124:127], a[252:255], v[108:111], a[124:127]
  s_nop 7
  v_max3_f32 v12, v128, v132, v136
  v_max_f32 v12, v12, v140
  v_cmp_nle_f32 vcc, v12, v13
  s_cbranch_vccnz K2_RARE_M
K2_RARE_M_ret:
  s_waitcnt vmcnt(0)
K2_LAST:
  s_barrier
  v_xor_b32 v3, 0x8000, v3
  ds_read_b128 a[224:227], v3 offset:0
  ds_read_b128 a[228:231], v3 offset:1024
  ds_read_b128 a[232:235], v3 offset:2048
  ds_read_b128 a[236:239], v3 offset:3072
  ds_read_b128 a[240:243], v3 offset:4096
  ds_read_b128 a[244:247], v3 offset:5120
  ds_read_b128 a[248:251], v3 offset:6144
  ds_read_b128 a[252:255], v3 offset:7168
  v_mov_b32 v242, 0x5a17
  v_min_u32 v243, 1, v1
  v_lshlrev_b32 v243, 30, v243
  s_add_u32 s48, s3, 229376
  s_lshl_b32 s46, s30, 14
  v_add_u32 v168, s46, v1
  v_xor_b32 v169, 0x8000, v168
  v_add_u32 v170, s35, v1
  v_xor_b32 v171, 0x4000, v170
  s_lshl_b32 s46, s44, 20
  s_lshl_b32 s47, s33, 13
  s_add_u32 s46, s46, s47
  s_lshl_b32 s47, s32, 12
  s_add_u32 s46, s46, s47
  s_add_u32 s46, s46, 50331648
  s_lshl_b32 s47, s31, 18
  s_add_u32 s63, s46, s47
  s_sub_u32 s64, s46, s47
  s_add_u32 s64, s64, 786432
  v_cmp_le_i32 s[52:53], 0, v9
  v_cmp_le_i32 s[54:55], 1, v9
  v_cmp_le_i32 s[56:57], 2, v9
  v_cndmask_b32 v64, v5, v64, s[52:53]
  v_cmp_le_i32 s[58:59], 3, v9
  v_cndmask_b32 v65, v5, v65, s[54:55]
  s_waitcnt lgkmcnt(0)
  v_mfma_f32_16x16x32_bf16 a[64:67], a[232:235], v[80:83], a[64:67]
  v_exp_f32 v148, v64
  v_cmp_le_i32 s[52:53], 16, v9
  v_mfma_f32_16x16x32_bf16 a[80:83], a[232:235], v[84:87], a[80:83]
  v_cndmask_b32 v66, v5, v66, s[56:57]
  v_exp_f32 v149, v65
  v_mfma_f32_16x16x32_bf16 a[68:71], a[236:239], v[80:83], a[68:71]
  v_cmp_le_i32 s[54:55], 17, v9
  v_cndmask_b32 v67, v5, v67, s[58:59]
  v_mfma_f32_16x16x32_bf16 a[84:87], a[236:239], v[84:87], a[84:87]
  v_exp_f32 v150, v66
  v_cvt_pk_bf16_f32 v104, v148, v149
  v_cmp_le_i32 s[56:57], 18, v9
  v_mfma_f32_16x16x32_bf16 a[72:75], a[248:251], v[80:83], a[72:75]
  v_cndmask_b32 v68, v5, v68, s[52:53]
  v_exp_f32 v151, v67
  v_mfma_f32_16x16x32_bf16 a[88:91], a[248:251], v[84:87], a[88:91]
  v_cmp_le_i32 s[58:59], 19, v9
  v_cndmask_b32 v69, v5, v69, s[54:55]
  v_mfma_f32_16x16x32_bf16 a[76:79], a[252:255], v[80:83], a[76:79]
  v_exp_f32 v152, v68
  v_cvt_pk_bf16_f32 v105, v150, v151
  v_mfma_f32_16x16x32_bf16 a[92:95], a[252:255], v[84:87], a[92:95]
  v_cmp_le_i32 s[52:53], -16, v9
  v_cndmask_b32 v70, v5, v70, s[56:57]
  v_mfma_f32_16x16x32_bf16 a[0:3], a[224:227], v[80:83], a[0:3]
  v_exp_f32 v153, v69
  v_cmp_le_i32 s[54:55], -15, v9
  v_mfma_f32_16x16x32_bf16 a[16:19], a[224:227], v[84:87], a[16:19]
  v_cndmask_b32 v71, v5, v71, s[58:59]
  v_exp_f32 v154, v70
  v_mfma_f32_16x16x32_bf16 a[4:7], a[228:231], v[80:83], a[4:7]
  v_cvt_pk_bf16_f32 v106, v152, v153
  v_cmp_le_i32 s[56:57], -14, v9
  v_cndmask_b32 v72, v5, v72, s[52:53]
  v_mfma_f32_16x16x32_bf16 a[20:23], a[228:231], v[84:87], a[20:23]
  v_exp_f32 v155, v71
  v_cmp_le_i32 s[58:59], -13, v9
  v_mfma_f32_16x16x32_bf16 a[8:11], a[240:243], v[80:83], a[8:11]
  ds_write_b128 v168, a[64:67] offset:0
  v_cndmask_b32 v73, v5, v73, s[54:55]
  v_exp_f32 v148, v72
  v_mfma_f32_16x16x32_bf16 a[24:27], a[240:243], v[84:87], a[24:27]
  v_cvt_pk_bf16_f32 v107, v154, v155
  v_cmp_le_i32 s[52:53], 0, v9
  v_cndmask_b32 v74, v5, v74, s[56:57]
  v_mfma_f32_16x16x32_bf16 a[12:15], a[244:247], v[80:83], a[12:15]
  ds_write_b128 v168, a[68:71] offset:1024
  v_exp_f32 v149, v73
  v_cmp_le_i32 s[54:55], 1, v9
  v_mfma_f32_16x16x32_bf16 a[28:31], a[244:247], v[84:87], a[28:31]
  v_cndmask_b32 v75, v5, v75, s[58:59]
  v_exp_f32 v150, v74
  v_mfma_f32_16x16x32_bf16 a[96:99], a[232:235], v[88:91], a[96:99]
  v_mfma_f32_16x16x32_bf16 a[112:115], a[232:235], v[92:95], a[112:115]
  ds_read_b128 a[232:235], v3 offset:18432
  ds_write_b128 v168, a[72:75] offset:2048
  v_cvt_pk_bf16_f32 v108, v148, v149
  v_mfma_f32_16x16x32_bf16 v[232:235], v[244:247], v[104:107], v[136:139]
  v_cmp_le_i32 s[56:57], 2, v9
  v_cndmask_b32 v76, v5, v76, s[52:53]
  v_mfma_f32_16x16x32_bf16 a[100:103], a[236:239], v[88:91], a[100:103]
  v_mfma_f32_16x16x32_bf16 a[116:119], a[236:239], v[92:95], a[116:119]
  ds_read_b128 a[236:239], v3 offset:19456
  ds_write_b128 v168, a[76:79] offset:3072
  v_exp_f32 v151, v75
  v_cmp_le_i32 s[58:59], 3, v9
  v_cndmask_b32 v77, v5, v77, s[54:55]
  v_mfma_f32_16x16x32_bf16 a[104:107], a[248:251], v[88:91], a[104:107]
  v_mfma_f32_16x16x32_bf16 a[120:123], a[248:251], v[92:95], a[120:123]
  ds_read_b128 a[248:251], v3 offset:22528
  v_exp_f32 v152, v76
  v_cvt_pk_bf16_f32 v109, v150, v151
  v_cndmask_b32 v78, v5, v78, s[56:57]
  v_exp_f32 v153, v77
  v_mfma_f32_16x16x32_bf16 a[108:111], a[252:255], v[88:91], a[108:111]
  v_mfma_f32_16x16x32_bf16 a[124:127], a[252:255], v[92:95], a[124:127]
  ds_read_b128 a[252:255], v3 offset:23552
  ds_write_b128 v168, a[80:83] offset:4096
  v_cndmask_b32 v79, v5, v79, s[58:59]
  v_exp_f32 v154, v78
  v_cvt_pk_bf16_f32 v110, v152, v153
  v_mfma_f32_16x16x32_bf16 a[32:35], a[224:227], v[88:91], a[32:35]
  v_mfma_f32_16x16x32_bf16 a[48:51], a[224:227], v[92:95], a[48:51]
  ds_read_b128 a[224:227], v3 offset:16384
  ds_write_b128 v168, a[84:87] offset:5120
  v_exp_f32 v155, v79
  s_nop 0
  v_cvt_pk_bf16_f32 v111, v154, v155
  v_mfma_f32_16x16x32_bf16 a[36:39], a[228:231], v[88:91], a[36:39]
  v_mfma_f32_16x16x32_bf16 a[52:55], a[228:231], v[92:95], a[52:55]
  ds_read_b128 a[228:231], v3 offset:17408
  ds_write_b128 v168, a[88:91] offset:6144
  s_nop 1
  v_mfma_f32_16x16x32_bf16 v[236:239], v[244:247], v[108:111], v[140:143]
  v_mfma_f32_16x16x32_bf16 a[40:43], a[240:243], v[88:91], a[40:43]
  v_mfma_f32_16x16x32_bf16 a[56:59], a[240:243], v[92:95], a[56:59]
  ds_read_b128 a[240:243], v3 offset:20480
  ds_write_b128 v168, a[92:95] offset:7168
  v_mfma_f32_16x16x32_bf16 a[44:47], a[244:247], v[88:91], a[44:47]
  v_mfma_f32_16x16x32_bf16 a[60:63], a[244:247], v[92:95], a[60:63]
  ds_read_b128 a[244:247], v3 offset:21504
  s_nop 7
  v_add_f32 v12, v232, v236
  v_cmp_nle_f32 vcc, v12, v13
  s_cbranch_vccnz K2_RARE_L
K2_RARE_L_ret:
  s_waitcnt lgkmcnt(11)
  v_mfma_f32_16x16x32_bf16 a[96:99], a[232:235], v[104:107], a[96:99]
  v_mov_b32 v249, v128
  v_mov_b32 v251, v132
  v_mov_b32 v253, v232
  v_mov_b32 v255, v236
  v_mfma_f32_16x16x32_bf16 a[112:115], a[232:235], v[108:111], a[112:115]
  v_mov_b32 v248, v112
  v_mov_b32 v250, v116
  v_mov_b32 v252, v120
  v_mov_b32 v254, v124
  v_mfma_f32_16x16x32_bf16 a[100:103], a[236:239], v[104:107], a[100:103]
  v_mfma_f32_16x16x32_bf16 a[116:119], a[236:239], v[108:111], a[116:119]
  s_waitcnt lgkmcnt(0)
  v_mfma_f32_16x16x32_bf16 a[104:107], a[248:251], v[104:107], a[104:107]
  v_mfma_f32_16x16x32_bf16 a[120:123], a[248:251], v[108:111], a[120:123]
  v_mfma_f32_16x16x32_bf16 a[108:111], a[252:255], v[104:107], a[108:111]
  v_mfma_f32_16x16x32_bf16 a[124:127], a[252:255], v[108:111], a[124:127]
  v_mfma_f32_16x16x32_bf16 a[32:35], a[224:227], v[104:107], a[32:35]
  ds_write_b128 v170, v[248:251]
  ds_write_b128 v170, v[252:255] offset:1024
  v_mfma_f32_16x16x32_bf16 a[48:51], a[224:227], v[108:111], a[48:51]
  v_add_u32 v240, 184, v0
  v_lshrrev_b32 v240, 8, v240
  v_mul_u32_u24 v240, 98304, v240
  v_lshl_add_u32 v240, v0, 7, v240
  s_mov_b32 s46, 229376
  v_mfma_f32_16x16x32_bf16 a[36:39], a[228:231], v[104:107], a[36:39]
  v_mfma_f32_16x16x32_bf16 a[52:55], a[228:231], v[108:111], a[52:55]
  v_mfma_f32_16x16x32_bf16 a[40:43], a[240:243], v[104:107], a[40:43]
  v_mfma_f32_16x16x32_bf16 a[56:59], a[240:243], v[108:111], a[56:59]
  s_waitcnt vmcnt(0) lgkmcnt(0)
  v_mfma_f32_16x16x32_bf16 a[44:47], a[244:247], v[104:107], a[44:47]
  s_barrier
  ds_read_b128 v[160:163], v171
  ds_read_b128 v[164:167], v171 offset:1024
  ds_read_b128 v[176:179], v169 offset:0
  ds_read_b128 v[180:183], v169 offset:1024
  ds_read_b128 v[184:187], v169 offset:2048
  ds_read_b128 v[188:191], v169 offset:3072
  ds_read_b128 v[192:195], v169 offset:4096
  v_mfma_f32_16x16x32_bf16 a[60:63], a[244:247], v[108:111], a[60:63]
  ds_read_b128 v[196:199], v169 offset:5120
  ds_read_b128 v[200:203], v169 offset:6144
  ds_read_b128 v[204:207], v169 offset:7168
  buffer_store_dword v242, v243, s[20:23], s48 offen sc1
  buffer_load_dword v241, v240, s[20:23], s46 offen sc1
  ds_write_b128 v168, a[96:99] offset:8192
  v_accvgpr_read_b32 v80, a0
  v_accvgpr_read_b32 v81, a1
  v_accvgpr_read_b32 v82, a2
  v_accvgpr_read_b32 v83, a3
  v_accvgpr_read_b32 v84, a4
  v_accvgpr_read_b32 v85, a5
  v_accvgpr_read_b32 v86, a6
  v_accvgpr_read_b32 v87, a7
  s_waitcnt lgkmcnt(9)
  v_min_f32 v172, v248, v160
  v_min_f32 v173, v250, v162
  ds_write_b128 v168, a[100:103] offset:9216
  v_min_f32 v174, v252, v164
  v_min_f32 v175, v254, v166
  v_sub_f32 v248, v172, v248
  v_sub_f32 v160, v172, v160
  v_sub_f32 v250, v173, v250
  v_sub_f32 v162, v173, v162
  v_sub_f32 v252, v174, v252
  v_sub_f32 v164, v174, v164
  v_sub_f32 v254, v175, v254
  v_sub_f32 v166, v175, v166
  v_exp_f32 v248, v248
  ds_write_b128 v168, a[104:107] offset:10240
  v_exp_f32 v160, v160
  v_exp_f32 v250, v250
  v_exp_f32 v162, v162
  v_exp_f32 v252, v252
  v_exp_f32 v164, v164
  v_exp_f32 v254, v254
  v_exp_f32 v166, v166
  v_mul_f32 v172, v248, v249
  v_mul_f32 v173, v250, v251
  v_mul_f32 v174, v252, v253
  v_mul_f32 v175, v254, v255
  ds_write_b128 v168, a[108:111] offset:11264
  v_fmac_f32 v172, v160, v161
  v_fmac_f32 v173, v162, v163
  v_fmac_f32 v174, v164, v165
  v_fmac_f32 v175, v166, v167
  v_rcp_f32 v172, v172
  v_rcp_f32 v173, v173
  v_rcp_f32 v174, v174
  v_rcp_f32 v175, v175
  v_mul_f32 v248, v248, v172
  v_mul_f32 v160, v160, v172
  v_mul_f32 v250, v250, v173
  ds_write_b128 v168, a[112:115] offset:12288
  v_mul_f32 v162, v162, v173
  v_mul_f32 v252, v252, v174
  v_mul_f32 v164, v164, v174
  v_mul_f32 v254, v254, v175
  v_mul_f32 v166, v166, v175
  s_waitcnt lgkmcnt(11)
  v_mul_f32 v176, v176, v160
  v_mul_f32 v177, v177, v160
  v_mul_f32 v178, v178, v160
  v_mul_f32 v179, v179, v160
  v_mul_f32 v180, v180, v160
  ds_write_b128 v168, a[116:119] offset:13312
  v_mul_f32 v181, v181, v160
  v_mul_f32 v182, v182, v160
  v_mul_f32 v183, v183, v160
  v_fmac_f32 v176, v80, v248
  v_fmac_f32 v177, v81, v248
  v_fmac_f32 v178, v82, v248
  v_fmac_f32 v179, v83, v248
  v_fmac_f32 v180, v84, v248
  v_fmac_f32 v181, v85, v248
  v_fmac_f32 v182, v86, v248
  v_fmac_f32 v183, v87, v248
  ds_write_b128 v168, a[120:123] offset:14336
  v_cvt_pk_bf16_f32 v176, v176, v177
  v_cvt_pk_bf16_f32 v177, v178, v179
  v_cvt_pk_bf16_f32 v178, v180, v181
  v_cvt_pk_bf16_f32 v179, v182, v183
  buffer_store_dwordx4 v[176:179], v1, s[20:23], s63 offen offset:0 sc1
  v_accvgpr_read_b32 v88, a8
  v_accvgpr_read_b32 v89, a9
  v_accvgpr_read_b32 v90, a10
  v_accvgpr_read_b32 v91, a11
  v_accvgpr_read_b32 v92, a12
  v_accvgpr_read_b32 v93, a13
  ds_write_b128 v168, a[124:127] offset:15360
  v_accvgpr_read_b32 v94, a14
  v_accvgpr_read_b32 v95, a15
  s_waitcnt lgkmcnt(12)
  v_mul_f32 v184, v184, v160
  v_mul_f32 v185, v185, v160
  v_mul_f32 v186, v186, v160
  v_mul_f32 v187, v187, v160
  v_mul_f32 v188, v188, v160
  v_mul_f32 v189, v189, v160
  v_mul_f32 v190, v190, v160
  v_mul_f32 v191, v191, v160
  v_fmac_f32 v184, v88, v248
  v_fmac_f32 v185, v89, v248
  v_fmac_f32 v186, v90, v248
  v_fmac_f32 v187, v91, v248
  v_fmac_f32 v188, v92, v248
  v_fmac_f32 v189, v93, v248
  v_fmac_f32 v190, v94, v248
  v_fmac_f32 v191, v95, v248
  v_cvt_pk_bf16_f32 v184, v184, v185
  v_cvt_pk_bf16_f32 v185, v186, v187
  v_cvt_pk_bf16_f32 v186, v188, v189
  v_cvt_pk_bf16_f32 v187, v190, v191
  buffer_store_dwordx4 v[184:187], v1, s[20:23], s63 offen offset:2048 sc1
  v_accvgpr_read_b32 v80, a16
  v_accvgpr_read_b32 v81, a17
  v_accvgpr_read_b32 v82, a18
  v_accvgpr_read_b32 v83, a19
  v_accvgpr_read_b32 v84, a20
  v_accvgpr_read_b32 v85, a21
  v_accvgpr_read_b32 v86, a22
  v_accvgpr_read_b32 v87, a23
  s_waitcnt lgkmcnt(10)
  v_mul_f32 v192, v192, v162
  v_mul_f32 v193, v193, v162
  v_mul_f32 v194, v194, v162
  v_mul_f32 v195, v195, v162
  v_mul_f32 v196, v196, v162
  v_mul_f32 v197, v197, v162
  v_mul_f32 v198, v198, v162
  v_mul_f32 v199, v199, v162
  v_fmac_f32 v192, v80, v250
  v_fmac_f32 v193, v81, v250
  v_fmac_f32 v194, v82, v250
  v_fmac_f32 v195, v83, v250
  v_fmac_f32 v196, v84, v250
  v_fmac_f32 v197, v85, v250
  v_fmac_f32 v198, v86, v250
  v_fmac_f32 v199, v87, v250
  v_cvt_pk_bf16_f32 v192, v192, v193
  v_cvt_pk_bf16_f32 v193, v194, v195
  v_cvt_pk_bf16_f32 v194, v196, v197
  v_cvt_pk_bf16_f32 v195, v198, v199
  buffer_store_dwordx4 v[192:195], v1, s[20:23], s63 offen offset:1024 sc1
  s_waitcnt lgkmcnt(0)
  s_barrier
  ds_read_b128 v[208:211], v169 offset:8192
  ds_read_b128 v[212:215], v169 offset:9216
  ds_read_b128 v[216:219], v169 offset:10240
  ds_read_b128 v[220:223], v169 offset:11264
  ds_read_b128 v[224:227], v169 offset:12288
  ds_read_b128 v[228:231], v169 offset:13312
  ds_read_b128 v[232:235], v169 offset:14336
  ds_read_b128 v[236:239], v169 offset:15360
  v_accvgpr_read_b32 v88, a24
  v_accvgpr_read_b32 v89, a25
  v_accvgpr_read_b32 v90, a26
  v_accvgpr_read_b32 v91, a27
  v_accvgpr_read_b32 v92, a28
  v_accvgpr_read_b32 v93, a29
  v_accvgpr_read_b32 v94, a30
  v_accvgpr_read_b32 v95, a31
  s_nop 0
  v_mul_f32 v200, v200, v162
  v_mul_f32 v201, v201, v162
  v_mul_f32 v202, v202, v162
  v_mul_f32 v203, v203, v162
  v_mul_f32 v204, v204, v162
  v_mul_f32 v205, v205, v162
  v_mul_f32 v206, v206, v162
  v_mul_f32 v207, v207, v162
  v_fmac_f32 v200, v88, v250
  v_fmac_f32 v201, v89, v250
  v_fmac_f32 v202, v90, v250
  v_fmac_f32 v203, v91, v250
  v_fmac_f32 v204, v92, v250
  v_fmac_f32 v205, v93, v250
  v_fmac_f32 v206, v94, v250
  v_fmac_f32 v207, v95, v250
  v_cvt_pk_bf16_f32 v200, v200, v201
  v_cvt_pk_bf16_f32 v201, v202, v203
  v_cvt_pk_bf16_f32 v202, v204, v205
  v_cvt_pk_bf16_f32 v203, v206, v207
  buffer_store_dwordx4 v[200:203], v1, s[20:23], s63 offen offset:3072 sc1
  v_accvgpr_read_b32 v80, a32
  v_accvgpr_read_b32 v81, a33
  v_accvgpr_read_b32 v82, a34
  v_accvgpr_read_b32 v83, a35
  v_accvgpr_read_b32 v84, a36
  v_accvgpr_read_b32 v85, a37
  v_accvgpr_read_b32 v86, a38
  v_accvgpr_read_b32 v87, a39
  s_waitcnt lgkmcnt(6)
  v_mul_f32 v208, v208, v164
  v_mul_f32 v209, v209, v164
  v_mul_f32 v210, v210, v164
  v_mul_f32 v211, v211, v164
  v_mul_f32 v212, v212, v164
  v_mul_f32 v213, v213, v164
  v_mul_f32 v214, v214, v164
  v_mul_f32 v215, v215, v164
  v_fmac_f32 v208, v80, v252
  v_fmac_f32 v209, v81, v252
  v_fmac_f32 v210, v82, v252
  v_fmac_f32 v211, v83, v252
  v_fmac_f32 v212, v84, v252
  v_fmac_f32 v213, v85, v252
  v_fmac_f32 v214, v86, v252
  v_fmac_f32 v215, v87, v252
  v_cvt_pk_bf16_f32 v208, v208, v209
  v_cvt_pk_bf16_f32 v209, v210, v211
  v_cvt_pk_bf16_f32 v210, v212, v213
  v_cvt_pk_bf16_f32 v211, v214, v215
  buffer_store_dwordx4 v[208:211], v1, s[20:23], s64 offen offset:0 sc1
  v_accvgpr_read_b32 v88, a40
  v_accvgpr_read_b32 v89, a41
  v_accvgpr_read_b32 v90, a42
  v_accvgpr_read_b32 v91, a43
  v_accvgpr_read_b32 v92, a44
  v_accvgpr_read_b32 v93, a45
  v_accvgpr_read_b32 v94, a46
  v_accvgpr_read_b32 v95, a47
  s_waitcnt lgkmcnt(4)
  v_mul_f32 v216, v216, v164
  v_mul_f32 v217, v217, v164
  v_mul_f32 v218, v218, v164
  v_mul_f32 v219, v219, v164
  v_mul_f32 v220, v220, v164
  v_mul_f32 v221, v221, v164
  v_mul_f32 v222, v222, v164
  v_mul_f32 v223, v223, v164
  v_fmac_f32 v216, v88, v252
  v_fmac_f32 v217, v89, v252
  v_fmac_f32 v218, v90, v252
  v_fmac_f32 v219, v91, v252
  v_fmac_f32 v220, v92, v252
  v_fmac_f32 v221, v93, v252
  v_fmac_f32 v222, v94, v252
  v_fmac_f32 v223, v95, v252
  v_cvt_pk_bf16_f32 v216, v216, v217
  v_cvt_pk_bf16_f32 v217, v218, v219
  v_cvt_pk_bf16_f32 v218, v220, v221
  v_cvt_pk_bf16_f32 v219, v222, v223
  buffer_store_dwordx4 v[216:219], v1, s[20:23], s64 offen offset:2048 sc1
  v_accvgpr_read_b32 v80, a48
  v_accvgpr_read_b32 v81, a49
  v_accvgpr_read_b32 v82, a50
  v_accvgpr_read_b32 v83, a51
  v_accvgpr_read_b32 v84, a52
  v_accvgpr_read_b32 v85, a53
  v_accvgpr_read_b32 v86, a54
  v_accvgpr_read_b32 v87, a55
  s_waitcnt lgkmcnt(2)
  v_mul_f32 v224, v224, v166
  v_mul_f32 v225, v225, v166
  v_mul_f32 v226, v226, v166
  v_mul_f32 v227, v227, v166
  v_mul_f32 v228, v228, v166
  v_mul_f32 v229, v229, v166
  v_mul_f32 v230, v230, v166
  v_mul_f32 v231, v231, v166
  v_fmac_f32 v224, v80, v254
  v_fmac_f32 v225, v81, v254
  v_fmac_f32 v226, v82, v254
  v_fmac_f32 v227, v83, v254
  v_fmac_f32 v228, v84, v254
  v_fmac_f32 v229, v85, v254
  v_fmac_f32 v230, v86, v254
  v_fmac_f32 v231, v87, v254
  v_cvt_pk_bf16_f32 v224, v224, v225
  v_cvt_pk_bf16_f32 v225, v226, v227
  v_cvt_pk_bf16_f32 v226, v228, v229
  v_cvt_pk_bf16_f32 v227, v230, v231
  buffer_store_dwordx4 v[224:227], v1, s[20:23], s64 offen offset:1024 sc1
  v_accvgpr_read_b32 v88, a56
  v_accvgpr_read_b32 v89, a57
  v_accvgpr_read_b32 v90, a58
  v_accvgpr_read_b32 v91, a59
  v_accvgpr_read_b32 v92, a60
  v_accvgpr_read_b32 v93, a61
  v_accvgpr_read_b32 v94, a62
  v_accvgpr_read_b32 v95, a63
  s_waitcnt lgkmcnt(0)
  v_mul_f32 v232, v232, v166
  v_mul_f32 v233, v233, v166
  v_mul_f32 v234, v234, v166
  v_mul_f32 v235, v235, v166
  v_mul_f32 v236, v236, v166
  v_mul_f32 v237, v237, v166
  v_mul_f32 v238, v238, v166
  v_mul_f32 v239, v239, v166
  v_fmac_f32 v232, v88, v254
  v_fmac_f32 v233, v89, v254
  v_fmac_f32 v234, v90, v254
  v_fmac_f32 v235, v91, v254
  v_fmac_f32 v236, v92, v254
  v_fmac_f32 v237, v93, v254
  v_fmac_f32 v238, v94, v254
  v_fmac_f32 v239, v95, v254
  v_cvt_pk_bf16_f32 v232, v232, v233
  v_cvt_pk_bf16_f32 v233, v234, v235
  v_cvt_pk_bf16_f32 v234, v236, v237
  v_cvt_pk_bf16_f32 v235, v238, v239
  buffer_store_dwordx4 v[232:235], v1, s[20:23], s64 offen offset:3072 sc1
KC_START:
  s_load_dwordx2 s[16:17], s[0:1], 0
  s_load_dwordx2 s[12:13], s[0:1], 96
  s_load_dwordx2 s[24:25], s[0:1], 64
  v_and_b32 v2, 63, v0
  s_lshr_b32 s38, s2, 3
  s_and_b32 s32, s38, 7
  s_lshr_b32 s38, s38, 3
  s_and_b32 s31, s2, 7
  s_lshl_b32 s31, s31, 2
  s_add_u32 s31, s31, s38
  s_bfe_u32 s47, s2, 0x20001
  s_lshr_b32 s51, s2, 5
  s_and_b32 s38, s2, 1
  s_lshl_b32 s51, s51, 1
  s_add_u32 s51, s51, s38
  s_bfe_u32 s60, s2, 0x20003
  s_lshl_b32 s60, s60, 1
  s_lshl_b32 s35, s51, 2
  s_add_u32 s35, s35, s30
  s_lshl_b32 s35, s35, 18
  s_lshl_b32 s38, s47, 16
  s_add_u32 s35, s35, s38
  s_add_u32 s35, s35, 50331648
  s_lshr_b32 s38, s30, 1
  s_add_u32 s36, s60, s38
  s_lshl_b32 s36, s36, 19
  s_lshl_b32 s38, s47, 17
  s_add_u32 s36, s36, s38
  s_and_b32 s38, s30, 1
  s_lshl_b32 s38, s38, 12
  s_add_u32 s36, s36, s38
  s_add_u32 s36, s36, 67108864
  s_lshl_b32 s40, s30, 12
  s_lshl_b32 s42, s32, 2
  s_add_u32 s42, s42, s30
  s_lshl_b32 s42, s42, 16
  s_add_u32 s42, s42, 71303168
  s_cmp_eq_u32 s32, 7
  s_cselect_b32 s42, 0x80000000, s42
  s_sub_u32 s38, 15, s51
  s_cmp_lt_u32 s51, 8
  s_cselect_b32 s38, s51, s38
  s_cselect_b32 s48, 0, 32768
  s_lshl_b32 s38, s38, 12
  s_lshl_b32 s39, s47, 8
  s_add_u32 s38, s38, s39
  s_add_u32 s48, s48, s38
  s_add_u32 s48, s48, 262144
  v_and_b32 v5, 3, v2
  v_bfe_u32 v6, v2, 2, 1
  v_lshlrev_b32 v5, 10, v5
  v_lshl_add_u32 v5, v6, 7, v5
  s_add_u32 s37, s3, 196608
  s_waitcnt vmcnt(8)
  v_cmp_ne_u32 vcc, v242, v241
  s_cbranch_vccnz KC_JSPIN
KC_JSPIN_RET:
  s_waitcnt vmcnt(0)
  s_barrier
  buffer_store_dword v242, v243, s[20:23], s37 offen sc1
  s_add_u32 m0, s40, 16384
  s_nop 0
  buffer_load_dwordx4 v1, s[20:23], s36 offen offset:0 lds
  buffer_load_dwordx4 v1, s[20:23], s36 offen offset:1024 lds
  buffer_load_dwordx4 v1, s[20:23], s36 offen offset:2048 lds
  buffer_load_dwordx4 v1, s[20:23], s36 offen offset:3072 lds
  s_add_u32 s36, s36, 8192
  s_add_u32 m0, s40, 49152
  s_nop 0
  buffer_load_dwordx4 v1, s[20:23], s36 offen offset:0 lds
  buffer_load_dwordx4 v1, s[20:23], s36 offen offset:1024 lds
  buffer_load_dwordx4 v1, s[20:23], s36 offen offset:2048 lds
  buffer_load_dwordx4 v1, s[20:23], s36 offen offset:3072 lds
  s_add_u32 s36, s36, 8192
  s_add_u32 m0, s40, 81920
  s_nop 0
  buffer_load_dwordx4 v1, s[20:23], s36 offen offset:0 lds
  buffer_load_dwordx4 v1, s[20:23], s36 offen offset:1024 lds
  buffer_load_dwordx4 v1, s[20:23], s36 offen offset:2048 lds
  buffer_load_dwordx4 v1, s[20:23], s36 offen offset:3072 lds
  s_add_u32 s36, s36, 8192
  s_add_u32 m0, s40, 114688
  s_nop 0
  buffer_load_dwordx4 v1, s[20:23], s36 offen offset:0 lds
  buffer_load_dwordx4 v1, s[20:23], s36 offen offset:1024 lds
  buffer_load_dwordx4 v1, s[20:23], s36 offen offset:2048 lds
  buffer_load_dwordx4 v1, s[20:23], s36 offen offset:3072 lds
  s_add_u32 s36, s36, 8192
  s_waitcnt lgkmcnt(0)
  buffer_load_dwordx4 a[0:3], v1, s[20:23], s42 offen offset:0
  buffer_load_dwordx4 a[4:7], v1, s[20:23], s42 offen offset:1024
  s_add_u32 s42, s42, 4096
  buffer_load_dwordx4 a[16:19], v1, s[20:23], s42 offen offset:0
  buffer_load_dwordx4 a[20:23], v1, s[20:23], s42 offen offset:1024
  s_add_u32 s42, s42, 4096
  buffer_load_dwordx4 a[32:35], v1, s[20:23], s42 offen offset:0
  buffer_load_dwordx4 a[36:39], v1, s[20:23], s42 offen offset:1024
  s_add_u32 s42, s42, 4096
  buffer_load_dwordx4 a[48:51], v1, s[20:23], s42 offen offset:0
  buffer_load_dwordx4 a[52:55], v1, s[20:23], s42 offen offset:1024
  s_add_u32 s42, s42, 4096
  buffer_load_dwordx4 a[64:67], v1, s[20:23], s42 offen offset:0
  buffer_load_dwordx4 a[68:71], v1, s[20:23], s42 offen offset:1024
  s_add_u32 s42, s42, 4096
  buffer_load_dwordx4 a[80:83], v1, s[20:23], s42 offen offset:0
  buffer_load_dwordx4 a[84:87], v1, s[20:23], s42 offen offset:1024
  s_add_u32 s42, s42, 4096
  buffer_load_dwordx4 a[96:99], v1, s[20:23], s42 offen offset:0
  buffer_load_dwordx4 a[100:103], v1, s[20:23], s42 offen offset:1024
  s_add_u32 s42, s42, 4096
  buffer_load_dwordx4 a[112:115], v1, s[20:23], s42 offen offset:0
  buffer_load_dwordx4 a[116:119], v1, s[20:23], s42 offen offset:1024
  s_add_u32 s42, s42, 4096
  buffer_load_dwordx4 a[128:131], v1, s[20:23], s42 offen offset:0
  buffer_load_dwordx4 a[132:135], v1, s[20:23], s42 offen offset:1024
  s_add_u32 s42, s42, 4096
  buffer_load_dwordx4 a[144:147], v1, s[20:23], s42 offen offset:0
  buffer_load_dwordx4 a[148:151], v1, s[20:23], s42 offen offset:1024
  s_add_u32 s42, s42, 4096
  buffer_load_dwordx4 a[160:163], v1, s[20:23], s42 offen offset:0
  buffer_load_dwordx4 a[164:167], v1, s[20:23], s42 offen offset:1024
  buffer_load_dword v241, v5, s[20:23], s48 offen sc1
  s_add_u32 s42, s42, 4096
  buffer_load_dwordx4 a[176:179], v1, s[20:23], s42 offen offset:0
  buffer_load_dwordx4 a[180:183], v1, s[20:23], s42 offen offset:1024
  s_getreg_b32 s50, hwreg(HW_REG_XCC_ID, 0, 4)
  s_add_u32 s50, s50, 23063
  s_lshl_b32 s41, s31, 10
  s_add_u32 s41, s41, 65536
  s_lshl_b32 s44, s32, 7
  s_add_u32 s44, s44, s41
  s_lshl_b32 s61, s51, 11
  s_lshl_b32 s37, s47, 9
  s_add_u32 s61, s61, s37
  s_lshl_b32 s37, s60, 6
  s_add_u32 s61, s61, s37
  s_add_u32 s61, s61, 65536
  s_cmp_eq_u32 s30, 0
  s_cselect_b32 s44, s44, 0x80000000
  s_cselect_b32 s61, s61, 0x80000000
  v_mov_b32 v10, s50
  v_mov_b32 v3, v243
  v_and_b32 v14, 15, v2
  v_lshlrev_b32 v14, 7, v14
  s_add_u32 s37, s44, 98304
  buffer_store_dword v10, v3, s[20:23], s37 offen sc1
  s_waitcnt vmcnt(3)
  v_cmp_ne_u32 vcc, v242, v241
  s_cbranch_vccnz KC_CSPIN
KC_CSPIN_RET:
  s_add_u32 m0, s40, 0
  s_nop 0
  buffer_load_dwordx4 v1, s[20:23], s35 offen offset:0  lds
  buffer_load_dwordx4 v1, s[20:23], s35 offen offset:1024  lds
  buffer_load_dwordx4 v1, s[20:23], s35 offen offset:2048  lds
  buffer_load_dwordx4 v1, s[20:23], s35 offen offset:3072  lds
  s_add_u32 s35, s35, 4096
  s_add_u32 m0, s40, 32768
  s_nop 0
  buffer_load_dwordx4 v1, s[20:23], s35 offen offset:0  lds
  buffer_load_dwordx4 v1, s[20:23], s35 offen offset:1024  lds
  buffer_load_dwordx4 v1, s[20:23], s35 offen offset:2048  lds
  buffer_load_dwordx4 v1, s[20:23], s35 offen offset:3072  lds
  s_add_u32 s35, s35, 4096
  s_lshr_b32 s37, s30, 1
  s_lshl_b32 s37, s37, 13
  v_add_u32 v4, s37, v1
  v_add_u32 v5, 0x10000, v4
  s_and_b32 s37, s30, 1
  s_lshl_b32 s37, s37, 13
  s_add_u32 s37, s37, 16384
  v_add_u32 v6, s37, v1
  v_add_u32 v7, 0x10000, v6
  s_waitcnt vmcnt(4)
  s_barrier
  ds_read_b128 v[80:83], v4 offset:0
  ds_read_b128 v[84:87], v4 offset:1024
  ds_read_b128 v[88:91], v4 offset:4096
  ds_read_b128 v[92:95], v4 offset:5120
  ds_read_b128 v[96:99], v6 offset:0
  ds_read_b128 v[100:103], v6 offset:1024
  ds_read_b128 v[104:107], v6 offset:2048
  ds_read_b128 v[108:111], v6 offset:3072
  s_waitcnt lgkmcnt(0)
  v_mfma_f32_16x16x32_bf16 v[16:19], v[96:99], v[80:83], 0
  ds_read_b128 v[112:115], v4 offset:2048
  v_mfma_f32_16x16x32_bf16 v[32:35], v[96:99], v[84:87], 0
  ds_read_b128 v[116:119], v4 offset:3072
  v_mfma_f32_16x16x32_bf16 v[48:51], v[96:99], v[88:91], 0
  ds_read_b128 v[120:123], v4 offset:6144
  v_mfma_f32_16x16x32_bf16 v[64:67], v[96:99], v[92:95], 0
  ds_read_b128 v[124:127], v4 offset:7168
  v_mfma_f32_16x16x32_bf16 v[20:23], v[100:103], v[80:83], 0
  ds_read_b128 v[128:131], v6 offset:4096
  v_mfma_f32_16x16x32_bf16 v[36:39], v[100:103], v[84:87], 0
  ds_read_b128 v[132:135], v6 offset:5120
  v_mfma_f32_16x16x32_bf16 v[52:55], v[100:103], v[88:91], 0
  ds_read_b128 v[136:139], v6 offset:6144
  v_mfma_f32_16x16x32_bf16 v[68:71], v[100:103], v[92:95], 0
  ds_read_b128 v[140:143], v6 offset:7168
  s_add_u32 m0, s40, 65536
  v_mfma_f32_16x16x32_bf16 v[24:27], v[104:107], v[80:83], 0
  buffer_load_dwordx4 v1, s[20:23], s35 offen offset:0  lds
  v_mfma_f32_16x16x32_bf16 v[40:43], v[104:107], v[84:87], 0
  v_mfma_f32_16x16x32_bf16 v[56:59], v[104:107], v[88:91], 0
  buffer_load_dwordx4 v1, s[20:23], s35 offen offset:1024  lds
  v_mfma_f32_16x16x32_bf16 v[72:75], v[104:107], v[92:95], 0
  v_mfma_f32_16x16x32_bf16 v[28:31], v[108:111], v[80:83], 0
  buffer_load_dwordx4 v1, s[20:23], s35 offen offset:2048  lds
  v_mfma_f32_16x16x32_bf16 v[44:47], v[108:111], v[84:87], 0
  v_mfma_f32_16x16x32_bf16 v[60:63], v[108:111], v[88:91], 0
  buffer_load_dwordx4 v1, s[20:23], s35 offen offset:3072  lds
  s_add_u32 s35, s35, 4096
  v_mfma_f32_16x16x32_bf16 v[76:79], v[108:111], v[92:95], 0
  s_waitcnt vmcnt(4) lgkmcnt(0)
  v_mfma_f32_16x16x32_bf16 v[16:19], v[128:131], v[112:115], v[16:19]
  s_barrier
  v_mfma_f32_16x16x32_bf16 v[32:35], v[128:131], v[116:119], v[32:35]
  ds_read_b128 v[80:83], v4 offset:32768
  v_mfma_f32_16x16x32_bf16 v[48:51], v[128:131], v[120:123], v[48:51]
  ds_read_b128 v[84:87], v4 offset:33792
  v_mfma_f32_16x16x32_bf16 v[64:67], v[128:131], v[124:127], v[64:67]
  ds_read_b128 v[88:91], v4 offset:36864
  v_mfma_f32_16x16x32_bf16 v[20:23], v[132:135], v[112:115], v[20:23]
  ds_read_b128 v[92:95], v4 offset:37888
  v_mfma_f32_16x16x32_bf16 v[36:39], v[132:135], v[116:119], v[36:39]
  ds_read_b128 v[96:99], v6 offset:32768
  v_mfma_f32_16x16x32_bf16 v[52:55], v[132:135], v[120:123], v[52:55]
  ds_read_b128 v[100:103], v6 offset:33792
  v_mfma_f32_16x16x32_bf16 v[68:71], v[132:135], v[124:127], v[68:71]
  ds_read_b128 v[104:107], v6 offset:34816
  v_mfma_f32_16x16x32_bf16 v[24:27], v[136:139], v[112:115], v[24:27]
  ds_read_b128 v[108:111], v6 offset:35840
  s_add_u32 m0, s40, 98304
  v_mfma_f32_16x16x32_bf16 v[40:43], v[136:139], v[116:119], v[40:43]
  buffer_load_dwordx4 v1, s[20:23], s35 offen offset:0  lds
  v_mfma_f32_16x16x32_bf16 v[56:59], v[136:139], v[120:123], v[56:59]
  v_mfma_f32_16x16x32_bf16 v[72:75], v[136:139], v[124:127], v[72:75]
  buffer_load_dwordx4 v1, s[20:23], s35 offen offset:1024  lds
  v_mfma_f32_16x16x32_bf16 v[28:31], v[140:143], v[112:115], v[28:31]
  buffer_load_dwordx4 v1, s[20:23], s35 offen offset:2048  lds
  v_mfma_f32_16x16x32_bf16 v[44:47], v[140:143], v[116:119], v[44:47]
  v_mfma_f32_16x16x32_bf16 v[60:63], v[140:143], v[120:123], v[60:63]
  buffer_load_dwordx4 v1, s[20:23], s35 offen offset:3072  lds
  s_add_u32 s35, s35, 4096
  v_mfma_f32_16x16x32_bf16 v[76:79], v[140:143], v[124:127], v[76:79]
  s_waitcnt lgkmcnt(0)
  v_mfma_f32_16x16x32_bf16 v[16:19], v[96:99], v[80:83], v[16:19]
  ds_read_b128 v[112:115], v4 offset:34816
  v_mfma_f32_16x16x32_bf16 v[32:35], v[96:99], v[84:87], v[32:35]
  ds_read_b128 v[116:119], v4 offset:35840
  v_mfma_f32_16x16x32_bf16 v[48:51], v[96:99], v[88:91], v[48:51]
  ds_read_b128 v[120:123], v4 offset:38912
  v_mfma_f32_16x16x32_bf16 v[64:67], v[96:99], v[92:95], v[64:67]
  ds_read_b128 v[124:127], v4 offset:39936
  v_mfma_f32_16x16x32_bf16 v[20:23], v[100:103], v[80:83], v[20:23]
  ds_read_b128 v[128:131], v6 offset:36864
  v_mfma_f32_16x16x32_bf16 v[36:39], v[100:103], v[84:87], v[36:39]
  ds_read_b128 v[132:135], v6 offset:37888
  v_mfma_f32_16x16x32_bf16 v[52:55], v[100:103], v[88:91], v[52:55]
  ds_read_b128 v[136:139], v6 offset:38912
  v_mfma_f32_16x16x32_bf16 v[68:71], v[100:103], v[92:95], v[68:71]
  ds_read_b128 v[140:143], v6 offset:39936
  v_mfma_f32_16x16x32_bf16 v[24:27], v[104:107], v[80:83], v[24:27]
  v_mfma_f32_16x16x32_bf16 v[40:43], v[104:107], v[84:87], v[40:43]
  v_mfma_f32_16x16x32_bf16 v[56:59], v[104:107], v[88:91], v[56:59]
  v_mfma_f32_16x16x32_bf16 v[72:75], v[104:107], v[92:95], v[72:75]
  v_mfma_f32_16x16x32_bf16 v[28:31], v[108:111], v[80:83], v[28:31]
  v_mfma_f32_16x16x32_bf16 v[44:47], v[108:111], v[84:87], v[44:47]
  v_mfma_f32_16x16x32_bf16 v[60:63], v[108:111], v[88:91], v[60:63]
  v_mfma_f32_16x16x32_bf16 v[76:79], v[108:111], v[92:95], v[76:79]
  s_waitcnt vmcnt(4) lgkmcnt(0)
  v_mfma_f32_16x16x32_bf16 v[16:19], v[128:131], v[112:115], v[16:19]
  s_barrier
  v_mfma_f32_16x16x32_bf16 v[32:35], v[128:131], v[116:119], v[32:35]
  ds_read_b128 v[80:83], v5 offset:0
  v_mfma_f32_16x16x32_bf16 v[48:51], v[128:131], v[120:123], v[48:51]
  ds_read_b128 v[84:87], v5 offset:1024
  v_mfma_f32_16x16x32_bf16 v[64:67], v[128:131], v[124:127], v[64:67]
  ds_read_b128 v[88:91], v5 offset:4096
  v_mfma_f32_16x16x32_bf16 v[20:23], v[132:135], v[112:115], v[20:23]
  ds_read_b128 v[92:95], v5 offset:5120
  v_mfma_f32_16x16x32_bf16 v[36:39], v[132:135], v[116:119], v[36:39]
  ds_read_b128 v[96:99], v7 offset:0
  v_mfma_f32_16x16x32_bf16 v[52:55], v[132:135], v[120:123], v[52:55]
  ds_read_b128 v[100:103], v7 offset:1024
  v_mfma_f32_16x16x32_bf16 v[68:71], v[132:135], v[124:127], v[68:71]
  ds_read_b128 v[104:107], v7 offset:2048
  v_mfma_f32_16x16x32_bf16 v[24:27], v[136:139], v[112:115], v[24:27]
  ds_read_b128 v[108:111], v7 offset:3072
  s_add_u32 m0, s40, 0
  v_mfma_f32_16x16x32_bf16 v[40:43], v[136:139], v[116:119], v[40:43]
  buffer_load_dwordx4 v1, s[20:23], s35 offen offset:0  lds
  v_mfma_f32_16x16x32_bf16 v[56:59], v[136:139], v[120:123], v[56:59]
  v_mfma_f32_16x16x32_bf16 v[72:75], v[136:139], v[124:127], v[72:75]
  buffer_load_dwordx4 v1, s[20:23], s35 offen offset:1024  lds
  v_mfma_f32_16x16x32_bf16 v[28:31], v[140:143], v[112:115], v[28:31]
  buffer_load_dwordx4 v1, s[20:23], s35 offen offset:2048  lds
  v_lshlrev_b32 v184, 7, v0
  v_mfma_f32_16x16x32_bf16 v[44:47], v[140:143], v[116:119], v[44:47]
  v_mov_b32 v186, 23063
  s_mov_b32 s62, 294912
  v_mfma_f32_16x16x32_bf16 v[60:63], v[140:143], v[120:123], v[60:63]
  buffer_load_dwordx4 v1, s[20:23], s35 offen offset:3072  lds
  s_add_u32 s35, s35, 4096
  v_mfma_f32_16x16x32_bf16 v[76:79], v[140:143], v[124:127], v[76:79]
  s_waitcnt lgkmcnt(0)
  v_mfma_f32_16x16x32_bf16 v[16:19], v[96:99], v[80:83], v[16:19]
  ds_read_b128 v[112:115], v5 offset:2048
  v_mfma_f32_16x16x32_bf16 v[32:35], v[96:99], v[84:87], v[32:35]
  ds_read_b128 v[116:119], v5 offset:3072
  v_mfma_f32_16x16x32_bf16 v[48:51], v[96:99], v[88:91], v[48:51]
  ds_read_b128 v[120:123], v5 offset:6144
  v_mfma_f32_16x16x32_bf16 v[64:67], v[96:99], v[92:95], v[64:67]
  ds_read_b128 v[124:127], v5 offset:7168
  v_mfma_f32_16x16x32_bf16 v[20:23], v[100:103], v[80:83], v[20:23]
  ds_read_b128 v[128:131], v7 offset:4096
  v_mfma_f32_16x16x32_bf16 v[36:39], v[100:103], v[84:87], v[36:39]
  ds_read_b128 v[132:135], v7 offset:5120
  v_mfma_f32_16x16x32_bf16 v[52:55], v[100:103], v[88:91], v[52:55]
  ds_read_b128 v[136:139], v7 offset:6144
  v_mfma_f32_16x16x32_bf16 v[68:71], v[100:103], v[92:95], v[68:71]
  ds_read_b128 v[140:143], v7 offset:7168
  s_add_u32 m0, s40, 16384
  v_mfma_f32_16x16x32_bf16 v[24:27], v[104:107], v[80:83], v[24:27]
  buffer_load_dwordx4 v1, s[20:23], s36 offen offset:0 lds
  v_mfma_f32_16x16x32_bf16 v[40:43], v[104:107], v[84:87], v[40:43]
  v_mfma_f32_16x16x32_bf16 v[56:59], v[104:107], v[88:91], v[56:59]
  buffer_load_dwordx4 v1, s[20:23], s36 offen offset:1024 lds
  v_mfma_f32_16x16x32_bf16 v[72:75], v[104:107], v[92:95], v[72:75]
  v_mfma_f32_16x16x32_bf16 v[28:31], v[108:111], v[80:83], v[28:31]
  buffer_load_dwordx4 v1, s[20:23], s36 offen offset:2048 lds
  v_mfma_f32_16x16x32_bf16 v[44:47], v[108:111], v[84:87], v[44:47]
  v_mfma_f32_16x16x32_bf16 v[60:63], v[108:111], v[88:91], v[60:63]
  buffer_load_dwordx4 v1, s[20:23], s36 offen offset:3072 lds
  s_add_u32 s36, s36, 8192
  v_mfma_f32_16x16x32_bf16 v[76:79], v[108:111], v[92:95], v[76:79]
  s_waitcnt vmcnt(8) lgkmcnt(0)
  v_mfma_f32_16x16x32_bf16 v[16:19], v[128:131], v[112:115], v[16:19]
  s_barrier
  v_mfma_f32_16x16x32_bf16 v[32:35], v[128:131], v[116:119], v[32:35]
  ds_read_b128 v[80:83], v5 offset:32768
  v_mfma_f32_16x16x32_bf16 v[48:51], v[128:131], v[120:123], v[48:51]
  ds_read_b128 v[84:87], v5 offset:33792
  v_mfma_f32_16x16x32_bf16 v[64:67], v[128:131], v[124:127], v[64:67]
  ds_read_b128 v[88:91], v5 offset:36864
  v_mfma_f32_16x16x32_bf16 v[20:23], v[132:135], v[112:115], v[20:23]
  ds_read_b128 v[92:95], v5 offset:37888
  v_mfma_f32_16x16x32_bf16 v[36:39], v[132:135], v[116:119], v[36:39]
  ds_read_b128 v[96:99], v7 offset:32768
  v_mfma_f32_16x16x32_bf16 v[52:55], v[132:135], v[120:123], v[52:55]
  ds_read_b128 v[100:103], v7 offset:33792
  v_mfma_f32_16x16x32_bf16 v[68:71], v[132:135], v[124:127], v[68:71]
  ds_read_b128 v[104:107], v7 offset:34816
  v_mfma_f32_16x16x32_bf16 v[24:27], v[136:139], v[112:115], v[24:27]
  ds_read_b128 v[108:111], v7 offset:35840
  s_add_u32 m0, s40, 32768
  v_mfma_f32_16x16x32_bf16 v[40:43], v[136:139], v[116:119], v[40:43]
  buffer_load_dwordx4 v1, s[20:23], s35 offen offset:0  lds
  v_mfma_f32_16x16x32_bf16 v[56:59], v[136:139], v[120:123], v[56:59]
  v_mfma_f32_16x16x32_bf16 v[72:75], v[136:139], v[124:127], v[72:75]
  buffer_load_dwordx4 v1, s[20:23], s35 offen offset:1024  lds
  v_mfma_f32_16x16x32_bf16 v[28:31], v[140:143], v[112:115], v[28:31]
  buffer_load_dwordx4 v1, s[20:23], s35 offen offset:2048  lds
  v_mfma_f32_16x16x32_bf16 v[44:47], v[140:143], v[116:119], v[44:47]
  v_mfma_f32_16x16x32_bf16 v[60:63], v[140:143], v[120:123], v[60:63]
  buffer_load_dwordx4 v1, s[20:23], s35 offen offset:3072  lds
  s_add_u32 s35, s35, 4096
  v_mfma_f32_16x16x32_bf16 v[76:79], v[140:143], v[124:127], v[76:79]
  s_waitcnt lgkmcnt(0)
  v_mfma_f32_16x16x32_bf16 v[16:19], v[96:99], v[80:83], v[16:19]
  ds_read_b128 v[112:115], v5 offset:34816
  v_mfma_f32_16x16x32_bf16 v[32:35], v[96:99], v[84:87], v[32:35]
  ds_read_b128 v[116:119], v5 offset:35840
  v_mfma_f32_16x16x32_bf16 v[48:51], v[96:99], v[88:91], v[48:51]
  ds_read_b128 v[120:123], v5 offset:38912
  v_mfma_f32_16x16x32_bf16 v[64:67], v[96:99], v[92:95], v[64:67]
  ds_read_b128 v[124:127], v5 offset:39936
  v_mfma_f32_16x16x32_bf16 v[20:23], v[100:103], v[80:83], v[20:23]
  ds_read_b128 v[128:131], v7 offset:36864
  v_mfma_f32_16x16x32_bf16 v[36:39], v[100:103], v[84:87], v[36:39]
  ds_read_b128 v[132:135], v7 offset:37888
  v_mfma_f32_16x16x32_bf16 v[52:55], v[100:103], v[88:91], v[52:55]
  ds_read_b128 v[136:139], v7 offset:38912
  v_mfma_f32_16x16x32_bf16 v[68:71], v[100:103], v[92:95], v[68:71]
  ds_read_b128 v[140:143], v7 offset:39936
  s_add_u32 m0, s40, 49152
  v_mfma_f32_16x16x32_bf16 v[24:27], v[104:107], v[80:83], v[24:27]
  buffer_load_dwordx4 v1, s[20:23], s36 offen offset:0 lds
  v_mfma_f32_16x16x32_bf16 v[40:43], v[104:107], v[84:87], v[40:43]
  v_mfma_f32_16x16x32_bf16 v[56:59], v[104:107], v[88:91], v[56:59]
  buffer_load_dwordx4 v1, s[20:23], s36 offen offset:1024 lds
  v_mfma_f32_16x16x32_bf16 v[72:75], v[104:107], v[92:95], v[72:75]
  v_mfma_f32_16x16x32_bf16 v[28:31], v[108:111], v[80:83], v[28:31]
  buffer_load_dwordx4 v1, s[20:23], s36 offen offset:2048 lds
  v_mfma_f32_16x16x32_bf16 v[44:47], v[108:111], v[84:87], v[44:47]
  v_mfma_f32_16x16x32_bf16 v[60:63], v[108:111], v[88:91], v[60:63]
  buffer_load_dwordx4 v1, s[20:23], s36 offen offset:3072 lds
  s_add_u32 s36, s36, 8192
  v_mfma_f32_16x16x32_bf16 v[76:79], v[108:111], v[92:95], v[76:79]
  s_waitcnt vmcnt(8) lgkmcnt(0)
  v_mfma_f32_16x16x32_bf16 v[16:19], v[128:131], v[112:115], v[16:19]
  s_barrier
  v_mfma_f32_16x16x32_bf16 v[32:35], v[128:131], v[116:119], v[32:35]
  ds_read_b128 v[80:83], v4 offset:0
  v_mfma_f32_16x16x32_bf16 v[48:51], v[128:131], v[120:123], v[48:51]
  ds_read_b128 v[84:87], v4 offset:1024
  v_mfma_f32_16x16x32_bf16 v[64:67], v[128:131], v[124:127], v[64:67]
  ds_read_b128 v[88:91], v4 offset:4096
  v_mfma_f32_16x16x32_bf16 v[20:23], v[132:135], v[112:115], v[20:23]
  ds_read_b128 v[92:95], v4 offset:5120
  v_mfma_f32_16x16x32_bf16 v[36:39], v[132:135], v[116:119], v[36:39]
  ds_read_b128 v[96:99], v6 offset:0
  v_mfma_f32_16x16x32_bf16 v[52:55], v[132:135], v[120:123], v[52:55]
  ds_read_b128 v[100:103], v6 offset:1024
  v_mfma_f32_16x16x32_bf16 v[68:71], v[132:135], v[124:127], v[68:71]
  ds_read_b128 v[104:107], v6 offset:2048
  v_mfma_f32_16x16x32_bf16 v[24:27], v[136:139], v[112:115], v[24:27]
  ds_read_b128 v[108:111], v6 offset:3072
  s_add_u32 m0, s40, 65536
  v_mfma_f32_16x16x32_bf16 v[40:43], v[136:139], v[116:119], v[40:43]
  buffer_load_dwordx4 v1, s[20:23], s35 offen offset:0  lds
  v_mfma_f32_16x16x32_bf16 v[56:59], v[136:139], v[120:123], v[56:59]
  v_mfma_f32_16x16x32_bf16 v[72:75], v[136:139], v[124:127], v[72:75]
  buffer_load_dwordx4 v1, s[20:23], s35 offen offset:1024  lds
  v_mfma_f32_16x16x32_bf16 v[28:31], v[140:143], v[112:115], v[28:31]
  buffer_load_dwordx4 v1, s[20:23], s35 offen offset:2048  lds
  v_mfma_f32_16x16x32_bf16 v[44:47], v[140:143], v[116:119], v[44:47]
  v_mfma_f32_16x16x32_bf16 v[60:63], v[140:143], v[120:123], v[60:63]
  buffer_load_dwordx4 v1, s[20:23], s35 offen offset:3072  lds
  s_add_u32 s35, s35, 4096
  v_mfma_f32_16x16x32_bf16 v[76:79], v[140:143], v[124:127], v[76:79]
  s_waitcnt lgkmcnt(0)
  v_mfma_f32_16x16x32_bf16 v[16:19], v[96:99], v[80:83], v[16:19]
  ds_read_b128 v[112:115], v4 offset:2048
  v_mfma_f32_16x16x32_bf16 v[32:35], v[96:99], v[84:87], v[32:35]
  ds_read_b128 v[116:119], v4 offset:3072
  v_mfma_f32_16x16x32_bf16 v[48:51], v[96:99], v[88:91], v[48:51]
  ds_read_b128 v[120:123], v4 offset:6144
  v_mfma_f32_16x16x32_bf16 v[64:67], v[96:99], v[92:95], v[64:67]
  ds_read_b128 v[124:127], v4 offset:7168
  v_mfma_f32_16x16x32_bf16 v[20:23], v[100:103], v[80:83], v[20:23]
  ds_read_b128 v[128:131], v6 offset:4096
  v_mfma_f32_16x16x32_bf16 v[36:39], v[100:103], v[84:87], v[36:39]
  ds_read_b128 v[132:135], v6 offset:5120
  v_mfma_f32_16x16x32_bf16 v[52:55], v[100:103], v[88:91], v[52:55]
  ds_read_b128 v[136:139], v6 offset:6144
  v_mfma_f32_16x16x32_bf16 v[68:71], v[100:103], v[92:95], v[68:71]
  ds_read_b128 v[140:143], v6 offset:7168
  s_add_u32 m0, s40, 81920
  v_mfma_f32_16x16x32_bf16 v[24:27], v[104:107], v[80:83], v[24:27]
  buffer_load_dwordx4 v1, s[20:23], s36 offen offset:0 lds
  v_mfma_f32_16x16x32_bf16 v[40:43], v[104:107], v[84:87], v[40:43]
  v_mfma_f32_16x16x32_bf16 v[56:59], v[104:107], v[88:91], v[56:59]
  buffer_load_dwordx4 v1, s[20:23], s36 offen offset:1024 lds
  v_mfma_f32_16x16x32_bf16 v[72:75], v[104:107], v[92:95], v[72:75]
  v_mfma_f32_16x16x32_bf16 v[28:31], v[108:111], v[80:83], v[28:31]
  buffer_load_dwordx4 v1, s[20:23], s36 offen offset:2048 lds
  v_mfma_f32_16x16x32_bf16 v[44:47], v[108:111], v[84:87], v[44:47]
  v_mfma_f32_16x16x32_bf16 v[60:63], v[108:111], v[88:91], v[60:63]
  buffer_load_dwordx4 v1, s[20:23], s36 offen offset:3072 lds
  s_add_u32 s36, s36, 8192
  v_mfma_f32_16x16x32_bf16 v[76:79], v[108:111], v[92:95], v[76:79]
  s_waitcnt vmcnt(8) lgkmcnt(0)
  v_mfma_f32_16x16x32_bf16 v[16:19], v[128:131], v[112:115], v[16:19]
  s_barrier
  v_mfma_f32_16x16x32_bf16 v[32:35], v[128:131], v[116:119], v[32:35]
  ds_read_b128 v[80:83], v4 offset:32768
  v_mfma_f32_16x16x32_bf16 v[48:51], v[128:131], v[120:123], v[48:51]
  ds_read_b128 v[84:87], v4 offset:33792
  v_mfma_f32_16x16x32_bf16 v[64:67], v[128:131], v[124:127], v[64:67]
  ds_read_b128 v[88:91], v4 offset:36864
  v_mfma_f32_16x16x32_bf16 v[20:23], v[132:135], v[112:115], v[20:23]
  ds_read_b128 v[92:95], v4 offset:37888
  v_mfma_f32_16x16x32_bf16 v[36:39], v[132:135], v[116:119], v[36:39]
  ds_read_b128 v[96:99], v6 offset:32768
  v_mfma_f32_16x16x32_bf16 v[52:55], v[132:135], v[120:123], v[52:55]
  ds_read_b128 v[100:103], v6 offset:33792
  s_mov_b32 s18, 0x200000
  s_mov_b32 s19, 0x00020000
  v_mfma_f32_16x16x32_bf16 v[68:71], v[132:135], v[124:127], v[68:71]
  ds_read_b128 v[104:107], v6 offset:34816
  s_mov_b32 s14, 0x200000
  s_mov_b32 s15, 0x00020000
  v_mfma_f32_16x16x32_bf16 v[24:27], v[136:139], v[112:115], v[24:27]
  ds_read_b128 v[108:111], v6 offset:35840
  s_mov_b32 s26, 3584
  s_add_u32 m0, s40, 98304
  v_mfma_f32_16x16x32_bf16 v[40:43], v[136:139], v[116:119], v[40:43]
  buffer_load_dwordx4 v1, s[20:23], s35 offen offset:0  lds
  s_mov_b32 s27, 0x00020000
  v_mfma_f32_16x16x32_bf16 v[56:59], v[136:139], v[120:123], v[56:59]
  s_mov_b32 s45, 1069066811
  v_lshrrev_b32 v15, 5, v2
  v_mfma_f32_16x16x32_bf16 v[72:75], v[136:139], v[124:127], v[72:75]
  buffer_load_dwordx4 v1, s[20:23], s35 offen offset:1024  lds
  v_bfe_u32 v12, v2, 3, 2
  v_mfma_f32_16x16x32_bf16 v[28:31], v[140:143], v[112:115], v[28:31]
  buffer_load_dwordx4 v1, s[20:23], s35 offen offset:2048  lds
  v_lshlrev_b32 v8, 7, v15
  v_mfma_f32_16x16x32_bf16 v[44:47], v[140:143], v[116:119], v[44:47]
  v_lshl_add_u32 v8, v12, 4, v8
  s_lshl_b32 s37, s30, 9
  v_mfma_f32_16x16x32_bf16 v[60:63], v[140:143], v[120:123], v[60:63]
  buffer_load_dwordx4 v1, s[20:23], s35 offen offset:3072  lds
  s_add_u32 s35, s35, 4096
  v_mfma_f32_16x16x32_bf16 v[76:79], v[140:143], v[124:127], v[76:79]
  s_waitcnt lgkmcnt(0)
  v_add_u32 v8, s37, v8
  v_and_b32 v13, 7, v2
  v_mfma_f32_16x16x32_bf16 v[16:19], v[96:99], v[80:83], v[16:19]
  ds_read_b128 v[112:115], v4 offset:34816
  v_lshrrev_b32 v9, 1, v8
  v_lshl_add_u32 v9, v13, 10, v9
  v_mfma_f32_16x16x32_bf16 v[32:35], v[96:99], v[84:87], v[32:35]
  ds_read_b128 v[116:119], v4 offset:35840
  s_lshl_b32 s37, s31, 3
  s_add_u32 s37, s37, s32
  v_mfma_f32_16x16x32_bf16 v[48:51], v[96:99], v[88:91], v[48:51]
  ds_read_b128 v[120:123], v4 offset:38912
  s_lshl_b32 s37, s37, 13
  v_mfma_f32_16x16x32_bf16 v[64:67], v[96:99], v[92:95], v[64:67]
  ds_read_b128 v[124:127], v4 offset:39936
  buffer_load_dwordx2 v[144:145], v9, s[16:19], s37 offen offset:0
  v_mfma_f32_16x16x32_bf16 v[20:23], v[100:103], v[80:83], v[20:23]
  ds_read_b128 v[128:131], v6 offset:36864
  buffer_load_dwordx2 v[146:147], v9, s[16:19], s37 offen offset:32
  v_mfma_f32_16x16x32_bf16 v[36:39], v[100:103], v[84:87], v[36:39]
  ds_read_b128 v[132:135], v6 offset:37888
  buffer_load_dwordx2 v[148:149], v9, s[16:19], s37 offen offset:128
  v_mfma_f32_16x16x32_bf16 v[52:55], v[100:103], v[88:91], v[52:55]
  ds_read_b128 v[136:139], v6 offset:38912
  buffer_load_dwordx2 v[150:151], v9, s[16:19], s37 offen offset:160
  v_mfma_f32_16x16x32_bf16 v[68:71], v[100:103], v[92:95], v[68:71]
  ds_read_b128 v[140:143], v6 offset:39936
  s_mov_b32 s38, 4096
  s_add_u32 m0, s40, 114688
  v_mfma_f32_16x16x32_bf16 v[24:27], v[104:107], v[80:83], v[24:27]
  buffer_load_dwordx4 v1, s[20:23], s36 offen offset:0 lds
  buffer_load_dwordx4 v[152:155], v8, s[20:23], s38 offen offset:0
  v_mfma_f32_16x16x32_bf16 v[40:43], v[104:107], v[84:87], v[40:43]
  buffer_load_dwordx4 v[156:159], v8, s[20:23], s38 offen offset:64
  v_mfma_f32_16x16x32_bf16 v[56:59], v[104:107], v[88:91], v[56:59]
  buffer_load_dwordx4 v1, s[20:23], s36 offen offset:1024 lds
  buffer_load_dwordx4 v[160:163], v8, s[20:23], s38 offen offset:256
  v_mfma_f32_16x16x32_bf16 v[72:75], v[104:107], v[92:95], v[72:75]
  buffer_load_dwordx4 v[164:167], v8, s[20:23], s38 offen offset:320
  v_mfma_f32_16x16x32_bf16 v[28:31], v[108:111], v[80:83], v[28:31]
  buffer_load_dwordx4 v1, s[20:23], s36 offen offset:2048 lds
  s_mov_b32 s38, 8192
  v_mfma_f32_16x16x32_bf16 v[44:47], v[108:111], v[84:87], v[44:47]
  buffer_load_dwordx4 v[168:171], v8, s[20:23], s38 offen offset:0
  v_mfma_f32_16x16x32_bf16 v[60:63], v[108:111], v[88:91], v[60:63]
  buffer_load_dwordx4 v1, s[20:23], s36 offen offset:3072 lds
  s_add_u32 s36, s36, 8192
  v_mfma_f32_16x16x32_bf16 v[76:79], v[108:111], v[92:95], v[76:79]
  s_waitcnt vmcnt(17) lgkmcnt(0)
  buffer_load_dwordx4 v[172:175], v8, s[20:23], s38 offen offset:64
  v_mfma_f32_16x16x32_bf16 v[16:19], v[128:131], v[112:115], v[16:19]
  s_barrier
  buffer_load_dwordx4 v[176:179], v8, s[20:23], s38 offen offset:256
  v_mfma_f32_16x16x32_bf16 v[32:35], v[128:131], v[116:119], v[32:35]
  ds_read_b128 v[80:83], v5 offset:0
  buffer_load_dwordx4 v[180:183], v8, s[20:23], s38 offen offset:320
  v_mfma_f32_16x16x32_bf16 v[48:51], v[128:131], v[120:123], v[48:51]
  ds_read_b128 v[84:87], v5 offset:1024
  s_mov_b32 s38, 6144
  v_mfma_f32_16x16x32_bf16 v[64:67], v[128:131], v[124:127], v[64:67]
  ds_read_b128 v[88:91], v5 offset:4096
  buffer_load_dwordx4 v[192:195], v8, s[20:23], s38 offen offset:0
  v_mfma_f32_16x16x32_bf16 v[20:23], v[132:135], v[112:115], v[20:23]
  ds_read_b128 v[92:95], v5 offset:5120
  buffer_load_dwordx4 v[196:199], v8, s[20:23], s38 offen offset:64
  v_mfma_f32_16x16x32_bf16 v[36:39], v[132:135], v[116:119], v[36:39]
  ds_read_b128 v[96:99], v7 offset:0
  buffer_load_dwordx4 v[200:203], v8, s[20:23], s38 offen offset:256
  v_mfma_f32_16x16x32_bf16 v[52:55], v[132:135], v[120:123], v[52:55]
  ds_read_b128 v[100:103], v7 offset:1024
  buffer_load_dwordx4 v[204:207], v8, s[20:23], s38 offen offset:320
  v_mfma_f32_16x16x32_bf16 v[68:71], v[132:135], v[124:127], v[68:71]
  ds_read_b128 v[104:107], v7 offset:2048
  v_lshlrev_b32 v12, 8, v12
  v_lshl_add_u32 v12, v13, 4, v12
  v_mfma_f32_16x16x32_bf16 v[24:27], v[136:139], v[112:115], v[24:27]
  ds_read_b128 v[108:111], v7 offset:3072
  v_lshl_add_u32 v13, v15, 11, v12
  s_add_u32 m0, s40, 0
  v_mfma_f32_16x16x32_bf16 v[40:43], v[136:139], v[116:119], v[40:43]
  buffer_load_dwordx4 v1, s[20:23], s35 offen offset:0  lds
  s_lshl_b32 s37, s32, 2
  v_mfma_f32_16x16x32_bf16 v[56:59], v[136:139], v[120:123], v[56:59]
  s_add_u32 s37, s37, s30
  s_lshl_b32 s37, s37, 7
  v_mfma_f32_16x16x32_bf16 v[72:75], v[136:139], v[124:127], v[72:75]
  buffer_load_dwordx4 v1, s[20:23], s35 offen offset:1024  lds
  v_lshrrev_b32 v15, 4, v2
  v_mfma_f32_16x16x32_bf16 v[28:31], v[140:143], v[112:115], v[28:31]
  buffer_load_dwordx4 v1, s[20:23], s35 offen offset:2048  lds
  v_lshlrev_b32 v15, 3, v15
  v_mfma_f32_16x16x32_bf16 v[44:47], v[140:143], v[116:119], v[44:47]
  buffer_load_dwordx2 v[224:225], v15, s[24:27], s37 offen offset:0
  v_mfma_f32_16x16x32_bf16 v[60:63], v[140:143], v[120:123], v[60:63]
  buffer_load_dwordx4 v1, s[20:23], s35 offen offset:3072  lds
  s_add_u32 s35, s35, 4096
  v_mfma_f32_16x16x32_bf16 v[76:79], v[140:143], v[124:127], v[76:79]
  s_waitcnt lgkmcnt(0)
  buffer_load_dwordx2 v[226:227], v15, s[24:27], s37 offen offset:32
  v_mfma_f32_16x16x32_bf16 v[16:19], v[96:99], v[80:83], v[16:19]
  ds_read_b128 v[112:115], v5 offset:2048
  buffer_load_dwordx2 v[228:229], v15, s[24:27], s37 offen offset:64
  v_mfma_f32_16x16x32_bf16 v[32:35], v[96:99], v[84:87], v[32:35]
  ds_read_b128 v[116:119], v5 offset:3072
  buffer_load_dwordx2 v[230:231], v15, s[24:27], s37 offen offset:96
  v_mfma_f32_16x16x32_bf16 v[48:51], v[96:99], v[88:91], v[48:51]
  ds_read_b128 v[120:123], v5 offset:6144
  s_add_u32 s39, s41, 98304
  v_and_b32 v15, 0x380, v14
  v_mfma_f32_16x16x32_bf16 v[64:67], v[96:99], v[92:95], v[64:67]
  ds_read_b128 v[124:127], v5 offset:7168
  buffer_load_dword v11, v15, s[20:23], s39 offen sc1
  v_mfma_f32_16x16x32_bf16 v[20:23], v[100:103], v[80:83], v[20:23]
  ds_read_b128 v[128:131], v7 offset:4096
  s_cmp_eq_u32 s30, 0
  s_cselect_b32 s41, s41, 0x80000000
  s_cselect_b32 s49, 0, -1
  v_mov_b32 v10, 23063
  v_mfma_f32_16x16x32_bf16 v[36:39], v[100:103], v[84:87], v[36:39]
  ds_read_b128 v[132:135], v7 offset:5120
  s_lshr_b32 s37, s30, 1
  s_lshl_b32 s33, s31, 1
  v_mfma_f32_16x16x32_bf16 v[52:55], v[100:103], v[88:91], v[52:55]
  ds_read_b128 v[136:139], v7 offset:6144
  s_add_u32 s33, s33, s37
  s_and_b32 s38, s30, 1
  v_mfma_f32_16x16x32_bf16 v[68:71], v[100:103], v[92:95], v[68:71]
  ds_read_b128 v[140:143], v7 offset:7168
  s_lshl_b32 s34, s32, 1
  s_add_u32 m0, s40, 16384
  v_mfma_f32_16x16x32_bf16 v[24:27], v[104:107], v[80:83], v[24:27]
  buffer_load_dwordx4 v1, s[20:23], s36 offen offset:0 lds
  s_add_u32 s34, s34, s38
  v_mfma_f32_16x16x32_bf16 v[40:43], v[104:107], v[84:87], v[40:43]
  s_lshl_b32 s43, s47, 21
  s_lshl_b32 s39, s51, 17
  v_mfma_f32_16x16x32_bf16 v[56:59], v[104:107], v[88:91], v[56:59]
  buffer_load_dwordx4 v1, s[20:23], s36 offen offset:1024 lds
  s_add_u32 s43, s43, s39
  v_mfma_f32_16x16x32_bf16 v[72:75], v[104:107], v[92:95], v[72:75]
  s_lshl_b32 s37, s37, 16
  s_add_u32 s43, s43, s37
  v_mfma_f32_16x16x32_bf16 v[28:31], v[108:111], v[80:83], v[28:31]
  buffer_load_dwordx4 v1, s[20:23], s36 offen offset:2048 lds
  s_add_u32 s37, s60, s38
  v_mfma_f32_16x16x32_bf16 v[44:47], v[108:111], v[84:87], v[44:47]
  s_lshl_b32 s37, s37, 12
  s_add_u32 s43, s43, s37
  v_mfma_f32_16x16x32_bf16 v[60:63], v[108:111], v[88:91], v[60:63]
  buffer_load_dwordx4 v1, s[20:23], s36 offen offset:3072 lds
  s_add_u32 s36, s36, 8192
  v_mfma_f32_16x16x32_bf16 v[76:79], v[108:111], v[92:95], v[76:79]
  s_waitcnt vmcnt(20) lgkmcnt(0)
  s_add_u32 s43, s43, 16777216
  s_lshr_b32 s37, s32, 2
  v_mfma_f32_16x16x32_bf16 v[16:19], v[128:131], v[112:115], v[16:19]
  s_barrier
  s_lshl_b32 s38, s31, 1
  s_add_u32 s37, s37, s38
  v_mfma_f32_16x16x32_bf16 v[32:35], v[128:131], v[116:119], v[32:35]
  ds_read_b128 v[80:83], v5 offset:32768
  s_lshl_b32 s48, s37, 15
  s_bfe_u32 s38, s32, 0x10001
  v_mfma_f32_16x16x32_bf16 v[48:51], v[128:131], v[120:123], v[48:51]
  ds_read_b128 v[84:87], v5 offset:33792
  s_lshl_b32 s38, s38, 10
  s_add_u32 s48, s48, s38
  v_mfma_f32_16x16x32_bf16 v[64:67], v[128:131], v[124:127], v[64:67]
  ds_read_b128 v[88:91], v5 offset:36864
  s_and_b32 s38, s32, 1
  s_lshl_b32 s38, s38, 7
  v_mfma_f32_16x16x32_bf16 v[20:23], v[132:135], v[112:115], v[20:23]
  ds_read_b128 v[92:95], v5 offset:37888
  s_add_u32 s48, s48, s38
  s_lshl_b32 s39, s30, 13
  v_mfma_f32_16x16x32_bf16 v[36:39], v[132:135], v[116:119], v[36:39]
  ds_read_b128 v[96:99], v7 offset:32768
  s_add_u32 s48, s48, s39
  v_mfma_f32_16x16x32_bf16 v[52:55], v[132:135], v[120:123], v[52:55]
  ds_read_b128 v[100:103], v7 offset:33792
  v_mfma_f32_16x16x32_bf16 v[68:71], v[132:135], v[124:127], v[68:71]
  ds_read_b128 v[104:107], v7 offset:34816
  v_mfma_f32_16x16x32_bf16 v[24:27], v[136:139], v[112:115], v[24:27]
  ds_read_b128 v[108:111], v7 offset:35840
  s_add_u32 m0, s40, 32768
  v_mfma_f32_16x16x32_bf16 v[40:43], v[136:139], v[116:119], v[40:43]
  buffer_load_dwordx4 v1, s[20:23], s35 offen offset:0  lds
  v_mfma_f32_16x16x32_bf16 v[56:59], v[136:139], v[120:123], v[56:59]
  v_mfma_f32_16x16x32_bf16 v[72:75], v[136:139], v[124:127], v[72:75]
  buffer_load_dwordx4 v1, s[20:23], s35 offen offset:1024  lds
  v_mfma_f32_16x16x32_bf16 v[28:31], v[140:143], v[112:115], v[28:31]
  buffer_load_dwordx4 v1, s[20:23], s35 offen offset:2048  lds
  v_mfma_f32_16x16x32_bf16 v[44:47], v[140:143], v[116:119], v[44:47]
  v_mfma_f32_16x16x32_bf16 v[60:63], v[140:143], v[120:123], v[60:63]
  buffer_load_dwordx4 v1, s[20:23], s35 offen offset:3072  lds
  s_add_u32 s35, s35, 4096
  v_mfma_f32_16x16x32_bf16 v[76:79], v[140:143], v[124:127], v[76:79]
  s_waitcnt lgkmcnt(0)
  v_mfma_f32_16x16x32_bf16 v[16:19], v[96:99], v[80:83], v[16:19]
  ds_read_b128 v[112:115], v5 offset:34816
  v_mfma_f32_16x16x32_bf16 v[32:35], v[96:99], v[84:87], v[32:35]
  ds_read_b128 v[116:119], v5 offset:35840
  v_mfma_f32_16x16x32_bf16 v[48:51], v[96:99], v[88:91], v[48:51]
  ds_read_b128 v[120:123], v5 offset:38912
  v_mfma_f32_16x16x32_bf16 v[64:67], v[96:99], v[92:95], v[64:67]
  ds_read_b128 v[124:127], v5 offset:39936
  v_mfma_f32_16x16x32_bf16 v[20:23], v[100:103], v[80:83], v[20:23]
  ds_read_b128 v[128:131], v7 offset:36864
  v_mfma_f32_16x16x32_bf16 v[36:39], v[100:103], v[84:87], v[36:39]
  ds_read_b128 v[132:135], v7 offset:37888
  v_mfma_f32_16x16x32_bf16 v[52:55], v[100:103], v[88:91], v[52:55]
  ds_read_b128 v[136:139], v7 offset:38912
  v_mfma_f32_16x16x32_bf16 v[68:71], v[100:103], v[92:95], v[68:71]
  ds_read_b128 v[140:143], v7 offset:39936
  s_add_u32 m0, s40, 49152
  v_mfma_f32_16x16x32_bf16 v[24:27], v[104:107], v[80:83], v[24:27]
  buffer_load_dwordx4 v1, s[20:23], s36 offen offset:0 lds
  v_mfma_f32_16x16x32_bf16 v[40:43], v[104:107], v[84:87], v[40:43]
  v_mfma_f32_16x16x32_bf16 v[56:59], v[104:107], v[88:91], v[56:59]
  buffer_load_dwordx4 v1, s[20:23], s36 offen offset:1024 lds
  v_mfma_f32_16x16x32_bf16 v[72:75], v[104:107], v[92:95], v[72:75]
  v_mfma_f32_16x16x32_bf16 v[28:31], v[108:111], v[80:83], v[28:31]
  buffer_load_dwordx4 v1, s[20:23], s36 offen offset:2048 lds
  v_mfma_f32_16x16x32_bf16 v[44:47], v[108:111], v[84:87], v[44:47]
  v_mfma_f32_16x16x32_bf16 v[60:63], v[108:111], v[88:91], v[60:63]
  buffer_load_dwordx4 v1, s[20:23], s36 offen offset:3072 lds
  s_add_u32 s36, s36, 8192
  v_mfma_f32_16x16x32_bf16 v[76:79], v[108:111], v[92:95], v[76:79]
  s_waitcnt vmcnt(8) lgkmcnt(0)
  v_mfma_f32_16x16x32_bf16 v[16:19], v[128:131], v[112:115], v[16:19]
  s_barrier
  v_mfma_f32_16x16x32_bf16 v[32:35], v[128:131], v[116:119], v[32:35]
  ds_read_b128 v[80:83], v4 offset:0
  v_mfma_f32_16x16x32_bf16 v[48:51], v[128:131], v[120:123], v[48:51]
  ds_read_b128 v[84:87], v4 offset:1024
  v_mfma_f32_16x16x32_bf16 v[64:67], v[128:131], v[124:127], v[64:67]
  ds_read_b128 v[88:91], v4 offset:4096
  v_mfma_f32_16x16x32_bf16 v[20:23], v[132:135], v[112:115], v[20:23]
  ds_read_b128 v[92:95], v4 offset:5120
  v_mfma_f32_16x16x32_bf16 v[36:39], v[132:135], v[116:119], v[36:39]
  ds_read_b128 v[96:99], v6 offset:0
  v_mfma_f32_16x16x32_bf16 v[52:55], v[132:135], v[120:123], v[52:55]
  ds_read_b128 v[100:103], v6 offset:1024
  v_mfma_f32_16x16x32_bf16 v[68:71], v[132:135], v[124:127], v[68:71]
  ds_read_b128 v[104:107], v6 offset:2048
  v_mfma_f32_16x16x32_bf16 v[24:27], v[136:139], v[112:115], v[24:27]
  ds_read_b128 v[108:111], v6 offset:3072
  s_add_u32 m0, s40, 65536
  v_mfma_f32_16x16x32_bf16 v[40:43], v[136:139], v[116:119], v[40:43]
  buffer_load_dwordx4 v1, s[20:23], s35 offen offset:0  lds
  v_mfma_f32_16x16x32_bf16 v[56:59], v[136:139], v[120:123], v[56:59]
  v_mfma_f32_16x16x32_bf16 v[72:75], v[136:139], v[124:127], v[72:75]
  buffer_load_dwordx4 v1, s[20:23], s35 offen offset:1024  lds
  v_mfma_f32_16x16x32_bf16 v[28:31], v[140:143], v[112:115], v[28:31]
  buffer_load_dwordx4 v1, s[20:23], s35 offen offset:2048  lds
  v_mfma_f32_16x16x32_bf16 v[44:47], v[140:143], v[116:119], v[44:47]
  s_nop 0
  v_cmp_eq_u32 vcc, s50, v11
  v_mfma_f32_16x16x32_bf16 v[60:63], v[140:143], v[120:123], v[60:63]
  buffer_load_dwordx4 v1, s[20:23], s35 offen offset:3072  lds
  s_add_u32 s35, s35, 4096
  v_mfma_f32_16x16x32_bf16 v[76:79], v[140:143], v[124:127], v[76:79]
  s_waitcnt lgkmcnt(0)
  s_mov_b32 s52, s20
  s_mov_b32 s53, s21
  v_mfma_f32_16x16x32_bf16 v[16:19], v[96:99], v[80:83], v[16:19]
  ds_read_b128 v[112:115], v4 offset:2048
  s_mov_b32 s55, 0x00020000
  s_mov_b32 s56, s20
  v_mfma_f32_16x16x32_bf16 v[32:35], v[96:99], v[84:87], v[32:35]
  ds_read_b128 v[116:119], v4 offset:3072
  s_mov_b32 s57, s21
  s_mov_b32 s59, 0x00020000
  v_mfma_f32_16x16x32_bf16 v[48:51], v[96:99], v[88:91], v[48:51]
  ds_read_b128 v[120:123], v4 offset:6144
  s_cmp_eq_u32 vcc_lo, -1
  s_cselect_b32 s54, 75497472, 0
  s_cselect_b32 s58, 0, 75497472
  v_lshlrev_b32 v240, 16, v224
  v_mfma_f32_16x16x32_bf16 v[64:67], v[96:99], v[92:95], v[64:67]
  ds_read_b128 v[124:127], v4 offset:7168
  v_and_b32 v241, 0xffff0000, v224
  v_lshlrev_b32 v242, 16, v225
  v_mfma_f32_16x16x32_bf16 v[20:23], v[100:103], v[80:83], v[20:23]
  ds_read_b128 v[128:131], v6 offset:4096
  v_and_b32 v243, 0xffff0000, v225
  v_lshlrev_b32 v244, 16, v226
  v_mfma_f32_16x16x32_bf16 v[36:39], v[100:103], v[84:87], v[36:39]
  ds_read_b128 v[132:135], v6 offset:5120
  v_and_b32 v245, 0xffff0000, v226
  v_lshlrev_b32 v246, 16, v227
  v_mfma_f32_16x16x32_bf16 v[52:55], v[100:103], v[88:91], v[52:55]
  ds_read_b128 v[136:139], v6 offset:6144
  v_and_b32 v247, 0xffff0000, v227
  v_lshlrev_b32 v248, 16, v228
  v_mfma_f32_16x16x32_bf16 v[68:71], v[100:103], v[92:95], v[68:71]
  ds_read_b128 v[140:143], v6 offset:7168
  v_and_b32 v249, 0xffff0000, v228
  s_add_u32 m0, s40, 81920
  v_mfma_f32_16x16x32_bf16 v[24:27], v[104:107], v[80:83], v[24:27]
  buffer_load_dwordx4 v1, s[20:23], s36 offen offset:0 lds
  v_lshlrev_b32 v250, 16, v229
  v_mfma_f32_16x16x32_bf16 v[40:43], v[104:107], v[84:87], v[40:43]
  v_and_b32 v251, 0xffff0000, v229
  v_lshlrev_b32 v252, 16, v230
  v_mfma_f32_16x16x32_bf16 v[56:59], v[104:107], v[88:91], v[56:59]
  buffer_load_dwordx4 v1, s[20:23], s36 offen offset:1024 lds
  v_and_b32 v253, 0xffff0000, v230
  v_mfma_f32_16x16x32_bf16 v[72:75], v[104:107], v[92:95], v[72:75]
  v_lshlrev_b32 v254, 16, v231
  v_and_b32 v255, 0xffff0000, v231
  v_mfma_f32_16x16x32_bf16 v[28:31], v[108:111], v[80:83], v[28:31]
  buffer_load_dwordx4 v1, s[20:23], s36 offen offset:2048 lds
  v_mul_f32 v240, s45, v240
  v_mfma_f32_16x16x32_bf16 v[44:47], v[108:111], v[84:87], v[44:47]
  v_mul_f32 v241, s45, v241
  v_mul_f32 v242, s45, v242
  v_mfma_f32_16x16x32_bf16 v[60:63], v[108:111], v[88:91], v[60:63]
  buffer_load_dwordx4 v1, s[20:23], s36 offen offset:3072 lds
  s_add_u32 s36, s36, 8192
  v_mfma_f32_16x16x32_bf16 v[76:79], v[108:111], v[92:95], v[76:79]
  s_waitcnt vmcnt(8) lgkmcnt(0)
  v_mul_f32 v243, s45, v243
  v_mul_f32 v244, s45, v244
  v_mfma_f32_16x16x32_bf16 v[16:19], v[128:131], v[112:115], v[16:19]
  s_barrier
  v_mul_f32 v245, s45, v245
  v_mul_f32 v246, s45, v246
  v_mfma_f32_16x16x32_bf16 v[32:35], v[128:131], v[116:119], v[32:35]
  ds_read_b128 v[80:83], v4 offset:32768
  v_mul_f32 v247, s45, v247
  v_mul_f32 v248, s45, v248
  v_mfma_f32_16x16x32_bf16 v[48:51], v[128:131], v[120:123], v[48:51]
  ds_read_b128 v[84:87], v4 offset:33792
  v_mul_f32 v249, s45, v249
  v_mul_f32 v250, s45, v250
  v_mfma_f32_16x16x32_bf16 v[64:67], v[128:131], v[124:127], v[64:67]
  ds_read_b128 v[88:91], v4 offset:36864
  v_mul_f32 v251, s45, v251
  v_mul_f32 v252, s45, v252
  v_mfma_f32_16x16x32_bf16 v[20:23], v[132:135], v[112:115], v[20:23]
  ds_read_b128 v[92:95], v4 offset:37888
  v_mul_f32 v253, s45, v253
  v_mul_f32 v254, s45, v254
  v_mfma_f32_16x16x32_bf16 v[36:39], v[132:135], v[116:119], v[36:39]
  ds_read_b128 v[96:99], v6 offset:32768
  v_mul_f32 v255, s45, v255
  v_lshlrev_b32 v208, 16, v144
  v_mfma_f32_16x16x32_bf16 v[52:55], v[132:135], v[120:123], v[52:55]
  ds_read_b128 v[100:103], v6 offset:33792
  v_and_b32 v209, 0xffff0000, v144
  v_lshlrev_b32 v210, 16, v145
  v_mfma_f32_16x16x32_bf16 v[68:71], v[132:135], v[124:127], v[68:71]
  ds_read_b128 v[104:107], v6 offset:34816
  v_and_b32 v211, 0xffff0000, v145
  v_lshlrev_b32 v212, 16, v146
  v_mfma_f32_16x16x32_bf16 v[24:27], v[136:139], v[112:115], v[24:27]
  ds_read_b128 v[108:111], v6 offset:35840
  v_and_b32 v213, 0xffff0000, v146
  s_add_u32 m0, s40, 98304
  v_mfma_f32_16x16x32_bf16 v[40:43], v[136:139], v[116:119], v[40:43]
  buffer_load_dwordx4 v1, s[20:23], s35 offen offset:0  lds
  v_lshlrev_b32 v214, 16, v147
  v_mfma_f32_16x16x32_bf16 v[56:59], v[136:139], v[120:123], v[56:59]
  v_and_b32 v215, 0xffff0000, v147
  v_lshlrev_b32 v216, 16, v148
  v_mfma_f32_16x16x32_bf16 v[72:75], v[136:139], v[124:127], v[72:75]
  buffer_load_dwordx4 v1, s[20:23], s35 offen offset:1024  lds
  v_and_b32 v217, 0xffff0000, v148
  v_mfma_f32_16x16x32_bf16 v[28:31], v[140:143], v[112:115], v[28:31]
  buffer_load_dwordx4 v1, s[20:23], s35 offen offset:2048  lds
  v_lshlrev_b32 v218, 16, v149
  v_mfma_f32_16x16x32_bf16 v[44:47], v[140:143], v[116:119], v[44:47]
  v_and_b32 v219, 0xffff0000, v149
  v_lshlrev_b32 v220, 16, v150
  v_mfma_f32_16x16x32_bf16 v[60:63], v[140:143], v[120:123], v[60:63]
  buffer_load_dwordx4 v1, s[20:23], s35 offen offset:3072  lds
  s_add_u32 s35, s35, 4096
  v_mfma_f32_16x16x32_bf16 v[76:79], v[140:143], v[124:127], v[76:79]
  s_waitcnt lgkmcnt(0)
  v_and_b32 v221, 0xffff0000, v150
  v_lshlrev_b32 v222, 16, v151
  v_mfma_f32_16x16x32_bf16 v[16:19], v[96:99], v[80:83], v[16:19]
  ds_read_b128 v[112:115], v4 offset:34816
  v_and_b32 v223, 0xffff0000, v151
  v_add_f32 v168, 1.0, v168
  v_mfma_f32_16x16x32_bf16 v[32:35], v[96:99], v[84:87], v[32:35]
  ds_read_b128 v[116:119], v4 offset:35840
  v_add_f32 v169, 1.0, v169
  v_add_f32 v170, 1.0, v170
  v_mfma_f32_16x16x32_bf16 v[48:51], v[96:99], v[88:91], v[48:51]
  ds_read_b128 v[120:123], v4 offset:38912
  v_add_f32 v171, 1.0, v171
  v_add_f32 v172, 1.0, v172
  v_mfma_f32_16x16x32_bf16 v[64:67], v[96:99], v[92:95], v[64:67]
  ds_read_b128 v[124:127], v4 offset:39936
  v_add_f32 v173, 1.0, v173
  v_add_f32 v174, 1.0, v174
  v_mfma_f32_16x16x32_bf16 v[20:23], v[100:103], v[80:83], v[20:23]
  ds_read_b128 v[128:131], v6 offset:36864
  v_add_f32 v175, 1.0, v175
  v_add_f32 v176, 1.0, v176
  v_mfma_f32_16x16x32_bf16 v[36:39], v[100:103], v[84:87], v[36:39]
  ds_read_b128 v[132:135], v6 offset:37888
  v_add_f32 v177, 1.0, v177
  v_add_f32 v178, 1.0, v178
  v_mfma_f32_16x16x32_bf16 v[52:55], v[100:103], v[88:91], v[52:55]
  ds_read_b128 v[136:139], v6 offset:38912
  v_add_f32 v179, 1.0, v179
  v_add_f32 v180, 1.0, v180
  v_mfma_f32_16x16x32_bf16 v[68:71], v[100:103], v[92:95], v[68:71]
  ds_read_b128 v[140:143], v6 offset:39936
  v_add_f32 v181, 1.0, v181
  s_add_u32 m0, s40, 114688
  v_mfma_f32_16x16x32_bf16 v[24:27], v[104:107], v[80:83], v[24:27]
  buffer_load_dwordx4 v1, s[20:23], s36 offen offset:0 lds
  v_add_f32 v182, 1.0, v182
  v_mfma_f32_16x16x32_bf16 v[40:43], v[104:107], v[84:87], v[40:43]
  v_add_f32 v183, 1.0, v183
  v_cvt_pk_bf16_f32 v168, v168, v168
  v_mfma_f32_16x16x32_bf16 v[56:59], v[104:107], v[88:91], v[56:59]
  buffer_load_dwordx4 v1, s[20:23], s36 offen offset:1024 lds
  v_cvt_pk_bf16_f32 v169, v169, v169
  v_mfma_f32_16x16x32_bf16 v[72:75], v[104:107], v[92:95], v[72:75]
  v_cvt_pk_bf16_f32 v170, v170, v170
  v_cvt_pk_bf16_f32 v171, v171, v171
  v_mfma_f32_16x16x32_bf16 v[28:31], v[108:111], v[80:83], v[28:31]
  buffer_load_dwordx4 v1, s[20:23], s36 offen offset:2048 lds
  v_cvt_pk_bf16_f32 v172, v172, v172
  v_mfma_f32_16x16x32_bf16 v[44:47], v[108:111], v[84:87], v[44:47]
  v_cvt_pk_bf16_f32 v173, v173, v173
  v_cvt_pk_bf16_f32 v174, v174, v174
  v_mfma_f32_16x16x32_bf16 v[60:63], v[108:111], v[88:91], v[60:63]
  buffer_load_dwordx4 v1, s[20:23], s36 offen offset:3072 lds
  s_add_u32 s36, s36, 8192
  v_mfma_f32_16x16x32_bf16 v[76:79], v[108:111], v[92:95], v[76:79]
  s_waitcnt vmcnt(8) lgkmcnt(0)
  v_cvt_pk_bf16_f32 v175, v175, v175
  v_cvt_pk_bf16_f32 v176, v176, v176
  v_mfma_f32_16x16x32_bf16 v[16:19], v[128:131], v[112:115], v[16:19]
  s_barrier
  v_cvt_pk_bf16_f32 v177, v177, v177
  v_cvt_pk_bf16_f32 v178, v178, v178
  v_mfma_f32_16x16x32_bf16 v[32:35], v[128:131], v[116:119], v[32:35]
  ds_read_b128 v[80:83], v5 offset:0
  v_cvt_pk_bf16_f32 v179, v179, v179
  v_cvt_pk_bf16_f32 v180, v180, v180
  v_mfma_f32_16x16x32_bf16 v[48:51], v[128:131], v[120:123], v[48:51]
  ds_read_b128 v[84:87], v5 offset:1024
  v_cvt_pk_bf16_f32 v181, v181, v181
  v_cvt_pk_bf16_f32 v182, v182, v182
  v_mfma_f32_16x16x32_bf16 v[64:67], v[128:131], v[124:127], v[64:67]
  ds_read_b128 v[88:91], v5 offset:4096
  v_cvt_pk_bf16_f32 v183, v183, v183
  v_lshlrev_b32 v168, 16, v168
  v_mfma_f32_16x16x32_bf16 v[20:23], v[132:135], v[112:115], v[20:23]
  ds_read_b128 v[92:95], v5 offset:5120
  v_lshlrev_b32 v169, 16, v169
  v_lshlrev_b32 v170, 16, v170
  v_mfma_f32_16x16x32_bf16 v[36:39], v[132:135], v[116:119], v[36:39]
  ds_read_b128 v[96:99], v7 offset:0
  v_lshlrev_b32 v171, 16, v171
  v_lshlrev_b32 v172, 16, v172
  v_mfma_f32_16x16x32_bf16 v[52:55], v[132:135], v[120:123], v[52:55]
  ds_read_b128 v[100:103], v7 offset:1024
  v_lshlrev_b32 v173, 16, v173
  v_lshlrev_b32 v174, 16, v174
  v_mfma_f32_16x16x32_bf16 v[68:71], v[132:135], v[124:127], v[68:71]
  ds_read_b128 v[104:107], v7 offset:2048
  v_lshlrev_b32 v175, 16, v175
  v_lshlrev_b32 v176, 16, v176
  v_mfma_f32_16x16x32_bf16 v[24:27], v[136:139], v[112:115], v[24:27]
  ds_read_b128 v[108:111], v7 offset:3072
  v_lshlrev_b32 v177, 16, v177
  s_add_u32 m0, s40, 0
  v_mfma_f32_16x16x32_bf16 v[40:43], v[136:139], v[116:119], v[40:43]
  buffer_load_dwordx4 v1, s[20:23], s35 offen offset:0  lds
  v_lshlrev_b32 v178, 16, v178
  v_mfma_f32_16x16x32_bf16 v[56:59], v[136:139], v[120:123], v[56:59]
  v_lshlrev_b32 v179, 16, v179
  v_lshlrev_b32 v180, 16, v180
  v_mfma_f32_16x16x32_bf16 v[72:75], v[136:139], v[124:127], v[72:75]
  buffer_load_dwordx4 v1, s[20:23], s35 offen offset:1024  lds
  v_lshlrev_b32 v181, 16, v181
  v_mfma_f32_16x16x32_bf16 v[28:31], v[140:143], v[112:115], v[28:31]
  buffer_load_dwordx4 v1, s[20:23], s35 offen offset:2048  lds
  v_lshlrev_b32 v182, 16, v182
  v_mfma_f32_16x16x32_bf16 v[44:47], v[140:143], v[116:119], v[44:47]
  v_lshlrev_b32 v183, 16, v183
  v_mul_f32 v192, s45, v192
  v_mfma_f32_16x16x32_bf16 v[60:63], v[140:143], v[120:123], v[60:63]
  buffer_load_dwordx4 v1, s[20:23], s35 offen offset:3072  lds
  s_add_u32 s35, s35, 4096
  v_mfma_f32_16x16x32_bf16 v[76:79], v[140:143], v[124:127], v[76:79]
  s_waitcnt lgkmcnt(0)
  v_mul_f32 v193, s45, v193
  v_mul_f32 v194, s45, v194
  v_mfma_f32_16x16x32_bf16 v[16:19], v[96:99], v[80:83], v[16:19]
  ds_read_b128 v[112:115], v5 offset:2048
  v_mul_f32 v195, s45, v195
  v_mul_f32 v196, s45, v196
  v_mfma_f32_16x16x32_bf16 v[32:35], v[96:99], v[84:87], v[32:35]
  ds_read_b128 v[116:119], v5 offset:3072
  v_mul_f32 v197, s45, v197
  v_mul_f32 v198, s45, v198
  v_mfma_f32_16x16x32_bf16 v[48:51], v[96:99], v[88:91], v[48:51]
  ds_read_b128 v[120:123], v5 offset:6144
  v_mul_f32 v199, s45, v199
  v_mul_f32 v200, s45, v200
  v_mfma_f32_16x16x32_bf16 v[64:67], v[96:99], v[92:95], v[64:67]
  ds_read_b128 v[124:127], v5 offset:7168
  v_mul_f32 v201, s45, v201
  v_mul_f32 v202, s45, v202
  v_mfma_f32_16x16x32_bf16 v[20:23], v[100:103], v[80:83], v[20:23]
  ds_read_b128 v[128:131], v7 offset:4096
  v_mul_f32 v203, s45, v203
  v_mul_f32 v204, s45, v204
  v_mfma_f32_16x16x32_bf16 v[36:39], v[100:103], v[84:87], v[36:39]
  ds_read_b128 v[132:135], v7 offset:5120
  v_mul_f32 v205, s45, v205
  v_mul_f32 v206, s45, v206
  v_mfma_f32_16x16x32_bf16 v[52:55], v[100:103], v[88:91], v[52:55]
  ds_read_b128 v[136:139], v7 offset:6144
  v_mul_f32 v207, s45, v207
  v_and_b32 v187, 7, v2
  v_mfma_f32_16x16x32_bf16 v[68:71], v[100:103], v[92:95], v[68:71]
  ds_read_b128 v[140:143], v7 offset:7168
  v_lshlrev_b32 v187, 5, v187
  s_add_u32 m0, s40, 16384
  v_mfma_f32_16x16x32_bf16 v[24:27], v[104:107], v[80:83], v[24:27]
  buffer_load_dwordx4 v1, s[20:23], s36 offen offset:0 lds
  v_add_u32 v187, 0x20000, v187
  v_mfma_f32_16x16x32_bf16 v[40:43], v[104:107], v[84:87], v[40:43]
  s_lshl_b32 s37, s30, 3
  v_add_u32 v188, s37, v187
  v_mfma_f32_16x16x32_bf16 v[56:59], v[104:107], v[88:91], v[56:59]
  buffer_load_dwordx4 v1, s[20:23], s36 offen offset:1024 lds
  v_mfma_f32_16x16x32_bf16 v[72:75], v[104:107], v[92:95], v[72:75]
  v_mfma_f32_16x16x32_bf16 v[28:31], v[108:111], v[80:83], v[28:31]
  buffer_load_dwordx4 v1, s[20:23], s36 offen offset:2048 lds
  v_mfma_f32_16x16x32_bf16 v[44:47], v[108:111], v[84:87], v[44:47]
  v_mfma_f32_16x16x32_bf16 v[60:63], v[108:111], v[88:91], v[60:63]
  buffer_load_dwordx4 v1, s[20:23], s36 offen offset:3072 lds
  s_add_u32 s36, s36, 8192
  v_mfma_f32_16x16x32_bf16 v[76:79], v[108:111], v[92:95], v[76:79]
  s_waitcnt vmcnt(8) lgkmcnt(0)
  v_mfma_f32_16x16x32_bf16 v[16:19], v[128:131], v[112:115], v[16:19]
  s_barrier
  v_mfma_f32_16x16x32_bf16 v[32:35], v[128:131], v[116:119], v[32:35]
  ds_read_b128 v[80:83], v5 offset:32768
  v_mfma_f32_16x16x32_bf16 v[48:51], v[128:131], v[120:123], v[48:51]
  ds_read_b128 v[84:87], v5 offset:33792
  v_mfma_f32_16x16x32_bf16 v[64:67], v[128:131], v[124:127], v[64:67]
  ds_read_b128 v[88:91], v5 offset:36864
  v_mfma_f32_16x16x32_bf16 v[20:23], v[132:135], v[112:115], v[20:23]
  ds_read_b128 v[92:95], v5 offset:37888
  v_mfma_f32_16x16x32_bf16 v[36:39], v[132:135], v[116:119], v[36:39]
  ds_read_b128 v[96:99], v7 offset:32768
  v_mfma_f32_16x16x32_bf16 v[52:55], v[132:135], v[120:123], v[52:55]
  ds_read_b128 v[100:103], v7 offset:33792
  v_mfma_f32_16x16x32_bf16 v[68:71], v[132:135], v[124:127], v[68:71]
  ds_read_b128 v[104:107], v7 offset:34816
  v_mfma_f32_16x16x32_bf16 v[24:27], v[136:139], v[112:115], v[24:27]
  ds_read_b128 v[108:111], v7 offset:35840
  s_add_u32 m0, s40, 32768
  v_mfma_f32_16x16x32_bf16 v[40:43], v[136:139], v[116:119], v[40:43]
  buffer_load_dwordx4 v1, s[20:23], s35 offen offset:0  lds
  v_mfma_f32_16x16x32_bf16 v[56:59], v[136:139], v[120:123], v[56:59]
  buffer_load_dword v185, v184, s[20:23], s62 offen sc1
  v_mfma_f32_16x16x32_bf16 v[72:75], v[136:139], v[124:127], v[72:75]
  buffer_load_dwordx4 v1, s[20:23], s35 offen offset:1024  lds
  v_mfma_f32_16x16x32_bf16 v[28:31], v[140:143], v[112:115], v[28:31]
  buffer_load_dwordx4 v1, s[20:23], s35 offen offset:2048  lds
  v_mfma_f32_16x16x32_bf16 v[44:47], v[140:143], v[116:119], v[44:47]
  v_mfma_f32_16x16x32_bf16 v[60:63], v[140:143], v[120:123], v[60:63]
  buffer_load_dwordx4 v1, s[20:23], s35 offen offset:3072  lds
  s_add_u32 s35, s35, 4096
  v_mfma_f32_16x16x32_bf16 v[76:79], v[140:143], v[124:127], v[76:79]
  s_waitcnt lgkmcnt(0)
  v_mfma_f32_16x16x32_bf16 v[16:19], v[96:99], v[80:83], v[16:19]
  ds_read_b128 v[112:115], v5 offset:34816
  v_mfma_f32_16x16x32_bf16 v[32:35], v[96:99], v[84:87], v[32:35]
  ds_read_b128 v[116:119], v5 offset:35840
  v_mfma_f32_16x16x32_bf16 v[48:51], v[96:99], v[88:91], v[48:51]
  ds_read_b128 v[120:123], v5 offset:38912
  v_mfma_f32_16x16x32_bf16 v[64:67], v[96:99], v[92:95], v[64:67]
  ds_read_b128 v[124:127], v5 offset:39936
  v_mfma_f32_16x16x32_bf16 v[20:23], v[100:103], v[80:83], v[20:23]
  ds_read_b128 v[128:131], v7 offset:36864
  v_mfma_f32_16x16x32_bf16 v[36:39], v[100:103], v[84:87], v[36:39]
  ds_read_b128 v[132:135], v7 offset:37888
  v_mfma_f32_16x16x32_bf16 v[52:55], v[100:103], v[88:91], v[52:55]
  ds_read_b128 v[136:139], v7 offset:38912
  v_mfma_f32_16x16x32_bf16 v[68:71], v[100:103], v[92:95], v[68:71]
  ds_read_b128 v[140:143], v7 offset:39936
  s_add_u32 m0, s40, 49152
  v_mfma_f32_16x16x32_bf16 v[24:27], v[104:107], v[80:83], v[24:27]
  buffer_load_dwordx4 v1, s[20:23], s36 offen offset:0 lds
  v_mfma_f32_16x16x32_bf16 v[40:43], v[104:107], v[84:87], v[40:43]
  v_mfma_f32_16x16x32_bf16 v[56:59], v[104:107], v[88:91], v[56:59]
  buffer_load_dwordx4 v1, s[20:23], s36 offen offset:1024 lds
  v_mfma_f32_16x16x32_bf16 v[72:75], v[104:107], v[92:95], v[72:75]
  v_mfma_f32_16x16x32_bf16 v[28:31], v[108:111], v[80:83], v[28:31]
  buffer_load_dwordx4 v1, s[20:23], s36 offen offset:2048 lds
  v_mfma_f32_16x16x32_bf16 v[44:47], v[108:111], v[84:87], v[44:47]
  v_mfma_f32_16x16x32_bf16 v[60:63], v[108:111], v[88:91], v[60:63]
  buffer_load_dwordx4 v1, s[20:23], s36 offen offset:3072 lds
  s_add_u32 s36, s36, 8192
  v_mfma_f32_16x16x32_bf16 v[76:79], v[108:111], v[92:95], v[76:79]
  s_waitcnt vmcnt(9) lgkmcnt(0)
  v_mfma_f32_16x16x32_bf16 v[16:19], v[128:131], v[112:115], v[16:19]
  s_barrier
  v_mfma_f32_16x16x32_bf16 v[32:35], v[128:131], v[116:119], v[32:35]
  ds_read_b128 v[80:83], v4 offset:0
  v_mfma_f32_16x16x32_bf16 v[48:51], v[128:131], v[120:123], v[48:51]
  ds_read_b128 v[84:87], v4 offset:1024
  v_mfma_f32_16x16x32_bf16 v[64:67], v[128:131], v[124:127], v[64:67]
  ds_read_b128 v[88:91], v4 offset:4096
  v_mfma_f32_16x16x32_bf16 v[20:23], v[132:135], v[112:115], v[20:23]
  ds_read_b128 v[92:95], v4 offset:5120
  v_mfma_f32_16x16x32_bf16 v[36:39], v[132:135], v[116:119], v[36:39]
  ds_read_b128 v[96:99], v6 offset:0
  v_mfma_f32_16x16x32_bf16 v[52:55], v[132:135], v[120:123], v[52:55]
  ds_read_b128 v[100:103], v6 offset:1024
  v_mfma_f32_16x16x32_bf16 v[68:71], v[132:135], v[124:127], v[68:71]
  ds_read_b128 v[104:107], v6 offset:2048
  v_mfma_f32_16x16x32_bf16 v[24:27], v[136:139], v[112:115], v[24:27]
  ds_read_b128 v[108:111], v6 offset:3072
  s_add_u32 m0, s40, 65536
  v_mfma_f32_16x16x32_bf16 v[40:43], v[136:139], v[116:119], v[40:43]
  buffer_load_dwordx4 v1, s[20:23], s35 offen offset:0  lds
  v_mfma_f32_16x16x32_bf16 v[56:59], v[136:139], v[120:123], v[56:59]
  v_mfma_f32_16x16x32_bf16 v[72:75], v[136:139], v[124:127], v[72:75]
  buffer_load_dwordx4 v1, s[20:23], s35 offen offset:1024  lds
  v_mfma_f32_16x16x32_bf16 v[28:31], v[140:143], v[112:115], v[28:31]
  buffer_load_dwordx4 v1, s[20:23], s35 offen offset:2048  lds
  v_mfma_f32_16x16x32_bf16 v[44:47], v[140:143], v[116:119], v[44:47]
  v_mfma_f32_16x16x32_bf16 v[60:63], v[140:143], v[120:123], v[60:63]
  buffer_load_dwordx4 v1, s[20:23], s35 offen offset:3072  lds
  s_add_u32 s35, s35, 4096
  v_mfma_f32_16x16x32_bf16 v[76:79], v[140:143], v[124:127], v[76:79]
  s_waitcnt lgkmcnt(0)
  v_mfma_f32_16x16x32_bf16 v[16:19], v[96:99], v[80:83], v[16:19]
  ds_read_b128 v[112:115], v4 offset:2048
  v_mfma_f32_16x16x32_bf16 v[32:35], v[96:99], v[84:87], v[32:35]
  ds_read_b128 v[116:119], v4 offset:3072
  v_mfma_f32_16x16x32_bf16 v[48:51], v[96:99], v[88:91], v[48:51]
  ds_read_b128 v[120:123], v4 offset:6144
  v_mfma_f32_16x16x32_bf16 v[64:67], v[96:99], v[92:95], v[64:67]
  ds_read_b128 v[124:127], v4 offset:7168
  v_mfma_f32_16x16x32_bf16 v[20:23], v[100:103], v[80:83], v[20:23]
  ds_read_b128 v[128:131], v6 offset:4096
  v_mfma_f32_16x16x32_bf16 v[36:39], v[100:103], v[84:87], v[36:39]
  ds_read_b128 v[132:135], v6 offset:5120
  v_mfma_f32_16x16x32_bf16 v[52:55], v[100:103], v[88:91], v[52:55]
  ds_read_b128 v[136:139], v6 offset:6144
  v_mfma_f32_16x16x32_bf16 v[68:71], v[100:103], v[92:95], v[68:71]
  ds_read_b128 v[140:143], v6 offset:7168
  s_add_u32 m0, s40, 81920
  v_mfma_f32_16x16x32_bf16 v[24:27], v[104:107], v[80:83], v[24:27]
  buffer_load_dwordx4 v1, s[20:23], s36 offen offset:0 lds
  v_mfma_f32_16x16x32_bf16 v[40:43], v[104:107], v[84:87], v[40:43]
  v_mfma_f32_16x16x32_bf16 v[56:59], v[104:107], v[88:91], v[56:59]
  buffer_load_dwordx4 v1, s[20:23], s36 offen offset:1024 lds
  v_mfma_f32_16x16x32_bf16 v[72:75], v[104:107], v[92:95], v[72:75]
  v_mfma_f32_16x16x32_bf16 v[28:31], v[108:111], v[80:83], v[28:31]
  buffer_load_dwordx4 v1, s[20:23], s36 offen offset:2048 lds
  v_mfma_f32_16x16x32_bf16 v[44:47], v[108:111], v[84:87], v[44:47]
  v_mfma_f32_16x16x32_bf16 v[60:63], v[108:111], v[88:91], v[60:63]
  buffer_load_dwordx4 v1, s[20:23], s36 offen offset:3072 lds
  s_add_u32 s36, s36, 8192
  v_mfma_f32_16x16x32_bf16 v[76:79], v[108:111], v[92:95], v[76:79]
  s_waitcnt vmcnt(8) lgkmcnt(0)
  v_mfma_f32_16x16x32_bf16 v[16:19], v[128:131], v[112:115], v[16:19]
  s_barrier
  v_mfma_f32_16x16x32_bf16 v[32:35], v[128:131], v[116:119], v[32:35]
  ds_read_b128 v[80:83], v4 offset:32768
  v_mfma_f32_16x16x32_bf16 v[48:51], v[128:131], v[120:123], v[48:51]
  ds_read_b128 v[84:87], v4 offset:33792
  v_mfma_f32_16x16x32_bf16 v[64:67], v[128:131], v[124:127], v[64:67]
  ds_read_b128 v[88:91], v4 offset:36864
  v_mfma_f32_16x16x32_bf16 v[20:23], v[132:135], v[112:115], v[20:23]
  ds_read_b128 v[92:95], v4 offset:37888
  v_mfma_f32_16x16x32_bf16 v[36:39], v[132:135], v[116:119], v[36:39]
  ds_read_b128 v[96:99], v6 offset:32768
  v_mfma_f32_16x16x32_bf16 v[52:55], v[132:135], v[120:123], v[52:55]
  ds_read_b128 v[100:103], v6 offset:33792
  v_mfma_f32_16x16x32_bf16 v[68:71], v[132:135], v[124:127], v[68:71]
  ds_read_b128 v[104:107], v6 offset:34816
  v_mfma_f32_16x16x32_bf16 v[24:27], v[136:139], v[112:115], v[24:27]
  ds_read_b128 v[108:111], v6 offset:35840
  s_add_u32 m0, s40, 98304
  v_mfma_f32_16x16x32_bf16 v[40:43], v[136:139], v[116:119], v[40:43]
  buffer_load_dwordx4 v1, s[20:23], s35 offen offset:0  lds
  v_mfma_f32_16x16x32_bf16 v[56:59], v[136:139], v[120:123], v[56:59]
  v_mfma_f32_16x16x32_bf16 v[72:75], v[136:139], v[124:127], v[72:75]
  buffer_load_dwordx4 v1, s[20:23], s35 offen offset:1024  lds
  v_mfma_f32_16x16x32_bf16 v[28:31], v[140:143], v[112:115], v[28:31]
  buffer_load_dwordx4 v1, s[20:23], s35 offen offset:2048  lds
  v_mfma_f32_16x16x32_bf16 v[44:47], v[140:143], v[116:119], v[44:47]
  v_mfma_f32_16x16x32_bf16 v[60:63], v[140:143], v[120:123], v[60:63]
  buffer_load_dwordx4 v1, s[20:23], s35 offen offset:3072  lds
  s_add_u32 s35, s35, 4096
  v_mfma_f32_16x16x32_bf16 v[76:79], v[140:143], v[124:127], v[76:79]
  s_waitcnt lgkmcnt(0)
  v_mfma_f32_16x16x32_bf16 v[16:19], v[96:99], v[80:83], v[16:19]
  ds_read_b128 v[112:115], v4 offset:34816
  v_mfma_f32_16x16x32_bf16 v[32:35], v[96:99], v[84:87], v[32:35]
  ds_read_b128 v[116:119], v4 offset:35840
  v_mfma_f32_16x16x32_bf16 v[48:51], v[96:99], v[88:91], v[48:51]
  ds_read_b128 v[120:123], v4 offset:38912
  v_mfma_f32_16x16x32_bf16 v[64:67], v[96:99], v[92:95], v[64:67]
  ds_read_b128 v[124:127], v4 offset:39936
  v_mfma_f32_16x16x32_bf16 v[20:23], v[100:103], v[80:83], v[20:23]
  ds_read_b128 v[128:131], v6 offset:36864
  s_nop 0
  v_cmp_ne_u32 vcc, v186, v185
  v_mfma_f32_16x16x32_bf16 v[36:39], v[100:103], v[84:87], v[36:39]
  ds_read_b128 v[132:135], v6 offset:37888
  s_cbranch_vccnz KC_LSPIN
KC_LSPIN_RET:
  v_mfma_f32_16x16x32_bf16 v[52:55], v[100:103], v[88:91], v[52:55]
  ds_read_b128 v[136:139], v6 offset:38912
  v_mfma_f32_16x16x32_bf16 v[68:71], v[100:103], v[92:95], v[68:71]
  ds_read_b128 v[140:143], v6 offset:39936
  s_add_u32 m0, s40, 114688
  v_mfma_f32_16x16x32_bf16 v[24:27], v[104:107], v[80:83], v[24:27]
  buffer_load_dwordx4 v1, s[20:23], s36 offen offset:0 lds
  v_mfma_f32_16x16x32_bf16 v[40:43], v[104:107], v[84:87], v[40:43]
  v_mfma_f32_16x16x32_bf16 v[56:59], v[104:107], v[88:91], v[56:59]
  buffer_load_dwordx4 v1, s[20:23], s36 offen offset:1024 lds
  v_mfma_f32_16x16x32_bf16 v[72:75], v[104:107], v[92:95], v[72:75]
  v_mfma_f32_16x16x32_bf16 v[28:31], v[108:111], v[80:83], v[28:31]
  buffer_load_dwordx4 v1, s[20:23], s36 offen offset:2048 lds
  v_mfma_f32_16x16x32_bf16 v[44:47], v[108:111], v[84:87], v[44:47]
  v_mfma_f32_16x16x32_bf16 v[60:63], v[108:111], v[88:91], v[60:63]
  buffer_load_dwordx4 v1, s[20:23], s36 offen offset:3072 lds
  s_add_u32 s36, s36, 8192
  v_mfma_f32_16x16x32_bf16 v[76:79], v[108:111], v[92:95], v[76:79]
  s_waitcnt vmcnt(8) lgkmcnt(0)
  v_mfma_f32_16x16x32_bf16 v[16:19], v[128:131], v[112:115], v[16:19]
  s_barrier
  v_mfma_f32_16x16x32_bf16 v[32:35], v[128:131], v[116:119], v[32:35]
  ds_read_b128 v[80:83], v5 offset:0
  v_mfma_f32_16x16x32_bf16 v[48:51], v[128:131], v[120:123], v[48:51]
  ds_read_b128 v[84:87], v5 offset:1024
  v_mfma_f32_16x16x32_bf16 v[64:67], v[128:131], v[124:127], v[64:67]
  ds_read_b128 v[88:91], v5 offset:4096
  v_mfma_f32_16x16x32_bf16 v[20:23], v[132:135], v[112:115], v[20:23]
  ds_read_b128 v[92:95], v5 offset:5120
  v_mfma_f32_16x16x32_bf16 v[36:39], v[132:135], v[116:119], v[36:39]
  ds_read_b128 v[96:99], v7 offset:0
  v_mfma_f32_16x16x32_bf16 v[52:55], v[132:135], v[120:123], v[52:55]
  ds_read_b128 v[100:103], v7 offset:1024
  v_mfma_f32_16x16x32_bf16 v[68:71], v[132:135], v[124:127], v[68:71]
  ds_read_b128 v[104:107], v7 offset:2048
  v_mfma_f32_16x16x32_bf16 v[24:27], v[136:139], v[112:115], v[24:27]
  ds_read_b128 v[108:111], v7 offset:3072
  s_add_u32 s42, s42, 4096
  v_mfma_f32_16x16x32_bf16 v[40:43], v[136:139], v[116:119], v[40:43]
  buffer_load_dwordx4 a[192:195], v1, s[20:23], s42 offen offset:0
  v_mfma_f32_16x16x32_bf16 v[56:59], v[136:139], v[120:123], v[56:59]
  v_mfma_f32_16x16x32_bf16 v[72:75], v[136:139], v[124:127], v[72:75]
  v_mfma_f32_16x16x32_bf16 v[28:31], v[140:143], v[112:115], v[28:31]
  v_mfma_f32_16x16x32_bf16 v[44:47], v[140:143], v[116:119], v[44:47]
  v_mfma_f32_16x16x32_bf16 v[60:63], v[140:143], v[120:123], v[60:63]
  buffer_load_dwordx4 a[196:199], v1, s[20:23], s42 offen offset:1024
  v_mfma_f32_16x16x32_bf16 v[76:79], v[140:143], v[124:127], v[76:79]
  s_waitcnt lgkmcnt(0)
  v_mfma_f32_16x16x32_bf16 v[16:19], v[96:99], v[80:83], v[16:19]
  ds_read_b128 v[112:115], v5 offset:2048
  v_mfma_f32_16x16x32_bf16 v[32:35], v[96:99], v[84:87], v[32:35]
  ds_read_b128 v[116:119], v5 offset:3072
  v_mfma_f32_16x16x32_bf16 v[48:51], v[96:99], v[88:91], v[48:51]
  ds_read_b128 v[120:123], v5 offset:6144
  v_mfma_f32_16x16x32_bf16 v[64:67], v[96:99], v[92:95], v[64:67]
  ds_read_b128 v[124:127], v5 offset:7168
  v_mfma_f32_16x16x32_bf16 v[20:23], v[100:103], v[80:83], v[20:23]
  ds_read_b128 v[128:131], v7 offset:4096
  v_mfma_f32_16x16x32_bf16 v[36:39], v[100:103], v[84:87], v[36:39]
  ds_read_b128 v[132:135], v7 offset:5120
  v_mfma_f32_16x16x32_bf16 v[52:55], v[100:103], v[88:91], v[52:55]
  ds_read_b128 v[136:139], v7 offset:6144
  v_mfma_f32_16x16x32_bf16 v[68:71], v[100:103], v[92:95], v[68:71]
  ds_read_b128 v[140:143], v7 offset:7168
  s_add_u32 s42, s42, 4096
  v_mfma_f32_16x16x32_bf16 v[24:27], v[104:107], v[80:83], v[24:27]
  buffer_load_dwordx4 a[208:211], v1, s[20:23], s42 offen offset:0
  v_mfma_f32_16x16x32_bf16 v[40:43], v[104:107], v[84:87], v[40:43]
  v_mfma_f32_16x16x32_bf16 v[56:59], v[104:107], v[88:91], v[56:59]
  v_mfma_f32_16x16x32_bf16 v[72:75], v[104:107], v[92:95], v[72:75]
  v_mfma_f32_16x16x32_bf16 v[28:31], v[108:111], v[80:83], v[28:31]
  v_mfma_f32_16x16x32_bf16 v[44:47], v[108:111], v[84:87], v[44:47]
  buffer_load_dwordx4 a[212:215], v1, s[20:23], s42 offen offset:1024
  v_mfma_f32_16x16x32_bf16 v[60:63], v[108:111], v[88:91], v[60:63]
  v_mfma_f32_16x16x32_bf16 v[76:79], v[108:111], v[92:95], v[76:79]
  s_waitcnt vmcnt(4) lgkmcnt(0)
  v_mfma_f32_16x16x32_bf16 v[16:19], v[128:131], v[112:115], v[16:19]
  s_barrier
  v_mfma_f32_16x16x32_bf16 v[32:35], v[128:131], v[116:119], v[32:35]
  ds_read_b128 v[80:83], v5 offset:32768
  v_mfma_f32_16x16x32_bf16 v[48:51], v[128:131], v[120:123], v[48:51]
  ds_read_b128 v[84:87], v5 offset:33792
  v_mfma_f32_16x16x32_bf16 v[64:67], v[128:131], v[124:127], v[64:67]
  ds_read_b128 v[88:91], v5 offset:36864
  v_mfma_f32_16x16x32_bf16 v[20:23], v[132:135], v[112:115], v[20:23]
  ds_read_b128 v[92:95], v5 offset:37888
  v_mfma_f32_16x16x32_bf16 v[36:39], v[132:135], v[116:119], v[36:39]
  ds_read_b128 v[96:99], v7 offset:32768
  v_mfma_f32_16x16x32_bf16 v[52:55], v[132:135], v[120:123], v[52:55]
  ds_read_b128 v[100:103], v7 offset:33792
  v_mfma_f32_16x16x32_bf16 v[68:71], v[132:135], v[124:127], v[68:71]
  ds_read_b128 v[104:107], v7 offset:34816
  v_mfma_f32_16x16x32_bf16 v[24:27], v[136:139], v[112:115], v[24:27]
  ds_read_b128 v[108:111], v7 offset:35840
  s_add_u32 s42, s42, 4096
  v_mfma_f32_16x16x32_bf16 v[40:43], v[136:139], v[116:119], v[40:43]
  buffer_load_dwordx4 a[224:227], v1, s[20:23], s42 offen offset:0
  v_mfma_f32_16x16x32_bf16 v[56:59], v[136:139], v[120:123], v[56:59]
  v_mfma_f32_16x16x32_bf16 v[72:75], v[136:139], v[124:127], v[72:75]
  v_mfma_f32_16x16x32_bf16 v[28:31], v[140:143], v[112:115], v[28:31]
  v_mfma_f32_16x16x32_bf16 v[44:47], v[140:143], v[116:119], v[44:47]
  v_mfma_f32_16x16x32_bf16 v[60:63], v[140:143], v[120:123], v[60:63]
  buffer_load_dwordx4 a[228:231], v1, s[20:23], s42 offen offset:1024
  v_mfma_f32_16x16x32_bf16 v[76:79], v[140:143], v[124:127], v[76:79]
  s_waitcnt lgkmcnt(0)
  v_mfma_f32_16x16x32_bf16 v[16:19], v[96:99], v[80:83], v[16:19]
  ds_read_b128 v[112:115], v5 offset:34816
  v_mfma_f32_16x16x32_bf16 v[32:35], v[96:99], v[84:87], v[32:35]
  ds_read_b128 v[116:119], v5 offset:35840
  v_mfma_f32_16x16x32_bf16 v[48:51], v[96:99], v[88:91], v[48:51]
  ds_read_b128 v[120:123], v5 offset:38912
  v_mfma_f32_16x16x32_bf16 v[64:67], v[96:99], v[92:95], v[64:67]
  ds_read_b128 v[124:127], v5 offset:39936
  v_mfma_f32_16x16x32_bf16 v[20:23], v[100:103], v[80:83], v[20:23]
  ds_read_b128 v[128:131], v7 offset:36864
  v_mfma_f32_16x16x32_bf16 v[36:39], v[100:103], v[84:87], v[36:39]
  ds_read_b128 v[132:135], v7 offset:37888
  v_mfma_f32_16x16x32_bf16 v[52:55], v[100:103], v[88:91], v[52:55]
  ds_read_b128 v[136:139], v7 offset:38912
  v_mfma_f32_16x16x32_bf16 v[68:71], v[100:103], v[92:95], v[68:71]
  ds_read_b128 v[140:143], v7 offset:39936
  s_add_u32 s42, s42, 4096
  v_mfma_f32_16x16x32_bf16 v[24:27], v[104:107], v[80:83], v[24:27]
  buffer_load_dwordx4 a[240:243], v1, s[20:23], s42 offen offset:0
  v_mfma_f32_16x16x32_bf16 v[40:43], v[104:107], v[84:87], v[40:43]
  v_mfma_f32_16x16x32_bf16 v[56:59], v[104:107], v[88:91], v[56:59]
  v_mfma_f32_16x16x32_bf16 v[72:75], v[104:107], v[92:95], v[72:75]
  v_mfma_f32_16x16x32_bf16 v[28:31], v[108:111], v[80:83], v[28:31]
  v_mfma_f32_16x16x32_bf16 v[44:47], v[108:111], v[84:87], v[44:47]
  buffer_load_dwordx4 a[244:247], v1, s[20:23], s42 offen offset:1024
  v_mfma_f32_16x16x32_bf16 v[60:63], v[108:111], v[88:91], v[60:63]
  v_mfma_f32_16x16x32_bf16 v[76:79], v[108:111], v[92:95], v[76:79]
  s_waitcnt lgkmcnt(0)
  v_mfma_f32_16x16x32_bf16 v[16:19], v[128:131], v[112:115], v[16:19]
  v_mfma_f32_16x16x32_bf16 v[32:35], v[128:131], v[116:119], v[32:35]
  s_sub_u32 s42, s42, 61440
  v_mfma_f32_16x16x32_bf16 v[48:51], v[128:131], v[120:123], v[48:51]
  buffer_load_dwordx4 a[8:11], v1, s[20:23], s42 offen offset:2048
  v_mfma_f32_16x16x32_bf16 v[64:67], v[128:131], v[124:127], v[64:67]
  v_mfma_f32_16x16x32_bf16 v[20:23], v[132:135], v[112:115], v[20:23]
  v_mfma_f32_16x16x32_bf16 v[36:39], v[132:135], v[116:119], v[36:39]
  v_mfma_f32_16x16x32_bf16 v[52:55], v[132:135], v[120:123], v[52:55]
  v_mfma_f32_16x16x32_bf16 v[68:71], v[132:135], v[124:127], v[68:71]
  v_mfma_f32_16x16x32_bf16 v[24:27], v[136:139], v[112:115], v[24:27]
  v_mfma_f32_16x16x32_bf16 v[40:43], v[136:139], v[116:119], v[40:43]
  v_mfma_f32_16x16x32_bf16 v[56:59], v[136:139], v[120:123], v[56:59]
  v_mfma_f32_16x16x32_bf16 v[72:75], v[136:139], v[124:127], v[72:75]
  v_mfma_f32_16x16x32_bf16 v[28:31], v[140:143], v[112:115], v[28:31]
  v_mfma_f32_16x16x32_bf16 v[44:47], v[140:143], v[116:119], v[44:47]
  v_mfma_f32_16x16x32_bf16 v[60:63], v[140:143], v[120:123], v[60:63]
  v_mfma_f32_16x16x32_bf16 v[76:79], v[140:143], v[124:127], v[76:79]
  s_add_u32 s37, s43, 32768
  v_cvt_pk_bf16_f32 v16, v16, v17
  v_cvt_pk_bf16_f32 v17, v18, v19
  v_cvt_pk_bf16_f32 v18, v20, v21
  v_cvt_pk_bf16_f32 v19, v22, v23
  buffer_store_dwordx4 v[16:19], v1, s[20:23], s43 offen offset:0 sc1
  v_cvt_pk_bf16_f32 v32, v32, v33
  v_cvt_pk_bf16_f32 v33, v34, v35
  v_cvt_pk_bf16_f32 v34, v36, v37
  v_cvt_pk_bf16_f32 v35, v38, v39
  buffer_store_dwordx4 v[32:35], v1, s[20:23], s43 offen offset:1024 sc1
  v_cvt_pk_bf16_f32 v48, v48, v49
  v_cvt_pk_bf16_f32 v49, v50, v51
  v_cvt_pk_bf16_f32 v50, v52, v53
  v_cvt_pk_bf16_f32 v51, v54, v55
  buffer_store_dwordx4 v[48:51], v1, s[20:23], s37 offen offset:0 sc1
  v_cvt_pk_bf16_f32 v64, v64, v65
  v_cvt_pk_bf16_f32 v65, v66, v67
  v_cvt_pk_bf16_f32 v66, v68, v69
  v_cvt_pk_bf16_f32 v67, v70, v71
  buffer_store_dwordx4 v[64:67], v1, s[20:23], s37 offen offset:1024 sc1
  v_cvt_pk_bf16_f32 v24, v24, v25
  v_cvt_pk_bf16_f32 v25, v26, v27
  v_cvt_pk_bf16_f32 v26, v28, v29
  v_cvt_pk_bf16_f32 v27, v30, v31
  buffer_store_dwordx4 v[24:27], v1, s[20:23], s43 offen offset:2048 sc1
  v_cvt_pk_bf16_f32 v40, v40, v41
  v_cvt_pk_bf16_f32 v41, v42, v43
  v_cvt_pk_bf16_f32 v42, v44, v45
  v_cvt_pk_bf16_f32 v43, v46, v47
  buffer_store_dwordx4 v[40:43], v1, s[20:23], s43 offen offset:3072 sc1
  v_cvt_pk_bf16_f32 v56, v56, v57
  v_cvt_pk_bf16_f32 v57, v58, v59
  v_cvt_pk_bf16_f32 v58, v60, v61
  v_cvt_pk_bf16_f32 v59, v62, v63
  buffer_store_dwordx4 v[56:59], v1, s[20:23], s37 offen offset:2048 sc1
  v_cvt_pk_bf16_f32 v72, v72, v73
  v_cvt_pk_bf16_f32 v73, v74, v75
  v_cvt_pk_bf16_f32 v74, v76, v77
  v_cvt_pk_bf16_f32 v75, v78, v79
  buffer_store_dwordx4 v[72:75], v1, s[20:23], s37 offen offset:3072 sc1
  s_mul_i32 s36, s32, 229376
  s_mul_i32 s37, s30, 57344
  s_add_u32 s36, s36, s37
  s_add_u32 s36, s36, 73400320
  s_and_b32 s38, s30, 1
  s_lshl_b32 s38, s38, 11
  v_add_u32 v6, s38, v1
  v_xor_b32 v7, 0x800, v6
  s_lshl_b32 s60, s30, 14
  buffer_load_dwordx4 a[12:15], v1, s[20:23], s42 offen offset:3072
  s_add_u32 s42, s42, 4096
  buffer_load_dwordx4 a[24:27], v1, s[20:23], s42 offen offset:2048
  buffer_load_dwordx4 a[28:31], v1, s[20:23], s42 offen offset:3072
  s_add_u32 s42, s42, 4096
  buffer_load_dwordx4 a[40:43], v1, s[20:23], s42 offen offset:2048
  buffer_load_dwordx4 a[44:47], v1, s[20:23], s42 offen offset:3072
  s_add_u32 s42, s42, 4096
  buffer_load_dwordx4 a[56:59], v1, s[20:23], s42 offen offset:2048
  buffer_load_dwordx4 a[60:63], v1, s[20:23], s42 offen offset:3072
  s_add_u32 s42, s42, 4096
  buffer_load_dwordx4 a[72:75], v1, s[20:23], s42 offen offset:2048
  buffer_load_dwordx4 a[76:79], v1, s[20:23], s42 offen offset:3072
  s_add_u32 s42, s42, 4096
  buffer_load_dwordx4 a[88:91], v1, s[20:23], s42 offen offset:2048
  s_waitcnt vmcnt(10)
  s_barrier
  buffer_store_dword v10, v3, s[20:23], s61 offen sc1
  buffer_load_dwordx4 a[92:95], v1, s[20:23], s42 offen offset:3072
  s_add_u32 s42, s42, 4096
  buffer_load_dwordx4 a[104:107], v1, s[20:23], s42 offen offset:2048
  buffer_load_dwordx4 a[108:111], v1, s[20:23], s42 offen offset:3072
  s_add_u32 s42, s42, 4096
  buffer_load_dwordx4 a[120:123], v1, s[20:23], s42 offen offset:2048
  buffer_load_dwordx4 a[124:127], v1, s[20:23], s42 offen offset:3072
  s_add_u32 s42, s42, 4096
  buffer_load_dwordx4 a[136:139], v1, s[20:23], s42 offen offset:2048
  buffer_load_dwordx4 a[140:143], v1, s[20:23], s42 offen offset:3072
  s_add_u32 s42, s42, 4096
  buffer_load_dwordx4 a[152:155], v1, s[20:23], s42 offen offset:2048
  buffer_load_dwordx4 a[156:159], v1, s[20:23], s42 offen offset:3072
  s_add_u32 s42, s42, 4096
  buffer_load_dwordx4 a[168:171], v1, s[20:23], s42 offen offset:2048
  buffer_load_dwordx4 a[172:175], v1, s[20:23], s42 offen offset:3072
  s_add_u32 s42, s42, 4096
  buffer_load_dwordx4 a[184:187], v1, s[20:23], s42 offen offset:2048
  buffer_load_dwordx4 a[188:191], v1, s[20:23], s42 offen offset:3072
  s_add_u32 s42, s42, 4096
  buffer_load_dwordx4 a[200:203], v1, s[20:23], s42 offen offset:2048
  buffer_load_dwordx4 a[204:207], v1, s[20:23], s42 offen offset:3072
  s_add_u32 s42, s42, 4096
  buffer_load_dwordx4 a[216:219], v1, s[20:23], s42 offen offset:2048
  s_and_b32 s39, s41, 0xfffffbff
  buffer_load_dword v15, v14, s[20:23], s39 offen sc1
  buffer_load_dwordx4 a[220:223], v1, s[20:23], s42 offen offset:3072
  s_add_u32 s42, s42, 4096
  buffer_load_dwordx4 a[232:235], v1, s[20:23], s42 offen offset:2048
  buffer_load_dwordx4 a[236:239], v1, s[20:23], s42 offen offset:3072
  s_add_u32 s42, s42, 4096
  buffer_load_dwordx4 a[248:251], v1, s[20:23], s42 offen offset:2048
  s_waitcnt vmcnt(4)
  v_cmp_eq_u32 vcc, 23063, v15
  s_or_b32 s37, vcc_lo, s49
  s_cmp_eq_u32 s37, -1
  s_cbranch_scc0 KC_PA_SLOW
KC_PA_OK:
  s_barrier
  s_add_u32 s37, s48, 16777216
  buffer_load_dwordx4 v[80:83], v13, s[20:23], s37 offen sc1
  s_add_u32 s37, s48, 16781312
  buffer_load_dwordx4 v[84:87], v13, s[20:23], s37 offen sc1
  s_add_u32 s37, s48, 18874368
  buffer_load_dwordx4 v[88:91], v13, s[20:23], s37 offen sc1
  s_add_u32 s37, s48, 18878464
  buffer_load_dwordx4 v[92:95], v13, s[20:23], s37 offen sc1
  s_add_u32 s37, s48, 20971520
  buffer_load_dwordx4 v[96:99], v13, s[20:23], s37 offen sc1
  s_add_u32 s37, s48, 20975616
  buffer_load_dwordx4 v[100:103], v13, s[20:23], s37 offen sc1
  s_add_u32 s37, s48, 23068672
  buffer_load_dwordx4 v[104:107], v13, s[20:23], s37 offen sc1
  s_add_u32 s37, s48, 23072768
  buffer_load_dwordx4 v[108:111], v13, s[20:23], s37 offen sc1
  buffer_load_dwordx4 a[252:255], v1, s[20:23], s42 offen offset:3072
  s_add_u32 m0, s60, 0
  s_add_u32 s51, s36, 28672
  buffer_load_dwordx4 v1, s[20:23], s51 offen offset:0 lds
  buffer_load_dwordx4 v1, s[20:23], s51 offen offset:1024 lds
  buffer_load_dwordx4 v1, s[20:23], s51 offen offset:2048 lds
  buffer_load_dwordx4 v1, s[20:23], s51 offen offset:3072 lds
  s_add_u32 m0, s60, 4096
  s_add_u32 s51, s36, 36864
  buffer_load_dwordx4 v1, s[20:23], s51 offen offset:0 lds
  s_waitcnt vmcnt(12)
  v_lshlrev_b32 v16, 16, v80
  v_and_b32 v17, 0xffff0000, v80
  v_lshlrev_b32 v18, 16, v81
  v_and_b32 v19, 0xffff0000, v81
  v_lshlrev_b32 v20, 16, v82
  v_and_b32 v21, 0xffff0000, v82
  v_lshlrev_b32 v22, 16, v83
  v_and_b32 v23, 0xffff0000, v83
  v_lshlrev_b32 v24, 16, v84
  v_and_b32 v25, 0xffff0000, v84
  v_lshlrev_b32 v26, 16, v85
  v_and_b32 v27, 0xffff0000, v85
  v_lshlrev_b32 v28, 16, v86
  v_and_b32 v29, 0xffff0000, v86
  v_lshlrev_b32 v30, 16, v87
  v_and_b32 v31, 0xffff0000, v87
  s_waitcnt vmcnt(10)
  v_lshlrev_b32 v32, 16, v88
  v_and_b32 v33, 0xffff0000, v88
  v_lshlrev_b32 v34, 16, v89
  v_and_b32 v35, 0xffff0000, v89
  v_lshlrev_b32 v36, 16, v90
  v_and_b32 v37, 0xffff0000, v90
  v_lshlrev_b32 v38, 16, v91
  v_and_b32 v39, 0xffff0000, v91
  v_lshlrev_b32 v40, 16, v92
  v_and_b32 v41, 0xffff0000, v92
  v_lshlrev_b32 v42, 16, v93
  v_and_b32 v43, 0xffff0000, v93
  v_lshlrev_b32 v44, 16, v94
  v_and_b32 v45, 0xffff0000, v94
  v_lshlrev_b32 v46, 16, v95
  v_and_b32 v47, 0xffff0000, v95
  v_add_f32 v16, v16, v32
  v_add_f32 v17, v17, v33
  v_add_f32 v18, v18, v34
  v_add_f32 v19, v19, v35
  v_add_f32 v20, v20, v36
  v_add_f32 v21, v21, v37
  v_add_f32 v22, v22, v38
  v_add_f32 v23, v23, v39
  v_add_f32 v24, v24, v40
  v_add_f32 v25, v25, v41
  v_add_f32 v26, v26, v42
  v_add_f32 v27, v27, v43
  v_add_f32 v28, v28, v44
  v_add_f32 v29, v29, v45
  v_add_f32 v30, v30, v46
  v_add_f32 v31, v31, v47
  s_waitcnt vmcnt(8)
  v_lshlrev_b32 v32, 16, v96
  v_and_b32 v33, 0xffff0000, v96
  v_lshlrev_b32 v34, 16, v97
  v_and_b32 v35, 0xffff0000, v97
  v_lshlrev_b32 v36, 16, v98
  v_and_b32 v37, 0xffff0000, v98
  v_lshlrev_b32 v38, 16, v99
  v_and_b32 v39, 0xffff0000, v99
  v_lshlrev_b32 v40, 16, v100
  v_and_b32 v41, 0xffff0000, v100
  v_lshlrev_b32 v42, 16, v101
  v_and_b32 v43, 0xffff0000, v101
  v_lshlrev_b32 v44, 16, v102
  v_and_b32 v45, 0xffff0000, v102
  v_lshlrev_b32 v46, 16, v103
  v_and_b32 v47, 0xffff0000, v103
  v_add_f32 v16, v16, v32
  v_add_f32 v17, v17, v33
  v_add_f32 v18, v18, v34
  v_add_f32 v19, v19, v35
  v_add_f32 v20, v20, v36
  v_add_f32 v21, v21, v37
  v_add_f32 v22, v22, v38
  v_add_f32 v23, v23, v39
  v_add_f32 v24, v24, v40
  v_add_f32 v25, v25, v41
  v_add_f32 v26, v26, v42
  v_add_f32 v27, v27, v43
  v_add_f32 v28, v28, v44
  v_add_f32 v29, v29, v45
  v_add_f32 v30, v30, v46
  v_add_f32 v31, v31, v47
  s_waitcnt vmcnt(6)
  v_lshlrev_b32 v32, 16, v104
  v_and_b32 v33, 0xffff0000, v104
  v_lshlrev_b32 v34, 16, v105
  v_and_b32 v35, 0xffff0000, v105
  v_lshlrev_b32 v36, 16, v106
  v_and_b32 v37, 0xffff0000, v106
  v_lshlrev_b32 v38, 16, v107
  v_and_b32 v39, 0xffff0000, v107
  v_lshlrev_b32 v40, 16, v108
  v_and_b32 v41, 0xffff0000, v108
  v_lshlrev_b32 v42, 16, v109
  v_and_b32 v43, 0xffff0000, v109
  v_lshlrev_b32 v44, 16, v110
  v_and_b32 v45, 0xffff0000, v110
  v_lshlrev_b32 v46, 16, v111
  v_and_b32 v47, 0xffff0000, v111
  v_add_f32 v16, v16, v32
  v_add_f32 v17, v17, v33
  v_add_f32 v18, v18, v34
  v_add_f32 v19, v19, v35
  v_add_f32 v20, v20, v36
  v_add_f32 v21, v21, v37
  v_add_f32 v22, v22, v38
  v_add_f32 v23, v23, v39
  v_add_f32 v24, v24, v40
  v_add_f32 v25, v25, v41
  v_add_f32 v26, v26, v42
  v_add_f32 v27, v27, v43
  v_add_f32 v28, v28, v44
  v_add_f32 v29, v29, v45
  v_add_f32 v30, v30, v46
  v_add_f32 v31, v31, v47
  v_fmac_f32 v208, v16, v152
  v_fmac_f32 v209, v17, v153
  v_fmac_f32 v210, v18, v154
  v_fmac_f32 v211, v19, v155
  v_fmac_f32 v212, v20, v156
  v_fmac_f32 v213, v21, v157
  v_fmac_f32 v214, v22, v158
  v_fmac_f32 v215, v23, v159
  v_fmac_f32 v216, v24, v160
  v_fmac_f32 v217, v25, v161
  v_fmac_f32 v218, v26, v162
  v_fmac_f32 v219, v27, v163
  buffer_load_dwordx4 v1, s[20:23], s51 offen offset:1024 lds
  v_fmac_f32 v220, v28, v164
  v_fmac_f32 v221, v29, v165
  v_fmac_f32 v222, v30, v166
  v_fmac_f32 v223, v31, v167
  v_cvt_pk_bf16_f32 v32, v208, v209
  v_cvt_pk_bf16_f32 v33, v210, v211
  v_cvt_pk_bf16_f32 v34, v212, v213
  v_cvt_pk_bf16_f32 v35, v214, v215
  v_cvt_pk_bf16_f32 v36, v216, v217
  v_cvt_pk_bf16_f32 v37, v218, v219
  v_cvt_pk_bf16_f32 v38, v220, v221
  v_cvt_pk_bf16_f32 v39, v222, v223
  buffer_load_dwordx4 v1, s[20:23], s51 offen offset:2048 lds
  v_lshlrev_b32 v208, 16, v32
  v_and_b32 v209, 0xffff0000, v32
  v_lshlrev_b32 v210, 16, v33
  v_and_b32 v211, 0xffff0000, v33
  v_lshlrev_b32 v212, 16, v34
  v_and_b32 v213, 0xffff0000, v34
  v_lshlrev_b32 v214, 16, v35
  v_and_b32 v215, 0xffff0000, v35
  v_lshlrev_b32 v216, 16, v36
  v_and_b32 v217, 0xffff0000, v36
  v_lshlrev_b32 v218, 16, v37
  v_and_b32 v219, 0xffff0000, v37
  buffer_load_dwordx4 v1, s[20:23], s51 offen offset:3072 lds
  v_lshlrev_b32 v220, 16, v38
  v_and_b32 v221, 0xffff0000, v38
  v_lshlrev_b32 v222, 16, v39
  v_and_b32 v223, 0xffff0000, v39
  v_add_f32 v48, v208, v209
  v_add_f32 v48, v48, v210
  v_add_f32 v48, v48, v211
  v_add_f32 v48, v48, v212
  v_add_f32 v48, v48, v213
  v_add_f32 v48, v48, v214
  v_add_f32 v48, v48, v215
  v_add_f32 v48, v48, v216
  s_add_u32 m0, s60, 8192
  s_add_u32 s51, s36, 45056
  buffer_load_dwordx4 v1, s[20:23], s51 offen offset:0 lds
  v_add_f32 v48, v48, v217
  v_add_f32 v48, v48, v218
  v_add_f32 v48, v48, v219
  v_add_f32 v48, v48, v220
  v_add_f32 v48, v48, v221
  v_add_f32 v48, v48, v222
  v_add_f32 v48, v48, v223
  s_nop 1
  v_add_f32_dpp v48, v48, v48 row_ror:8 row_mask:0xf bank_mask:0xf
  v_mov_b32 v50, v48
  s_nop 1
  v_permlane16_swap_b32 v48, v50
  s_nop 0
  v_add_f32 v48, v48, v50
  v_mov_b32 v50, v48
  s_nop 1
  v_permlane32_swap_b32 v48, v50
  s_nop 0
  v_add_f32 v48, v48, v50
  v_mul_f32 v48, 0x3c000000, v48
  buffer_load_dwordx4 v1, s[20:23], s51 offen offset:1024 lds
  v_sub_f32 v208, v208, v48
  v_sub_f32 v209, v209, v48
  v_sub_f32 v210, v210, v48
  v_sub_f32 v211, v211, v48
  v_sub_f32 v212, v212, v48
  v_sub_f32 v213, v213, v48
  v_sub_f32 v214, v214, v48
  v_sub_f32 v215, v215, v48
  v_sub_f32 v216, v216, v48
  v_sub_f32 v217, v217, v48
  v_sub_f32 v218, v218, v48
  v_sub_f32 v219, v219, v48
  buffer_load_dwordx4 v1, s[20:23], s51 offen offset:2048 lds
  v_sub_f32 v220, v220, v48
  v_sub_f32 v221, v221, v48
  v_sub_f32 v222, v222, v48
  v_sub_f32 v223, v223, v48
  v_mul_f32 v49, v208, v208
  v_fmac_f32 v49, v209, v209
  v_fmac_f32 v49, v210, v210
  v_fmac_f32 v49, v211, v211
  v_fmac_f32 v49, v212, v212
  v_fmac_f32 v49, v213, v213
  v_fmac_f32 v49, v214, v214
  v_fmac_f32 v49, v215, v215
  buffer_load_dwordx4 v1, s[20:23], s51 offen offset:3072 lds
  v_fmac_f32 v49, v216, v216
  v_fmac_f32 v49, v217, v217
  v_fmac_f32 v49, v218, v218
  v_fmac_f32 v49, v219, v219
  v_fmac_f32 v49, v220, v220
  v_fmac_f32 v49, v221, v221
  v_fmac_f32 v49, v222, v222
  v_fmac_f32 v49, v223, v223
  s_nop 1
  v_add_f32_dpp v49, v49, v49 row_ror:8 row_mask:0xf bank_mask:0xf
  v_mov_b32 v50, v49
  s_nop 1
  v_permlane16_swap_b32 v49, v50
  s_nop 0
  v_add_f32 v49, v49, v50
  v_mov_b32 v50, v49
  s_nop 1
  v_permlane32_swap_b32 v49, v50
  s_nop 0
  v_add_f32 v49, v49, v50
  s_add_u32 m0, s60, 12288
  s_add_u32 s51, s36, 53248
  buffer_load_dwordx4 v1, s[20:23], s51 offen offset:0 lds
  ds_write_b64 v188, v[48:49]
  s_add_u32 s37, s48, 44040192
  s_add_u32 s38, s37, 4096
  s_waitcnt lgkmcnt(0)
  s_barrier
  ds_read_b128 v[56:59], v187
  ds_read_b128 v[60:63], v187 offset:16
  buffer_store_dwordx4 v[32:35], v13, s[52:55], s37 offen
  buffer_store_dwordx4 v[32:35], v13, s[56:59], s37 offen sc1
  buffer_store_dwordx4 v[36:39], v13, s[52:55], s38 offen
  buffer_store_dwordx4 v[36:39], v13, s[56:59], s38 offen sc1
  s_mov_b32 s39, 0x43000000
  s_waitcnt lgkmcnt(0)
  v_add_f32 v50, v56, v58
  v_add_f32 v49, v60, v62
  v_add_f32 v50, v50, v49
  v_mul_f32 v50, 0x3e800000, v50
  v_sub_f32 v56, v56, v50
  v_sub_f32 v58, v58, v50
  v_sub_f32 v60, v60, v50
  v_sub_f32 v62, v62, v50
  v_mul_f32 v56, v56, v56
  v_fmac_f32 v56, v58, v58
  v_fmac_f32 v56, v60, v60
  v_fmac_f32 v56, v62, v62
  buffer_load_dwordx4 v1, s[20:23], s51 offen offset:1024 lds
  v_add_f32 v57, v57, v59
  v_add_f32 v61, v61, v63
  v_add_f32 v57, v57, v61
  v_fma_f32 v56, v56, s39, v57
  v_mov_b32 v49, 0x3727c5ac
  v_fmac_f32 v49, 0x3b000000, v56
  v_rsq_f32 v49, v49
  v_sub_f32 v48, v48, v50
  v_mul_f32 v49, s45, v49
  s_add_u32 s37, s48, 41943040
  v_mul_f32 v48, v48, v49
  s_add_u32 s38, s37, 4096
  v_fma_f32 v208, v208, v49, v48
  v_fma_f32 v209, v209, v49, v48
  buffer_load_dwordx4 v1, s[20:23], s51 offen offset:2048 lds
  v_fma_f32 v210, v210, v49, v48
  v_fma_f32 v211, v211, v49, v48
  v_fma_f32 v212, v212, v49, v48
  v_fma_f32 v213, v213, v49, v48
  v_fma_f32 v214, v214, v49, v48
  v_fma_f32 v215, v215, v49, v48
  v_fma_f32 v208, v208, v168, v192
  v_fma_f32 v209, v209, v169, v193
  v_fma_f32 v210, v210, v170, v194
  v_fma_f32 v211, v211, v171, v195
  v_fma_f32 v212, v212, v172, v196
  v_fma_f32 v213, v213, v173, v197
  v_fma_f32 v214, v214, v174, v198
  v_fma_f32 v215, v215, v175, v199
  v_cvt_pk_bf16_f32 v40, v208, v209
  v_cvt_pk_bf16_f32 v41, v210, v211
  v_cvt_pk_bf16_f32 v42, v212, v213
  v_cvt_pk_bf16_f32 v43, v214, v215
  buffer_store_dwordx4 v[40:43], v13, s[52:55], s37 offen
  buffer_store_dwordx4 v[40:43], v13, s[56:59], s37 offen sc1
  v_fma_f32 v216, v216, v49, v48
  v_fma_f32 v217, v217, v49, v48
  v_fma_f32 v218, v218, v49, v48
  v_fma_f32 v219, v219, v49, v48
  v_fma_f32 v220, v220, v49, v48
  v_fma_f32 v221, v221, v49, v48
  v_fma_f32 v222, v222, v49, v48
  v_fma_f32 v223, v223, v49, v48
  v_fma_f32 v216, v216, v176, v200
  v_fma_f32 v217, v217, v177, v201
  v_fma_f32 v218, v218, v178, v202
  v_fma_f32 v219, v219, v179, v203
  v_fma_f32 v220, v220, v180, v204
  v_fma_f32 v221, v221, v181, v205
  v_fma_f32 v222, v222, v182, v206
  v_fma_f32 v223, v223, v183, v207
  v_cvt_pk_bf16_f32 v44, v216, v217
  v_cvt_pk_bf16_f32 v45, v218, v219
  v_cvt_pk_bf16_f32 v46, v220, v221
  v_cvt_pk_bf16_f32 v47, v222, v223
  buffer_store_dwordx4 v[44:47], v13, s[52:55], s38 offen
  buffer_store_dwordx4 v[44:47], v13, s[56:59], s38 offen sc1
  buffer_load_dwordx4 v1, s[20:23], s51 offen offset:3072 lds
  s_add_u32 s44, s44, 32768
  v_and_b32 v14, 0x380, v14
  s_waitcnt vmcnt(1)
  s_barrier
  buffer_store_dword v10, v3, s[52:55], s44 offen
  buffer_store_dword v10, v3, s[56:59], s44 offen sc1
  s_cmp_eq_u32 s32, 7
  s_cbranch_scc1 KC_SKIP2
  s_cmp_lg_u32 s30, 0
  s_cbranch_scc1 KC_PB_OK
  s_mov_b32 s38, 100000
  s_add_u32 s39, s41, 32768
  s_branch KC_PB_S
KC_PB_L:
  buffer_load_dword v15, v14, s[20:23], s39 offen sc1
  s_waitcnt vmcnt(0)
  v_cmp_eq_u32 vcc, 23063, v15
  s_cmp_eq_u32 vcc_lo, -1
  s_cbranch_scc1 KC_PB_OK
KC_PB_S:
  s_sleep 4
  s_sub_u32 s38, s38, 1
  s_cmp_lg_u32 s38, 0
  s_cbranch_scc1 KC_PB_L
KC_PB_OK:
  s_waitcnt vmcnt(0)
  s_barrier
  s_lshl_b32 s37, s31, 16
  s_add_u32 s37, s37, s40
  s_add_u32 s37, s37, 41943040
  s_add_u32 m0, s40, 65536
  s_add_u32 s39, s37, 0
  buffer_load_dwordx4 v1, s[20:23], s39 offen offset:0 sc1 lds
  buffer_load_dwordx4 v1, s[20:23], s39 offen offset:1024 sc1 lds
  buffer_load_dwordx4 v1, s[20:23], s39 offen offset:2048 sc1 lds
  buffer_load_dwordx4 v1, s[20:23], s39 offen offset:3072 sc1 lds
  s_add_u32 m0, s40, 81920
  s_add_u32 s39, s37, 16384
  buffer_load_dwordx4 v1, s[20:23], s39 offen offset:0 sc1 lds
  buffer_load_dwordx4 v1, s[20:23], s39 offen offset:1024 sc1 lds
  buffer_load_dwordx4 v1, s[20:23], s39 offen offset:2048 sc1 lds
  buffer_load_dwordx4 v1, s[20:23], s39 offen offset:3072 sc1 lds
  s_add_u32 m0, s40, 98304
  s_add_u32 s39, s37, 32768
  buffer_load_dwordx4 v1, s[20:23], s39 offen offset:0 sc1 lds
  buffer_load_dwordx4 v1, s[20:23], s39 offen offset:1024 sc1 lds
  buffer_load_dwordx4 v1, s[20:23], s39 offen offset:2048 sc1 lds
  buffer_load_dwordx4 v1, s[20:23], s39 offen offset:3072 sc1 lds
  s_add_u32 m0, s40, 114688
  s_add_u32 s39, s37, 49152
  buffer_load_dwordx4 v1, s[20:23], s39 offen offset:0 sc1 lds
  buffer_load_dwordx4 v1, s[20:23], s39 offen offset:1024 sc1 lds
  buffer_load_dwordx4 v1, s[20:23], s39 offen offset:2048 sc1 lds
  buffer_load_dwordx4 v1, s[20:23], s39 offen offset:3072 sc1 lds
  v_add_u32 v12, 0x10000, v1
  s_mul_i32 s43, s31, 229376
  s_lshl_b32 s35, s32, 14
  s_add_u32 s43, s43, s35
  s_add_u32 s43, s43, s40
  s_add_u32 s43, s43, 33554432
  s_add_u32 s35, s43, 114688
  s_waitcnt vmcnt(12)
  s_barrier
  ds_read_b128 v[80:83], v12 offset:0
  ds_read_b128 v[84:87], v12 offset:1024
  ds_read_b128 v[88:91], v12 offset:2048
  ds_read_b128 v[92:95], v12 offset:3072
  ds_read_b128 v[96:99], v12 offset:4096
  ds_read_b128 v[100:103], v12 offset:5120
  s_waitcnt lgkmcnt(4)
  v_mfma_f32_16x16x32_bf16 v[16:19], a[0:3], v[80:83], v[240:243]
  ds_read_b128 v[104:107], v12 offset:6144
  v_mfma_f32_16x16x32_bf16 v[20:23], a[4:7], v[80:83], v[244:247]
  v_mfma_f32_16x16x32_bf16 v[24:27], a[0:3], v[84:87], v[240:243]
  ds_read_b128 v[108:111], v12 offset:7168
  s_mul_i32 s37, s33, 114688
  s_mul_i32 s38, s30, 28672
  v_mfma_f32_16x16x32_bf16 v[28:31], a[4:7], v[84:87], v[244:247]
  s_waitcnt lgkmcnt(4)
  s_add_u32 s37, s37, s38
  v_add_u32 v4, s37, v1
  v_mfma_f32_16x16x32_bf16 v[16:19], a[16:19], v[88:91], v[16:19]
  ds_read_b128 v[80:83], v12 offset:8192
  s_xor_b32 s37, s33, 1
  s_add_u32 s51, s36, 0
  v_mfma_f32_16x16x32_bf16 v[20:23], a[20:23], v[88:91], v[20:23]
  buffer_load_dwordx4 v[144:147], v6, s[20:23], s51 offen offset:0
  s_mul_i32 s37, s37, 114688
  s_add_u32 s37, s37, s38
  v_mfma_f32_16x16x32_bf16 v[24:27], a[16:19], v[92:95], v[24:27]
  ds_read_b128 v[84:87], v12 offset:9216
  v_add_u32 v5, s37, v1
  v_lshrrev_b32 v15, 4, v2
  v_mfma_f32_16x16x32_bf16 v[28:31], a[20:23], v[92:95], v[28:31]
  s_waitcnt lgkmcnt(4)
  s_lshl_b32 s37, s34, 7
  v_lshlrev_b32 v8, 4, v15
  v_mfma_f32_16x16x32_bf16 v[16:19], a[32:35], v[96:99], v[16:19]
  ds_read_b128 v[88:91], v12 offset:10240
  v_add_u32 v8, s37, v8
  s_lshl_b32 s37, s33, 15
  v_mfma_f32_16x16x32_bf16 v[20:23], a[36:39], v[96:99], v[20:23]
  s_lshl_b32 s38, s34, 11
  s_add_u32 s38, s38, s37
  v_mfma_f32_16x16x32_bf16 v[24:27], a[32:35], v[100:103], v[24:27]
  ds_read_b128 v[92:95], v12 offset:11264
  s_add_u32 s48, s38, 44040192
  s_lshl_b32 s38, s34, 6
  v_mfma_f32_16x16x32_bf16 v[28:31], a[36:39], v[100:103], v[28:31]
  s_waitcnt lgkmcnt(4)
  s_add_u32 s38, s38, s37
  v_and_b32 v9, 15, v2
  v_mfma_f32_16x16x32_bf16 v[16:19], a[48:51], v[104:107], v[16:19]
  ds_read_b128 v[96:99], v12 offset:12288
  v_lshlrev_b32 v9, 10, v9
  v_and_b32 v15, 1, v15
  v_mfma_f32_16x16x32_bf16 v[20:23], a[52:55], v[104:107], v[20:23]
  buffer_load_dwordx4 v[148:151], v6, s[20:23], s51 offen offset:1024
  v_lshl_add_u32 v9, v15, 5, v9
  v_lshrrev_b32 v15, 5, v2
  v_mfma_f32_16x16x32_bf16 v[24:27], a[48:51], v[108:111], v[24:27]
  ds_read_b128 v[100:103], v12 offset:13312
  v_lshl_add_u32 v9, v15, 4, v9
  v_add_u32 v9, s38, v9
  v_mfma_f32_16x16x32_bf16 v[28:31], a[52:55], v[108:111], v[28:31]
  s_waitcnt lgkmcnt(4)
  s_mul_i32 s37, s30, 12288
  s_add_u32 s37, s37, 0x10000
  v_mfma_f32_16x16x32_bf16 v[16:19], a[64:67], v[80:83], v[16:19]
  ds_read_b128 v[104:107], v12 offset:14336
  v_add_u32 v11, s37, v1
  v_min_u32 v13, 0x300, v14
  v_mfma_f32_16x16x32_bf16 v[20:23], a[68:71], v[80:83], v[20:23]
  buffer_load_dwordx4 v[152:155], v7, s[20:23], s51 offen offset:0
  s_lshl_b32 s47, s31, 10
  s_add_u32 s47, s47, 360448
  v_mfma_f32_16x16x32_bf16 v[24:27], a[64:67], v[84:87], v[24:27]
  ds_read_b128 v[108:111], v12 offset:15360
  v_mfma_f32_16x16x32_bf16 v[28:31], a[68:71], v[84:87], v[28:31]
  s_waitcnt lgkmcnt(4)
  s_waitcnt vmcnt(11)
  v_mfma_f32_16x16x32_bf16 v[16:19], a[80:83], v[88:91], v[16:19]
  s_barrier
  ds_read_b128 v[80:83], v12 offset:16384
  v_mfma_f32_16x16x32_bf16 v[20:23], a[84:87], v[88:91], v[20:23]
  v_mfma_f32_16x16x32_bf16 v[24:27], a[80:83], v[92:95], v[24:27]
  ds_read_b128 v[84:87], v12 offset:17408
  v_mfma_f32_16x16x32_bf16 v[28:31], a[84:87], v[92:95], v[28:31]
  s_waitcnt lgkmcnt(4)
  v_mfma_f32_16x16x32_bf16 v[16:19], a[96:99], v[96:99], v[16:19]
  ds_read_b128 v[88:91], v12 offset:18432
  v_mfma_f32_16x16x32_bf16 v[20:23], a[100:103], v[96:99], v[20:23]
  buffer_load_dwordx4 v[156:159], v7, s[20:23], s51 offen offset:1024
  v_mfma_f32_16x16x32_bf16 v[24:27], a[96:99], v[100:103], v[24:27]
  ds_read_b128 v[92:95], v12 offset:19456
  v_mfma_f32_16x16x32_bf16 v[28:31], a[100:103], v[100:103], v[28:31]
  s_waitcnt lgkmcnt(4)
  v_mfma_f32_16x16x32_bf16 v[16:19], a[112:115], v[104:107], v[16:19]
  ds_read_b128 v[96:99], v12 offset:20480
  s_add_u32 s51, s36, 8192
  v_mfma_f32_16x16x32_bf16 v[20:23], a[116:119], v[104:107], v[20:23]
  buffer_load_dwordx4 v[160:163], v6, s[20:23], s51 offen offset:0
  v_mfma_f32_16x16x32_bf16 v[24:27], a[112:115], v[108:111], v[24:27]
  ds_read_b128 v[100:103], v12 offset:21504
  v_mfma_f32_16x16x32_bf16 v[28:31], a[116:119], v[108:111], v[28:31]
  s_waitcnt lgkmcnt(4)
  v_mfma_f32_16x16x32_bf16 v[16:19], a[128:131], v[80:83], v[16:19]
  ds_read_b128 v[104:107], v12 offset:22528
  v_mfma_f32_16x16x32_bf16 v[20:23], a[132:135], v[80:83], v[20:23]
  v_mfma_f32_16x16x32_bf16 v[24:27], a[128:131], v[84:87], v[24:27]
  ds_read_b128 v[108:111], v12 offset:23552
  v_mfma_f32_16x16x32_bf16 v[28:31], a[132:135], v[84:87], v[28:31]
  s_waitcnt lgkmcnt(4)
  v_mfma_f32_16x16x32_bf16 v[16:19], a[144:147], v[88:91], v[16:19]
  ds_read_b128 v[80:83], v12 offset:24576
  v_mfma_f32_16x16x32_bf16 v[20:23], a[148:151], v[88:91], v[20:23]
  buffer_load_dwordx4 v[164:167], v6, s[20:23], s51 offen offset:1024
  v_mfma_f32_16x16x32_bf16 v[24:27], a[144:147], v[92:95], v[24:27]
  ds_read_b128 v[84:87], v12 offset:25600
  v_mfma_f32_16x16x32_bf16 v[28:31], a[148:151], v[92:95], v[28:31]
  s_waitcnt lgkmcnt(4)
  v_mfma_f32_16x16x32_bf16 v[16:19], a[160:163], v[96:99], v[16:19]
  ds_read_b128 v[88:91], v12 offset:26624
  v_mfma_f32_16x16x32_bf16 v[20:23], a[164:167], v[96:99], v[20:23]
  buffer_load_dwordx4 v[168:171], v7, s[20:23], s51 offen offset:0
  v_mfma_f32_16x16x32_bf16 v[24:27], a[160:163], v[100:103], v[24:27]
  ds_read_b128 v[92:95], v12 offset:27648
  v_mfma_f32_16x16x32_bf16 v[28:31], a[164:167], v[100:103], v[28:31]
  s_waitcnt lgkmcnt(4)
  v_mfma_f32_16x16x32_bf16 v[16:19], a[176:179], v[104:107], v[16:19]
  ds_read_b128 v[96:99], v12 offset:28672
  v_mfma_f32_16x16x32_bf16 v[20:23], a[180:183], v[104:107], v[20:23]
  v_mfma_f32_16x16x32_bf16 v[24:27], a[176:179], v[108:111], v[24:27]
  ds_read_b128 v[100:103], v12 offset:29696
  v_mfma_f32_16x16x32_bf16 v[28:31], a[180:183], v[108:111], v[28:31]
  s_waitcnt lgkmcnt(4)
  v_mfma_f32_16x16x32_bf16 v[16:19], a[192:195], v[80:83], v[16:19]
  ds_read_b128 v[104:107], v12 offset:30720
  v_mfma_f32_16x16x32_bf16 v[20:23], a[196:199], v[80:83], v[20:23]
  buffer_load_dwordx4 v[172:175], v7, s[20:23], s51 offen offset:1024
  v_mfma_f32_16x16x32_bf16 v[24:27], a[192:195], v[84:87], v[24:27]
  ds_read_b128 v[108:111], v12 offset:31744
  v_mfma_f32_16x16x32_bf16 v[28:31], a[196:199], v[84:87], v[28:31]
  s_waitcnt lgkmcnt(4)
  s_waitcnt vmcnt(8)
  v_mfma_f32_16x16x32_bf16 v[16:19], a[208:211], v[88:91], v[16:19]
  s_barrier
  ds_read_b128 v[80:83], v12 offset:32768
  s_add_u32 s51, s36, 16384
  v_mfma_f32_16x16x32_bf16 v[20:23], a[212:215], v[88:91], v[20:23]
  buffer_load_dwordx4 v[176:179], v6, s[20:23], s51 offen offset:0
  v_mfma_f32_16x16x32_bf16 v[24:27], a[208:211], v[92:95], v[24:27]
  ds_read_b128 v[84:87], v12 offset:33792
  v_mfma_f32_16x16x32_bf16 v[28:31], a[212:215], v[92:95], v[28:31]
  s_waitcnt lgkmcnt(4)
  v_mfma_f32_16x16x32_bf16 v[16:19], a[224:227], v[96:99], v[16:19]
  ds_read_b128 v[88:91], v12 offset:34816
  v_mfma_f32_16x16x32_bf16 v[20:23], a[228:231], v[96:99], v[20:23]
  v_mfma_f32_16x16x32_bf16 v[24:27], a[224:227], v[100:103], v[24:27]
  ds_read_b128 v[92:95], v12 offset:35840
  v_mfma_f32_16x16x32_bf16 v[28:31], a[228:231], v[100:103], v[28:31]
  s_waitcnt lgkmcnt(4)
  v_mfma_f32_16x16x32_bf16 v[16:19], a[240:243], v[104:107], v[16:19]
  ds_read_b128 v[96:99], v12 offset:36864
  v_mfma_f32_16x16x32_bf16 v[20:23], a[244:247], v[104:107], v[20:23]
  buffer_load_dwordx4 v[180:183], v6, s[20:23], s51 offen offset:1024
  v_mfma_f32_16x16x32_bf16 v[24:27], a[240:243], v[108:111], v[24:27]
  ds_read_b128 v[100:103], v12 offset:37888
  v_mfma_f32_16x16x32_bf16 v[28:31], a[244:247], v[108:111], v[28:31]
  s_waitcnt lgkmcnt(4)
  v_mfma_f32_16x16x32_bf16 v[48:51], a[0:3], v[80:83], v[240:243]
  ds_read_b128 v[104:107], v12 offset:38912
  v_mfma_f32_16x16x32_bf16 v[52:55], a[4:7], v[80:83], v[244:247]
  buffer_load_dwordx4 v[184:187], v7, s[20:23], s51 offen offset:0
  v_mfma_f32_16x16x32_bf16 v[56:59], a[0:3], v[84:87], v[240:243]
  ds_read_b128 v[108:111], v12 offset:39936
  v_mfma_f32_16x16x32_bf16 v[60:63], a[4:7], v[84:87], v[244:247]
  s_waitcnt lgkmcnt(4)
  v_mfma_f32_16x16x32_bf16 v[48:51], a[16:19], v[88:91], v[48:51]
  ds_read_b128 v[80:83], v12 offset:40960
  v_mfma_f32_16x16x32_bf16 v[52:55], a[20:23], v[88:91], v[52:55]
  v_exp_f32 v112, v16
  v_mfma_f32_16x16x32_bf16 v[56:59], a[16:19], v[92:95], v[56:59]
  ds_read_b128 v[84:87], v12 offset:41984
  v_exp_f32 v113, v17
  v_mfma_f32_16x16x32_bf16 v[60:63], a[20:23], v[92:95], v[60:63]
  s_waitcnt lgkmcnt(4)
  v_exp_f32 v114, v18
  v_mfma_f32_16x16x32_bf16 v[48:51], a[32:35], v[96:99], v[48:51]
  ds_read_b128 v[88:91], v12 offset:43008
  v_exp_f32 v115, v19
  v_mfma_f32_16x16x32_bf16 v[52:55], a[36:39], v[96:99], v[52:55]
  buffer_load_dwordx4 v[188:191], v7, s[20:23], s51 offen offset:1024
  v_exp_f32 v116, v20
  v_mfma_f32_16x16x32_bf16 v[56:59], a[32:35], v[100:103], v[56:59]
  ds_read_b128 v[92:95], v12 offset:44032
  v_exp_f32 v117, v21
  v_mfma_f32_16x16x32_bf16 v[60:63], a[36:39], v[100:103], v[60:63]
  s_waitcnt lgkmcnt(4)
  v_exp_f32 v118, v22
  v_mfma_f32_16x16x32_bf16 v[48:51], a[48:51], v[104:107], v[48:51]
  ds_read_b128 v[96:99], v12 offset:45056
  v_exp_f32 v119, v23
  s_add_u32 s51, s36, 24576
  v_mfma_f32_16x16x32_bf16 v[52:55], a[52:55], v[104:107], v[52:55]
  buffer_load_dwordx4 v[192:195], v6, s[20:23], s51 offen offset:0
  v_fma_f32 v120, v112, 0.5, 1.0
  v_fma_f32 v121, v113, 0.5, 1.0
  v_fma_f32 v122, v114, 0.5, 1.0
  v_mfma_f32_16x16x32_bf16 v[56:59], a[48:51], v[108:111], v[56:59]
  ds_read_b128 v[100:103], v12 offset:46080
  v_fma_f32 v123, v115, 0.5, 1.0
  v_fma_f32 v124, v116, 0.5, 1.0
  v_fma_f32 v125, v117, 0.5, 1.0
  v_mfma_f32_16x16x32_bf16 v[60:63], a[52:55], v[108:111], v[60:63]
  s_waitcnt lgkmcnt(4)
  v_fma_f32 v126, v118, 0.5, 1.0
  v_fma_f32 v127, v119, 0.5, 1.0
  v_fma_f32 v112, v112, v120, 1.0
  v_mfma_f32_16x16x32_bf16 v[48:51], a[64:67], v[80:83], v[48:51]
  ds_read_b128 v[104:107], v12 offset:47104
  v_fma_f32 v113, v113, v121, 1.0
  v_fma_f32 v114, v114, v122, 1.0
  v_fma_f32 v115, v115, v123, 1.0
  v_mfma_f32_16x16x32_bf16 v[52:55], a[68:71], v[80:83], v[52:55]
  v_fma_f32 v116, v116, v124, 1.0
  v_fma_f32 v117, v117, v125, 1.0
  v_fma_f32 v118, v118, v126, 1.0
  v_mfma_f32_16x16x32_bf16 v[56:59], a[64:67], v[84:87], v[56:59]
  ds_read_b128 v[108:111], v12 offset:48128
  v_fma_f32 v119, v119, v127, 1.0
  v_rcp_f32 v112, v112
  v_mfma_f32_16x16x32_bf16 v[60:63], a[68:71], v[84:87], v[60:63]
  s_waitcnt lgkmcnt(4)
  v_rcp_f32 v113, v113
  v_mfma_f32_16x16x32_bf16 v[48:51], a[80:83], v[88:91], v[48:51]
  ds_read_b128 v[80:83], v12 offset:49152
  v_rcp_f32 v114, v114
  v_mfma_f32_16x16x32_bf16 v[52:55], a[84:87], v[88:91], v[52:55]
  buffer_load_dwordx4 v[196:199], v6, s[20:23], s51 offen offset:1024
  v_rcp_f32 v115, v115
  v_mfma_f32_16x16x32_bf16 v[56:59], a[80:83], v[92:95], v[56:59]
  ds_read_b128 v[84:87], v12 offset:50176
  v_rcp_f32 v116, v116
  v_mfma_f32_16x16x32_bf16 v[60:63], a[84:87], v[92:95], v[60:63]
  s_waitcnt lgkmcnt(4)
  v_rcp_f32 v117, v117
  v_mfma_f32_16x16x32_bf16 v[48:51], a[96:99], v[96:99], v[48:51]
  ds_read_b128 v[88:91], v12 offset:51200
  v_rcp_f32 v118, v118
  v_mfma_f32_16x16x32_bf16 v[52:55], a[100:103], v[96:99], v[52:55]
  buffer_load_dwordx4 v[200:203], v7, s[20:23], s51 offen offset:0
  v_rcp_f32 v119, v119
  v_fma_f32 v16, -v16, v112, v16
  v_mfma_f32_16x16x32_bf16 v[56:59], a[96:99], v[100:103], v[56:59]
  ds_read_b128 v[92:95], v12 offset:52224
  v_fma_f32 v17, -v17, v113, v17
  v_fma_f32 v18, -v18, v114, v18
  v_fma_f32 v19, -v19, v115, v19
  v_mfma_f32_16x16x32_bf16 v[60:63], a[100:103], v[100:103], v[60:63]
  s_waitcnt lgkmcnt(4)
  v_fma_f32 v20, -v20, v116, v20
  v_fma_f32 v21, -v21, v117, v21
  v_fma_f32 v22, -v22, v118, v22
  v_mfma_f32_16x16x32_bf16 v[48:51], a[112:115], v[104:107], v[48:51]
  ds_read_b128 v[96:99], v12 offset:53248
  v_fma_f32 v23, -v23, v119, v23
  v_cvt_pk_bf16_f32 v16, v16, v17
  v_cvt_pk_bf16_f32 v17, v18, v19
  v_mfma_f32_16x16x32_bf16 v[52:55], a[116:119], v[104:107], v[52:55]
  v_cvt_pk_bf16_f32 v18, v20, v21
  v_cvt_pk_bf16_f32 v19, v22, v23
  v_mfma_f32_16x16x32_bf16 v[56:59], a[112:115], v[108:111], v[56:59]
  ds_read_b128 v[100:103], v12 offset:54272
  buffer_store_dwordx4 v[16:19], v1, s[20:23], s43 offen offset:0 sc1
  v_mfma_f32_16x16x32_bf16 v[60:63], a[116:119], v[108:111], v[60:63]
  s_waitcnt lgkmcnt(4)
  v_exp_f32 v128, v24
  v_mfma_f32_16x16x32_bf16 v[48:51], a[128:131], v[80:83], v[48:51]
  ds_read_b128 v[104:107], v12 offset:55296
  v_exp_f32 v129, v25
  v_mfma_f32_16x16x32_bf16 v[52:55], a[132:135], v[80:83], v[52:55]
  buffer_load_dwordx4 v[204:207], v7, s[20:23], s51 offen offset:1024
  v_exp_f32 v130, v26
  v_mfma_f32_16x16x32_bf16 v[56:59], a[128:131], v[84:87], v[56:59]
  ds_read_b128 v[108:111], v12 offset:56320
  v_exp_f32 v131, v27
  v_mfma_f32_16x16x32_bf16 v[60:63], a[132:135], v[84:87], v[60:63]
  s_waitcnt lgkmcnt(4)
  v_exp_f32 v132, v28
  v_mfma_f32_16x16x32_bf16 v[48:51], a[144:147], v[88:91], v[48:51]
  ds_read_b128 v[80:83], v12 offset:57344
  v_exp_f32 v133, v29
  s_add_u32 s51, s36, 32768
  v_mfma_f32_16x16x32_bf16 v[52:55], a[148:151], v[88:91], v[52:55]
  buffer_load_dwordx4 v[208:211], v6, s[20:23], s51 offen offset:0
  v_exp_f32 v134, v30
  v_mfma_f32_16x16x32_bf16 v[56:59], a[144:147], v[92:95], v[56:59]
  ds_read_b128 v[84:87], v12 offset:58368
  v_exp_f32 v135, v31
  v_fma_f32 v136, v128, 0.5, 1.0
  v_mfma_f32_16x16x32_bf16 v[60:63], a[148:151], v[92:95], v[60:63]
  s_waitcnt lgkmcnt(4)
  v_fma_f32 v137, v129, 0.5, 1.0
  v_fma_f32 v138, v130, 0.5, 1.0
  v_fma_f32 v139, v131, 0.5, 1.0
  v_mfma_f32_16x16x32_bf16 v[48:51], a[160:163], v[96:99], v[48:51]
  ds_read_b128 v[88:91], v12 offset:59392
  v_fma_f32 v140, v132, 0.5, 1.0
  v_fma_f32 v141, v133, 0.5, 1.0
  v_fma_f32 v142, v134, 0.5, 1.0
  v_mfma_f32_16x16x32_bf16 v[52:55], a[164:167], v[96:99], v[52:55]
  v_fma_f32 v143, v135, 0.5, 1.0
  v_fma_f32 v128, v128, v136, 1.0
  v_fma_f32 v129, v129, v137, 1.0
  v_mfma_f32_16x16x32_bf16 v[56:59], a[160:163], v[100:103], v[56:59]
  ds_read_b128 v[92:95], v12 offset:60416
  v_fma_f32 v130, v130, v138, 1.0
  v_fma_f32 v131, v131, v139, 1.0
  v_fma_f32 v132, v132, v140, 1.0
  v_mfma_f32_16x16x32_bf16 v[60:63], a[164:167], v[100:103], v[60:63]
  s_waitcnt lgkmcnt(4)
  v_fma_f32 v133, v133, v141, 1.0
  v_fma_f32 v134, v134, v142, 1.0
  v_fma_f32 v135, v135, v143, 1.0
  v_mfma_f32_16x16x32_bf16 v[48:51], a[176:179], v[104:107], v[48:51]
  ds_read_b128 v[96:99], v12 offset:61440
  v_rcp_f32 v128, v128
  v_mfma_f32_16x16x32_bf16 v[52:55], a[180:183], v[104:107], v[52:55]
  buffer_load_dwordx4 v[212:215], v6, s[20:23], s51 offen offset:1024
  v_rcp_f32 v129, v129
  v_mfma_f32_16x16x32_bf16 v[56:59], a[176:179], v[108:111], v[56:59]
  ds_read_b128 v[100:103], v12 offset:62464
  v_rcp_f32 v130, v130
  v_mfma_f32_16x16x32_bf16 v[60:63], a[180:183], v[108:111], v[60:63]
  s_waitcnt lgkmcnt(4)
  v_rcp_f32 v131, v131
  v_mfma_f32_16x16x32_bf16 v[48:51], a[192:195], v[80:83], v[48:51]
  ds_read_b128 v[104:107], v12 offset:63488
  v_rcp_f32 v132, v132
  v_mfma_f32_16x16x32_bf16 v[52:55], a[196:199], v[80:83], v[52:55]
  buffer_load_dwordx4 v[216:219], v7, s[20:23], s51 offen offset:0
  v_rcp_f32 v133, v133
  v_mfma_f32_16x16x32_bf16 v[56:59], a[192:195], v[84:87], v[56:59]
  ds_read_b128 v[108:111], v12 offset:64512
  v_rcp_f32 v134, v134
  v_mfma_f32_16x16x32_bf16 v[60:63], a[196:199], v[84:87], v[60:63]
  s_waitcnt lgkmcnt(4)
  v_rcp_f32 v135, v135
  v_fma_f32 v24, -v24, v128, v24
  v_mfma_f32_16x16x32_bf16 v[48:51], a[208:211], v[88:91], v[48:51]
  ds_read_b128 v[80:83], v12 offset:0
  v_fma_f32 v25, -v25, v129, v25
  v_fma_f32 v26, -v26, v130, v26
  v_fma_f32 v27, -v27, v131, v27
  v_mfma_f32_16x16x32_bf16 v[52:55], a[212:215], v[88:91], v[52:55]
  v_fma_f32 v28, -v28, v132, v28
  v_fma_f32 v29, -v29, v133, v29
  v_fma_f32 v30, -v30, v134, v30
  v_mfma_f32_16x16x32_bf16 v[56:59], a[208:211], v[92:95], v[56:59]
  ds_read_b128 v[84:87], v12 offset:1024
  v_fma_f32 v31, -v31, v135, v31
  v_cvt_pk_bf16_f32 v24, v24, v25
  v_cvt_pk_bf16_f32 v25, v26, v27
  v_mfma_f32_16x16x32_bf16 v[60:63], a[212:215], v[92:95], v[60:63]
  s_waitcnt lgkmcnt(4)
  v_cvt_pk_bf16_f32 v26, v28, v29
  v_cvt_pk_bf16_f32 v27, v30, v31
  v_mfma_f32_16x16x32_bf16 v[48:51], a[224:227], v[96:99], v[48:51]
  ds_read_b128 v[88:91], v12 offset:2048
  buffer_store_dwordx4 v[24:27], v1, s[20:23], s43 offen offset:1024 sc1
  v_mfma_f32_16x16x32_bf16 v[52:55], a[228:231], v[96:99], v[52:55]
  buffer_load_dwordx4 v[220:223], v7, s[20:23], s51 offen offset:1024
  v_mfma_f32_16x16x32_bf16 v[56:59], a[224:227], v[100:103], v[56:59]
  ds_read_b128 v[92:95], v12 offset:3072
  v_mfma_f32_16x16x32_bf16 v[60:63], a[228:231], v[100:103], v[60:63]
  s_waitcnt lgkmcnt(4)
  v_mfma_f32_16x16x32_bf16 v[48:51], a[240:243], v[104:107], v[48:51]
  ds_read_b128 v[96:99], v12 offset:4096
  s_add_u32 s51, s36, 40960
  v_mfma_f32_16x16x32_bf16 v[52:55], a[244:247], v[104:107], v[52:55]
  buffer_load_dwordx4 a[0:3], v6, s[20:23], s51 offen offset:0
  v_mfma_f32_16x16x32_bf16 v[56:59], a[240:243], v[108:111], v[56:59]
  ds_read_b128 v[100:103], v12 offset:5120
  v_mfma_f32_16x16x32_bf16 v[60:63], a[244:247], v[108:111], v[60:63]
  s_waitcnt lgkmcnt(4)
  v_mfma_f32_16x16x32_bf16 v[32:35], a[8:11], v[80:83], v[248:251]
  ds_read_b128 v[104:107], v12 offset:6144
  v_mfma_f32_16x16x32_bf16 v[36:39], a[12:15], v[80:83], v[252:255]
  v_mfma_f32_16x16x32_bf16 v[40:43], a[8:11], v[84:87], v[248:251]
  ds_read_b128 v[108:111], v12 offset:7168
  v_mfma_f32_16x16x32_bf16 v[44:47], a[12:15], v[84:87], v[252:255]
  s_waitcnt lgkmcnt(4)
  v_mfma_f32_16x16x32_bf16 v[32:35], a[24:27], v[88:91], v[32:35]
  ds_read_b128 v[80:83], v12 offset:8192
  v_mfma_f32_16x16x32_bf16 v[36:39], a[28:31], v[88:91], v[36:39]
  buffer_load_dwordx4 a[4:7], v6, s[20:23], s51 offen offset:1024
  v_exp_f32 v112, v48
  v_mfma_f32_16x16x32_bf16 v[40:43], a[24:27], v[92:95], v[40:43]
  ds_read_b128 v[84:87], v12 offset:9216
  v_exp_f32 v113, v49
  v_mfma_f32_16x16x32_bf16 v[44:47], a[28:31], v[92:95], v[44:47]
  s_waitcnt lgkmcnt(4)
  v_exp_f32 v114, v50
  v_mfma_f32_16x16x32_bf16 v[32:35], a[40:43], v[96:99], v[32:35]
  ds_read_b128 v[88:91], v12 offset:10240
  v_exp_f32 v115, v51
  v_mfma_f32_16x16x32_bf16 v[36:39], a[44:47], v[96:99], v[36:39]
  buffer_load_dwordx4 a[16:19], v7, s[20:23], s51 offen offset:0
  v_exp_f32 v116, v52
  v_mfma_f32_16x16x32_bf16 v[40:43], a[40:43], v[100:103], v[40:43]
  ds_read_b128 v[92:95], v12 offset:11264
  v_exp_f32 v117, v53
  v_mfma_f32_16x16x32_bf16 v[44:47], a[44:47], v[100:103], v[44:47]
  s_waitcnt lgkmcnt(4)
  v_exp_f32 v118, v54
  v_mfma_f32_16x16x32_bf16 v[32:35], a[56:59], v[104:107], v[32:35]
  ds_read_b128 v[96:99], v12 offset:12288
  v_exp_f32 v119, v55
  v_fma_f32 v120, v112, 0.5, 1.0
  v_mfma_f32_16x16x32_bf16 v[36:39], a[60:63], v[104:107], v[36:39]
  v_fma_f32 v121, v113, 0.5, 1.0
  v_fma_f32 v122, v114, 0.5, 1.0
  v_fma_f32 v123, v115, 0.5, 1.0
  v_mfma_f32_16x16x32_bf16 v[40:43], a[56:59], v[108:111], v[40:43]
  ds_read_b128 v[100:103], v12 offset:13312
  v_fma_f32 v124, v116, 0.5, 1.0
  v_fma_f32 v125, v117, 0.5, 1.0
  v_fma_f32 v126, v118, 0.5, 1.0
  v_mfma_f32_16x16x32_bf16 v[44:47], a[60:63], v[108:111], v[44:47]
  s_waitcnt lgkmcnt(4)
  v_fma_f32 v127, v119, 0.5, 1.0
  v_fma_f32 v112, v112, v120, 1.0
  v_fma_f32 v113, v113, v121, 1.0
  v_mfma_f32_16x16x32_bf16 v[32:35], a[72:75], v[80:83], v[32:35]
  ds_read_b128 v[104:107], v12 offset:14336
  v_fma_f32 v114, v114, v122, 1.0
  v_fma_f32 v115, v115, v123, 1.0
  v_fma_f32 v116, v116, v124, 1.0
  v_mfma_f32_16x16x32_bf16 v[36:39], a[76:79], v[80:83], v[36:39]
  buffer_load_dwordx4 a[20:23], v7, s[20:23], s51 offen offset:1024
  v_fma_f32 v117, v117, v125, 1.0
  v_fma_f32 v118, v118, v126, 1.0
  v_fma_f32 v119, v119, v127, 1.0
  v_mfma_f32_16x16x32_bf16 v[40:43], a[72:75], v[84:87], v[40:43]
  ds_read_b128 v[108:111], v12 offset:15360
  v_rcp_f32 v112, v112
  v_mfma_f32_16x16x32_bf16 v[44:47], a[76:79], v[84:87], v[44:47]
  s_waitcnt lgkmcnt(4)
  v_rcp_f32 v113, v113
  v_mfma_f32_16x16x32_bf16 v[32:35], a[88:91], v[88:91], v[32:35]
  ds_read_b128 v[80:83], v12 offset:16384
  v_rcp_f32 v114, v114
  s_add_u32 s51, s36, 49152
  v_mfma_f32_16x16x32_bf16 v[36:39], a[92:95], v[88:91], v[36:39]
  buffer_load_dwordx4 a[32:35], v6, s[20:23], s51 offen offset:0
  v_rcp_f32 v115, v115
  v_mfma_f32_16x16x32_bf16 v[40:43], a[88:91], v[92:95], v[40:43]
  ds_read_b128 v[84:87], v12 offset:17408
  v_rcp_f32 v116, v116
  v_mfma_f32_16x16x32_bf16 v[44:47], a[92:95], v[92:95], v[44:47]
  s_waitcnt lgkmcnt(4)
  v_rcp_f32 v117, v117
  v_mfma_f32_16x16x32_bf16 v[32:35], a[104:107], v[96:99], v[32:35]
  ds_read_b128 v[88:91], v12 offset:18432
  v_rcp_f32 v118, v118
  v_mfma_f32_16x16x32_bf16 v[36:39], a[108:111], v[96:99], v[36:39]
  v_rcp_f32 v119, v119
  v_fma_f32 v48, -v48, v112, v48
  v_mfma_f32_16x16x32_bf16 v[40:43], a[104:107], v[100:103], v[40:43]
  ds_read_b128 v[92:95], v12 offset:19456
  v_fma_f32 v49, -v49, v113, v49
  v_fma_f32 v50, -v50, v114, v50
  v_fma_f32 v51, -v51, v115, v51
  v_mfma_f32_16x16x32_bf16 v[44:47], a[108:111], v[100:103], v[44:47]
  s_waitcnt lgkmcnt(4)
  v_fma_f32 v52, -v52, v116, v52
  v_fma_f32 v53, -v53, v117, v53
  v_fma_f32 v54, -v54, v118, v54
  v_mfma_f32_16x16x32_bf16 v[32:35], a[120:123], v[104:107], v[32:35]
  ds_read_b128 v[96:99], v12 offset:20480
  v_fma_f32 v55, -v55, v119, v55
  v_cvt_pk_bf16_f32 v48, v48, v49
  v_cvt_pk_bf16_f32 v49, v50, v51
  v_mfma_f32_16x16x32_bf16 v[36:39], a[124:127], v[104:107], v[36:39]
  buffer_load_dwordx4 a[36:39], v6, s[20:23], s51 offen offset:1024
  v_cvt_pk_bf16_f32 v50, v52, v53
  v_cvt_pk_bf16_f32 v51, v54, v55
  v_mfma_f32_16x16x32_bf16 v[40:43], a[120:123], v[108:111], v[40:43]
  ds_read_b128 v[100:103], v12 offset:21504
  buffer_store_dwordx4 v[48:51], v1, s[20:23], s35 offen offset:0 sc1
  v_mfma_f32_16x16x32_bf16 v[44:47], a[124:127], v[108:111], v[44:47]
  s_waitcnt lgkmcnt(4)
  v_exp_f32 v128, v56
  v_mfma_f32_16x16x32_bf16 v[32:35], a[136:139], v[80:83], v[32:35]
  ds_read_b128 v[104:107], v12 offset:22528
  v_exp_f32 v129, v57
  v_mfma_f32_16x16x32_bf16 v[36:39], a[140:143], v[80:83], v[36:39]
  buffer_load_dwordx4 a[48:51], v7, s[20:23], s51 offen offset:0
  v_exp_f32 v130, v58
  v_mfma_f32_16x16x32_bf16 v[40:43], a[136:139], v[84:87], v[40:43]
  ds_read_b128 v[108:111], v12 offset:23552
  v_exp_f32 v131, v59
  v_mfma_f32_16x16x32_bf16 v[44:47], a[140:143], v[84:87], v[44:47]
  s_waitcnt lgkmcnt(4)
  v_exp_f32 v132, v60
  v_mfma_f32_16x16x32_bf16 v[32:35], a[152:155], v[88:91], v[32:35]
  ds_read_b128 v[80:83], v12 offset:24576
  v_exp_f32 v133, v61
  v_mfma_f32_16x16x32_bf16 v[36:39], a[156:159], v[88:91], v[36:39]
  v_exp_f32 v134, v62
  v_mfma_f32_16x16x32_bf16 v[40:43], a[152:155], v[92:95], v[40:43]
  ds_read_b128 v[84:87], v12 offset:25600
  v_exp_f32 v135, v63
  v_fma_f32 v136, v128, 0.5, 1.0
  v_mfma_f32_16x16x32_bf16 v[44:47], a[156:159], v[92:95], v[44:47]
  s_waitcnt lgkmcnt(4)
  v_fma_f32 v137, v129, 0.5, 1.0
  v_fma_f32 v138, v130, 0.5, 1.0
  v_fma_f32 v139, v131, 0.5, 1.0
  v_mfma_f32_16x16x32_bf16 v[32:35], a[168:171], v[96:99], v[32:35]
  ds_read_b128 v[88:91], v12 offset:26624
  v_fma_f32 v140, v132, 0.5, 1.0
  v_fma_f32 v141, v133, 0.5, 1.0
  v_fma_f32 v142, v134, 0.5, 1.0
  v_mfma_f32_16x16x32_bf16 v[36:39], a[172:175], v[96:99], v[36:39]
  buffer_load_dwordx4 a[52:55], v7, s[20:23], s51 offen offset:1024
  v_fma_f32 v143, v135, 0.5, 1.0
  v_fma_f32 v128, v128, v136, 1.0
  v_fma_f32 v129, v129, v137, 1.0
  v_mfma_f32_16x16x32_bf16 v[40:43], a[168:171], v[100:103], v[40:43]
  ds_read_b128 v[92:95], v12 offset:27648
  v_fma_f32 v130, v130, v138, 1.0
  v_fma_f32 v131, v131, v139, 1.0
  v_fma_f32 v132, v132, v140, 1.0
  v_mfma_f32_16x16x32_bf16 v[44:47], a[172:175], v[100:103], v[44:47]
  s_waitcnt lgkmcnt(4)
  v_fma_f32 v133, v133, v141, 1.0
  v_fma_f32 v134, v134, v142, 1.0
  v_fma_f32 v135, v135, v143, 1.0
  v_mfma_f32_16x16x32_bf16 v[32:35], a[184:187], v[104:107], v[32:35]
  ds_read_b128 v[96:99], v12 offset:28672
  v_rcp_f32 v128, v128
  s_add_u32 s51, s36, 4096
  v_mfma_f32_16x16x32_bf16 v[36:39], a[188:191], v[104:107], v[36:39]
  buffer_load_dwordx4 a[64:67], v6, s[20:23], s51 offen offset:0
  v_rcp_f32 v129, v129
  v_mfma_f32_16x16x32_bf16 v[40:43], a[184:187], v[108:111], v[40:43]
  ds_read_b128 v[100:103], v12 offset:29696
  v_rcp_f32 v130, v130
  v_mfma_f32_16x16x32_bf16 v[44:47], a[188:191], v[108:111], v[44:47]
  s_waitcnt lgkmcnt(4)
  v_rcp_f32 v131, v131
  v_mfma_f32_16x16x32_bf16 v[32:35], a[200:203], v[80:83], v[32:35]
  ds_read_b128 v[104:107], v12 offset:30720
  v_rcp_f32 v132, v132
  v_mfma_f32_16x16x32_bf16 v[36:39], a[204:207], v[80:83], v[36:39]
  v_rcp_f32 v133, v133
  v_mfma_f32_16x16x32_bf16 v[40:43], a[200:203], v[84:87], v[40:43]
  ds_read_b128 v[108:111], v12 offset:31744
  v_rcp_f32 v134, v134
  v_mfma_f32_16x16x32_bf16 v[44:47], a[204:207], v[84:87], v[44:47]
  s_waitcnt lgkmcnt(4)
  v_rcp_f32 v135, v135
  v_fma_f32 v56, -v56, v128, v56
  v_mfma_f32_16x16x32_bf16 v[32:35], a[216:219], v[88:91], v[32:35]
  ds_read_b128 v[80:83], v12 offset:32768
  v_fma_f32 v57, -v57, v129, v57
  v_fma_f32 v58, -v58, v130, v58
  v_fma_f32 v59, -v59, v131, v59
  v_mfma_f32_16x16x32_bf16 v[36:39], a[220:223], v[88:91], v[36:39]
  buffer_load_dwordx4 a[68:71], v6, s[20:23], s51 offen offset:1024
  v_fma_f32 v60, -v60, v132, v60
  v_fma_f32 v61, -v61, v133, v61
  v_fma_f32 v62, -v62, v134, v62
  v_mfma_f32_16x16x32_bf16 v[40:43], a[216:219], v[92:95], v[40:43]
  ds_read_b128 v[84:87], v12 offset:33792
  v_fma_f32 v63, -v63, v135, v63
  v_cvt_pk_bf16_f32 v56, v56, v57
  v_cvt_pk_bf16_f32 v57, v58, v59
  v_mfma_f32_16x16x32_bf16 v[44:47], a[220:223], v[92:95], v[44:47]
  s_waitcnt lgkmcnt(4)
  v_cvt_pk_bf16_f32 v58, v60, v61
  v_cvt_pk_bf16_f32 v59, v62, v63
  v_mfma_f32_16x16x32_bf16 v[32:35], a[232:235], v[96:99], v[32:35]
  ds_read_b128 v[88:91], v12 offset:34816
  buffer_store_dwordx4 v[56:59], v1, s[20:23], s35 offen offset:1024 sc1
  v_mfma_f32_16x16x32_bf16 v[36:39], a[236:239], v[96:99], v[36:39]
  buffer_load_dwordx4 a[80:83], v7, s[20:23], s51 offen offset:0
  v_mfma_f32_16x16x32_bf16 v[40:43], a[232:235], v[100:103], v[40:43]
  ds_read_b128 v[92:95], v12 offset:35840
  v_mfma_f32_16x16x32_bf16 v[44:47], a[236:239], v[100:103], v[44:47]
  s_waitcnt lgkmcnt(4)
  v_mfma_f32_16x16x32_bf16 v[32:35], a[248:251], v[104:107], v[32:35]
  ds_read_b128 v[96:99], v12 offset:36864
  v_mfma_f32_16x16x32_bf16 v[36:39], a[252:255], v[104:107], v[36:39]
  v_mfma_f32_16x16x32_bf16 v[40:43], a[248:251], v[108:111], v[40:43]
  ds_read_b128 v[100:103], v12 offset:37888
  v_mfma_f32_16x16x32_bf16 v[44:47], a[252:255], v[108:111], v[44:47]
  s_waitcnt lgkmcnt(4)
  v_mfma_f32_16x16x32_bf16 v[64:67], a[8:11], v[80:83], v[248:251]
  ds_read_b128 v[104:107], v12 offset:38912
  v_mfma_f32_16x16x32_bf16 v[68:71], a[12:15], v[80:83], v[252:255]
  buffer_load_dwordx4 a[84:87], v7, s[20:23], s51 offen offset:1024
  v_mfma_f32_16x16x32_bf16 v[72:75], a[8:11], v[84:87], v[248:251]
  ds_read_b128 v[108:111], v12 offset:39936
  v_mfma_f32_16x16x32_bf16 v[76:79], a[12:15], v[84:87], v[252:255]
  s_waitcnt lgkmcnt(4)
  v_mfma_f32_16x16x32_bf16 v[64:67], a[24:27], v[88:91], v[64:67]
  ds_read_b128 v[80:83], v12 offset:40960
  s_add_u32 s51, s36, 12288
  v_mfma_f32_16x16x32_bf16 v[68:71], a[28:31], v[88:91], v[68:71]
  buffer_load_dwordx4 a[96:99], v6, s[20:23], s51 offen offset:0
  v_exp_f32 v112, v32
  v_mfma_f32_16x16x32_bf16 v[72:75], a[24:27], v[92:95], v[72:75]
  ds_read_b128 v[84:87], v12 offset:41984
  v_exp_f32 v113, v33
  v_mfma_f32_16x16x32_bf16 v[76:79], a[28:31], v[92:95], v[76:79]
  s_waitcnt lgkmcnt(4)
  v_exp_f32 v114, v34
  v_mfma_f32_16x16x32_bf16 v[64:67], a[40:43], v[96:99], v[64:67]
  ds_read_b128 v[88:91], v12 offset:43008
  v_exp_f32 v115, v35
  v_mfma_f32_16x16x32_bf16 v[68:71], a[44:47], v[96:99], v[68:71]
  v_exp_f32 v116, v36
  v_mfma_f32_16x16x32_bf16 v[72:75], a[40:43], v[100:103], v[72:75]
  ds_read_b128 v[92:95], v12 offset:44032
  v_exp_f32 v117, v37
  v_mfma_f32_16x16x32_bf16 v[76:79], a[44:47], v[100:103], v[76:79]
  s_waitcnt lgkmcnt(4)
  v_exp_f32 v118, v38
  v_mfma_f32_16x16x32_bf16 v[64:67], a[56:59], v[104:107], v[64:67]
  ds_read_b128 v[96:99], v12 offset:45056
  v_exp_f32 v119, v39
  v_fma_f32 v120, v112, 0.5, 1.0
  v_mfma_f32_16x16x32_bf16 v[68:71], a[60:63], v[104:107], v[68:71]
  buffer_load_dwordx4 a[100:103], v6, s[20:23], s51 offen offset:1024
  v_fma_f32 v121, v113, 0.5, 1.0
  v_fma_f32 v122, v114, 0.5, 1.0
  v_fma_f32 v123, v115, 0.5, 1.0
  v_mfma_f32_16x16x32_bf16 v[72:75], a[56:59], v[108:111], v[72:75]
  ds_read_b128 v[100:103], v12 offset:46080
  v_fma_f32 v124, v116, 0.5, 1.0
  v_fma_f32 v125, v117, 0.5, 1.0
  v_fma_f32 v126, v118, 0.5, 1.0
  v_mfma_f32_16x16x32_bf16 v[76:79], a[60:63], v[108:111], v[76:79]
  s_waitcnt lgkmcnt(4)
  v_fma_f32 v127, v119, 0.5, 1.0
  v_fma_f32 v112, v112, v120, 1.0
  v_fma_f32 v113, v113, v121, 1.0
  v_mfma_f32_16x16x32_bf16 v[64:67], a[72:75], v[80:83], v[64:67]
  ds_read_b128 v[104:107], v12 offset:47104
  v_fma_f32 v114, v114, v122, 1.0
  v_fma_f32 v115, v115, v123, 1.0
  v_fma_f32 v116, v116, v124, 1.0
  v_mfma_f32_16x16x32_bf16 v[68:71], a[76:79], v[80:83], v[68:71]
  buffer_load_dwordx4 a[112:115], v7, s[20:23], s51 offen offset:0
  v_fma_f32 v117, v117, v125, 1.0
  v_fma_f32 v118, v118, v126, 1.0
  v_fma_f32 v119, v119, v127, 1.0
  v_mfma_f32_16x16x32_bf16 v[72:75], a[72:75], v[84:87], v[72:75]
  ds_read_b128 v[108:111], v12 offset:48128
  v_rcp_f32 v112, v112
  v_mfma_f32_16x16x32_bf16 v[76:79], a[76:79], v[84:87], v[76:79]
  s_waitcnt lgkmcnt(4)
  v_rcp_f32 v113, v113
  v_mfma_f32_16x16x32_bf16 v[64:67], a[88:91], v[88:91], v[64:67]
  ds_read_b128 v[80:83], v12 offset:49152
  v_rcp_f32 v114, v114
  v_mfma_f32_16x16x32_bf16 v[68:71], a[92:95], v[88:91], v[68:71]
  v_rcp_f32 v115, v115
  v_mfma_f32_16x16x32_bf16 v[72:75], a[88:91], v[92:95], v[72:75]
  ds_read_b128 v[84:87], v12 offset:50176
  v_rcp_f32 v116, v116
  v_mfma_f32_16x16x32_bf16 v[76:79], a[92:95], v[92:95], v[76:79]
  s_waitcnt lgkmcnt(4)
  v_rcp_f32 v117, v117
  v_mfma_f32_16x16x32_bf16 v[64:67], a[104:107], v[96:99], v[64:67]
  ds_read_b128 v[88:91], v12 offset:51200
  v_rcp_f32 v118, v118
  v_mfma_f32_16x16x32_bf16 v[68:71], a[108:111], v[96:99], v[68:71]
  buffer_load_dwordx4 a[116:119], v7, s[20:23], s51 offen offset:1024
  v_rcp_f32 v119, v119
  v_fma_f32 v32, -v32, v112, v32
  v_mfma_f32_16x16x32_bf16 v[72:75], a[104:107], v[100:103], v[72:75]
  ds_read_b128 v[92:95], v12 offset:52224
  v_fma_f32 v33, -v33, v113, v33
  v_fma_f32 v34, -v34, v114, v34
  v_fma_f32 v35, -v35, v115, v35
  v_mfma_f32_16x16x32_bf16 v[76:79], a[108:111], v[100:103], v[76:79]
  s_waitcnt lgkmcnt(4)
  v_fma_f32 v36, -v36, v116, v36
  v_fma_f32 v37, -v37, v117, v37
  v_fma_f32 v38, -v38, v118, v38
  v_mfma_f32_16x16x32_bf16 v[64:67], a[120:123], v[104:107], v[64:67]
  ds_read_b128 v[96:99], v12 offset:53248
  v_fma_f32 v39, -v39, v119, v39
  v_cvt_pk_bf16_f32 v32, v32, v33
  s_add_u32 s51, s36, 20480
  v_mfma_f32_16x16x32_bf16 v[68:71], a[124:127], v[104:107], v[68:71]
  buffer_load_dwordx4 a[128:131], v6, s[20:23], s51 offen offset:0
  v_cvt_pk_bf16_f32 v33, v34, v35
  v_cvt_pk_bf16_f32 v34, v36, v37
  v_cvt_pk_bf16_f32 v35, v38, v39
  v_mfma_f32_16x16x32_bf16 v[72:75], a[120:123], v[108:111], v[72:75]
  ds_read_b128 v[100:103], v12 offset:54272
  buffer_store_dwordx4 v[32:35], v1, s[20:23], s43 offen offset:2048 sc1
  s_add_u32 s39, s44, 262144
  v_mfma_f32_16x16x32_bf16 v[76:79], a[124:127], v[108:111], v[76:79]
  s_waitcnt lgkmcnt(4)
  v_exp_f32 v128, v40
  s_waitcnt vmcnt(8)
  v_mfma_f32_16x16x32_bf16 v[64:67], a[136:139], v[80:83], v[64:67]
  ds_read_b128 v[104:107], v12 offset:55296
  s_barrier
  v_exp_f32 v129, v41
  v_mfma_f32_16x16x32_bf16 v[68:71], a[140:143], v[80:83], v[68:71]
  buffer_store_dword v10, v3, s[20:23], s39 offen sc1
  v_exp_f32 v130, v42
  v_mfma_f32_16x16x32_bf16 v[72:75], a[136:139], v[84:87], v[72:75]
  ds_read_b128 v[108:111], v12 offset:56320
  v_exp_f32 v131, v43
  v_mfma_f32_16x16x32_bf16 v[76:79], a[140:143], v[84:87], v[76:79]
  s_waitcnt lgkmcnt(4)
  v_exp_f32 v132, v44
  v_mfma_f32_16x16x32_bf16 v[64:67], a[152:155], v[88:91], v[64:67]
  ds_read_b128 v[80:83], v12 offset:57344
  v_exp_f32 v133, v45
  v_mfma_f32_16x16x32_bf16 v[68:71], a[156:159], v[88:91], v[68:71]
  buffer_load_dwordx4 a[132:135], v6, s[20:23], s51 offen offset:1024
  v_exp_f32 v134, v46
  v_mfma_f32_16x16x32_bf16 v[72:75], a[152:155], v[92:95], v[72:75]
  ds_read_b128 v[84:87], v12 offset:58368
  v_exp_f32 v135, v47
  v_fma_f32 v136, v128, 0.5, 1.0
  v_mfma_f32_16x16x32_bf16 v[76:79], a[156:159], v[92:95], v[76:79]
  s_waitcnt lgkmcnt(4)
  v_fma_f32 v137, v129, 0.5, 1.0
  v_fma_f32 v138, v130, 0.5, 1.0
  v_fma_f32 v139, v131, 0.5, 1.0
  v_mfma_f32_16x16x32_bf16 v[64:67], a[168:171], v[96:99], v[64:67]
  ds_read_b128 v[88:91], v12 offset:59392
  v_fma_f32 v140, v132, 0.5, 1.0
  v_fma_f32 v141, v133, 0.5, 1.0
  v_fma_f32 v142, v134, 0.5, 1.0
  v_mfma_f32_16x16x32_bf16 v[68:71], a[172:175], v[96:99], v[68:71]
  buffer_load_dwordx4 a[144:147], v7, s[20:23], s51 offen offset:0
  v_fma_f32 v143, v135, 0.5, 1.0
  v_fma_f32 v128, v128, v136, 1.0
  v_fma_f32 v129, v129, v137, 1.0
  v_mfma_f32_16x16x32_bf16 v[72:75], a[168:171], v[100:103], v[72:75]
  ds_read_b128 v[92:95], v12 offset:60416
  v_fma_f32 v130, v130, v138, 1.0
  v_fma_f32 v131, v131, v139, 1.0
  v_fma_f32 v132, v132, v140, 1.0
  v_mfma_f32_16x16x32_bf16 v[76:79], a[172:175], v[100:103], v[76:79]
  s_waitcnt lgkmcnt(4)
  v_fma_f32 v133, v133, v141, 1.0
  v_fma_f32 v134, v134, v142, 1.0
  v_fma_f32 v135, v135, v143, 1.0
  v_mfma_f32_16x16x32_bf16 v[64:67], a[184:187], v[104:107], v[64:67]
  ds_read_b128 v[96:99], v12 offset:61440
  v_rcp_f32 v128, v128
  v_mfma_f32_16x16x32_bf16 v[68:71], a[188:191], v[104:107], v[68:71]
  v_rcp_f32 v129, v129
  v_mfma_f32_16x16x32_bf16 v[72:75], a[184:187], v[108:111], v[72:75]
  ds_read_b128 v[100:103], v12 offset:62464
  v_rcp_f32 v130, v130
  v_mfma_f32_16x16x32_bf16 v[76:79], a[188:191], v[108:111], v[76:79]
  s_waitcnt lgkmcnt(4)
  v_rcp_f32 v131, v131
  v_mfma_f32_16x16x32_bf16 v[64:67], a[200:203], v[80:83], v[64:67]
  ds_read_b128 v[104:107], v12 offset:63488
  v_rcp_f32 v132, v132
  v_mfma_f32_16x16x32_bf16 v[68:71], a[204:207], v[80:83], v[68:71]
  buffer_load_dwordx4 a[148:151], v7, s[20:23], s51 offen offset:1024
  v_rcp_f32 v133, v133
  v_mfma_f32_16x16x32_bf16 v[72:75], a[200:203], v[84:87], v[72:75]
  ds_read_b128 v[108:111], v12 offset:64512
  v_rcp_f32 v134, v134
  v_mfma_f32_16x16x32_bf16 v[76:79], a[204:207], v[84:87], v[76:79]
  s_waitcnt lgkmcnt(4)
  v_rcp_f32 v135, v135
  v_fma_f32 v40, -v40, v128, v40
  v_mfma_f32_16x16x32_bf16 v[64:67], a[216:219], v[88:91], v[64:67]
  v_fma_f32 v41, -v41, v129, v41
  v_fma_f32 v42, -v42, v130, v42
  v_fma_f32 v43, -v43, v131, v43
  v_mfma_f32_16x16x32_bf16 v[68:71], a[220:223], v[88:91], v[68:71]
  v_fma_f32 v44, -v44, v132, v44
  v_fma_f32 v45, -v45, v133, v45
  v_fma_f32 v46, -v46, v134, v46
  v_mfma_f32_16x16x32_bf16 v[72:75], a[216:219], v[92:95], v[72:75]
  v_fma_f32 v47, -v47, v135, v47
  v_cvt_pk_bf16_f32 v40, v40, v41
  v_cvt_pk_bf16_f32 v41, v42, v43
  v_mfma_f32_16x16x32_bf16 v[76:79], a[220:223], v[92:95], v[76:79]
  s_waitcnt lgkmcnt(2)
  v_cvt_pk_bf16_f32 v42, v44, v45
  v_cvt_pk_bf16_f32 v43, v46, v47
  v_mfma_f32_16x16x32_bf16 v[64:67], a[232:235], v[96:99], v[64:67]
  buffer_store_dwordx4 v[40:43], v1, s[20:23], s43 offen offset:3072 sc1
  v_mfma_f32_16x16x32_bf16 v[68:71], a[236:239], v[96:99], v[68:71]
  v_mfma_f32_16x16x32_bf16 v[72:75], a[232:235], v[100:103], v[72:75]
  v_mfma_f32_16x16x32_bf16 v[76:79], a[236:239], v[100:103], v[76:79]
  s_waitcnt lgkmcnt(0)
  v_mfma_f32_16x16x32_bf16 v[64:67], a[248:251], v[104:107], v[64:67]
  v_mfma_f32_16x16x32_bf16 v[68:71], a[252:255], v[104:107], v[68:71]
  v_mfma_f32_16x16x32_bf16 v[72:75], a[248:251], v[108:111], v[72:75]
  v_mfma_f32_16x16x32_bf16 v[76:79], a[252:255], v[108:111], v[76:79]
  s_nop 7
  v_exp_f32 v112, v64
  v_exp_f32 v113, v65
  v_exp_f32 v114, v66
  v_exp_f32 v115, v67
  v_exp_f32 v116, v68
  v_exp_f32 v117, v69
  v_exp_f32 v118, v70
  v_exp_f32 v119, v71
  buffer_load_dword v15, v13, s[20:23], s47 offen sc1
  v_fma_f32 v120, v112, 0.5, 1.0
  v_fma_f32 v121, v113, 0.5, 1.0
  v_fma_f32 v122, v114, 0.5, 1.0
  v_fma_f32 v123, v115, 0.5, 1.0
  v_fma_f32 v124, v116, 0.5, 1.0
  v_fma_f32 v125, v117, 0.5, 1.0
  v_fma_f32 v126, v118, 0.5, 1.0
  v_fma_f32 v127, v119, 0.5, 1.0
  v_fma_f32 v112, v112, v120, 1.0
  v_fma_f32 v113, v113, v121, 1.0
  v_fma_f32 v114, v114, v122, 1.0
  v_fma_f32 v115, v115, v123, 1.0
  v_fma_f32 v116, v116, v124, 1.0
  v_fma_f32 v117, v117, v125, 1.0
  v_fma_f32 v118, v118, v126, 1.0
  v_fma_f32 v119, v119, v127, 1.0
  v_rcp_f32 v112, v112
  v_rcp_f32 v113, v113
  v_rcp_f32 v114, v114
  v_rcp_f32 v115, v115
  v_rcp_f32 v116, v116
  v_rcp_f32 v117, v117
  v_rcp_f32 v118, v118
  v_rcp_f32 v119, v119
  v_fma_f32 v64, -v64, v112, v64
  v_fma_f32 v65, -v65, v113, v65
  v_fma_f32 v66, -v66, v114, v66
  v_fma_f32 v67, -v67, v115, v67
  v_fma_f32 v68, -v68, v116, v68
  v_fma_f32 v69, -v69, v117, v69
  v_fma_f32 v70, -v70, v118, v70
  v_fma_f32 v71, -v71, v119, v71
  v_cvt_pk_bf16_f32 v64, v64, v65
  v_cvt_pk_bf16_f32 v65, v66, v67
  v_cvt_pk_bf16_f32 v66, v68, v69
  v_cvt_pk_bf16_f32 v67, v70, v71
  buffer_store_dwordx4 v[64:67], v1, s[20:23], s35 offen offset:2048 sc1
  v_exp_f32 v128, v72
  v_exp_f32 v129, v73
  v_exp_f32 v130, v74
  v_exp_f32 v131, v75
  v_exp_f32 v132, v76
  v_exp_f32 v133, v77
  v_exp_f32 v134, v78
  v_exp_f32 v135, v79
  v_fma_f32 v136, v128, 0.5, 1.0
  v_fma_f32 v137, v129, 0.5, 1.0
  v_fma_f32 v138, v130, 0.5, 1.0
  v_fma_f32 v139, v131, 0.5, 1.0
  v_fma_f32 v140, v132, 0.5, 1.0
  v_fma_f32 v141, v133, 0.5, 1.0
  v_fma_f32 v142, v134, 0.5, 1.0
  v_fma_f32 v143, v135, 0.5, 1.0
  v_fma_f32 v128, v128, v136, 1.0
  v_fma_f32 v129, v129, v137, 1.0
  v_fma_f32 v130, v130, v138, 1.0
  v_fma_f32 v131, v131, v139, 1.0
  v_fma_f32 v132, v132, v140, 1.0
  v_fma_f32 v133, v133, v141, 1.0
  v_fma_f32 v134, v134, v142, 1.0
  s_waitcnt vmcnt(1)
  v_cmp_ne_u32 vcc, v10, v15
  s_cbranch_vccnz KC_C0SPIN
KC_C0SPIN_RET:
  s_mov_b32 s46, 33554432
  buffer_load_dwordx4 v[80:83], v4, s[20:23], s46 offen offset:0 sc1
  buffer_load_dwordx4 v[84:87], v4, s[20:23], s46 offen offset:1024 sc1
  buffer_load_dwordx4 v[88:91], v5, s[20:23], s46 offen offset:0 sc1
  buffer_load_dwordx4 v[92:95], v5, s[20:23], s46 offen offset:1024 sc1
  s_mov_b32 s46, 33558528
  buffer_load_dwordx4 v[96:99], v4, s[20:23], s46 offen offset:0 sc1
  buffer_load_dwordx4 v[100:103], v4, s[20:23], s46 offen offset:1024 sc1
  buffer_load_dwordx4 v[104:107], v5, s[20:23], s46 offen offset:0 sc1
  buffer_load_dwordx4 v[108:111], v5, s[20:23], s46 offen offset:1024 sc1
  v_fma_f32 v135, v135, v143, 1.0
  v_rcp_f32 v128, v128
  v_rcp_f32 v129, v129
  v_rcp_f32 v130, v130
  v_rcp_f32 v131, v131
  v_rcp_f32 v132, v132
  v_rcp_f32 v133, v133
  v_rcp_f32 v134, v134
  v_rcp_f32 v135, v135
  v_fma_f32 v72, -v72, v128, v72
  v_fma_f32 v73, -v73, v129, v73
  v_fma_f32 v74, -v74, v130, v74
  v_fma_f32 v75, -v75, v131, v75
  v_fma_f32 v76, -v76, v132, v76
  v_fma_f32 v77, -v77, v133, v77
  v_fma_f32 v78, -v78, v134, v78
  v_fma_f32 v79, -v79, v135, v79
  v_cvt_pk_bf16_f32 v72, v72, v73
  v_cvt_pk_bf16_f32 v73, v74, v75
  v_cvt_pk_bf16_f32 v74, v76, v77
  v_cvt_pk_bf16_f32 v75, v78, v79
  buffer_store_dwordx4 v[72:75], v1, s[20:23], s35 offen offset:3072 sc1
  s_branch KC_PH3
KC_SKIP2:
  s_add_u32 s51, s36, 0
  buffer_load_dwordx4 v[144:147], v6, s[20:23], s51 offen offset:0
  buffer_load_dwordx4 v[148:151], v6, s[20:23], s51 offen offset:1024
  buffer_load_dwordx4 v[152:155], v7, s[20:23], s51 offen offset:0
  buffer_load_dwordx4 v[156:159], v7, s[20:23], s51 offen offset:1024
  s_add_u32 s51, s36, 8192
  buffer_load_dwordx4 v[160:163], v6, s[20:23], s51 offen offset:0
  buffer_load_dwordx4 v[164:167], v6, s[20:23], s51 offen offset:1024
  buffer_load_dwordx4 v[168:171], v7, s[20:23], s51 offen offset:0
  buffer_load_dwordx4 v[172:175], v7, s[20:23], s51 offen offset:1024
  s_add_u32 s51, s36, 16384
  buffer_load_dwordx4 v[176:179], v6, s[20:23], s51 offen offset:0
  buffer_load_dwordx4 v[180:183], v6, s[20:23], s51 offen offset:1024
  buffer_load_dwordx4 v[184:187], v7, s[20:23], s51 offen offset:0
  buffer_load_dwordx4 v[188:191], v7, s[20:23], s51 offen offset:1024
  s_add_u32 s51, s36, 24576
  buffer_load_dwordx4 v[192:195], v6, s[20:23], s51 offen offset:0
  buffer_load_dwordx4 v[196:199], v6, s[20:23], s51 offen offset:1024
  buffer_load_dwordx4 v[200:203], v7, s[20:23], s51 offen offset:0
  buffer_load_dwordx4 v[204:207], v7, s[20:23], s51 offen offset:1024
  s_add_u32 s51, s36, 32768
  buffer_load_dwordx4 v[208:211], v6, s[20:23], s51 offen offset:0
  buffer_load_dwordx4 v[212:215], v6, s[20:23], s51 offen offset:1024
  buffer_load_dwordx4 v[216:219], v7, s[20:23], s51 offen offset:0
  buffer_load_dwordx4 v[220:223], v7, s[20:23], s51 offen offset:1024
  s_add_u32 s51, s36, 40960
  buffer_load_dwordx4 a[0:3], v6, s[20:23], s51 offen offset:0
  buffer_load_dwordx4 a[4:7], v6, s[20:23], s51 offen offset:1024
  buffer_load_dwordx4 a[16:19], v7, s[20:23], s51 offen offset:0
  buffer_load_dwordx4 a[20:23], v7, s[20:23], s51 offen offset:1024
  s_add_u32 s51, s36, 49152
  buffer_load_dwordx4 a[32:35], v6, s[20:23], s51 offen offset:0
  buffer_load_dwordx4 a[36:39], v6, s[20:23], s51 offen offset:1024
  buffer_load_dwordx4 a[48:51], v7, s[20:23], s51 offen offset:0
  buffer_load_dwordx4 a[52:55], v7, s[20:23], s51 offen offset:1024
  s_add_u32 s51, s36, 4096
  buffer_load_dwordx4 a[64:67], v6, s[20:23], s51 offen offset:0
  buffer_load_dwordx4 a[68:71], v6, s[20:23], s51 offen offset:1024
  buffer_load_dwordx4 a[80:83], v7, s[20:23], s51 offen offset:0
  buffer_load_dwordx4 a[84:87], v7, s[20:23], s51 offen offset:1024
  s_add_u32 s51, s36, 12288
  buffer_load_dwordx4 a[96:99], v6, s[20:23], s51 offen offset:0
  buffer_load_dwordx4 a[100:103], v6, s[20:23], s51 offen offset:1024
  buffer_load_dwordx4 a[112:115], v7, s[20:23], s51 offen offset:0
  buffer_load_dwordx4 a[116:119], v7, s[20:23], s51 offen offset:1024
  s_add_u32 s51, s36, 20480
  buffer_load_dwordx4 a[128:131], v6, s[20:23], s51 offen offset:0
  buffer_load_dwordx4 a[132:135], v6, s[20:23], s51 offen offset:1024
  buffer_load_dwordx4 a[144:147], v7, s[20:23], s51 offen offset:0
  buffer_load_dwordx4 a[148:151], v7, s[20:23], s51 offen offset:1024
  s_mul_i32 s37, s33, 114688
  s_mul_i32 s38, s30, 28672
  s_add_u32 s37, s37, s38
  v_add_u32 v4, s37, v1
  s_xor_b32 s37, s33, 1
  s_mul_i32 s37, s37, 114688
  s_add_u32 s37, s37, s38
  v_add_u32 v5, s37, v1
  v_lshrrev_b32 v15, 4, v2
  s_lshl_b32 s37, s34, 7
  v_lshlrev_b32 v8, 4, v15
  v_add_u32 v8, s37, v8
  s_lshl_b32 s37, s33, 15
  s_lshl_b32 s38, s34, 11
  s_add_u32 s38, s38, s37
  s_add_u32 s48, s38, 44040192
  s_lshl_b32 s38, s34, 6
  s_add_u32 s38, s38, s37
  v_and_b32 v9, 15, v2
  v_lshlrev_b32 v9, 10, v9
  v_and_b32 v15, 1, v15
  v_lshl_add_u32 v9, v15, 5, v9
  v_lshrrev_b32 v15, 5, v2
  v_lshl_add_u32 v9, v15, 4, v9
  v_add_u32 v9, s38, v9
  s_mul_i32 s37, s30, 12288
  s_add_u32 s37, s37, 0x10000
  v_add_u32 v11, s37, v1
  v_min_u32 v13, 0x300, v14
  s_lshl_b32 s47, s31, 10
  s_add_u32 s47, s47, 360448
  s_cmp_lg_u32 s30, 0
  s_cbranch_scc1 KC_PC7_OK
  s_mov_b32 s38, 100000
  s_add_u32 s39, s41, 294912
KC_PC7_L:
  buffer_load_dword v15, v14, s[20:23], s39 offen sc1
  s_waitcnt vmcnt(0)
  v_cmp_eq_u32 vcc, 23063, v15
  s_and_b32 s37, vcc_lo, 0x7f
  s_cmp_eq_u32 s37, 0x7f
  s_cbranch_scc1 KC_PC7_OK
KC_PC7_S:
  s_sleep 8
  s_sub_u32 s38, s38, 1
  s_cmp_lg_u32 s38, 0
  s_cbranch_scc1 KC_PC7_L
KC_PC7_OK:
  s_waitcnt vmcnt(0)
  s_barrier
  s_mov_b32 s46, 33554432
  buffer_load_dwordx4 v[80:83], v4, s[20:23], s46 offen offset:0 sc1
  buffer_load_dwordx4 v[84:87], v4, s[20:23], s46 offen offset:1024 sc1
  buffer_load_dwordx4 v[88:91], v5, s[20:23], s46 offen offset:0 sc1
  buffer_load_dwordx4 v[92:95], v5, s[20:23], s46 offen offset:1024 sc1
  s_mov_b32 s46, 33558528
  buffer_load_dwordx4 v[96:99], v4, s[20:23], s46 offen offset:0 sc1
  buffer_load_dwordx4 v[100:103], v4, s[20:23], s46 offen offset:1024 sc1
  buffer_load_dwordx4 v[104:107], v5, s[20:23], s46 offen offset:0 sc1
  buffer_load_dwordx4 v[108:111], v5, s[20:23], s46 offen offset:1024 sc1
  buffer_load_dword v15, v13, s[20:23], s47 offen sc1
KC_PH3:
  s_mov_b32 s46, 33562624
  buffer_load_dwordx4 v[112:115], v4, s[20:23], s46 offen offset:0 sc1
  buffer_load_dwordx4 v[116:119], v4, s[20:23], s46 offen offset:1024 sc1
  buffer_load_dwordx4 v[120:123], v5, s[20:23], s46 offen offset:0 sc1
  buffer_load_dwordx4 v[124:127], v5, s[20:23], s46 offen offset:1024 sc1
  s_mov_b32 s46, 33566720
  buffer_load_dwordx4 v[128:131], v4, s[20:23], s46 offen offset:0 sc1
  buffer_load_dwordx4 v[132:135], v4, s[20:23], s46 offen offset:1024 sc1
  buffer_load_dwordx4 v[136:139], v5, s[20:23], s46 offen offset:0 sc1
  buffer_load_dwordx4 v[140:143], v5, s[20:23], s46 offen offset:1024 sc1
  s_add_u32 s44, s44, 32768
  s_add_u32 s47, s47, 4294737920
  s_mov_b32 s38, 10240
  v_add_u32 v6, s60, v6
  v_add_u32 v7, s60, v7
  s_waitcnt vmcnt(13)
  v_mfma_f32_16x16x32_bf16 v[64:67], v[152:155], v[88:91], 0
  v_mfma_f32_16x16x32_bf16 v[72:75], v[152:155], v[92:95], 0
  v_mfma_f32_16x16x32_bf16 v[68:71], v[156:159], v[88:91], 0
  v_mfma_f32_16x16x32_bf16 v[76:79], v[156:159], v[92:95], 0
  v_mfma_f32_16x16x32_bf16 v[48:51], v[144:147], v[88:91], 0
  v_mfma_f32_16x16x32_bf16 v[56:59], v[144:147], v[92:95], 0
  s_waitcnt vmcnt(8)
  v_mfma_f32_16x16x32_bf16 v[52:55], v[148:151], v[88:91], 0
  s_barrier
  v_mfma_f32_16x16x32_bf16 v[60:63], v[148:151], v[92:95], 0
  buffer_store_dword v10, v3, s[20:23], s44 offen sc1
  v_mfma_f32_16x16x32_bf16 v[32:35], v[152:155], v[80:83], 0
  v_mfma_f32_16x16x32_bf16 v[40:43], v[152:155], v[84:87], 0
  ds_read_b128 a[160:163], v6 offset:0
  v_mfma_f32_16x16x32_bf16 v[36:39], v[156:159], v[80:83], 0
  v_mfma_f32_16x16x32_bf16 v[44:47], v[156:159], v[84:87], 0
  ds_read_b128 a[164:167], v6 offset:1024
  v_mfma_f32_16x16x32_bf16 v[16:19], v[144:147], v[80:83], 0
  v_mfma_f32_16x16x32_bf16 v[24:27], v[144:147], v[84:87], 0
  ds_read_b128 a[176:179], v7 offset:0
  v_mfma_f32_16x16x32_bf16 v[20:23], v[148:151], v[80:83], 0
  v_mfma_f32_16x16x32_bf16 v[28:31], v[148:151], v[84:87], 0
  ds_read_b128 a[180:183], v7 offset:1024
  s_nop 0
  s_mov_b32 s46, 33570816
  v_mfma_f32_16x16x32_bf16 v[64:67], v[168:171], v[104:107], v[64:67]
  buffer_load_dwordx4 v[80:83], v4, s[20:23], s46 offen offset:0 sc1
  v_mfma_f32_16x16x32_bf16 v[72:75], v[168:171], v[108:111], v[72:75]
  ds_read_b128 a[192:195], v6 offset:4096
  v_mfma_f32_16x16x32_bf16 v[68:71], v[172:175], v[104:107], v[68:71]
  buffer_load_dwordx4 v[84:87], v4, s[20:23], s46 offen offset:1024 sc1
  v_mfma_f32_16x16x32_bf16 v[76:79], v[172:175], v[108:111], v[76:79]
  ds_read_b128 a[196:199], v6 offset:5120
  v_mfma_f32_16x16x32_bf16 v[48:51], v[160:163], v[104:107], v[48:51]
  buffer_load_dwordx4 v[88:91], v5, s[20:23], s46 offen offset:0 sc1
  v_mfma_f32_16x16x32_bf16 v[56:59], v[160:163], v[108:111], v[56:59]
  ds_read_b128 a[208:211], v7 offset:4096
  v_mfma_f32_16x16x32_bf16 v[52:55], v[164:167], v[104:107], v[52:55]
  buffer_load_dwordx4 v[92:95], v5, s[20:23], s46 offen offset:1024 sc1
  v_mfma_f32_16x16x32_bf16 v[60:63], v[164:167], v[108:111], v[60:63]
  ds_read_b128 a[212:215], v7 offset:5120
  v_mfma_f32_16x16x32_bf16 v[32:35], v[168:171], v[96:99], v[32:35]
  v_mfma_f32_16x16x32_bf16 v[40:43], v[168:171], v[100:103], v[40:43]
  ds_read_b128 a[224:227], v6 offset:8192
  v_mfma_f32_16x16x32_bf16 v[36:39], v[172:175], v[96:99], v[36:39]
  v_mfma_f32_16x16x32_bf16 v[44:47], v[172:175], v[100:103], v[44:47]
  ds_read_b128 a[228:231], v6 offset:9216
  v_mfma_f32_16x16x32_bf16 v[16:19], v[160:163], v[96:99], v[16:19]
  v_mfma_f32_16x16x32_bf16 v[24:27], v[160:163], v[100:103], v[24:27]
  ds_read_b128 a[240:243], v7 offset:8192
  v_mfma_f32_16x16x32_bf16 v[20:23], v[164:167], v[96:99], v[20:23]
  v_mfma_f32_16x16x32_bf16 v[28:31], v[164:167], v[100:103], v[28:31]
  ds_read_b128 a[244:247], v7 offset:9216
  s_waitcnt vmcnt(9)
  s_mov_b32 s46, 33574912
  v_mfma_f32_16x16x32_bf16 v[64:67], v[184:187], v[120:123], v[64:67]
  buffer_load_dwordx4 v[96:99], v4, s[20:23], s46 offen offset:0 sc1
  v_mfma_f32_16x16x32_bf16 v[72:75], v[184:187], v[124:127], v[72:75]
  ds_read_b128 a[8:11], v6 offset:12288
  v_mfma_f32_16x16x32_bf16 v[68:71], v[188:191], v[120:123], v[68:71]
  buffer_load_dwordx4 v[100:103], v4, s[20:23], s46 offen offset:1024 sc1
  v_mfma_f32_16x16x32_bf16 v[76:79], v[188:191], v[124:127], v[76:79]
  ds_read_b128 a[12:15], v6 offset:13312
  v_mfma_f32_16x16x32_bf16 v[48:51], v[176:179], v[120:123], v[48:51]
  buffer_load_dwordx4 v[104:107], v5, s[20:23], s46 offen offset:0 sc1
  v_mfma_f32_16x16x32_bf16 v[56:59], v[176:179], v[124:127], v[56:59]
  ds_read_b128 a[24:27], v7 offset:12288
  v_mfma_f32_16x16x32_bf16 v[52:55], v[180:183], v[120:123], v[52:55]
  buffer_load_dwordx4 v[108:111], v5, s[20:23], s46 offen offset:1024 sc1
  v_mfma_f32_16x16x32_bf16 v[60:63], v[180:183], v[124:127], v[60:63]
  ds_read_b128 a[28:31], v7 offset:13312
  v_mfma_f32_16x16x32_bf16 v[32:35], v[184:187], v[112:115], v[32:35]
  v_mfma_f32_16x16x32_bf16 v[40:43], v[184:187], v[116:119], v[40:43]
  v_mfma_f32_16x16x32_bf16 v[36:39], v[188:191], v[112:115], v[36:39]
  v_mfma_f32_16x16x32_bf16 v[44:47], v[188:191], v[116:119], v[44:47]
  v_mfma_f32_16x16x32_bf16 v[16:19], v[176:179], v[112:115], v[16:19]
  v_mfma_f32_16x16x32_bf16 v[24:27], v[176:179], v[116:119], v[24:27]
  v_mfma_f32_16x16x32_bf16 v[20:23], v[180:183], v[112:115], v[20:23]
  v_mfma_f32_16x16x32_bf16 v[28:31], v[180:183], v[116:119], v[28:31]
  s_waitcnt vmcnt(9)
  s_mov_b32 s46, 33579008
  v_mfma_f32_16x16x32_bf16 v[64:67], v[200:203], v[136:139], v[64:67]
  buffer_load_dwordx4 v[112:115], v4, s[20:23], s46 offen offset:0 sc1
  v_mfma_f32_16x16x32_bf16 v[72:75], v[200:203], v[140:143], v[72:75]
  v_mfma_f32_16x16x32_bf16 v[68:71], v[204:207], v[136:139], v[68:71]
  buffer_load_dwordx4 v[116:119], v4, s[20:23], s46 offen offset:1024 sc1
  v_mfma_f32_16x16x32_bf16 v[76:79], v[204:207], v[140:143], v[76:79]
  v_mfma_f32_16x16x32_bf16 v[48:51], v[192:195], v[136:139], v[48:51]
  buffer_load_dwordx4 v[120:123], v5, s[20:23], s46 offen offset:0 sc1
  v_mfma_f32_16x16x32_bf16 v[56:59], v[192:195], v[140:143], v[56:59]
  v_mfma_f32_16x16x32_bf16 v[52:55], v[196:199], v[136:139], v[52:55]
  buffer_load_dwordx4 v[124:127], v5, s[20:23], s46 offen offset:1024 sc1
  v_mfma_f32_16x16x32_bf16 v[60:63], v[196:199], v[140:143], v[60:63]
  v_mfma_f32_16x16x32_bf16 v[32:35], v[200:203], v[128:131], v[32:35]
  v_mfma_f32_16x16x32_bf16 v[40:43], v[200:203], v[132:135], v[40:43]
  v_mfma_f32_16x16x32_bf16 v[36:39], v[204:207], v[128:131], v[36:39]
  v_mfma_f32_16x16x32_bf16 v[44:47], v[204:207], v[132:135], v[44:47]
  v_mfma_f32_16x16x32_bf16 v[16:19], v[192:195], v[128:131], v[16:19]
  buffer_load_dword v15, v13, s[20:23], s47 offen sc1
  v_mfma_f32_16x16x32_bf16 v[24:27], v[192:195], v[132:135], v[24:27]
  v_mfma_f32_16x16x32_bf16 v[20:23], v[196:199], v[128:131], v[20:23]
  buffer_load_dwordx4 v[232:235], v8, s[20:23], s38 offen offset:0
  v_mfma_f32_16x16x32_bf16 v[28:31], v[196:199], v[132:135], v[28:31]
  s_waitcnt vmcnt(10)
  v_mfma_f32_16x16x32_bf16 v[64:67], v[216:219], v[88:91], v[64:67]
  buffer_load_dwordx4 v[236:239], v8, s[20:23], s38 offen offset:64
  v_mfma_f32_16x16x32_bf16 v[72:75], v[216:219], v[92:95], v[72:75]
  v_mfma_f32_16x16x32_bf16 v[68:71], v[220:223], v[88:91], v[68:71]
  buffer_load_dwordx4 v[224:227], v1, s[20:23], s48 offen sc1
  v_mfma_f32_16x16x32_bf16 v[76:79], v[220:223], v[92:95], v[76:79]
  v_mfma_f32_16x16x32_bf16 v[48:51], v[208:211], v[88:91], v[48:51]
  buffer_load_dwordx4 v[228:231], v1, s[20:23], s48 offen offset:1024 sc1
  v_mfma_f32_16x16x32_bf16 v[56:59], v[208:211], v[92:95], v[56:59]
  v_mfma_f32_16x16x32_bf16 v[52:55], v[212:215], v[88:91], v[52:55]
  v_mfma_f32_16x16x32_bf16 v[60:63], v[212:215], v[92:95], v[60:63]
  v_mfma_f32_16x16x32_bf16 v[32:35], v[216:219], v[80:83], v[32:35]
  v_mfma_f32_16x16x32_bf16 v[40:43], v[216:219], v[84:87], v[40:43]
  v_mfma_f32_16x16x32_bf16 v[36:39], v[220:223], v[80:83], v[36:39]
  v_mfma_f32_16x16x32_bf16 v[44:47], v[220:223], v[84:87], v[44:47]
  v_mfma_f32_16x16x32_bf16 v[16:19], v[208:211], v[80:83], v[16:19]
  v_mfma_f32_16x16x32_bf16 v[24:27], v[208:211], v[84:87], v[24:27]
  v_mfma_f32_16x16x32_bf16 v[20:23], v[212:215], v[80:83], v[20:23]
  v_mfma_f32_16x16x32_bf16 v[28:31], v[212:215], v[84:87], v[28:31]
  s_waitcnt vmcnt(9)
  v_mfma_f32_16x16x32_bf16 v[64:67], a[16:19], v[104:107], v[64:67]
  v_mfma_f32_16x16x32_bf16 v[72:75], a[16:19], v[108:111], v[72:75]
  v_mfma_f32_16x16x32_bf16 v[68:71], a[20:23], v[104:107], v[68:71]
  v_mfma_f32_16x16x32_bf16 v[76:79], a[20:23], v[108:111], v[76:79]
  v_mfma_f32_16x16x32_bf16 v[48:51], a[0:3], v[104:107], v[48:51]
  v_mfma_f32_16x16x32_bf16 v[56:59], a[0:3], v[108:111], v[56:59]
  v_mfma_f32_16x16x32_bf16 v[52:55], a[4:7], v[104:107], v[52:55]
  s_waitcnt vmcnt(4)
  v_cmp_ne_u32 vcc, v10, v15
  s_cbranch_vccnz KC_C1SPIN
KC_C1SPIN_RET:
  v_mfma_f32_16x16x32_bf16 v[60:63], a[4:7], v[108:111], v[60:63]
  s_mov_b32 s46, 33556480
  v_mfma_f32_16x16x32_bf16 v[32:35], a[16:19], v[96:99], v[32:35]
  buffer_load_dwordx4 v[128:131], v4, s[20:23], s46 offen offset:0 sc1
  v_mfma_f32_16x16x32_bf16 v[40:43], a[16:19], v[100:103], v[40:43]
  v_mfma_f32_16x16x32_bf16 v[36:39], a[20:23], v[96:99], v[36:39]
  buffer_load_dwordx4 v[132:135], v4, s[20:23], s46 offen offset:1024 sc1
  v_mfma_f32_16x16x32_bf16 v[44:47], a[20:23], v[100:103], v[44:47]
  v_mfma_f32_16x16x32_bf16 v[16:19], a[0:3], v[96:99], v[16:19]
  buffer_load_dwordx4 v[136:139], v5, s[20:23], s46 offen offset:0 sc1
  v_mfma_f32_16x16x32_bf16 v[24:27], a[0:3], v[100:103], v[24:27]
  v_mfma_f32_16x16x32_bf16 v[20:23], a[4:7], v[96:99], v[20:23]
  buffer_load_dwordx4 v[140:143], v5, s[20:23], s46 offen offset:1024 sc1
  v_mfma_f32_16x16x32_bf16 v[28:31], a[4:7], v[100:103], v[28:31]
  s_nop 0
  s_mov_b32 s46, 33560576
  v_mfma_f32_16x16x32_bf16 v[64:67], a[48:51], v[120:123], v[64:67]
  buffer_load_dwordx4 v[80:83], v4, s[20:23], s46 offen offset:0 sc1
  v_mfma_f32_16x16x32_bf16 v[72:75], a[48:51], v[124:127], v[72:75]
  v_mfma_f32_16x16x32_bf16 v[68:71], a[52:55], v[120:123], v[68:71]
  buffer_load_dwordx4 v[84:87], v4, s[20:23], s46 offen offset:1024 sc1
  v_mfma_f32_16x16x32_bf16 v[76:79], a[52:55], v[124:127], v[76:79]
  v_mfma_f32_16x16x32_bf16 v[48:51], a[32:35], v[120:123], v[48:51]
  buffer_load_dwordx4 v[88:91], v5, s[20:23], s46 offen offset:0 sc1
  s_waitcnt lgkmcnt(0)
  v_mfma_f32_16x16x32_bf16 v[56:59], a[32:35], v[124:127], v[56:59]
  v_mfma_f32_16x16x32_bf16 v[52:55], a[36:39], v[120:123], v[52:55]
  buffer_load_dwordx4 v[92:95], v5, s[20:23], s46 offen offset:1024 sc1
  v_mfma_f32_16x16x32_bf16 v[60:63], a[36:39], v[124:127], v[60:63]
  s_mov_b32 s46, 33564672
  v_mfma_f32_16x16x32_bf16 v[32:35], a[48:51], v[112:115], v[32:35]
  buffer_load_dwordx4 v[96:99], v4, s[20:23], s46 offen offset:0 sc1
  v_mfma_f32_16x16x32_bf16 v[40:43], a[48:51], v[116:119], v[40:43]
  v_mfma_f32_16x16x32_bf16 v[36:39], a[52:55], v[112:115], v[36:39]
  buffer_load_dwordx4 v[100:103], v4, s[20:23], s46 offen offset:1024 sc1
  v_mfma_f32_16x16x32_bf16 v[44:47], a[52:55], v[116:119], v[44:47]
  v_mfma_f32_16x16x32_bf16 v[16:19], a[32:35], v[112:115], v[16:19]
  buffer_load_dwordx4 v[104:107], v5, s[20:23], s46 offen offset:0 sc1
  v_mfma_f32_16x16x32_bf16 v[24:27], a[32:35], v[116:119], v[24:27]
  v_mfma_f32_16x16x32_bf16 v[20:23], a[36:39], v[112:115], v[20:23]
  buffer_load_dwordx4 v[108:111], v5, s[20:23], s46 offen offset:1024 sc1
  v_mfma_f32_16x16x32_bf16 v[28:31], a[36:39], v[116:119], v[28:31]
  s_waitcnt vmcnt(8)
  s_mov_b32 s46, 33568768
  v_mfma_f32_16x16x32_bf16 v[64:67], a[80:83], v[136:139], v[64:67]
  buffer_load_dwordx4 v[112:115], v4, s[20:23], s46 offen offset:0 sc1
  v_mfma_f32_16x16x32_bf16 v[72:75], a[80:83], v[140:143], v[72:75]
  v_mfma_f32_16x16x32_bf16 v[68:71], a[84:87], v[136:139], v[68:71]
  buffer_load_dwordx4 v[116:119], v4, s[20:23], s46 offen offset:1024 sc1
  v_mfma_f32_16x16x32_bf16 v[76:79], a[84:87], v[140:143], v[76:79]
  v_mfma_f32_16x16x32_bf16 v[48:51], a[64:67], v[136:139], v[48:51]
  buffer_load_dwordx4 v[120:123], v5, s[20:23], s46 offen offset:0 sc1
  v_mfma_f32_16x16x32_bf16 v[56:59], a[64:67], v[140:143], v[56:59]
  v_mfma_f32_16x16x32_bf16 v[52:55], a[68:71], v[136:139], v[52:55]
  buffer_load_dwordx4 v[124:127], v5, s[20:23], s46 offen offset:1024 sc1
  v_mfma_f32_16x16x32_bf16 v[60:63], a[68:71], v[140:143], v[60:63]
  v_mfma_f32_16x16x32_bf16 v[32:35], a[80:83], v[128:131], v[32:35]
  v_mfma_f32_16x16x32_bf16 v[40:43], a[80:83], v[132:135], v[40:43]
  v_mfma_f32_16x16x32_bf16 v[36:39], a[84:87], v[128:131], v[36:39]
  v_mfma_f32_16x16x32_bf16 v[44:47], a[84:87], v[132:135], v[44:47]
  v_mfma_f32_16x16x32_bf16 v[16:19], a[64:67], v[128:131], v[16:19]
  v_mfma_f32_16x16x32_bf16 v[24:27], a[64:67], v[132:135], v[24:27]
  v_mfma_f32_16x16x32_bf16 v[20:23], a[68:71], v[128:131], v[20:23]
  v_mfma_f32_16x16x32_bf16 v[28:31], a[68:71], v[132:135], v[28:31]
  s_waitcnt vmcnt(8)
  s_mov_b32 s46, 33572864
  v_mfma_f32_16x16x32_bf16 v[64:67], a[112:115], v[88:91], v[64:67]
  buffer_load_dwordx4 v[128:131], v4, s[20:23], s46 offen offset:0 sc1
  v_mfma_f32_16x16x32_bf16 v[72:75], a[112:115], v[92:95], v[72:75]
  v_mfma_f32_16x16x32_bf16 v[68:71], a[116:119], v[88:91], v[68:71]
  buffer_load_dwordx4 v[132:135], v4, s[20:23], s46 offen offset:1024 sc1
  v_mfma_f32_16x16x32_bf16 v[76:79], a[116:119], v[92:95], v[76:79]
  v_mfma_f32_16x16x32_bf16 v[48:51], a[96:99], v[88:91], v[48:51]
  buffer_load_dwordx4 v[136:139], v5, s[20:23], s46 offen offset:0 sc1
  s_nop 0
  v_mfma_f32_16x16x32_bf16 v[56:59], a[96:99], v[92:95], v[56:59]
  v_mul_f32 v232, 0x3f317218, v232
  v_mul_f32 v233, 0x3f317218, v233
  v_mfma_f32_16x16x32_bf16 v[52:55], a[100:103], v[88:91], v[52:55]
  buffer_load_dwordx4 v[140:143], v5, s[20:23], s46 offen offset:1024 sc1
  v_mul_f32 v234, 0x3f317218, v234
  v_mfma_f32_16x16x32_bf16 v[60:63], a[100:103], v[92:95], v[60:63]
  v_mul_f32 v235, 0x3f317218, v235
  v_mul_f32 v236, 0x3f317218, v236
  v_mfma_f32_16x16x32_bf16 v[32:35], a[112:115], v[80:83], v[32:35]
  v_mul_f32 v237, 0x3f317218, v237
  v_mul_f32 v238, 0x3f317218, v238
  v_mfma_f32_16x16x32_bf16 v[40:43], a[112:115], v[84:87], v[40:43]
  v_mul_f32 v239, 0x3f317218, v239
  s_xor_b32 s37, s30, 1
  v_mfma_f32_16x16x32_bf16 v[36:39], a[116:119], v[80:83], v[36:39]
  s_mul_i32 s37, s37, 12288
  s_add_u32 s37, s37, 0x10000
  v_mfma_f32_16x16x32_bf16 v[44:47], a[116:119], v[84:87], v[44:47]
  v_add_u32 v249, s37, v1
  s_xor_b32 s37, s30, 2
  v_mfma_f32_16x16x32_bf16 v[16:19], a[96:99], v[80:83], v[16:19]
  s_mul_i32 s37, s37, 12288
  s_add_u32 s37, s37, 0x10000
  v_mfma_f32_16x16x32_bf16 v[24:27], a[96:99], v[84:87], v[24:27]
  v_add_u32 v250, s37, v1
  s_xor_b32 s37, s30, 3
  v_mfma_f32_16x16x32_bf16 v[20:23], a[100:103], v[80:83], v[20:23]
  s_mul_i32 s37, s37, 12288
  s_add_u32 s37, s37, 0x10000
  v_mfma_f32_16x16x32_bf16 v[28:31], a[100:103], v[84:87], v[28:31]
  s_waitcnt vmcnt(8)
  s_mov_b32 s46, 33576960
  v_mfma_f32_16x16x32_bf16 v[64:67], a[144:147], v[104:107], v[64:67]
  buffer_load_dwordx4 v[80:83], v4, s[20:23], s46 offen offset:0 sc1
  v_add_u32 v251, s37, v1
  v_mfma_f32_16x16x32_bf16 v[72:75], a[144:147], v[108:111], v[72:75]
  s_mov_b32 s39, 16384
  v_mfma_f32_16x16x32_bf16 v[68:71], a[148:151], v[104:107], v[68:71]
  buffer_load_dwordx4 v[84:87], v4, s[20:23], s46 offen offset:1024 sc1
  v_mfma_f32_16x16x32_bf16 v[76:79], a[148:151], v[108:111], v[76:79]
  v_mfma_f32_16x16x32_bf16 v[48:51], a[128:131], v[104:107], v[48:51]
  buffer_load_dwordx4 v[88:91], v5, s[20:23], s46 offen offset:0 sc1
  v_mfma_f32_16x16x32_bf16 v[56:59], a[128:131], v[108:111], v[56:59]
  v_mfma_f32_16x16x32_bf16 v[52:55], a[132:135], v[104:107], v[52:55]
  buffer_load_dwordx4 v[92:95], v5, s[20:23], s46 offen offset:1024 sc1
  v_mfma_f32_16x16x32_bf16 v[60:63], a[132:135], v[108:111], v[60:63]
  v_mfma_f32_16x16x32_bf16 v[32:35], a[144:147], v[96:99], v[32:35]
  v_mfma_f32_16x16x32_bf16 v[40:43], a[144:147], v[100:103], v[40:43]
  v_mfma_f32_16x16x32_bf16 v[36:39], a[148:151], v[96:99], v[36:39]
  v_mfma_f32_16x16x32_bf16 v[44:47], a[148:151], v[100:103], v[44:47]
  v_mfma_f32_16x16x32_bf16 v[16:19], a[128:131], v[96:99], v[16:19]
  v_mfma_f32_16x16x32_bf16 v[24:27], a[128:131], v[100:103], v[24:27]
  v_mfma_f32_16x16x32_bf16 v[20:23], a[132:135], v[96:99], v[20:23]
  v_mfma_f32_16x16x32_bf16 v[28:31], a[132:135], v[100:103], v[28:31]
  s_waitcnt vmcnt(8)
  s_mov_b32 s46, 33581056
  v_mfma_f32_16x16x32_bf16 v[64:67], a[176:179], v[120:123], v[64:67]
  buffer_load_dwordx4 v[96:99], v4, s[20:23], s46 offen offset:0 sc1
  v_mfma_f32_16x16x32_bf16 v[72:75], a[176:179], v[124:127], v[72:75]
  v_mfma_f32_16x16x32_bf16 v[68:71], a[180:183], v[120:123], v[68:71]
  buffer_load_dwordx4 v[100:103], v4, s[20:23], s46 offen offset:1024 sc1
  v_mfma_f32_16x16x32_bf16 v[76:79], a[180:183], v[124:127], v[76:79]
  v_mfma_f32_16x16x32_bf16 v[48:51], a[160:163], v[120:123], v[48:51]
  buffer_load_dwordx4 v[104:107], v5, s[20:23], s46 offen offset:0 sc1
  v_mfma_f32_16x16x32_bf16 v[56:59], a[160:163], v[124:127], v[56:59]
  v_mfma_f32_16x16x32_bf16 v[52:55], a[164:167], v[120:123], v[52:55]
  buffer_load_dwordx4 v[108:111], v5, s[20:23], s46 offen offset:1024 sc1
  v_mfma_f32_16x16x32_bf16 v[60:63], a[164:167], v[124:127], v[60:63]
  v_mfma_f32_16x16x32_bf16 v[32:35], a[176:179], v[112:115], v[32:35]
  v_mfma_f32_16x16x32_bf16 v[40:43], a[176:179], v[116:119], v[40:43]
  v_mfma_f32_16x16x32_bf16 v[36:39], a[180:183], v[112:115], v[36:39]
  v_mfma_f32_16x16x32_bf16 v[44:47], a[180:183], v[116:119], v[44:47]
  v_mfma_f32_16x16x32_bf16 v[16:19], a[160:163], v[112:115], v[16:19]
  v_mfma_f32_16x16x32_bf16 v[24:27], a[160:163], v[116:119], v[24:27]
  v_mfma_f32_16x16x32_bf16 v[20:23], a[164:167], v[112:115], v[20:23]
  v_mfma_f32_16x16x32_bf16 v[28:31], a[164:167], v[116:119], v[28:31]
  s_waitcnt vmcnt(8)
  v_mfma_f32_16x16x32_bf16 v[64:67], a[208:211], v[136:139], v[64:67]
  v_mfma_f32_16x16x32_bf16 v[72:75], a[208:211], v[140:143], v[72:75]
  v_mfma_f32_16x16x32_bf16 v[68:71], a[212:215], v[136:139], v[68:71]
  v_mfma_f32_16x16x32_bf16 v[76:79], a[212:215], v[140:143], v[76:79]
  v_mfma_f32_16x16x32_bf16 v[48:51], a[192:195], v[136:139], v[48:51]
  v_mfma_f32_16x16x32_bf16 v[56:59], a[192:195], v[140:143], v[56:59]
  v_mfma_f32_16x16x32_bf16 v[52:55], a[196:199], v[136:139], v[52:55]
  v_mfma_f32_16x16x32_bf16 v[60:63], a[196:199], v[140:143], v[60:63]
  v_mfma_f32_16x16x32_bf16 v[32:35], a[208:211], v[128:131], v[32:35]
  v_mfma_f32_16x16x32_bf16 v[40:43], a[208:211], v[132:135], v[40:43]
  v_mfma_f32_16x16x32_bf16 v[36:39], a[212:215], v[128:131], v[36:39]
  v_mfma_f32_16x16x32_bf16 v[44:47], a[212:215], v[132:135], v[44:47]
  v_mfma_f32_16x16x32_bf16 v[16:19], a[192:195], v[128:131], v[16:19]
  v_mfma_f32_16x16x32_bf16 v[24:27], a[192:195], v[132:135], v[24:27]
  v_mfma_f32_16x16x32_bf16 v[20:23], a[196:199], v[128:131], v[20:23]
  v_mfma_f32_16x16x32_bf16 v[28:31], a[196:199], v[132:135], v[28:31]
  s_waitcnt vmcnt(4)
  v_mfma_f32_16x16x32_bf16 v[64:67], a[240:243], v[88:91], v[64:67]
  v_mfma_f32_16x16x32_bf16 v[72:75], a[240:243], v[92:95], v[72:75]
  v_mfma_f32_16x16x32_bf16 v[68:71], a[244:247], v[88:91], v[68:71]
  v_mfma_f32_16x16x32_bf16 v[76:79], a[244:247], v[92:95], v[76:79]
  s_waitcnt vmcnt(0)
  v_mfma_f32_16x16x32_bf16 v[64:67], a[24:27], v[104:107], v[64:67]
  v_mfma_f32_16x16x32_bf16 v[72:75], a[24:27], v[108:111], v[72:75]
  v_mfma_f32_16x16x32_bf16 v[68:71], a[28:31], v[104:107], v[68:71]
  v_mfma_f32_16x16x32_bf16 v[76:79], a[28:31], v[108:111], v[76:79]
  v_mfma_f32_16x16x32_bf16 v[48:51], a[224:227], v[88:91], v[48:51]
  v_mfma_f32_16x16x32_bf16 v[56:59], a[224:227], v[92:95], v[56:59]
  v_mfma_f32_16x16x32_bf16 v[52:55], a[228:231], v[88:91], v[52:55]
  v_mfma_f32_16x16x32_bf16 v[60:63], a[228:231], v[92:95], v[60:63]
  v_mfma_f32_16x16x32_bf16 v[48:51], a[8:11], v[104:107], v[48:51]
  v_mfma_f32_16x16x32_bf16 v[56:59], a[8:11], v[108:111], v[56:59]
  v_mfma_f32_16x16x32_bf16 v[52:55], a[12:15], v[104:107], v[52:55]
  v_mfma_f32_16x16x32_bf16 v[60:63], a[12:15], v[108:111], v[60:63]
  v_mfma_f32_16x16x32_bf16 v[32:35], a[240:243], v[80:83], v[32:35]
  ds_write_b128 v251, v[64:67] offset:8192
  v_mfma_f32_16x16x32_bf16 v[40:43], a[240:243], v[84:87], v[40:43]
  v_mfma_f32_16x16x32_bf16 v[36:39], a[244:247], v[80:83], v[36:39]
  v_mfma_f32_16x16x32_bf16 v[44:47], a[244:247], v[84:87], v[44:47]
  ds_write_b128 v251, v[68:71] offset:9216
  v_mfma_f32_16x16x32_bf16 v[32:35], a[24:27], v[96:99], v[32:35]
  v_mfma_f32_16x16x32_bf16 v[40:43], a[24:27], v[100:103], v[40:43]
  v_mfma_f32_16x16x32_bf16 v[36:39], a[28:31], v[96:99], v[36:39]
  ds_write_b128 v251, v[72:75] offset:10240
  v_mfma_f32_16x16x32_bf16 v[44:47], a[28:31], v[100:103], v[44:47]
  v_mfma_f32_16x16x32_bf16 v[16:19], a[224:227], v[80:83], v[16:19]
  v_mfma_f32_16x16x32_bf16 v[24:27], a[224:227], v[84:87], v[24:27]
  ds_write_b128 v251, v[76:79] offset:11264
  v_mfma_f32_16x16x32_bf16 v[20:23], a[228:231], v[80:83], v[20:23]
  v_mfma_f32_16x16x32_bf16 v[28:31], a[228:231], v[84:87], v[28:31]
  v_mfma_f32_16x16x32_bf16 v[16:19], a[8:11], v[96:99], v[16:19]
  ds_write_b128 v250, v[48:51] offset:4096
  v_mfma_f32_16x16x32_bf16 v[24:27], a[8:11], v[100:103], v[24:27]
  v_mfma_f32_16x16x32_bf16 v[20:23], a[12:15], v[96:99], v[20:23]
  v_mfma_f32_16x16x32_bf16 v[28:31], a[12:15], v[100:103], v[28:31]
  ds_write_b128 v250, v[52:55] offset:5120
  ds_write_b128 v250, v[56:59] offset:6144
  ds_write_b128 v250, v[60:63] offset:7168
  ds_write_b128 v249, v[32:35] offset:0
  ds_write_b128 v249, v[36:39] offset:1024
  ds_write_b128 v249, v[40:43] offset:2048
  ds_write_b128 v249, v[44:47] offset:3072
  v_lshlrev_b32 v80, 16, v224
  v_and_b32 v81, 0xffff0000, v224
  v_lshlrev_b32 v82, 16, v225
  v_and_b32 v83, 0xffff0000, v225
  v_lshlrev_b32 v84, 16, v226
  v_and_b32 v85, 0xffff0000, v226
  v_lshlrev_b32 v86, 16, v227
  v_and_b32 v87, 0xffff0000, v227
  v_lshlrev_b32 v88, 16, v228
  v_and_b32 v89, 0xffff0000, v228
  v_lshlrev_b32 v90, 16, v229
  v_and_b32 v91, 0xffff0000, v229
  v_lshlrev_b32 v92, 16, v230
  v_and_b32 v93, 0xffff0000, v230
  v_lshlrev_b32 v94, 16, v231
  v_and_b32 v95, 0xffff0000, v231
  s_waitcnt lgkmcnt(0)
  s_barrier
  ds_read_b128 v[32:35], v11 offset:0
  ds_read_b128 v[36:39], v11 offset:1024
  ds_read_b128 v[40:43], v11 offset:2048
  ds_read_b128 v[44:47], v11 offset:3072
  ds_read_b128 v[48:51], v11 offset:4096
  ds_read_b128 v[52:55], v11 offset:5120
  ds_read_b128 v[56:59], v11 offset:6144
  ds_read_b128 v[60:63], v11 offset:7168
  ds_read_b128 v[64:67], v11 offset:8192
  ds_read_b128 v[68:71], v11 offset:9216
  ds_read_b128 v[72:75], v11 offset:10240
  ds_read_b128 v[76:79], v11 offset:11264
  s_waitcnt lgkmcnt(8)
  v_add_f32 v16, v16, v32
  v_add_f32 v17, v17, v33
  v_add_f32 v18, v18, v34
  v_add_f32 v19, v19, v35
  v_add_f32 v20, v20, v36
  v_add_f32 v21, v21, v37
  v_add_f32 v22, v22, v38
  v_add_f32 v23, v23, v39
  v_add_f32 v24, v24, v40
  v_add_f32 v25, v25, v41
  v_add_f32 v26, v26, v42
  v_add_f32 v27, v27, v43
  v_add_f32 v28, v28, v44
  v_add_f32 v29, v29, v45
  v_add_f32 v30, v30, v46
  v_add_f32 v31, v31, v47
  s_waitcnt lgkmcnt(4)
  v_add_f32 v16, v16, v48
  v_add_f32 v17, v17, v49
  v_add_f32 v18, v18, v50
  v_add_f32 v19, v19, v51
  v_add_f32 v20, v20, v52
  v_add_f32 v21, v21, v53
  v_add_f32 v22, v22, v54
  v_add_f32 v23, v23, v55
  v_add_f32 v24, v24, v56
  v_add_f32 v25, v25, v57
  v_add_f32 v26, v26, v58
  v_add_f32 v27, v27, v59
  v_add_f32 v28, v28, v60
  v_add_f32 v29, v29, v61
  v_add_f32 v30, v30, v62
  v_add_f32 v31, v31, v63
  s_waitcnt lgkmcnt(0)
  v_add_f32 v16, v16, v64
  v_add_f32 v17, v17, v65
  v_add_f32 v18, v18, v66
  v_add_f32 v19, v19, v67
  v_add_f32 v20, v20, v68
  v_add_f32 v21, v21, v69
  v_add_f32 v22, v22, v70
  v_add_f32 v23, v23, v71
  v_add_f32 v24, v24, v72
  v_add_f32 v25, v25, v73
  v_add_f32 v26, v26, v74
  v_add_f32 v27, v27, v75
  v_add_f32 v28, v28, v76
  v_add_f32 v29, v29, v77
  v_add_f32 v30, v30, v78
  v_add_f32 v31, v31, v79
  v_fmac_f32 v80, v16, v232
  v_fmac_f32 v81, v17, v233
  v_fmac_f32 v82, v18, v234
  v_fmac_f32 v83, v19, v235
  v_fmac_f32 v84, v20, v236
  v_fmac_f32 v85, v21, v237
  v_fmac_f32 v86, v22, v238
  v_fmac_f32 v87, v23, v239
  v_fmac_f32 v88, v24, v232
  v_fmac_f32 v89, v25, v233
  v_fmac_f32 v90, v26, v234
  v_fmac_f32 v91, v27, v235
  v_fmac_f32 v92, v28, v236
  v_fmac_f32 v93, v29, v237
  v_fmac_f32 v94, v30, v238
  v_fmac_f32 v95, v31, v239
  v_cvt_pk_bf16_f32 v32, v80, v81
  v_cvt_pk_bf16_f32 v33, v82, v83
  v_cvt_pk_bf16_f32 v34, v84, v85
  v_cvt_pk_bf16_f32 v35, v86, v87
  v_cvt_pk_bf16_f32 v36, v88, v89
  v_cvt_pk_bf16_f32 v37, v90, v91
  v_cvt_pk_bf16_f32 v38, v92, v93
  v_cvt_pk_bf16_f32 v39, v94, v95
  s_nop 0
  v_permlane16_swap_b32 v32, v34
  v_permlane16_swap_b32 v33, v35
  buffer_store_dwordx4 v[32:35], v9, s[12:15], 0 offen
  v_permlane16_swap_b32 v36, v38
  v_permlane16_swap_b32 v37, v39
  buffer_store_dwordx4 v[36:39], v9, s[12:15], s39 offen
  s_endpgm
KC_PA_SLOW:
  s_cmp_lg_u32 s30, 0
  s_cbranch_scc1 KC_PAS_OK
  s_mov_b32 s38, 100000
  s_and_b32 s39, s41, 0xfffffbff
  s_branch KC_PAS_S
KC_PAS_L:
  buffer_load_dword v15, v14, s[20:23], s39 offen sc1
  s_waitcnt vmcnt(0)
  v_cmp_eq_u32 vcc, 23063, v15
  s_cmp_eq_u32 vcc_lo, -1
  s_cbranch_scc1 KC_PAS_OK
KC_PAS_S:
  s_sleep 4
  s_sub_u32 s38, s38, 1
  s_cmp_lg_u32 s38, 0
  s_cbranch_scc1 KC_PAS_L
KC_PAS_OK:
  s_branch KC_PA_OK
KC_C0SPIN:
  s_mov_b32 s39, 100000
KC_C0SPIN_L:
  s_sleep 1
  buffer_load_dword v15, v13, s[20:23], s47 offen sc1
  s_waitcnt vmcnt(0)
  v_cmp_ne_u32 vcc, v10, v15
  s_cbranch_vccz KC_C0SPIN_RET
  s_sub_u32 s39, s39, 1
  s_cmp_lg_u32 s39, 0
  s_cbranch_scc1 KC_C0SPIN_L
  s_branch KC_C0SPIN_RET
KC_C1SPIN:
  s_mov_b32 s39, 100000
KC_C1SPIN_L:
  s_sleep 1
  buffer_load_dword v15, v13, s[20:23], s47 offen sc1
  s_waitcnt vmcnt(0)
  v_cmp_ne_u32 vcc, v10, v15
  s_cbranch_vccz KC_C1SPIN_RET
  s_sub_u32 s39, s39, 1
  s_cmp_lg_u32 s39, 0
  s_cbranch_scc1 KC_C1SPIN_L
  s_branch KC_C1SPIN_RET
KC_JSPIN:
  s_mov_b32 s39, 100000
  s_mov_b32 s38, 229376
KC_JSPIN_L:
  s_sleep 4
  buffer_load_dword v241, v240, s[20:23], s38 offen sc1
  s_waitcnt vmcnt(0)
  v_cmp_ne_u32 vcc, v242, v241
  s_cbranch_vccz KC_JSPIN_RET
  s_sub_u32 s39, s39, 1
  s_cmp_lg_u32 s39, 0
  s_cbranch_scc1 KC_JSPIN_L
  s_branch KC_JSPIN_RET
KC_CSPIN:
  s_mov_b32 s39, 100000
KC_CSPIN_L:
  s_sleep 4
  buffer_load_dword v241, v5, s[20:23], s48 offen sc1
  s_waitcnt vmcnt(0)
  v_cmp_ne_u32 vcc, v242, v241
  s_cbranch_vccz KC_CSPIN_RET
  s_sub_u32 s39, s39, 1
  s_cmp_lg_u32 s39, 0
  s_cbranch_scc1 KC_CSPIN_L
  s_branch KC_CSPIN_RET
KC_LSPIN:
  s_mov_b32 s63, 100000
KC_LSPIN_L:
  s_sleep 4
  buffer_load_dword v185, v184, s[20:23], s62 offen sc1
  s_waitcnt vmcnt(0)
  v_cmp_ne_u32 vcc, v186, v185
  s_cbranch_vccz KC_LSPIN_RET
  s_sub_u32 s63, s63, 1
  s_cmp_lg_u32 s63, 0
  s_cbranch_scc1 KC_LSPIN_L
  s_branch KC_LSPIN_RET
K2_END:
  s_endpgm
K2_RARE_O:
  s_nop 15
  s_nop 7
  v_max3_f32 v252, v48, v49, v50
  v_max3_f32 v252, v252, v51, v52
  v_max3_f32 v252, v252, v53, v54
  v_max3_f32 v252, v252, v55, 0
  v_mov_b32 v253, v252
  s_nop 1
  v_permlane16_swap_b32 v252, v253
  s_nop 1
  v_max_f32 v252, v252, v253
  v_mov_b32 v253, v252
  s_nop 1
  v_permlane32_swap_b32 v252, v253
  s_nop 1
  v_max_f32 v252, v252, v253
  v_exp_f32 v253, -v252
  v_sub_f32 v112, v112, v252
  v_sub_f32 v113, v113, v252
  v_sub_f32 v114, v114, v252
  v_sub_f32 v115, v115, v252
  v_sub_f32 v48, v48, v252
  v_sub_f32 v16, v16, v252
  v_sub_f32 v49, v49, v252
  v_sub_f32 v17, v17, v252
  v_sub_f32 v50, v50, v252
  v_sub_f32 v18, v18, v252
  v_sub_f32 v51, v51, v252
  v_sub_f32 v19, v19, v252
  v_sub_f32 v52, v52, v252
  v_sub_f32 v20, v20, v252
  v_sub_f32 v53, v53, v252
  v_sub_f32 v21, v21, v252
  v_sub_f32 v54, v54, v252
  v_sub_f32 v22, v22, v252
  v_sub_f32 v55, v55, v252
  v_sub_f32 v23, v23, v252
  v_mul_f32 v128, v128, v253
  v_accvgpr_read_b32 v156, a0
  v_accvgpr_read_b32 v157, a1
  v_accvgpr_read_b32 v158, a2
  v_accvgpr_read_b32 v159, a3
  v_mul_f32 v156, v156, v253
  v_mul_f32 v157, v157, v253
  v_mul_f32 v158, v158, v253
  v_mul_f32 v159, v159, v253
  v_accvgpr_write_b32 a0, v156
  v_accvgpr_write_b32 a1, v157
  v_accvgpr_write_b32 a2, v158
  v_accvgpr_write_b32 a3, v159
  v_accvgpr_read_b32 v156, a4
  v_accvgpr_read_b32 v157, a5
  v_accvgpr_read_b32 v158, a6
  v_accvgpr_read_b32 v159, a7
  v_mul_f32 v156, v156, v253
  v_mul_f32 v157, v157, v253
  v_mul_f32 v158, v158, v253
  v_mul_f32 v159, v159, v253
  v_accvgpr_write_b32 a4, v156
  v_accvgpr_write_b32 a5, v157
  v_accvgpr_write_b32 a6, v158
  v_accvgpr_write_b32 a7, v159
  v_accvgpr_read_b32 v156, a8
  v_accvgpr_read_b32 v157, a9
  v_accvgpr_read_b32 v158, a10
  v_accvgpr_read_b32 v159, a11
  v_mul_f32 v156, v156, v253
  v_mul_f32 v157, v157, v253
  v_mul_f32 v158, v158, v253
  v_mul_f32 v159, v159, v253
  v_accvgpr_write_b32 a8, v156
  v_accvgpr_write_b32 a9, v157
  v_accvgpr_write_b32 a10, v158
  v_accvgpr_write_b32 a11, v159
  v_accvgpr_read_b32 v156, a12
  v_accvgpr_read_b32 v157, a13
  v_accvgpr_read_b32 v158, a14
  v_accvgpr_read_b32 v159, a15
  v_mul_f32 v156, v156, v253
  v_mul_f32 v157, v157, v253
  v_mul_f32 v158, v158, v253
  v_mul_f32 v159, v159, v253
  v_accvgpr_write_b32 a12, v156
  v_accvgpr_write_b32 a13, v157
  v_accvgpr_write_b32 a14, v158
  v_accvgpr_write_b32 a15, v159
  v_accvgpr_read_b32 v156, a64
  v_accvgpr_read_b32 v157, a65
  v_accvgpr_read_b32 v158, a66
  v_accvgpr_read_b32 v159, a67
  v_mul_f32 v156, v156, v253
  v_mul_f32 v157, v157, v253
  v_mul_f32 v158, v158, v253
  v_mul_f32 v159, v159, v253
  v_accvgpr_write_b32 a64, v156
  v_accvgpr_write_b32 a65, v157
  v_accvgpr_write_b32 a66, v158
  v_accvgpr_write_b32 a67, v159
  v_accvgpr_read_b32 v156, a68
  v_accvgpr_read_b32 v157, a69
  v_accvgpr_read_b32 v158, a70
  v_accvgpr_read_b32 v159, a71
  v_mul_f32 v156, v156, v253
  v_mul_f32 v157, v157, v253
  v_mul_f32 v158, v158, v253
  v_mul_f32 v159, v159, v253
  v_accvgpr_write_b32 a68, v156
  v_accvgpr_write_b32 a69, v157
  v_accvgpr_write_b32 a70, v158
  v_accvgpr_write_b32 a71, v159
  v_accvgpr_read_b32 v156, a72
  v_accvgpr_read_b32 v157, a73
  v_accvgpr_read_b32 v158, a74
  v_accvgpr_read_b32 v159, a75
  v_mul_f32 v156, v156, v253
  v_mul_f32 v157, v157, v253
  v_mul_f32 v158, v158, v253
  v_mul_f32 v159, v159, v253
  v_accvgpr_write_b32 a72, v156
  v_accvgpr_write_b32 a73, v157
  v_accvgpr_write_b32 a74, v158
  v_accvgpr_write_b32 a75, v159
  v_accvgpr_read_b32 v156, a76
  v_accvgpr_read_b32 v157, a77
  v_accvgpr_read_b32 v158, a78
  v_accvgpr_read_b32 v159, a79
  v_mul_f32 v156, v156, v253
  v_mul_f32 v157, v157, v253
  v_mul_f32 v158, v158, v253
  v_mul_f32 v159, v159, v253
  v_accvgpr_write_b32 a76, v156
  v_accvgpr_write_b32 a77, v157
  v_accvgpr_write_b32 a78, v158
  v_accvgpr_write_b32 a79, v159
  v_max3_f32 v252, v56, v57, v58
  v_max3_f32 v252, v252, v59, v60
  v_max3_f32 v252, v252, v61, v62
  v_max3_f32 v252, v252, v63, 0
  v_mov_b32 v253, v252
  s_nop 1
  v_permlane16_swap_b32 v252, v253
  s_nop 1
  v_max_f32 v252, v252, v253
  v_mov_b32 v253, v252
  s_nop 1
  v_permlane32_swap_b32 v252, v253
  s_nop 1
  v_max_f32 v252, v252, v253
  v_exp_f32 v253, -v252
  v_sub_f32 v116, v116, v252
  v_sub_f32 v117, v117, v252
  v_sub_f32 v118, v118, v252
  v_sub_f32 v119, v119, v252
  v_sub_f32 v56, v56, v252
  v_sub_f32 v24, v24, v252
  v_sub_f32 v57, v57, v252
  v_sub_f32 v25, v25, v252
  v_sub_f32 v58, v58, v252
  v_sub_f32 v26, v26, v252
  v_sub_f32 v59, v59, v252
  v_sub_f32 v27, v27, v252
  v_sub_f32 v60, v60, v252
  v_sub_f32 v28, v28, v252
  v_sub_f32 v61, v61, v252
  v_sub_f32 v29, v29, v252
  v_sub_f32 v62, v62, v252
  v_sub_f32 v30, v30, v252
  v_sub_f32 v63, v63, v252
  v_sub_f32 v31, v31, v252
  v_mul_f32 v132, v132, v253
  v_accvgpr_read_b32 v156, a16
  v_accvgpr_read_b32 v157, a17
  v_accvgpr_read_b32 v158, a18
  v_accvgpr_read_b32 v159, a19
  v_mul_f32 v156, v156, v253
  v_mul_f32 v157, v157, v253
  v_mul_f32 v158, v158, v253
  v_mul_f32 v159, v159, v253
  v_accvgpr_write_b32 a16, v156
  v_accvgpr_write_b32 a17, v157
  v_accvgpr_write_b32 a18, v158
  v_accvgpr_write_b32 a19, v159
  v_accvgpr_read_b32 v156, a20
  v_accvgpr_read_b32 v157, a21
  v_accvgpr_read_b32 v158, a22
  v_accvgpr_read_b32 v159, a23
  v_mul_f32 v156, v156, v253
  v_mul_f32 v157, v157, v253
  v_mul_f32 v158, v158, v253
  v_mul_f32 v159, v159, v253
  v_accvgpr_write_b32 a20, v156
  v_accvgpr_write_b32 a21, v157
  v_accvgpr_write_b32 a22, v158
  v_accvgpr_write_b32 a23, v159
  v_accvgpr_read_b32 v156, a24
  v_accvgpr_read_b32 v157, a25
  v_accvgpr_read_b32 v158, a26
  v_accvgpr_read_b32 v159, a27
  v_mul_f32 v156, v156, v253
  v_mul_f32 v157, v157, v253
  v_mul_f32 v158, v158, v253
  v_mul_f32 v159, v159, v253
  v_accvgpr_write_b32 a24, v156
  v_accvgpr_write_b32 a25, v157
  v_accvgpr_write_b32 a26, v158
  v_accvgpr_write_b32 a27, v159
  v_accvgpr_read_b32 v156, a28
  v_accvgpr_read_b32 v157, a29
  v_accvgpr_read_b32 v158, a30
  v_accvgpr_read_b32 v159, a31
  v_mul_f32 v156, v156, v253
  v_mul_f32 v157, v157, v253
  v_mul_f32 v158, v158, v253
  v_mul_f32 v159, v159, v253
  v_accvgpr_write_b32 a28, v156
  v_accvgpr_write_b32 a29, v157
  v_accvgpr_write_b32 a30, v158
  v_accvgpr_write_b32 a31, v159
  v_accvgpr_read_b32 v156, a80
  v_accvgpr_read_b32 v157, a81
  v_accvgpr_read_b32 v158, a82
  v_accvgpr_read_b32 v159, a83
  v_mul_f32 v156, v156, v253
  v_mul_f32 v157, v157, v253
  v_mul_f32 v158, v158, v253
  v_mul_f32 v159, v159, v253
  v_accvgpr_write_b32 a80, v156
  v_accvgpr_write_b32 a81, v157
  v_accvgpr_write_b32 a82, v158
  v_accvgpr_write_b32 a83, v159
  v_accvgpr_read_b32 v156, a84
  v_accvgpr_read_b32 v157, a85
  v_accvgpr_read_b32 v158, a86
  v_accvgpr_read_b32 v159, a87
  v_mul_f32 v156, v156, v253
  v_mul_f32 v157, v157, v253
  v_mul_f32 v158, v158, v253
  v_mul_f32 v159, v159, v253
  v_accvgpr_write_b32 a84, v156
  v_accvgpr_write_b32 a85, v157
  v_accvgpr_write_b32 a86, v158
  v_accvgpr_write_b32 a87, v159
  v_accvgpr_read_b32 v156, a88
  v_accvgpr_read_b32 v157, a89
  v_accvgpr_read_b32 v158, a90
  v_accvgpr_read_b32 v159, a91
  v_mul_f32 v156, v156, v253
  v_mul_f32 v157, v157, v253
  v_mul_f32 v158, v158, v253
  v_mul_f32 v159, v159, v253
  v_accvgpr_write_b32 a88, v156
  v_accvgpr_write_b32 a89, v157
  v_accvgpr_write_b32 a90, v158
  v_accvgpr_write_b32 a91, v159
  v_accvgpr_read_b32 v156, a92
  v_accvgpr_read_b32 v157, a93
  v_accvgpr_read_b32 v158, a94
  v_accvgpr_read_b32 v159, a95
  v_mul_f32 v156, v156, v253
  v_mul_f32 v157, v157, v253
  v_mul_f32 v158, v158, v253
  v_mul_f32 v159, v159, v253
  v_accvgpr_write_b32 a92, v156
  v_accvgpr_write_b32 a93, v157
  v_accvgpr_write_b32 a94, v158
  v_accvgpr_write_b32 a95, v159
  v_max3_f32 v252, v64, v65, v66
  v_max3_f32 v252, v252, v67, v68
  v_max3_f32 v252, v252, v69, v70
  v_max3_f32 v252, v252, v71, 0
  v_mov_b32 v253, v252
  s_nop 1
  v_permlane16_swap_b32 v252, v253
  s_nop 1
  v_max_f32 v252, v252, v253
  v_mov_b32 v253, v252
  s_nop 1
  v_permlane32_swap_b32 v252, v253
  s_nop 1
  v_max_f32 v252, v252, v253
  v_exp_f32 v253, -v252
  v_sub_f32 v120, v120, v252
  v_sub_f32 v121, v121, v252
  v_sub_f32 v122, v122, v252
  v_sub_f32 v123, v123, v252
  v_sub_f32 v64, v64, v252
  v_sub_f32 v32, v32, v252
  v_sub_f32 v65, v65, v252
  v_sub_f32 v33, v33, v252
  v_sub_f32 v66, v66, v252
  v_sub_f32 v34, v34, v252
  v_sub_f32 v67, v67, v252
  v_sub_f32 v35, v35, v252
  v_sub_f32 v68, v68, v252
  v_sub_f32 v36, v36, v252
  v_sub_f32 v69, v69, v252
  v_sub_f32 v37, v37, v252
  v_sub_f32 v70, v70, v252
  v_sub_f32 v38, v38, v252
  v_sub_f32 v71, v71, v252
  v_sub_f32 v39, v39, v252
  v_mul_f32 v136, v136, v253
  v_accvgpr_read_b32 v156, a32
  v_accvgpr_read_b32 v157, a33
  v_accvgpr_read_b32 v158, a34
  v_accvgpr_read_b32 v159, a35
  v_mul_f32 v156, v156, v253
  v_mul_f32 v157, v157, v253
  v_mul_f32 v158, v158, v253
  v_mul_f32 v159, v159, v253
  v_accvgpr_write_b32 a32, v156
  v_accvgpr_write_b32 a33, v157
  v_accvgpr_write_b32 a34, v158
  v_accvgpr_write_b32 a35, v159
  v_accvgpr_read_b32 v156, a36
  v_accvgpr_read_b32 v157, a37
  v_accvgpr_read_b32 v158, a38
  v_accvgpr_read_b32 v159, a39
  v_mul_f32 v156, v156, v253
  v_mul_f32 v157, v157, v253
  v_mul_f32 v158, v158, v253
  v_mul_f32 v159, v159, v253
  v_accvgpr_write_b32 a36, v156
  v_accvgpr_write_b32 a37, v157
  v_accvgpr_write_b32 a38, v158
  v_accvgpr_write_b32 a39, v159
  v_accvgpr_read_b32 v156, a40
  v_accvgpr_read_b32 v157, a41
  v_accvgpr_read_b32 v158, a42
  v_accvgpr_read_b32 v159, a43
  v_mul_f32 v156, v156, v253
  v_mul_f32 v157, v157, v253
  v_mul_f32 v158, v158, v253
  v_mul_f32 v159, v159, v253
  v_accvgpr_write_b32 a40, v156
  v_accvgpr_write_b32 a41, v157
  v_accvgpr_write_b32 a42, v158
  v_accvgpr_write_b32 a43, v159
  v_accvgpr_read_b32 v156, a44
  v_accvgpr_read_b32 v157, a45
  v_accvgpr_read_b32 v158, a46
  v_accvgpr_read_b32 v159, a47
  v_mul_f32 v156, v156, v253
  v_mul_f32 v157, v157, v253
  v_mul_f32 v158, v158, v253
  v_mul_f32 v159, v159, v253
  v_accvgpr_write_b32 a44, v156
  v_accvgpr_write_b32 a45, v157
  v_accvgpr_write_b32 a46, v158
  v_accvgpr_write_b32 a47, v159
  v_accvgpr_read_b32 v156, a96
  v_accvgpr_read_b32 v157, a97
  v_accvgpr_read_b32 v158, a98
  v_accvgpr_read_b32 v159, a99
  v_mul_f32 v156, v156, v253
  v_mul_f32 v157, v157, v253
  v_mul_f32 v158, v158, v253
  v_mul_f32 v159, v159, v253
  v_accvgpr_write_b32 a96, v156
  v_accvgpr_write_b32 a97, v157
  v_accvgpr_write_b32 a98, v158
  v_accvgpr_write_b32 a99, v159
  v_accvgpr_read_b32 v156, a100
  v_accvgpr_read_b32 v157, a101
  v_accvgpr_read_b32 v158, a102
  v_accvgpr_read_b32 v159, a103
  v_mul_f32 v156, v156, v253
  v_mul_f32 v157, v157, v253
  v_mul_f32 v158, v158, v253
  v_mul_f32 v159, v159, v253
  v_accvgpr_write_b32 a100, v156
  v_accvgpr_write_b32 a101, v157
  v_accvgpr_write_b32 a102, v158
  v_accvgpr_write_b32 a103, v159
  v_accvgpr_read_b32 v156, a104
  v_accvgpr_read_b32 v157, a105
  v_accvgpr_read_b32 v158, a106
  v_accvgpr_read_b32 v159, a107
  v_mul_f32 v156, v156, v253
  v_mul_f32 v157, v157, v253
  v_mul_f32 v158, v158, v253
  v_mul_f32 v159, v159, v253
  v_accvgpr_write_b32 a104, v156
  v_accvgpr_write_b32 a105, v157
  v_accvgpr_write_b32 a106, v158
  v_accvgpr_write_b32 a107, v159
  v_accvgpr_read_b32 v156, a108
  v_accvgpr_read_b32 v157, a109
  v_accvgpr_read_b32 v158, a110
  v_accvgpr_read_b32 v159, a111
  v_mul_f32 v156, v156, v253
  v_mul_f32 v157, v157, v253
  v_mul_f32 v158, v158, v253
  v_mul_f32 v159, v159, v253
  v_accvgpr_write_b32 a108, v156
  v_accvgpr_write_b32 a109, v157
  v_accvgpr_write_b32 a110, v158
  v_accvgpr_write_b32 a111, v159
  v_max3_f32 v252, v72, v73, v74
  v_max3_f32 v252, v252, v75, v76
  v_max3_f32 v252, v252, v77, v78
  v_max3_f32 v252, v252, v79, 0
  v_mov_b32 v253, v252
  s_nop 1
  v_permlane16_swap_b32 v252, v253
  s_nop 1
  v_max_f32 v252, v252, v253
  v_mov_b32 v253, v252
  s_nop 1
  v_permlane32_swap_b32 v252, v253
  s_nop 1
  v_max_f32 v252, v252, v253
  v_exp_f32 v253, -v252
  v_sub_f32 v124, v124, v252
  v_sub_f32 v125, v125, v252
  v_sub_f32 v126, v126, v252
  v_sub_f32 v127, v127, v252
  v_sub_f32 v72, v72, v252
  v_sub_f32 v40, v40, v252
  v_sub_f32 v73, v73, v252
  v_sub_f32 v41, v41, v252
  v_sub_f32 v74, v74, v252
  v_sub_f32 v42, v42, v252
  v_sub_f32 v75, v75, v252
  v_sub_f32 v43, v43, v252
  v_sub_f32 v76, v76, v252
  v_sub_f32 v44, v44, v252
  v_sub_f32 v77, v77, v252
  v_sub_f32 v45, v45, v252
  v_sub_f32 v78, v78, v252
  v_sub_f32 v46, v46, v252
  v_sub_f32 v79, v79, v252
  v_sub_f32 v47, v47, v252
  v_mul_f32 v140, v140, v253
  v_accvgpr_read_b32 v156, a48
  v_accvgpr_read_b32 v157, a49
  v_accvgpr_read_b32 v158, a50
  v_accvgpr_read_b32 v159, a51
  v_mul_f32 v156, v156, v253
  v_mul_f32 v157, v157, v253
  v_mul_f32 v158, v158, v253
  v_mul_f32 v159, v159, v253
  v_accvgpr_write_b32 a48, v156
  v_accvgpr_write_b32 a49, v157
  v_accvgpr_write_b32 a50, v158
  v_accvgpr_write_b32 a51, v159
  v_accvgpr_read_b32 v156, a52
  v_accvgpr_read_b32 v157, a53
  v_accvgpr_read_b32 v158, a54
  v_accvgpr_read_b32 v159, a55
  v_mul_f32 v156, v156, v253
  v_mul_f32 v157, v157, v253
  v_mul_f32 v158, v158, v253
  v_mul_f32 v159, v159, v253
  v_accvgpr_write_b32 a52, v156
  v_accvgpr_write_b32 a53, v157
  v_accvgpr_write_b32 a54, v158
  v_accvgpr_write_b32 a55, v159
  v_accvgpr_read_b32 v156, a56
  v_accvgpr_read_b32 v157, a57
  v_accvgpr_read_b32 v158, a58
  v_accvgpr_read_b32 v159, a59
  v_mul_f32 v156, v156, v253
  v_mul_f32 v157, v157, v253
  v_mul_f32 v158, v158, v253
  v_mul_f32 v159, v159, v253
  v_accvgpr_write_b32 a56, v156
  v_accvgpr_write_b32 a57, v157
  v_accvgpr_write_b32 a58, v158
  v_accvgpr_write_b32 a59, v159
  v_accvgpr_read_b32 v156, a60
  v_accvgpr_read_b32 v157, a61
  v_accvgpr_read_b32 v158, a62
  v_accvgpr_read_b32 v159, a63
  v_mul_f32 v156, v156, v253
  v_mul_f32 v157, v157, v253
  v_mul_f32 v158, v158, v253
  v_mul_f32 v159, v159, v253
  v_accvgpr_write_b32 a60, v156
  v_accvgpr_write_b32 a61, v157
  v_accvgpr_write_b32 a62, v158
  v_accvgpr_write_b32 a63, v159
  v_accvgpr_read_b32 v156, a112
  v_accvgpr_read_b32 v157, a113
  v_accvgpr_read_b32 v158, a114
  v_accvgpr_read_b32 v159, a115
  v_mul_f32 v156, v156, v253
  v_mul_f32 v157, v157, v253
  v_mul_f32 v158, v158, v253
  v_mul_f32 v159, v159, v253
  v_accvgpr_write_b32 a112, v156
  v_accvgpr_write_b32 a113, v157
  v_accvgpr_write_b32 a114, v158
  v_accvgpr_write_b32 a115, v159
  v_accvgpr_read_b32 v156, a116
  v_accvgpr_read_b32 v157, a117
  v_accvgpr_read_b32 v158, a118
  v_accvgpr_read_b32 v159, a119
  v_mul_f32 v156, v156, v253
  v_mul_f32 v157, v157, v253
  v_mul_f32 v158, v158, v253
  v_mul_f32 v159, v159, v253
  v_accvgpr_write_b32 a116, v156
  v_accvgpr_write_b32 a117, v157
  v_accvgpr_write_b32 a118, v158
  v_accvgpr_write_b32 a119, v159
  v_accvgpr_read_b32 v156, a120
  v_accvgpr_read_b32 v157, a121
  v_accvgpr_read_b32 v158, a122
  v_accvgpr_read_b32 v159, a123
  v_mul_f32 v156, v156, v253
  v_mul_f32 v157, v157, v253
  v_mul_f32 v158, v158, v253
  v_mul_f32 v159, v159, v253
  v_accvgpr_write_b32 a120, v156
  v_accvgpr_write_b32 a121, v157
  v_accvgpr_write_b32 a122, v158
  v_accvgpr_write_b32 a123, v159
  v_accvgpr_read_b32 v156, a124
  v_accvgpr_read_b32 v157, a125
  v_accvgpr_read_b32 v158, a126
  v_accvgpr_read_b32 v159, a127
  v_mul_f32 v156, v156, v253
  v_mul_f32 v157, v157, v253
  v_mul_f32 v158, v158, v253
  v_mul_f32 v159, v159, v253
  v_accvgpr_write_b32 a124, v156
  v_accvgpr_write_b32 a125, v157
  v_accvgpr_write_b32 a126, v158
  v_accvgpr_write_b32 a127, v159
  s_nop 1
  v_exp_f32 v148, v48
  v_exp_f32 v149, v49
  v_exp_f32 v150, v50
  v_cvt_pk_bf16_f32 v96, v148, v149
  v_exp_f32 v151, v51
  v_exp_f32 v152, v52
  v_cvt_pk_bf16_f32 v97, v150, v151
  v_exp_f32 v153, v53
  v_exp_f32 v154, v54
  v_cvt_pk_bf16_f32 v98, v152, v153
  v_exp_f32 v155, v55
  v_exp_f32 v148, v56
  v_cvt_pk_bf16_f32 v99, v154, v155
  v_exp_f32 v149, v57
  v_exp_f32 v150, v58
  v_cvt_pk_bf16_f32 v100, v148, v149
  v_mfma_f32_16x16x32_bf16 v[224:227], v[244:247], v[96:99], v[128:131]
  v_exp_f32 v151, v59
  v_exp_f32 v152, v60
  v_cvt_pk_bf16_f32 v101, v150, v151
  v_exp_f32 v153, v61
  v_exp_f32 v154, v62
  v_cvt_pk_bf16_f32 v102, v152, v153
  v_exp_f32 v155, v63
  v_exp_f32 v148, v64
  v_cvt_pk_bf16_f32 v103, v154, v155
  v_exp_f32 v149, v65
  v_exp_f32 v150, v66
  v_cvt_pk_bf16_f32 v104, v148, v149
  v_mfma_f32_16x16x32_bf16 v[228:231], v[244:247], v[100:103], v[132:135]
  v_exp_f32 v151, v67
  v_exp_f32 v152, v68
  v_cvt_pk_bf16_f32 v105, v150, v151
  v_exp_f32 v153, v69
  v_exp_f32 v154, v70
  v_cvt_pk_bf16_f32 v106, v152, v153
  v_exp_f32 v155, v71
  v_exp_f32 v148, v72
  v_cvt_pk_bf16_f32 v107, v154, v155
  v_exp_f32 v149, v73
  v_exp_f32 v150, v74
  v_cvt_pk_bf16_f32 v108, v148, v149
  v_mfma_f32_16x16x32_bf16 v[232:235], v[244:247], v[104:107], v[136:139]
  v_exp_f32 v151, v75
  v_exp_f32 v152, v76
  v_cvt_pk_bf16_f32 v109, v150, v151
  v_exp_f32 v153, v77
  v_exp_f32 v154, v78
  v_cvt_pk_bf16_f32 v110, v152, v153
  v_exp_f32 v155, v79
  s_nop 0
  v_cvt_pk_bf16_f32 v111, v154, v155
  s_nop 1
  v_mfma_f32_16x16x32_bf16 v[236:239], v[244:247], v[108:111], v[140:143]
  s_nop 7
  s_branch K2_RARE_O_ret
K2_RARE_E:
  s_nop 15
  s_nop 7
  v_max3_f32 v252, v16, v17, v18
  v_max3_f32 v252, v252, v19, v20
  v_max3_f32 v252, v252, v21, v22
  v_max3_f32 v252, v252, v23, 0
  v_mov_b32 v253, v252
  s_nop 1
  v_permlane16_swap_b32 v252, v253
  s_nop 1
  v_max_f32 v252, v252, v253
  v_mov_b32 v253, v252
  s_nop 1
  v_permlane32_swap_b32 v252, v253
  s_nop 1
  v_max_f32 v252, v252, v253
  v_exp_f32 v253, -v252
  v_sub_f32 v112, v112, v252
  v_sub_f32 v113, v113, v252
  v_sub_f32 v114, v114, v252
  v_sub_f32 v115, v115, v252
  v_sub_f32 v16, v16, v252
  v_sub_f32 v48, v48, v252
  v_sub_f32 v17, v17, v252
  v_sub_f32 v49, v49, v252
  v_sub_f32 v18, v18, v252
  v_sub_f32 v50, v50, v252
  v_sub_f32 v19, v19, v252
  v_sub_f32 v51, v51, v252
  v_sub_f32 v20, v20, v252
  v_sub_f32 v52, v52, v252
  v_sub_f32 v21, v21, v252
  v_sub_f32 v53, v53, v252
  v_sub_f32 v22, v22, v252
  v_sub_f32 v54, v54, v252
  v_sub_f32 v23, v23, v252
  v_sub_f32 v55, v55, v252
  v_mul_f32 v224, v224, v253
  v_accvgpr_read_b32 v156, a0
  v_accvgpr_read_b32 v157, a1
  v_accvgpr_read_b32 v158, a2
  v_accvgpr_read_b32 v159, a3
  v_mul_f32 v156, v156, v253
  v_mul_f32 v157, v157, v253
  v_mul_f32 v158, v158, v253
  v_mul_f32 v159, v159, v253
  v_accvgpr_write_b32 a0, v156
  v_accvgpr_write_b32 a1, v157
  v_accvgpr_write_b32 a2, v158
  v_accvgpr_write_b32 a3, v159
  v_accvgpr_read_b32 v156, a4
  v_accvgpr_read_b32 v157, a5
  v_accvgpr_read_b32 v158, a6
  v_accvgpr_read_b32 v159, a7
  v_mul_f32 v156, v156, v253
  v_mul_f32 v157, v157, v253
  v_mul_f32 v158, v158, v253
  v_mul_f32 v159, v159, v253
  v_accvgpr_write_b32 a4, v156
  v_accvgpr_write_b32 a5, v157
  v_accvgpr_write_b32 a6, v158
  v_accvgpr_write_b32 a7, v159
  v_accvgpr_read_b32 v156, a8
  v_accvgpr_read_b32 v157, a9
  v_accvgpr_read_b32 v158, a10
  v_accvgpr_read_b32 v159, a11
  v_mul_f32 v156, v156, v253
  v_mul_f32 v157, v157, v253
  v_mul_f32 v158, v158, v253
  v_mul_f32 v159, v159, v253
  v_accvgpr_write_b32 a8, v156
  v_accvgpr_write_b32 a9, v157
  v_accvgpr_write_b32 a10, v158
  v_accvgpr_write_b32 a11, v159
  v_accvgpr_read_b32 v156, a12
  v_accvgpr_read_b32 v157, a13
  v_accvgpr_read_b32 v158, a14
  v_accvgpr_read_b32 v159, a15
  v_mul_f32 v156, v156, v253
  v_mul_f32 v157, v157, v253
  v_mul_f32 v158, v158, v253
  v_mul_f32 v159, v159, v253
  v_accvgpr_write_b32 a12, v156
  v_accvgpr_write_b32 a13, v157
  v_accvgpr_write_b32 a14, v158
  v_accvgpr_write_b32 a15, v159
  v_accvgpr_read_b32 v156, a64
  v_accvgpr_read_b32 v157, a65
  v_accvgpr_read_b32 v158, a66
  v_accvgpr_read_b32 v159, a67
  v_mul_f32 v156, v156, v253
  v_mul_f32 v157, v157, v253
  v_mul_f32 v158, v158, v253
  v_mul_f32 v159, v159, v253
  v_accvgpr_write_b32 a64, v156
  v_accvgpr_write_b32 a65, v157
  v_accvgpr_write_b32 a66, v158
  v_accvgpr_write_b32 a67, v159
  v_accvgpr_read_b32 v156, a68
  v_accvgpr_read_b32 v157, a69
  v_accvgpr_read_b32 v158, a70
  v_accvgpr_read_b32 v159, a71
  v_mul_f32 v156, v156, v253
  v_mul_f32 v157, v157, v253
  v_mul_f32 v158, v158, v253
  v_mul_f32 v159, v159, v253
  v_accvgpr_write_b32 a68, v156
  v_accvgpr_write_b32 a69, v157
  v_accvgpr_write_b32 a70, v158
  v_accvgpr_write_b32 a71, v159
  v_accvgpr_read_b32 v156, a72
  v_accvgpr_read_b32 v157, a73
  v_accvgpr_read_b32 v158, a74
  v_accvgpr_read_b32 v159, a75
  v_mul_f32 v156, v156, v253
  v_mul_f32 v157, v157, v253
  v_mul_f32 v158, v158, v253
  v_mul_f32 v159, v159, v253
  v_accvgpr_write_b32 a72, v156
  v_accvgpr_write_b32 a73, v157
  v_accvgpr_write_b32 a74, v158
  v_accvgpr_write_b32 a75, v159
  v_accvgpr_read_b32 v156, a76
  v_accvgpr_read_b32 v157, a77
  v_accvgpr_read_b32 v158, a78
  v_accvgpr_read_b32 v159, a79
  v_mul_f32 v156, v156, v253
  v_mul_f32 v157, v157, v253
  v_mul_f32 v158, v158, v253
  v_mul_f32 v159, v159, v253
  v_accvgpr_write_b32 a76, v156
  v_accvgpr_write_b32 a77, v157
  v_accvgpr_write_b32 a78, v158
  v_accvgpr_write_b32 a79, v159
  v_max3_f32 v252, v24, v25, v26
  v_max3_f32 v252, v252, v27, v28
  v_max3_f32 v252, v252, v29, v30
  v_max3_f32 v252, v252, v31, 0
  v_mov_b32 v253, v252
  s_nop 1
  v_permlane16_swap_b32 v252, v253
  s_nop 1
  v_max_f32 v252, v252, v253
  v_mov_b32 v253, v252
  s_nop 1
  v_permlane32_swap_b32 v252, v253
  s_nop 1
  v_max_f32 v252, v252, v253
  v_exp_f32 v253, -v252
  v_sub_f32 v116, v116, v252
  v_sub_f32 v117, v117, v252
  v_sub_f32 v118, v118, v252
  v_sub_f32 v119, v119, v252
  v_sub_f32 v24, v24, v252
  v_sub_f32 v56, v56, v252
  v_sub_f32 v25, v25, v252
  v_sub_f32 v57, v57, v252
  v_sub_f32 v26, v26, v252
  v_sub_f32 v58, v58, v252
  v_sub_f32 v27, v27, v252
  v_sub_f32 v59, v59, v252
  v_sub_f32 v28, v28, v252
  v_sub_f32 v60, v60, v252
  v_sub_f32 v29, v29, v252
  v_sub_f32 v61, v61, v252
  v_sub_f32 v30, v30, v252
  v_sub_f32 v62, v62, v252
  v_sub_f32 v31, v31, v252
  v_sub_f32 v63, v63, v252
  v_mul_f32 v228, v228, v253
  v_accvgpr_read_b32 v156, a16
  v_accvgpr_read_b32 v157, a17
  v_accvgpr_read_b32 v158, a18
  v_accvgpr_read_b32 v159, a19
  v_mul_f32 v156, v156, v253
  v_mul_f32 v157, v157, v253
  v_mul_f32 v158, v158, v253
  v_mul_f32 v159, v159, v253
  v_accvgpr_write_b32 a16, v156
  v_accvgpr_write_b32 a17, v157
  v_accvgpr_write_b32 a18, v158
  v_accvgpr_write_b32 a19, v159
  v_accvgpr_read_b32 v156, a20
  v_accvgpr_read_b32 v157, a21
  v_accvgpr_read_b32 v158, a22
  v_accvgpr_read_b32 v159, a23
  v_mul_f32 v156, v156, v253
  v_mul_f32 v157, v157, v253
  v_mul_f32 v158, v158, v253
  v_mul_f32 v159, v159, v253
  v_accvgpr_write_b32 a20, v156
  v_accvgpr_write_b32 a21, v157
  v_accvgpr_write_b32 a22, v158
  v_accvgpr_write_b32 a23, v159
  v_accvgpr_read_b32 v156, a24
  v_accvgpr_read_b32 v157, a25
  v_accvgpr_read_b32 v158, a26
  v_accvgpr_read_b32 v159, a27
  v_mul_f32 v156, v156, v253
  v_mul_f32 v157, v157, v253
  v_mul_f32 v158, v158, v253
  v_mul_f32 v159, v159, v253
  v_accvgpr_write_b32 a24, v156
  v_accvgpr_write_b32 a25, v157
  v_accvgpr_write_b32 a26, v158
  v_accvgpr_write_b32 a27, v159
  v_accvgpr_read_b32 v156, a28
  v_accvgpr_read_b32 v157, a29
  v_accvgpr_read_b32 v158, a30
  v_accvgpr_read_b32 v159, a31
  v_mul_f32 v156, v156, v253
  v_mul_f32 v157, v157, v253
  v_mul_f32 v158, v158, v253
  v_mul_f32 v159, v159, v253
  v_accvgpr_write_b32 a28, v156
  v_accvgpr_write_b32 a29, v157
  v_accvgpr_write_b32 a30, v158
  v_accvgpr_write_b32 a31, v159
  v_accvgpr_read_b32 v156, a80
  v_accvgpr_read_b32 v157, a81
  v_accvgpr_read_b32 v158, a82
  v_accvgpr_read_b32 v159, a83
  v_mul_f32 v156, v156, v253
  v_mul_f32 v157, v157, v253
  v_mul_f32 v158, v158, v253
  v_mul_f32 v159, v159, v253
  v_accvgpr_write_b32 a80, v156
  v_accvgpr_write_b32 a81, v157
  v_accvgpr_write_b32 a82, v158
  v_accvgpr_write_b32 a83, v159
  v_accvgpr_read_b32 v156, a84
  v_accvgpr_read_b32 v157, a85
  v_accvgpr_read_b32 v158, a86
  v_accvgpr_read_b32 v159, a87
  v_mul_f32 v156, v156, v253
  v_mul_f32 v157, v157, v253
  v_mul_f32 v158, v158, v253
  v_mul_f32 v159, v159, v253
  v_accvgpr_write_b32 a84, v156
  v_accvgpr_write_b32 a85, v157
  v_accvgpr_write_b32 a86, v158
  v_accvgpr_write_b32 a87, v159
  v_accvgpr_read_b32 v156, a88
  v_accvgpr_read_b32 v157, a89
  v_accvgpr_read_b32 v158, a90
  v_accvgpr_read_b32 v159, a91
  v_mul_f32 v156, v156, v253
  v_mul_f32 v157, v157, v253
  v_mul_f32 v158, v158, v253
  v_mul_f32 v159, v159, v253
  v_accvgpr_write_b32 a88, v156
  v_accvgpr_write_b32 a89, v157
  v_accvgpr_write_b32 a90, v158
  v_accvgpr_write_b32 a91, v159
  v_accvgpr_read_b32 v156, a92
  v_accvgpr_read_b32 v157, a93
  v_accvgpr_read_b32 v158, a94
  v_accvgpr_read_b32 v159, a95
  v_mul_f32 v156, v156, v253
  v_mul_f32 v157, v157, v253
  v_mul_f32 v158, v158, v253
  v_mul_f32 v159, v159, v253
  v_accvgpr_write_b32 a92, v156
  v_accvgpr_write_b32 a93, v157
  v_accvgpr_write_b32 a94, v158
  v_accvgpr_write_b32 a95, v159
  v_max3_f32 v252, v32, v33, v34
  v_max3_f32 v252, v252, v35, v36
  v_max3_f32 v252, v252, v37, v38
  v_max3_f32 v252, v252, v39, 0
  v_mov_b32 v253, v252
  s_nop 1
  v_permlane16_swap_b32 v252, v253
  s_nop 1
  v_max_f32 v252, v252, v253
  v_mov_b32 v253, v252
  s_nop 1
  v_permlane32_swap_b32 v252, v253
  s_nop 1
  v_max_f32 v252, v252, v253
  v_exp_f32 v253, -v252
  v_sub_f32 v120, v120, v252
  v_sub_f32 v121, v121, v252
  v_sub_f32 v122, v122, v252
  v_sub_f32 v123, v123, v252
  v_sub_f32 v32, v32, v252
  v_sub_f32 v64, v64, v252
  v_sub_f32 v33, v33, v252
  v_sub_f32 v65, v65, v252
  v_sub_f32 v34, v34, v252
  v_sub_f32 v66, v66, v252
  v_sub_f32 v35, v35, v252
  v_sub_f32 v67, v67, v252
  v_sub_f32 v36, v36, v252
  v_sub_f32 v68, v68, v252
  v_sub_f32 v37, v37, v252
  v_sub_f32 v69, v69, v252
  v_sub_f32 v38, v38, v252
  v_sub_f32 v70, v70, v252
  v_sub_f32 v39, v39, v252
  v_sub_f32 v71, v71, v252
  v_mul_f32 v232, v232, v253
  v_accvgpr_read_b32 v156, a32
  v_accvgpr_read_b32 v157, a33
  v_accvgpr_read_b32 v158, a34
  v_accvgpr_read_b32 v159, a35
  v_mul_f32 v156, v156, v253
  v_mul_f32 v157, v157, v253
  v_mul_f32 v158, v158, v253
  v_mul_f32 v159, v159, v253
  v_accvgpr_write_b32 a32, v156
  v_accvgpr_write_b32 a33, v157
  v_accvgpr_write_b32 a34, v158
  v_accvgpr_write_b32 a35, v159
  v_accvgpr_read_b32 v156, a36
  v_accvgpr_read_b32 v157, a37
  v_accvgpr_read_b32 v158, a38
  v_accvgpr_read_b32 v159, a39
  v_mul_f32 v156, v156, v253
  v_mul_f32 v157, v157, v253
  v_mul_f32 v158, v158, v253
  v_mul_f32 v159, v159, v253
  v_accvgpr_write_b32 a36, v156
  v_accvgpr_write_b32 a37, v157
  v_accvgpr_write_b32 a38, v158
  v_accvgpr_write_b32 a39, v159
  v_accvgpr_read_b32 v156, a40
  v_accvgpr_read_b32 v157, a41
  v_accvgpr_read_b32 v158, a42
  v_accvgpr_read_b32 v159, a43
  v_mul_f32 v156, v156, v253
  v_mul_f32 v157, v157, v253
  v_mul_f32 v158, v158, v253
  v_mul_f32 v159, v159, v253
  v_accvgpr_write_b32 a40, v156
  v_accvgpr_write_b32 a41, v157
  v_accvgpr_write_b32 a42, v158
  v_accvgpr_write_b32 a43, v159
  v_accvgpr_read_b32 v156, a44
  v_accvgpr_read_b32 v157, a45
  v_accvgpr_read_b32 v158, a46
  v_accvgpr_read_b32 v159, a47
  v_mul_f32 v156, v156, v253
  v_mul_f32 v157, v157, v253
  v_mul_f32 v158, v158, v253
  v_mul_f32 v159, v159, v253
  v_accvgpr_write_b32 a44, v156
  v_accvgpr_write_b32 a45, v157
  v_accvgpr_write_b32 a46, v158
  v_accvgpr_write_b32 a47, v159
  v_accvgpr_read_b32 v156, a96
  v_accvgpr_read_b32 v157, a97
  v_accvgpr_read_b32 v158, a98
  v_accvgpr_read_b32 v159, a99
  v_mul_f32 v156, v156, v253
  v_mul_f32 v157, v157, v253
  v_mul_f32 v158, v158, v253
  v_mul_f32 v159, v159, v253
  v_accvgpr_write_b32 a96, v156
  v_accvgpr_write_b32 a97, v157
  v_accvgpr_write_b32 a98, v158
  v_accvgpr_write_b32 a99, v159
  v_accvgpr_read_b32 v156, a100
  v_accvgpr_read_b32 v157, a101
  v_accvgpr_read_b32 v158, a102
  v_accvgpr_read_b32 v159, a103
  v_mul_f32 v156, v156, v253
  v_mul_f32 v157, v157, v253
  v_mul_f32 v158, v158, v253
  v_mul_f32 v159, v159, v253
  v_accvgpr_write_b32 a100, v156
  v_accvgpr_write_b32 a101, v157
  v_accvgpr_write_b32 a102, v158
  v_accvgpr_write_b32 a103, v159
  v_accvgpr_read_b32 v156, a104
  v_accvgpr_read_b32 v157, a105
  v_accvgpr_read_b32 v158, a106
  v_accvgpr_read_b32 v159, a107
  v_mul_f32 v156, v156, v253
  v_mul_f32 v157, v157, v253
  v_mul_f32 v158, v158, v253
  v_mul_f32 v159, v159, v253
  v_accvgpr_write_b32 a104, v156
  v_accvgpr_write_b32 a105, v157
  v_accvgpr_write_b32 a106, v158
  v_accvgpr_write_b32 a107, v159
  v_accvgpr_read_b32 v156, a108
  v_accvgpr_read_b32 v157, a109
  v_accvgpr_read_b32 v158, a110
  v_accvgpr_read_b32 v159, a111
  v_mul_f32 v156, v156, v253
  v_mul_f32 v157, v157, v253
  v_mul_f32 v158, v158, v253
  v_mul_f32 v159, v159, v253
  v_accvgpr_write_b32 a108, v156
  v_accvgpr_write_b32 a109, v157
  v_accvgpr_write_b32 a110, v158
  v_accvgpr_write_b32 a111, v159
  v_max3_f32 v252, v40, v41, v42
  v_max3_f32 v252, v252, v43, v44
  v_max3_f32 v252, v252, v45, v46
  v_max3_f32 v252, v252, v47, 0
  v_mov_b32 v253, v252
  s_nop 1
  v_permlane16_swap_b32 v252, v253
  s_nop 1
  v_max_f32 v252, v252, v253
  v_mov_b32 v253, v252
  s_nop 1
  v_permlane32_swap_b32 v252, v253
  s_nop 1
  v_max_f32 v252, v252, v253
  v_exp_f32 v253, -v252
  v_sub_f32 v124, v124, v252
  v_sub_f32 v125, v125, v252
  v_sub_f32 v126, v126, v252
  v_sub_f32 v127, v127, v252
  v_sub_f32 v40, v40, v252
  v_sub_f32 v72, v72, v252
  v_sub_f32 v41, v41, v252
  v_sub_f32 v73, v73, v252
  v_sub_f32 v42, v42, v252
  v_sub_f32 v74, v74, v252
  v_sub_f32 v43, v43, v252
  v_sub_f32 v75, v75, v252
  v_sub_f32 v44, v44, v252
  v_sub_f32 v76, v76, v252
  v_sub_f32 v45, v45, v252
  v_sub_f32 v77, v77, v252
  v_sub_f32 v46, v46, v252
  v_sub_f32 v78, v78, v252
  v_sub_f32 v47, v47, v252
  v_sub_f32 v79, v79, v252
  v_mul_f32 v236, v236, v253
  v_accvgpr_read_b32 v156, a48
  v_accvgpr_read_b32 v157, a49
  v_accvgpr_read_b32 v158, a50
  v_accvgpr_read_b32 v159, a51
  v_mul_f32 v156, v156, v253
  v_mul_f32 v157, v157, v253
  v_mul_f32 v158, v158, v253
  v_mul_f32 v159, v159, v253
  v_accvgpr_write_b32 a48, v156
  v_accvgpr_write_b32 a49, v157
  v_accvgpr_write_b32 a50, v158
  v_accvgpr_write_b32 a51, v159
  v_accvgpr_read_b32 v156, a52
  v_accvgpr_read_b32 v157, a53
  v_accvgpr_read_b32 v158, a54
  v_accvgpr_read_b32 v159, a55
  v_mul_f32 v156, v156, v253
  v_mul_f32 v157, v157, v253
  v_mul_f32 v158, v158, v253
  v_mul_f32 v159, v159, v253
  v_accvgpr_write_b32 a52, v156
  v_accvgpr_write_b32 a53, v157
  v_accvgpr_write_b32 a54, v158
  v_accvgpr_write_b32 a55, v159
  v_accvgpr_read_b32 v156, a56
  v_accvgpr_read_b32 v157, a57
  v_accvgpr_read_b32 v158, a58
  v_accvgpr_read_b32 v159, a59
  v_mul_f32 v156, v156, v253
  v_mul_f32 v157, v157, v253
  v_mul_f32 v158, v158, v253
  v_mul_f32 v159, v159, v253
  v_accvgpr_write_b32 a56, v156
  v_accvgpr_write_b32 a57, v157
  v_accvgpr_write_b32 a58, v158
  v_accvgpr_write_b32 a59, v159
  v_accvgpr_read_b32 v156, a60
  v_accvgpr_read_b32 v157, a61
  v_accvgpr_read_b32 v158, a62
  v_accvgpr_read_b32 v159, a63
  v_mul_f32 v156, v156, v253
  v_mul_f32 v157, v157, v253
  v_mul_f32 v158, v158, v253
  v_mul_f32 v159, v159, v253
  v_accvgpr_write_b32 a60, v156
  v_accvgpr_write_b32 a61, v157
  v_accvgpr_write_b32 a62, v158
  v_accvgpr_write_b32 a63, v159
  v_accvgpr_read_b32 v156, a112
  v_accvgpr_read_b32 v157, a113
  v_accvgpr_read_b32 v158, a114
  v_accvgpr_read_b32 v159, a115
  v_mul_f32 v156, v156, v253
  v_mul_f32 v157, v157, v253
  v_mul_f32 v158, v158, v253
  v_mul_f32 v159, v159, v253
  v_accvgpr_write_b32 a112, v156
  v_accvgpr_write_b32 a113, v157
  v_accvgpr_write_b32 a114, v158
  v_accvgpr_write_b32 a115, v159
  v_accvgpr_read_b32 v156, a116
  v_accvgpr_read_b32 v157, a117
  v_accvgpr_read_b32 v158, a118
  v_accvgpr_read_b32 v159, a119
  v_mul_f32 v156, v156, v253
  v_mul_f32 v157, v157, v253
  v_mul_f32 v158, v158, v253
  v_mul_f32 v159, v159, v253
  v_accvgpr_write_b32 a116, v156
  v_accvgpr_write_b32 a117, v157
  v_accvgpr_write_b32 a118, v158
  v_accvgpr_write_b32 a119, v159
  v_accvgpr_read_b32 v156, a120
  v_accvgpr_read_b32 v157, a121
  v_accvgpr_read_b32 v158, a122
  v_accvgpr_read_b32 v159, a123
  v_mul_f32 v156, v156, v253
  v_mul_f32 v157, v157, v253
  v_mul_f32 v158, v158, v253
  v_mul_f32 v159, v159, v253
  v_accvgpr_write_b32 a120, v156
  v_accvgpr_write_b32 a121, v157
  v_accvgpr_write_b32 a122, v158
  v_accvgpr_write_b32 a123, v159
  v_accvgpr_read_b32 v156, a124
  v_accvgpr_read_b32 v157, a125
  v_accvgpr_read_b32 v158, a126
  v_accvgpr_read_b32 v159, a127
  v_mul_f32 v156, v156, v253
  v_mul_f32 v157, v157, v253
  v_mul_f32 v158, v158, v253
  v_mul_f32 v159, v159, v253
  v_accvgpr_write_b32 a124, v156
  v_accvgpr_write_b32 a125, v157
  v_accvgpr_write_b32 a126, v158
  v_accvgpr_write_b32 a127, v159
  s_nop 1
  v_exp_f32 v148, v16
  v_exp_f32 v149, v17
  v_exp_f32 v150, v18
  v_cvt_pk_bf16_f32 v80, v148, v149
  v_exp_f32 v151, v19
  v_exp_f32 v152, v20
  v_cvt_pk_bf16_f32 v81, v150, v151
  v_exp_f32 v153, v21
  v_exp_f32 v154, v22
  v_cvt_pk_bf16_f32 v82, v152, v153
  v_exp_f32 v155, v23
  v_exp_f32 v148, v24
  v_cvt_pk_bf16_f32 v83, v154, v155
  v_exp_f32 v149, v25
  v_exp_f32 v150, v26
  v_cvt_pk_bf16_f32 v84, v148, v149
  v_mfma_f32_16x16x32_bf16 v[128:131], v[244:247], v[80:83], v[224:227]
  v_exp_f32 v151, v27
  v_exp_f32 v152, v28
  v_cvt_pk_bf16_f32 v85, v150, v151
  v_exp_f32 v153, v29
  v_exp_f32 v154, v30
  v_cvt_pk_bf16_f32 v86, v152, v153
  v_exp_f32 v155, v31
  v_exp_f32 v148, v32
  v_cvt_pk_bf16_f32 v87, v154, v155
  v_exp_f32 v149, v33
  v_exp_f32 v150, v34
  v_cvt_pk_bf16_f32 v88, v148, v149
  v_mfma_f32_16x16x32_bf16 v[132:135], v[244:247], v[84:87], v[228:231]
  v_exp_f32 v151, v35
  v_exp_f32 v152, v36
  v_cvt_pk_bf16_f32 v89, v150, v151
  v_exp_f32 v153, v37
  v_exp_f32 v154, v38
  v_cvt_pk_bf16_f32 v90, v152, v153
  v_exp_f32 v155, v39
  v_exp_f32 v148, v40
  v_cvt_pk_bf16_f32 v91, v154, v155
  v_exp_f32 v149, v41
  v_exp_f32 v150, v42
  v_cvt_pk_bf16_f32 v92, v148, v149
  v_mfma_f32_16x16x32_bf16 v[136:139], v[244:247], v[88:91], v[232:235]
  v_exp_f32 v151, v43
  v_exp_f32 v152, v44
  v_cvt_pk_bf16_f32 v93, v150, v151
  v_exp_f32 v153, v45
  v_exp_f32 v154, v46
  v_cvt_pk_bf16_f32 v94, v152, v153
  v_exp_f32 v155, v47
  s_nop 0
  v_cvt_pk_bf16_f32 v95, v154, v155
  s_nop 1
  v_mfma_f32_16x16x32_bf16 v[140:143], v[244:247], v[92:95], v[236:239]
  s_nop 7
  s_branch K2_RARE_E_ret
K2_RARE_T1:
  s_nop 15
  s_nop 7
  v_max3_f32 v252, v16, v17, v18
  v_max3_f32 v252, v252, v19, v20
  v_max3_f32 v252, v252, v21, v22
  v_max3_f32 v252, v252, v23, 0
  v_mov_b32 v253, v252
  s_nop 1
  v_permlane16_swap_b32 v252, v253
  s_nop 1
  v_max_f32 v252, v252, v253
  v_mov_b32 v253, v252
  s_nop 1
  v_permlane32_swap_b32 v252, v253
  s_nop 1
  v_max_f32 v252, v252, v253
  v_exp_f32 v253, -v252
  v_sub_f32 v112, v112, v252
  v_sub_f32 v113, v113, v252
  v_sub_f32 v114, v114, v252
  v_sub_f32 v115, v115, v252
  v_sub_f32 v16, v16, v252
  v_sub_f32 v48, v48, v252
  v_sub_f32 v17, v17, v252
  v_sub_f32 v49, v49, v252
  v_sub_f32 v18, v18, v252
  v_sub_f32 v50, v50, v252
  v_sub_f32 v19, v19, v252
  v_sub_f32 v51, v51, v252
  v_sub_f32 v20, v20, v252
  v_sub_f32 v52, v52, v252
  v_sub_f32 v21, v21, v252
  v_sub_f32 v53, v53, v252
  v_sub_f32 v22, v22, v252
  v_sub_f32 v54, v54, v252
  v_sub_f32 v23, v23, v252
  v_sub_f32 v55, v55, v252
  v_mul_f32 v224, v224, v253
  v_accvgpr_read_b32 v156, a0
  v_accvgpr_read_b32 v157, a1
  v_accvgpr_read_b32 v158, a2
  v_accvgpr_read_b32 v159, a3
  v_mul_f32 v156, v156, v253
  v_mul_f32 v157, v157, v253
  v_mul_f32 v158, v158, v253
  v_mul_f32 v159, v159, v253
  v_accvgpr_write_b32 a0, v156
  v_accvgpr_write_b32 a1, v157
  v_accvgpr_write_b32 a2, v158
  v_accvgpr_write_b32 a3, v159
  v_accvgpr_read_b32 v156, a4
  v_accvgpr_read_b32 v157, a5
  v_accvgpr_read_b32 v158, a6
  v_accvgpr_read_b32 v159, a7
  v_mul_f32 v156, v156, v253
  v_mul_f32 v157, v157, v253
  v_mul_f32 v158, v158, v253
  v_mul_f32 v159, v159, v253
  v_accvgpr_write_b32 a4, v156
  v_accvgpr_write_b32 a5, v157
  v_accvgpr_write_b32 a6, v158
  v_accvgpr_write_b32 a7, v159
  v_accvgpr_read_b32 v156, a8
  v_accvgpr_read_b32 v157, a9
  v_accvgpr_read_b32 v158, a10
  v_accvgpr_read_b32 v159, a11
  v_mul_f32 v156, v156, v253
  v_mul_f32 v157, v157, v253
  v_mul_f32 v158, v158, v253
  v_mul_f32 v159, v159, v253
  v_accvgpr_write_b32 a8, v156
  v_accvgpr_write_b32 a9, v157
  v_accvgpr_write_b32 a10, v158
  v_accvgpr_write_b32 a11, v159
  v_accvgpr_read_b32 v156, a12
  v_accvgpr_read_b32 v157, a13
  v_accvgpr_read_b32 v158, a14
  v_accvgpr_read_b32 v159, a15
  v_mul_f32 v156, v156, v253
  v_mul_f32 v157, v157, v253
  v_mul_f32 v158, v158, v253
  v_mul_f32 v159, v159, v253
  v_accvgpr_write_b32 a12, v156
  v_accvgpr_write_b32 a13, v157
  v_accvgpr_write_b32 a14, v158
  v_accvgpr_write_b32 a15, v159
  v_accvgpr_read_b32 v156, a64
  v_accvgpr_read_b32 v157, a65
  v_accvgpr_read_b32 v158, a66
  v_accvgpr_read_b32 v159, a67
  v_mul_f32 v156, v156, v253
  v_mul_f32 v157, v157, v253
  v_mul_f32 v158, v158, v253
  v_mul_f32 v159, v159, v253
  v_accvgpr_write_b32 a64, v156
  v_accvgpr_write_b32 a65, v157
  v_accvgpr_write_b32 a66, v158
  v_accvgpr_write_b32 a67, v159
  v_accvgpr_read_b32 v156, a68
  v_accvgpr_read_b32 v157, a69
  v_accvgpr_read_b32 v158, a70
  v_accvgpr_read_b32 v159, a71
  v_mul_f32 v156, v156, v253
  v_mul_f32 v157, v157, v253
  v_mul_f32 v158, v158, v253
  v_mul_f32 v159, v159, v253
  v_accvgpr_write_b32 a68, v156
  v_accvgpr_write_b32 a69, v157
  v_accvgpr_write_b32 a70, v158
  v_accvgpr_write_b32 a71, v159
  v_accvgpr_read_b32 v156, a72
  v_accvgpr_read_b32 v157, a73
  v_accvgpr_read_b32 v158, a74
  v_accvgpr_read_b32 v159, a75
  v_mul_f32 v156, v156, v253
  v_mul_f32 v157, v157, v253
  v_mul_f32 v158, v158, v253
  v_mul_f32 v159, v159, v253
  v_accvgpr_write_b32 a72, v156
  v_accvgpr_write_b32 a73, v157
  v_accvgpr_write_b32 a74, v158
  v_accvgpr_write_b32 a75, v159
  v_accvgpr_read_b32 v156, a76
  v_accvgpr_read_b32 v157, a77
  v_accvgpr_read_b32 v158, a78
  v_accvgpr_read_b32 v159, a79
  v_mul_f32 v156, v156, v253
  v_mul_f32 v157, v157, v253
  v_mul_f32 v158, v158, v253
  v_mul_f32 v159, v159, v253
  v_accvgpr_write_b32 a76, v156
  v_accvgpr_write_b32 a77, v157
  v_accvgpr_write_b32 a78, v158
  v_accvgpr_write_b32 a79, v159
  v_max3_f32 v252, v24, v25, v26
  v_max3_f32 v252, v252, v27, v28
  v_max3_f32 v252, v252, v29, v30
  v_max3_f32 v252, v252, v31, 0
  v_mov_b32 v253, v252
  s_nop 1
  v_permlane16_swap_b32 v252, v253
  s_nop 1
  v_max_f32 v252, v252, v253
  v_mov_b32 v253, v252
  s_nop 1
  v_permlane32_swap_b32 v252, v253
  s_nop 1
  v_max_f32 v252, v252, v253
  v_exp_f32 v253, -v252
  v_sub_f32 v116, v116, v252
  v_sub_f32 v117, v117, v252
  v_sub_f32 v118, v118, v252
  v_sub_f32 v119, v119, v252
  v_sub_f32 v24, v24, v252
  v_sub_f32 v56, v56, v252
  v_sub_f32 v25, v25, v252
  v_sub_f32 v57, v57, v252
  v_sub_f32 v26, v26, v252
  v_sub_f32 v58, v58, v252
  v_sub_f32 v27, v27, v252
  v_sub_f32 v59, v59, v252
  v_sub_f32 v28, v28, v252
  v_sub_f32 v60, v60, v252
  v_sub_f32 v29, v29, v252
  v_sub_f32 v61, v61, v252
  v_sub_f32 v30, v30, v252
  v_sub_f32 v62, v62, v252
  v_sub_f32 v31, v31, v252
  v_sub_f32 v63, v63, v252
  v_mul_f32 v228, v228, v253
  v_accvgpr_read_b32 v156, a16
  v_accvgpr_read_b32 v157, a17
  v_accvgpr_read_b32 v158, a18
  v_accvgpr_read_b32 v159, a19
  v_mul_f32 v156, v156, v253
  v_mul_f32 v157, v157, v253
  v_mul_f32 v158, v158, v253
  v_mul_f32 v159, v159, v253
  v_accvgpr_write_b32 a16, v156
  v_accvgpr_write_b32 a17, v157
  v_accvgpr_write_b32 a18, v158
  v_accvgpr_write_b32 a19, v159
  v_accvgpr_read_b32 v156, a20
  v_accvgpr_read_b32 v157, a21
  v_accvgpr_read_b32 v158, a22
  v_accvgpr_read_b32 v159, a23
  v_mul_f32 v156, v156, v253
  v_mul_f32 v157, v157, v253
  v_mul_f32 v158, v158, v253
  v_mul_f32 v159, v159, v253
  v_accvgpr_write_b32 a20, v156
  v_accvgpr_write_b32 a21, v157
  v_accvgpr_write_b32 a22, v158
  v_accvgpr_write_b32 a23, v159
  v_accvgpr_read_b32 v156, a24
  v_accvgpr_read_b32 v157, a25
  v_accvgpr_read_b32 v158, a26
  v_accvgpr_read_b32 v159, a27
  v_mul_f32 v156, v156, v253
  v_mul_f32 v157, v157, v253
  v_mul_f32 v158, v158, v253
  v_mul_f32 v159, v159, v253
  v_accvgpr_write_b32 a24, v156
  v_accvgpr_write_b32 a25, v157
  v_accvgpr_write_b32 a26, v158
  v_accvgpr_write_b32 a27, v159
  v_accvgpr_read_b32 v156, a28
  v_accvgpr_read_b32 v157, a29
  v_accvgpr_read_b32 v158, a30
  v_accvgpr_read_b32 v159, a31
  v_mul_f32 v156, v156, v253
  v_mul_f32 v157, v157, v253
  v_mul_f32 v158, v158, v253
  v_mul_f32 v159, v159, v253
  v_accvgpr_write_b32 a28, v156
  v_accvgpr_write_b32 a29, v157
  v_accvgpr_write_b32 a30, v158
  v_accvgpr_write_b32 a31, v159
  v_accvgpr_read_b32 v156, a80
  v_accvgpr_read_b32 v157, a81
  v_accvgpr_read_b32 v158, a82
  v_accvgpr_read_b32 v159, a83
  v_mul_f32 v156, v156, v253
  v_mul_f32 v157, v157, v253
  v_mul_f32 v158, v158, v253
  v_mul_f32 v159, v159, v253
  v_accvgpr_write_b32 a80, v156
  v_accvgpr_write_b32 a81, v157
  v_accvgpr_write_b32 a82, v158
  v_accvgpr_write_b32 a83, v159
  v_accvgpr_read_b32 v156, a84
  v_accvgpr_read_b32 v157, a85
  v_accvgpr_read_b32 v158, a86
  v_accvgpr_read_b32 v159, a87
  v_mul_f32 v156, v156, v253
  v_mul_f32 v157, v157, v253
  v_mul_f32 v158, v158, v253
  v_mul_f32 v159, v159, v253
  v_accvgpr_write_b32 a84, v156
  v_accvgpr_write_b32 a85, v157
  v_accvgpr_write_b32 a86, v158
  v_accvgpr_write_b32 a87, v159
  v_accvgpr_read_b32 v156, a88
  v_accvgpr_read_b32 v157, a89
  v_accvgpr_read_b32 v158, a90
  v_accvgpr_read_b32 v159, a91
  v_mul_f32 v156, v156, v253
  v_mul_f32 v157, v157, v253
  v_mul_f32 v158, v158, v253
  v_mul_f32 v159, v159, v253
  v_accvgpr_write_b32 a88, v156
  v_accvgpr_write_b32 a89, v157
  v_accvgpr_write_b32 a90, v158
  v_accvgpr_write_b32 a91, v159
  v_accvgpr_read_b32 v156, a92
  v_accvgpr_read_b32 v157, a93
  v_accvgpr_read_b32 v158, a94
  v_accvgpr_read_b32 v159, a95
  v_mul_f32 v156, v156, v253
  v_mul_f32 v157, v157, v253
  v_mul_f32 v158, v158, v253
  v_mul_f32 v159, v159, v253
  v_accvgpr_write_b32 a92, v156
  v_accvgpr_write_b32 a93, v157
  v_accvgpr_write_b32 a94, v158
  v_accvgpr_write_b32 a95, v159
  v_max3_f32 v252, v32, v33, v34
  v_max3_f32 v252, v252, v35, v36
  v_max3_f32 v252, v252, v37, v38
  v_max3_f32 v252, v252, v39, 0
  v_mov_b32 v253, v252
  s_nop 1
  v_permlane16_swap_b32 v252, v253
  s_nop 1
  v_max_f32 v252, v252, v253
  v_mov_b32 v253, v252
  s_nop 1
  v_permlane32_swap_b32 v252, v253
  s_nop 1
  v_max_f32 v252, v252, v253
  v_exp_f32 v253, -v252
  v_sub_f32 v120, v120, v252
  v_sub_f32 v121, v121, v252
  v_sub_f32 v122, v122, v252
  v_sub_f32 v123, v123, v252
  v_sub_f32 v32, v32, v252
  v_sub_f32 v64, v64, v252
  v_sub_f32 v33, v33, v252
  v_sub_f32 v65, v65, v252
  v_sub_f32 v34, v34, v252
  v_sub_f32 v66, v66, v252
  v_sub_f32 v35, v35, v252
  v_sub_f32 v67, v67, v252
  v_sub_f32 v36, v36, v252
  v_sub_f32 v68, v68, v252
  v_sub_f32 v37, v37, v252
  v_sub_f32 v69, v69, v252
  v_sub_f32 v38, v38, v252
  v_sub_f32 v70, v70, v252
  v_sub_f32 v39, v39, v252
  v_sub_f32 v71, v71, v252
  v_mul_f32 v232, v232, v253
  v_accvgpr_read_b32 v156, a32
  v_accvgpr_read_b32 v157, a33
  v_accvgpr_read_b32 v158, a34
  v_accvgpr_read_b32 v159, a35
  v_mul_f32 v156, v156, v253
  v_mul_f32 v157, v157, v253
  v_mul_f32 v158, v158, v253
  v_mul_f32 v159, v159, v253
  v_accvgpr_write_b32 a32, v156
  v_accvgpr_write_b32 a33, v157
  v_accvgpr_write_b32 a34, v158
  v_accvgpr_write_b32 a35, v159
  v_accvgpr_read_b32 v156, a36
  v_accvgpr_read_b32 v157, a37
  v_accvgpr_read_b32 v158, a38
  v_accvgpr_read_b32 v159, a39
  v_mul_f32 v156, v156, v253
  v_mul_f32 v157, v157, v253
  v_mul_f32 v158, v158, v253
  v_mul_f32 v159, v159, v253
  v_accvgpr_write_b32 a36, v156
  v_accvgpr_write_b32 a37, v157
  v_accvgpr_write_b32 a38, v158
  v_accvgpr_write_b32 a39, v159
  v_accvgpr_read_b32 v156, a40
  v_accvgpr_read_b32 v157, a41
  v_accvgpr_read_b32 v158, a42
  v_accvgpr_read_b32 v159, a43
  v_mul_f32 v156, v156, v253
  v_mul_f32 v157, v157, v253
  v_mul_f32 v158, v158, v253
  v_mul_f32 v159, v159, v253
  v_accvgpr_write_b32 a40, v156
  v_accvgpr_write_b32 a41, v157
  v_accvgpr_write_b32 a42, v158
  v_accvgpr_write_b32 a43, v159
  v_accvgpr_read_b32 v156, a44
  v_accvgpr_read_b32 v157, a45
  v_accvgpr_read_b32 v158, a46
  v_accvgpr_read_b32 v159, a47
  v_mul_f32 v156, v156, v253
  v_mul_f32 v157, v157, v253
  v_mul_f32 v158, v158, v253
  v_mul_f32 v159, v159, v253
  v_accvgpr_write_b32 a44, v156
  v_accvgpr_write_b32 a45, v157
  v_accvgpr_write_b32 a46, v158
  v_accvgpr_write_b32 a47, v159
  v_accvgpr_read_b32 v156, a96
  v_accvgpr_read_b32 v157, a97
  v_accvgpr_read_b32 v158, a98
  v_accvgpr_read_b32 v159, a99
  v_mul_f32 v156, v156, v253
  v_mul_f32 v157, v157, v253
  v_mul_f32 v158, v158, v253
  v_mul_f32 v159, v159, v253
  v_accvgpr_write_b32 a96, v156
  v_accvgpr_write_b32 a97, v157
  v_accvgpr_write_b32 a98, v158
  v_accvgpr_write_b32 a99, v159
  v_accvgpr_read_b32 v156, a100
  v_accvgpr_read_b32 v157, a101
  v_accvgpr_read_b32 v158, a102
  v_accvgpr_read_b32 v159, a103
  v_mul_f32 v156, v156, v253
  v_mul_f32 v157, v157, v253
  v_mul_f32 v158, v158, v253
  v_mul_f32 v159, v159, v253
  v_accvgpr_write_b32 a100, v156
  v_accvgpr_write_b32 a101, v157
  v_accvgpr_write_b32 a102, v158
  v_accvgpr_write_b32 a103, v159
  v_accvgpr_read_b32 v156, a104
  v_accvgpr_read_b32 v157, a105
  v_accvgpr_read_b32 v158, a106
  v_accvgpr_read_b32 v159, a107
  v_mul_f32 v156, v156, v253
  v_mul_f32 v157, v157, v253
  v_mul_f32 v158, v158, v253
  v_mul_f32 v159, v159, v253
  v_accvgpr_write_b32 a104, v156
  v_accvgpr_write_b32 a105, v157
  v_accvgpr_write_b32 a106, v158
  v_accvgpr_write_b32 a107, v159
  v_accvgpr_read_b32 v156, a108
  v_accvgpr_read_b32 v157, a109
  v_accvgpr_read_b32 v158, a110
  v_accvgpr_read_b32 v159, a111
  v_mul_f32 v156, v156, v253
  v_mul_f32 v157, v157, v253
  v_mul_f32 v158, v158, v253
  v_mul_f32 v159, v159, v253
  v_accvgpr_write_b32 a108, v156
  v_accvgpr_write_b32 a109, v157
  v_accvgpr_write_b32 a110, v158
  v_accvgpr_write_b32 a111, v159
  v_max3_f32 v252, v40, v41, v42
  v_max3_f32 v252, v252, v43, v44
  v_max3_f32 v252, v252, v45, v46
  v_max3_f32 v252, v252, v47, 0
  v_mov_b32 v253, v252
  s_nop 1
  v_permlane16_swap_b32 v252, v253
  s_nop 1
  v_max_f32 v252, v252, v253
  v_mov_b32 v253, v252
  s_nop 1
  v_permlane32_swap_b32 v252, v253
  s_nop 1
  v_max_f32 v252, v252, v253
  v_exp_f32 v253, -v252
  v_sub_f32 v124, v124, v252
  v_sub_f32 v125, v125, v252
  v_sub_f32 v126, v126, v252
  v_sub_f32 v127, v127, v252
  v_sub_f32 v40, v40, v252
  v_sub_f32 v72, v72, v252
  v_sub_f32 v41, v41, v252
  v_sub_f32 v73, v73, v252
  v_sub_f32 v42, v42, v252
  v_sub_f32 v74, v74, v252
  v_sub_f32 v43, v43, v252
  v_sub_f32 v75, v75, v252
  v_sub_f32 v44, v44, v252
  v_sub_f32 v76, v76, v252
  v_sub_f32 v45, v45, v252
  v_sub_f32 v77, v77, v252
  v_sub_f32 v46, v46, v252
  v_sub_f32 v78, v78, v252
  v_sub_f32 v47, v47, v252
  v_sub_f32 v79, v79, v252
  v_mul_f32 v236, v236, v253
  v_accvgpr_read_b32 v156, a48
  v_accvgpr_read_b32 v157, a49
  v_accvgpr_read_b32 v158, a50
  v_accvgpr_read_b32 v159, a51
  v_mul_f32 v156, v156, v253
  v_mul_f32 v157, v157, v253
  v_mul_f32 v158, v158, v253
  v_mul_f32 v159, v159, v253
  v_accvgpr_write_b32 a48, v156
  v_accvgpr_write_b32 a49, v157
  v_accvgpr_write_b32 a50, v158
  v_accvgpr_write_b32 a51, v159
  v_accvgpr_read_b32 v156, a52
  v_accvgpr_read_b32 v157, a53
  v_accvgpr_read_b32 v158, a54
  v_accvgpr_read_b32 v159, a55
  v_mul_f32 v156, v156, v253
  v_mul_f32 v157, v157, v253
  v_mul_f32 v158, v158, v253
  v_mul_f32 v159, v159, v253
  v_accvgpr_write_b32 a52, v156
  v_accvgpr_write_b32 a53, v157
  v_accvgpr_write_b32 a54, v158
  v_accvgpr_write_b32 a55, v159
  v_accvgpr_read_b32 v156, a56
  v_accvgpr_read_b32 v157, a57
  v_accvgpr_read_b32 v158, a58
  v_accvgpr_read_b32 v159, a59
  v_mul_f32 v156, v156, v253
  v_mul_f32 v157, v157, v253
  v_mul_f32 v158, v158, v253
  v_mul_f32 v159, v159, v253
  v_accvgpr_write_b32 a56, v156
  v_accvgpr_write_b32 a57, v157
  v_accvgpr_write_b32 a58, v158
  v_accvgpr_write_b32 a59, v159
  v_accvgpr_read_b32 v156, a60
  v_accvgpr_read_b32 v157, a61
  v_accvgpr_read_b32 v158, a62
  v_accvgpr_read_b32 v159, a63
  v_mul_f32 v156, v156, v253
  v_mul_f32 v157, v157, v253
  v_mul_f32 v158, v158, v253
  v_mul_f32 v159, v159, v253
  v_accvgpr_write_b32 a60, v156
  v_accvgpr_write_b32 a61, v157
  v_accvgpr_write_b32 a62, v158
  v_accvgpr_write_b32 a63, v159
  v_accvgpr_read_b32 v156, a112
  v_accvgpr_read_b32 v157, a113
  v_accvgpr_read_b32 v158, a114
  v_accvgpr_read_b32 v159, a115
  v_mul_f32 v156, v156, v253
  v_mul_f32 v157, v157, v253
  v_mul_f32 v158, v158, v253
  v_mul_f32 v159, v159, v253
  v_accvgpr_write_b32 a112, v156
  v_accvgpr_write_b32 a113, v157
  v_accvgpr_write_b32 a114, v158
  v_accvgpr_write_b32 a115, v159
  v_accvgpr_read_b32 v156, a116
  v_accvgpr_read_b32 v157, a117
  v_accvgpr_read_b32 v158, a118
  v_accvgpr_read_b32 v159, a119
  v_mul_f32 v156, v156, v253
  v_mul_f32 v157, v157, v253
  v_mul_f32 v158, v158, v253
  v_mul_f32 v159, v159, v253
  v_accvgpr_write_b32 a116, v156
  v_accvgpr_write_b32 a117, v157
  v_accvgpr_write_b32 a118, v158
  v_accvgpr_write_b32 a119, v159
  v_accvgpr_read_b32 v156, a120
  v_accvgpr_read_b32 v157, a121
  v_accvgpr_read_b32 v158, a122
  v_accvgpr_read_b32 v159, a123
  v_mul_f32 v156, v156, v253
  v_mul_f32 v157, v157, v253
  v_mul_f32 v158, v158, v253
  v_mul_f32 v159, v159, v253
  v_accvgpr_write_b32 a120, v156
  v_accvgpr_write_b32 a121, v157
  v_accvgpr_write_b32 a122, v158
  v_accvgpr_write_b32 a123, v159
  v_accvgpr_read_b32 v156, a124
  v_accvgpr_read_b32 v157, a125
  v_accvgpr_read_b32 v158, a126
  v_accvgpr_read_b32 v159, a127
  v_mul_f32 v156, v156, v253
  v_mul_f32 v157, v157, v253
  v_mul_f32 v158, v158, v253
  v_mul_f32 v159, v159, v253
  v_accvgpr_write_b32 a124, v156
  v_accvgpr_write_b32 a125, v157
  v_accvgpr_write_b32 a126, v158
  v_accvgpr_write_b32 a127, v159
  s_nop 1
  v_exp_f32 v148, v16
  v_exp_f32 v149, v17
  v_exp_f32 v150, v18
  v_cvt_pk_bf16_f32 v80, v148, v149
  v_exp_f32 v151, v19
  v_exp_f32 v152, v20
  v_cvt_pk_bf16_f32 v81, v150, v151
  v_exp_f32 v153, v21
  v_exp_f32 v154, v22
  v_cvt_pk_bf16_f32 v82, v152, v153
  v_exp_f32 v155, v23
  v_exp_f32 v148, v24
  v_cvt_pk_bf16_f32 v83, v154, v155
  v_exp_f32 v149, v25
  v_exp_f32 v150, v26
  v_cvt_pk_bf16_f32 v84, v148, v149
  v_mfma_f32_16x16x32_bf16 v[128:131], v[244:247], v[80:83], v[224:227]
  v_exp_f32 v151, v27
  v_exp_f32 v152, v28
  v_cvt_pk_bf16_f32 v85, v150, v151
  v_exp_f32 v153, v29
  v_exp_f32 v154, v30
  v_cvt_pk_bf16_f32 v86, v152, v153
  v_exp_f32 v155, v31
  v_exp_f32 v148, v32
  v_cvt_pk_bf16_f32 v87, v154, v155
  v_exp_f32 v149, v33
  v_exp_f32 v150, v34
  v_cvt_pk_bf16_f32 v88, v148, v149
  v_mfma_f32_16x16x32_bf16 v[132:135], v[244:247], v[84:87], v[228:231]
  v_exp_f32 v151, v35
  v_exp_f32 v152, v36
  v_cvt_pk_bf16_f32 v89, v150, v151
  v_exp_f32 v153, v37
  v_exp_f32 v154, v38
  v_cvt_pk_bf16_f32 v90, v152, v153
  v_exp_f32 v155, v39
  v_exp_f32 v148, v40
  v_cvt_pk_bf16_f32 v91, v154, v155
  v_exp_f32 v149, v41
  v_exp_f32 v150, v42
  v_cvt_pk_bf16_f32 v92, v148, v149
  v_mfma_f32_16x16x32_bf16 v[136:139], v[244:247], v[88:91], v[232:235]
  v_exp_f32 v151, v43
  v_exp_f32 v152, v44
  v_cvt_pk_bf16_f32 v93, v150, v151
  v_exp_f32 v153, v45
  v_exp_f32 v154, v46
  v_cvt_pk_bf16_f32 v94, v152, v153
  v_exp_f32 v155, v47
  s_nop 0
  v_cvt_pk_bf16_f32 v95, v154, v155
  s_nop 1
  v_mfma_f32_16x16x32_bf16 v[140:143], v[244:247], v[92:95], v[236:239]
  s_nop 7
  s_branch K2_RARE_T1_ret
K2_RARE_T2:
  s_nop 15
  s_nop 7
  v_max3_f32 v252, v64, v65, v66
  v_max3_f32 v252, v252, v67, v68
  v_max3_f32 v252, v252, v69, v70
  v_max3_f32 v252, v252, v71, 0
  v_mov_b32 v253, v252
  s_nop 1
  v_permlane16_swap_b32 v252, v253
  s_nop 1
  v_max_f32 v252, v252, v253
  v_mov_b32 v253, v252
  s_nop 1
  v_permlane32_swap_b32 v252, v253
  s_nop 1
  v_max_f32 v252, v252, v253
  v_exp_f32 v253, -v252
  v_sub_f32 v120, v120, v252
  v_sub_f32 v121, v121, v252
  v_sub_f32 v122, v122, v252
  v_sub_f32 v123, v123, v252
  v_sub_f32 v64, v64, v252
  v_sub_f32 v65, v65, v252
  v_sub_f32 v66, v66, v252
  v_sub_f32 v67, v67, v252
  v_sub_f32 v68, v68, v252
  v_sub_f32 v69, v69, v252
  v_sub_f32 v70, v70, v252
  v_sub_f32 v71, v71, v252
  v_mul_f32 v136, v136, v253
  v_accvgpr_read_b32 v156, a32
  v_accvgpr_read_b32 v157, a33
  v_accvgpr_read_b32 v158, a34
  v_accvgpr_read_b32 v159, a35
  v_mul_f32 v156, v156, v253
  v_mul_f32 v157, v157, v253
  v_mul_f32 v158, v158, v253
  v_mul_f32 v159, v159, v253
  v_accvgpr_write_b32 a32, v156
  v_accvgpr_write_b32 a33, v157
  v_accvgpr_write_b32 a34, v158
  v_accvgpr_write_b32 a35, v159
  v_accvgpr_read_b32 v156, a36
  v_accvgpr_read_b32 v157, a37
  v_accvgpr_read_b32 v158, a38
  v_accvgpr_read_b32 v159, a39
  v_mul_f32 v156, v156, v253
  v_mul_f32 v157, v157, v253
  v_mul_f32 v158, v158, v253
  v_mul_f32 v159, v159, v253
  v_accvgpr_write_b32 a36, v156
  v_accvgpr_write_b32 a37, v157
  v_accvgpr_write_b32 a38, v158
  v_accvgpr_write_b32 a39, v159
  v_accvgpr_read_b32 v156, a40
  v_accvgpr_read_b32 v157, a41
  v_accvgpr_read_b32 v158, a42
  v_accvgpr_read_b32 v159, a43
  v_mul_f32 v156, v156, v253
  v_mul_f32 v157, v157, v253
  v_mul_f32 v158, v158, v253
  v_mul_f32 v159, v159, v253
  v_accvgpr_write_b32 a40, v156
  v_accvgpr_write_b32 a41, v157
  v_accvgpr_write_b32 a42, v158
  v_accvgpr_write_b32 a43, v159
  v_accvgpr_read_b32 v156, a44
  v_accvgpr_read_b32 v157, a45
  v_accvgpr_read_b32 v158, a46
  v_accvgpr_read_b32 v159, a47
  v_mul_f32 v156, v156, v253
  v_mul_f32 v157, v157, v253
  v_mul_f32 v158, v158, v253
  v_mul_f32 v159, v159, v253
  v_accvgpr_write_b32 a44, v156
  v_accvgpr_write_b32 a45, v157
  v_accvgpr_write_b32 a46, v158
  v_accvgpr_write_b32 a47, v159
  v_accvgpr_read_b32 v156, a96
  v_accvgpr_read_b32 v157, a97
  v_accvgpr_read_b32 v158, a98
  v_accvgpr_read_b32 v159, a99
  v_mul_f32 v156, v156, v253
  v_mul_f32 v157, v157, v253
  v_mul_f32 v158, v158, v253
  v_mul_f32 v159, v159, v253
  v_accvgpr_write_b32 a96, v156
  v_accvgpr_write_b32 a97, v157
  v_accvgpr_write_b32 a98, v158
  v_accvgpr_write_b32 a99, v159
  v_accvgpr_read_b32 v156, a100
  v_accvgpr_read_b32 v157, a101
  v_accvgpr_read_b32 v158, a102
  v_accvgpr_read_b32 v159, a103
  v_mul_f32 v156, v156, v253
  v_mul_f32 v157, v157, v253
  v_mul_f32 v158, v158, v253
  v_mul_f32 v159, v159, v253
  v_accvgpr_write_b32 a100, v156
  v_accvgpr_write_b32 a101, v157
  v_accvgpr_write_b32 a102, v158
  v_accvgpr_write_b32 a103, v159
  v_accvgpr_read_b32 v156, a104
  v_accvgpr_read_b32 v157, a105
  v_accvgpr_read_b32 v158, a106
  v_accvgpr_read_b32 v159, a107
  v_mul_f32 v156, v156, v253
  v_mul_f32 v157, v157, v253
  v_mul_f32 v158, v158, v253
  v_mul_f32 v159, v159, v253
  v_accvgpr_write_b32 a104, v156
  v_accvgpr_write_b32 a105, v157
  v_accvgpr_write_b32 a106, v158
  v_accvgpr_write_b32 a107, v159
  v_accvgpr_read_b32 v156, a108
  v_accvgpr_read_b32 v157, a109
  v_accvgpr_read_b32 v158, a110
  v_accvgpr_read_b32 v159, a111
  v_mul_f32 v156, v156, v253
  v_mul_f32 v157, v157, v253
  v_mul_f32 v158, v158, v253
  v_mul_f32 v159, v159, v253
  v_accvgpr_write_b32 a108, v156
  v_accvgpr_write_b32 a109, v157
  v_accvgpr_write_b32 a110, v158
  v_accvgpr_write_b32 a111, v159
  v_max3_f32 v252, v72, v73, v74
  v_max3_f32 v252, v252, v75, v76
  v_max3_f32 v252, v252, v77, v78
  v_max3_f32 v252, v252, v79, 0
  v_mov_b32 v253, v252
  s_nop 1
  v_permlane16_swap_b32 v252, v253
  s_nop 1
  v_max_f32 v252, v252, v253
  v_mov_b32 v253, v252
  s_nop 1
  v_permlane32_swap_b32 v252, v253
  s_nop 1
  v_max_f32 v252, v252, v253
  v_exp_f32 v253, -v252
  v_sub_f32 v124, v124, v252
  v_sub_f32 v125, v125, v252
  v_sub_f32 v126, v126, v252
  v_sub_f32 v127, v127, v252
  v_sub_f32 v72, v72, v252
  v_sub_f32 v73, v73, v252
  v_sub_f32 v74, v74, v252
  v_sub_f32 v75, v75, v252
  v_sub_f32 v76, v76, v252
  v_sub_f32 v77, v77, v252
  v_sub_f32 v78, v78, v252
  v_sub_f32 v79, v79, v252
  v_mul_f32 v140, v140, v253
  v_accvgpr_read_b32 v156, a48
  v_accvgpr_read_b32 v157, a49
  v_accvgpr_read_b32 v158, a50
  v_accvgpr_read_b32 v159, a51
  v_mul_f32 v156, v156, v253
  v_mul_f32 v157, v157, v253
  v_mul_f32 v158, v158, v253
  v_mul_f32 v159, v159, v253
  v_accvgpr_write_b32 a48, v156
  v_accvgpr_write_b32 a49, v157
  v_accvgpr_write_b32 a50, v158
  v_accvgpr_write_b32 a51, v159
  v_accvgpr_read_b32 v156, a52
  v_accvgpr_read_b32 v157, a53
  v_accvgpr_read_b32 v158, a54
  v_accvgpr_read_b32 v159, a55
  v_mul_f32 v156, v156, v253
  v_mul_f32 v157, v157, v253
  v_mul_f32 v158, v158, v253
  v_mul_f32 v159, v159, v253
  v_accvgpr_write_b32 a52, v156
  v_accvgpr_write_b32 a53, v157
  v_accvgpr_write_b32 a54, v158
  v_accvgpr_write_b32 a55, v159
  v_accvgpr_read_b32 v156, a56
  v_accvgpr_read_b32 v157, a57
  v_accvgpr_read_b32 v158, a58
  v_accvgpr_read_b32 v159, a59
  v_mul_f32 v156, v156, v253
  v_mul_f32 v157, v157, v253
  v_mul_f32 v158, v158, v253
  v_mul_f32 v159, v159, v253
  v_accvgpr_write_b32 a56, v156
  v_accvgpr_write_b32 a57, v157
  v_accvgpr_write_b32 a58, v158
  v_accvgpr_write_b32 a59, v159
  v_accvgpr_read_b32 v156, a60
  v_accvgpr_read_b32 v157, a61
  v_accvgpr_read_b32 v158, a62
  v_accvgpr_read_b32 v159, a63
  v_mul_f32 v156, v156, v253
  v_mul_f32 v157, v157, v253
  v_mul_f32 v158, v158, v253
  v_mul_f32 v159, v159, v253
  v_accvgpr_write_b32 a60, v156
  v_accvgpr_write_b32 a61, v157
  v_accvgpr_write_b32 a62, v158
  v_accvgpr_write_b32 a63, v159
  v_accvgpr_read_b32 v156, a112
  v_accvgpr_read_b32 v157, a113
  v_accvgpr_read_b32 v158, a114
  v_accvgpr_read_b32 v159, a115
  v_mul_f32 v156, v156, v253
  v_mul_f32 v157, v157, v253
  v_mul_f32 v158, v158, v253
  v_mul_f32 v159, v159, v253
  v_accvgpr_write_b32 a112, v156
  v_accvgpr_write_b32 a113, v157
  v_accvgpr_write_b32 a114, v158
  v_accvgpr_write_b32 a115, v159
  v_accvgpr_read_b32 v156, a116
  v_accvgpr_read_b32 v157, a117
  v_accvgpr_read_b32 v158, a118
  v_accvgpr_read_b32 v159, a119
  v_mul_f32 v156, v156, v253
  v_mul_f32 v157, v157, v253
  v_mul_f32 v158, v158, v253
  v_mul_f32 v159, v159, v253
  v_accvgpr_write_b32 a116, v156
  v_accvgpr_write_b32 a117, v157
  v_accvgpr_write_b32 a118, v158
  v_accvgpr_write_b32 a119, v159
  v_accvgpr_read_b32 v156, a120
  v_accvgpr_read_b32 v157, a121
  v_accvgpr_read_b32 v158, a122
  v_accvgpr_read_b32 v159, a123
  v_mul_f32 v156, v156, v253
  v_mul_f32 v157, v157, v253
  v_mul_f32 v158, v158, v253
  v_mul_f32 v159, v159, v253
  v_accvgpr_write_b32 a120, v156
  v_accvgpr_write_b32 a121, v157
  v_accvgpr_write_b32 a122, v158
  v_accvgpr_write_b32 a123, v159
  v_accvgpr_read_b32 v156, a124
  v_accvgpr_read_b32 v157, a125
  v_accvgpr_read_b32 v158, a126
  v_accvgpr_read_b32 v159, a127
  v_mul_f32 v156, v156, v253
  v_mul_f32 v157, v157, v253
  v_mul_f32 v158, v158, v253
  v_mul_f32 v159, v159, v253
  v_accvgpr_write_b32 a124, v156
  v_accvgpr_write_b32 a125, v157
  v_accvgpr_write_b32 a126, v158
  v_accvgpr_write_b32 a127, v159
  s_nop 1
  v_exp_f32 v148, v64
  v_exp_f32 v149, v65
  v_exp_f32 v150, v66
  v_cvt_pk_bf16_f32 v104, v148, v149
  v_exp_f32 v151, v67
  v_exp_f32 v152, v68
  v_cvt_pk_bf16_f32 v105, v150, v151
  v_exp_f32 v153, v69
  v_exp_f32 v154, v70
  v_cvt_pk_bf16_f32 v106, v152, v153
  v_exp_f32 v155, v71
  v_exp_f32 v148, v72
  v_cvt_pk_bf16_f32 v107, v154, v155
  v_exp_f32 v149, v73
  v_exp_f32 v150, v74
  v_cvt_pk_bf16_f32 v108, v148, v149
  v_mfma_f32_16x16x32_bf16 v[232:235], v[244:247], v[104:107], v[136:139]
  v_exp_f32 v151, v75
  v_exp_f32 v152, v76
  v_cvt_pk_bf16_f32 v109, v150, v151
  v_exp_f32 v153, v77
  v_exp_f32 v154, v78
  v_cvt_pk_bf16_f32 v110, v152, v153
  v_exp_f32 v155, v79
  s_nop 0
  v_cvt_pk_bf16_f32 v111, v154, v155
  s_nop 1
  v_mfma_f32_16x16x32_bf16 v[236:239], v[244:247], v[108:111], v[140:143]
  s_nop 7
  s_branch K2_RARE_T2_ret
K2_RARE_M:
  s_nop 15
  s_nop 7
  v_max3_f32 v252, v16, v17, v18
  v_max3_f32 v252, v252, v19, v20
  v_max3_f32 v252, v252, v21, v22
  v_max3_f32 v252, v252, v23, 0
  v_mov_b32 v253, v252
  s_nop 1
  v_permlane16_swap_b32 v252, v253
  s_nop 1
  v_max_f32 v252, v252, v253
  v_mov_b32 v253, v252
  s_nop 1
  v_permlane32_swap_b32 v252, v253
  s_nop 1
  v_max_f32 v252, v252, v253
  v_exp_f32 v253, -v252
  v_sub_f32 v112, v112, v252
  v_sub_f32 v113, v113, v252
  v_sub_f32 v114, v114, v252
  v_sub_f32 v115, v115, v252
  v_sub_f32 v16, v16, v252
  v_sub_f32 v48, v48, v252
  v_sub_f32 v17, v17, v252
  v_sub_f32 v49, v49, v252
  v_sub_f32 v18, v18, v252
  v_sub_f32 v50, v50, v252
  v_sub_f32 v19, v19, v252
  v_sub_f32 v51, v51, v252
  v_sub_f32 v20, v20, v252
  v_sub_f32 v52, v52, v252
  v_sub_f32 v21, v21, v252
  v_sub_f32 v53, v53, v252
  v_sub_f32 v22, v22, v252
  v_sub_f32 v54, v54, v252
  v_sub_f32 v23, v23, v252
  v_sub_f32 v55, v55, v252
  v_mul_f32 v224, v224, v253
  v_accvgpr_read_b32 v156, a0
  v_accvgpr_read_b32 v157, a1
  v_accvgpr_read_b32 v158, a2
  v_accvgpr_read_b32 v159, a3
  v_mul_f32 v156, v156, v253
  v_mul_f32 v157, v157, v253
  v_mul_f32 v158, v158, v253
  v_mul_f32 v159, v159, v253
  v_accvgpr_write_b32 a0, v156
  v_accvgpr_write_b32 a1, v157
  v_accvgpr_write_b32 a2, v158
  v_accvgpr_write_b32 a3, v159
  v_accvgpr_read_b32 v156, a4
  v_accvgpr_read_b32 v157, a5
  v_accvgpr_read_b32 v158, a6
  v_accvgpr_read_b32 v159, a7
  v_mul_f32 v156, v156, v253
  v_mul_f32 v157, v157, v253
  v_mul_f32 v158, v158, v253
  v_mul_f32 v159, v159, v253
  v_accvgpr_write_b32 a4, v156
  v_accvgpr_write_b32 a5, v157
  v_accvgpr_write_b32 a6, v158
  v_accvgpr_write_b32 a7, v159
  v_accvgpr_read_b32 v156, a8
  v_accvgpr_read_b32 v157, a9
  v_accvgpr_read_b32 v158, a10
  v_accvgpr_read_b32 v159, a11
  v_mul_f32 v156, v156, v253
  v_mul_f32 v157, v157, v253
  v_mul_f32 v158, v158, v253
  v_mul_f32 v159, v159, v253
  v_accvgpr_write_b32 a8, v156
  v_accvgpr_write_b32 a9, v157
  v_accvgpr_write_b32 a10, v158
  v_accvgpr_write_b32 a11, v159
  v_accvgpr_read_b32 v156, a12
  v_accvgpr_read_b32 v157, a13
  v_accvgpr_read_b32 v158, a14
  v_accvgpr_read_b32 v159, a15
  v_mul_f32 v156, v156, v253
  v_mul_f32 v157, v157, v253
  v_mul_f32 v158, v158, v253
  v_mul_f32 v159, v159, v253
  v_accvgpr_write_b32 a12, v156
  v_accvgpr_write_b32 a13, v157
  v_accvgpr_write_b32 a14, v158
  v_accvgpr_write_b32 a15, v159
  v_accvgpr_read_b32 v156, a64
  v_accvgpr_read_b32 v157, a65
  v_accvgpr_read_b32 v158, a66
  v_accvgpr_read_b32 v159, a67
  v_mul_f32 v156, v156, v253
  v_mul_f32 v157, v157, v253
  v_mul_f32 v158, v158, v253
  v_mul_f32 v159, v159, v253
  v_accvgpr_write_b32 a64, v156
  v_accvgpr_write_b32 a65, v157
  v_accvgpr_write_b32 a66, v158
  v_accvgpr_write_b32 a67, v159
  v_accvgpr_read_b32 v156, a68
  v_accvgpr_read_b32 v157, a69
  v_accvgpr_read_b32 v158, a70
  v_accvgpr_read_b32 v159, a71
  v_mul_f32 v156, v156, v253
  v_mul_f32 v157, v157, v253
  v_mul_f32 v158, v158, v253
  v_mul_f32 v159, v159, v253
  v_accvgpr_write_b32 a68, v156
  v_accvgpr_write_b32 a69, v157
  v_accvgpr_write_b32 a70, v158
  v_accvgpr_write_b32 a71, v159
  v_accvgpr_read_b32 v156, a72
  v_accvgpr_read_b32 v157, a73
  v_accvgpr_read_b32 v158, a74
  v_accvgpr_read_b32 v159, a75
  v_mul_f32 v156, v156, v253
  v_mul_f32 v157, v157, v253
  v_mul_f32 v158, v158, v253
  v_mul_f32 v159, v159, v253
  v_accvgpr_write_b32 a72, v156
  v_accvgpr_write_b32 a73, v157
  v_accvgpr_write_b32 a74, v158
  v_accvgpr_write_b32 a75, v159
  v_accvgpr_read_b32 v156, a76
  v_accvgpr_read_b32 v157, a77
  v_accvgpr_read_b32 v158, a78
  v_accvgpr_read_b32 v159, a79
  v_mul_f32 v156, v156, v253
  v_mul_f32 v157, v157, v253
  v_mul_f32 v158, v158, v253
  v_mul_f32 v159, v159, v253
  v_accvgpr_write_b32 a76, v156
  v_accvgpr_write_b32 a77, v157
  v_accvgpr_write_b32 a78, v158
  v_accvgpr_write_b32 a79, v159
  v_max3_f32 v252, v24, v25, v26
  v_max3_f32 v252, v252, v27, v28
  v_max3_f32 v252, v252, v29, v30
  v_max3_f32 v252, v252, v31, 0
  v_mov_b32 v253, v252
  s_nop 1
  v_permlane16_swap_b32 v252, v253
  s_nop 1
  v_max_f32 v252, v252, v253
  v_mov_b32 v253, v252
  s_nop 1
  v_permlane32_swap_b32 v252, v253
  s_nop 1
  v_max_f32 v252, v252, v253
  v_exp_f32 v253, -v252
  v_sub_f32 v116, v116, v252
  v_sub_f32 v117, v117, v252
  v_sub_f32 v118, v118, v252
  v_sub_f32 v119, v119, v252
  v_sub_f32 v24, v24, v252
  v_sub_f32 v56, v56, v252
  v_sub_f32 v25, v25, v252
  v_sub_f32 v57, v57, v252
  v_sub_f32 v26, v26, v252
  v_sub_f32 v58, v58, v252
  v_sub_f32 v27, v27, v252
  v_sub_f32 v59, v59, v252
  v_sub_f32 v28, v28, v252
  v_sub_f32 v60, v60, v252
  v_sub_f32 v29, v29, v252
  v_sub_f32 v61, v61, v252
  v_sub_f32 v30, v30, v252
  v_sub_f32 v62, v62, v252
  v_sub_f32 v31, v31, v252
  v_sub_f32 v63, v63, v252
  v_mul_f32 v228, v228, v253
  v_accvgpr_read_b32 v156, a16
  v_accvgpr_read_b32 v157, a17
  v_accvgpr_read_b32 v158, a18
  v_accvgpr_read_b32 v159, a19
  v_mul_f32 v156, v156, v253
  v_mul_f32 v157, v157, v253
  v_mul_f32 v158, v158, v253
  v_mul_f32 v159, v159, v253
  v_accvgpr_write_b32 a16, v156
  v_accvgpr_write_b32 a17, v157
  v_accvgpr_write_b32 a18, v158
  v_accvgpr_write_b32 a19, v159
  v_accvgpr_read_b32 v156, a20
  v_accvgpr_read_b32 v157, a21
  v_accvgpr_read_b32 v158, a22
  v_accvgpr_read_b32 v159, a23
  v_mul_f32 v156, v156, v253
  v_mul_f32 v157, v157, v253
  v_mul_f32 v158, v158, v253
  v_mul_f32 v159, v159, v253
  v_accvgpr_write_b32 a20, v156
  v_accvgpr_write_b32 a21, v157
  v_accvgpr_write_b32 a22, v158
  v_accvgpr_write_b32 a23, v159
  v_accvgpr_read_b32 v156, a24
  v_accvgpr_read_b32 v157, a25
  v_accvgpr_read_b32 v158, a26
  v_accvgpr_read_b32 v159, a27
  v_mul_f32 v156, v156, v253
  v_mul_f32 v157, v157, v253
  v_mul_f32 v158, v158, v253
  v_mul_f32 v159, v159, v253
  v_accvgpr_write_b32 a24, v156
  v_accvgpr_write_b32 a25, v157
  v_accvgpr_write_b32 a26, v158
  v_accvgpr_write_b32 a27, v159
  v_accvgpr_read_b32 v156, a28
  v_accvgpr_read_b32 v157, a29
  v_accvgpr_read_b32 v158, a30
  v_accvgpr_read_b32 v159, a31
  v_mul_f32 v156, v156, v253
  v_mul_f32 v157, v157, v253
  v_mul_f32 v158, v158, v253
  v_mul_f32 v159, v159, v253
  v_accvgpr_write_b32 a28, v156
  v_accvgpr_write_b32 a29, v157
  v_accvgpr_write_b32 a30, v158
  v_accvgpr_write_b32 a31, v159
  v_accvgpr_read_b32 v156, a80
  v_accvgpr_read_b32 v157, a81
  v_accvgpr_read_b32 v158, a82
  v_accvgpr_read_b32 v159, a83
  v_mul_f32 v156, v156, v253
  v_mul_f32 v157, v157, v253
  v_mul_f32 v158, v158, v253
  v_mul_f32 v159, v159, v253
  v_accvgpr_write_b32 a80, v156
  v_accvgpr_write_b32 a81, v157
  v_accvgpr_write_b32 a82, v158
  v_accvgpr_write_b32 a83, v159
  v_accvgpr_read_b32 v156, a84
  v_accvgpr_read_b32 v157, a85
  v_accvgpr_read_b32 v158, a86
  v_accvgpr_read_b32 v159, a87
  v_mul_f32 v156, v156, v253
  v_mul_f32 v157, v157, v253
  v_mul_f32 v158, v158, v253
  v_mul_f32 v159, v159, v253
  v_accvgpr_write_b32 a84, v156
  v_accvgpr_write_b32 a85, v157
  v_accvgpr_write_b32 a86, v158
  v_accvgpr_write_b32 a87, v159
  v_accvgpr_read_b32 v156, a88
  v_accvgpr_read_b32 v157, a89
  v_accvgpr_read_b32 v158, a90
  v_accvgpr_read_b32 v159, a91
  v_mul_f32 v156, v156, v253
  v_mul_f32 v157, v157, v253
  v_mul_f32 v158, v158, v253
  v_mul_f32 v159, v159, v253
  v_accvgpr_write_b32 a88, v156
  v_accvgpr_write_b32 a89, v157
  v_accvgpr_write_b32 a90, v158
  v_accvgpr_write_b32 a91, v159
  v_accvgpr_read_b32 v156, a92
  v_accvgpr_read_b32 v157, a93
  v_accvgpr_read_b32 v158, a94
  v_accvgpr_read_b32 v159, a95
  v_mul_f32 v156, v156, v253
  v_mul_f32 v157, v157, v253
  v_mul_f32 v158, v158, v253
  v_mul_f32 v159, v159, v253
  v_accvgpr_write_b32 a92, v156
  v_accvgpr_write_b32 a93, v157
  v_accvgpr_write_b32 a94, v158
  v_accvgpr_write_b32 a95, v159
  v_max3_f32 v252, v32, v33, v34
  v_max3_f32 v252, v252, v35, v36
  v_max3_f32 v252, v252, v37, v38
  v_max3_f32 v252, v252, v39, 0
  v_mov_b32 v253, v252
  s_nop 1
  v_permlane16_swap_b32 v252, v253
  s_nop 1
  v_max_f32 v252, v252, v253
  v_mov_b32 v253, v252
  s_nop 1
  v_permlane32_swap_b32 v252, v253
  s_nop 1
  v_max_f32 v252, v252, v253
  v_exp_f32 v253, -v252
  v_sub_f32 v120, v120, v252
  v_sub_f32 v121, v121, v252
  v_sub_f32 v122, v122, v252
  v_sub_f32 v123, v123, v252
  v_sub_f32 v32, v32, v252
  v_sub_f32 v64, v64, v252
  v_sub_f32 v33, v33, v252
  v_sub_f32 v65, v65, v252
  v_sub_f32 v34, v34, v252
  v_sub_f32 v66, v66, v252
  v_sub_f32 v35, v35, v252
  v_sub_f32 v67, v67, v252
  v_sub_f32 v36, v36, v252
  v_sub_f32 v68, v68, v252
  v_sub_f32 v37, v37, v252
  v_sub_f32 v69, v69, v252
  v_sub_f32 v38, v38, v252
  v_sub_f32 v70, v70, v252
  v_sub_f32 v39, v39, v252
  v_sub_f32 v71, v71, v252
  v_mul_f32 v232, v232, v253
  v_accvgpr_read_b32 v156, a32
  v_accvgpr_read_b32 v157, a33
  v_accvgpr_read_b32 v158, a34
  v_accvgpr_read_b32 v159, a35
  v_mul_f32 v156, v156, v253
  v_mul_f32 v157, v157, v253
  v_mul_f32 v158, v158, v253
  v_mul_f32 v159, v159, v253
  v_accvgpr_write_b32 a32, v156
  v_accvgpr_write_b32 a33, v157
  v_accvgpr_write_b32 a34, v158
  v_accvgpr_write_b32 a35, v159
  v_accvgpr_read_b32 v156, a36
  v_accvgpr_read_b32 v157, a37
  v_accvgpr_read_b32 v158, a38
  v_accvgpr_read_b32 v159, a39
  v_mul_f32 v156, v156, v253
  v_mul_f32 v157, v157, v253
  v_mul_f32 v158, v158, v253
  v_mul_f32 v159, v159, v253
  v_accvgpr_write_b32 a36, v156
  v_accvgpr_write_b32 a37, v157
  v_accvgpr_write_b32 a38, v158
  v_accvgpr_write_b32 a39, v159
  v_accvgpr_read_b32 v156, a40
  v_accvgpr_read_b32 v157, a41
  v_accvgpr_read_b32 v158, a42
  v_accvgpr_read_b32 v159, a43
  v_mul_f32 v156, v156, v253
  v_mul_f32 v157, v157, v253
  v_mul_f32 v158, v158, v253
  v_mul_f32 v159, v159, v253
  v_accvgpr_write_b32 a40, v156
  v_accvgpr_write_b32 a41, v157
  v_accvgpr_write_b32 a42, v158
  v_accvgpr_write_b32 a43, v159
  v_accvgpr_read_b32 v156, a44
  v_accvgpr_read_b32 v157, a45
  v_accvgpr_read_b32 v158, a46
  v_accvgpr_read_b32 v159, a47
  v_mul_f32 v156, v156, v253
  v_mul_f32 v157, v157, v253
  v_mul_f32 v158, v158, v253
  v_mul_f32 v159, v159, v253
  v_accvgpr_write_b32 a44, v156
  v_accvgpr_write_b32 a45, v157
  v_accvgpr_write_b32 a46, v158
  v_accvgpr_write_b32 a47, v159
  v_accvgpr_read_b32 v156, a96
  v_accvgpr_read_b32 v157, a97
  v_accvgpr_read_b32 v158, a98
  v_accvgpr_read_b32 v159, a99
  v_mul_f32 v156, v156, v253
  v_mul_f32 v157, v157, v253
  v_mul_f32 v158, v158, v253
  v_mul_f32 v159, v159, v253
  v_accvgpr_write_b32 a96, v156
  v_accvgpr_write_b32 a97, v157
  v_accvgpr_write_b32 a98, v158
  v_accvgpr_write_b32 a99, v159
  v_accvgpr_read_b32 v156, a100
  v_accvgpr_read_b32 v157, a101
  v_accvgpr_read_b32 v158, a102
  v_accvgpr_read_b32 v159, a103
  v_mul_f32 v156, v156, v253
  v_mul_f32 v157, v157, v253
  v_mul_f32 v158, v158, v253
  v_mul_f32 v159, v159, v253
  v_accvgpr_write_b32 a100, v156
  v_accvgpr_write_b32 a101, v157
  v_accvgpr_write_b32 a102, v158
  v_accvgpr_write_b32 a103, v159
  v_accvgpr_read_b32 v156, a104
  v_accvgpr_read_b32 v157, a105
  v_accvgpr_read_b32 v158, a106
  v_accvgpr_read_b32 v159, a107
  v_mul_f32 v156, v156, v253
  v_mul_f32 v157, v157, v253
  v_mul_f32 v158, v158, v253
  v_mul_f32 v159, v159, v253
  v_accvgpr_write_b32 a104, v156
  v_accvgpr_write_b32 a105, v157
  v_accvgpr_write_b32 a106, v158
  v_accvgpr_write_b32 a107, v159
  v_accvgpr_read_b32 v156, a108
  v_accvgpr_read_b32 v157, a109
  v_accvgpr_read_b32 v158, a110
  v_accvgpr_read_b32 v159, a111
  v_mul_f32 v156, v156, v253
  v_mul_f32 v157, v157, v253
  v_mul_f32 v158, v158, v253
  v_mul_f32 v159, v159, v253
  v_accvgpr_write_b32 a108, v156
  v_accvgpr_write_b32 a109, v157
  v_accvgpr_write_b32 a110, v158
  v_accvgpr_write_b32 a111, v159
  v_max3_f32 v252, v40, v41, v42
  v_max3_f32 v252, v252, v43, v44
  v_max3_f32 v252, v252, v45, v46
  v_max3_f32 v252, v252, v47, 0
  v_mov_b32 v253, v252
  s_nop 1
  v_permlane16_swap_b32 v252, v253
  s_nop 1
  v_max_f32 v252, v252, v253
  v_mov_b32 v253, v252
  s_nop 1
  v_permlane32_swap_b32 v252, v253
  s_nop 1
  v_max_f32 v252, v252, v253
  v_exp_f32 v253, -v252
  v_sub_f32 v124, v124, v252
  v_sub_f32 v125, v125, v252
  v_sub_f32 v126, v126, v252
  v_sub_f32 v127, v127, v252
  v_sub_f32 v40, v40, v252
  v_sub_f32 v72, v72, v252
  v_sub_f32 v41, v41, v252
  v_sub_f32 v73, v73, v252
  v_sub_f32 v42, v42, v252
  v_sub_f32 v74, v74, v252
  v_sub_f32 v43, v43, v252
  v_sub_f32 v75, v75, v252
  v_sub_f32 v44, v44, v252
  v_sub_f32 v76, v76, v252
  v_sub_f32 v45, v45, v252
  v_sub_f32 v77, v77, v252
  v_sub_f32 v46, v46, v252
  v_sub_f32 v78, v78, v252
  v_sub_f32 v47, v47, v252
  v_sub_f32 v79, v79, v252
  v_mul_f32 v236, v236, v253
  v_accvgpr_read_b32 v156, a48
  v_accvgpr_read_b32 v157, a49
  v_accvgpr_read_b32 v158, a50
  v_accvgpr_read_b32 v159, a51
  v_mul_f32 v156, v156, v253
  v_mul_f32 v157, v157, v253
  v_mul_f32 v158, v158, v253
  v_mul_f32 v159, v159, v253
  v_accvgpr_write_b32 a48, v156
  v_accvgpr_write_b32 a49, v157
  v_accvgpr_write_b32 a50, v158
  v_accvgpr_write_b32 a51, v159
  v_accvgpr_read_b32 v156, a52
  v_accvgpr_read_b32 v157, a53
  v_accvgpr_read_b32 v158, a54
  v_accvgpr_read_b32 v159, a55
  v_mul_f32 v156, v156, v253
  v_mul_f32 v157, v157, v253
  v_mul_f32 v158, v158, v253
  v_mul_f32 v159, v159, v253
  v_accvgpr_write_b32 a52, v156
  v_accvgpr_write_b32 a53, v157
  v_accvgpr_write_b32 a54, v158
  v_accvgpr_write_b32 a55, v159
  v_accvgpr_read_b32 v156, a56
  v_accvgpr_read_b32 v157, a57
  v_accvgpr_read_b32 v158, a58
  v_accvgpr_read_b32 v159, a59
  v_mul_f32 v156, v156, v253
  v_mul_f32 v157, v157, v253
  v_mul_f32 v158, v158, v253
  v_mul_f32 v159, v159, v253
  v_accvgpr_write_b32 a56, v156
  v_accvgpr_write_b32 a57, v157
  v_accvgpr_write_b32 a58, v158
  v_accvgpr_write_b32 a59, v159
  v_accvgpr_read_b32 v156, a60
  v_accvgpr_read_b32 v157, a61
  v_accvgpr_read_b32 v158, a62
  v_accvgpr_read_b32 v159, a63
  v_mul_f32 v156, v156, v253
  v_mul_f32 v157, v157, v253
  v_mul_f32 v158, v158, v253
  v_mul_f32 v159, v159, v253
  v_accvgpr_write_b32 a60, v156
  v_accvgpr_write_b32 a61, v157
  v_accvgpr_write_b32 a62, v158
  v_accvgpr_write_b32 a63, v159
  v_accvgpr_read_b32 v156, a112
  v_accvgpr_read_b32 v157, a113
  v_accvgpr_read_b32 v158, a114
  v_accvgpr_read_b32 v159, a115
  v_mul_f32 v156, v156, v253
  v_mul_f32 v157, v157, v253
  v_mul_f32 v158, v158, v253
  v_mul_f32 v159, v159, v253
  v_accvgpr_write_b32 a112, v156
  v_accvgpr_write_b32 a113, v157
  v_accvgpr_write_b32 a114, v158
  v_accvgpr_write_b32 a115, v159
  v_accvgpr_read_b32 v156, a116
  v_accvgpr_read_b32 v157, a117
  v_accvgpr_read_b32 v158, a118
  v_accvgpr_read_b32 v159, a119
  v_mul_f32 v156, v156, v253
  v_mul_f32 v157, v157, v253
  v_mul_f32 v158, v158, v253
  v_mul_f32 v159, v159, v253
  v_accvgpr_write_b32 a116, v156
  v_accvgpr_write_b32 a117, v157
  v_accvgpr_write_b32 a118, v158
  v_accvgpr_write_b32 a119, v159
  v_accvgpr_read_b32 v156, a120
  v_accvgpr_read_b32 v157, a121
  v_accvgpr_read_b32 v158, a122
  v_accvgpr_read_b32 v159, a123
  v_mul_f32 v156, v156, v253
  v_mul_f32 v157, v157, v253
  v_mul_f32 v158, v158, v253
  v_mul_f32 v159, v159, v253
  v_accvgpr_write_b32 a120, v156
  v_accvgpr_write_b32 a121, v157
  v_accvgpr_write_b32 a122, v158
  v_accvgpr_write_b32 a123, v159
  v_accvgpr_read_b32 v156, a124
  v_accvgpr_read_b32 v157, a125
  v_accvgpr_read_b32 v158, a126
  v_accvgpr_read_b32 v159, a127
  v_mul_f32 v156, v156, v253
  v_mul_f32 v157, v157, v253
  v_mul_f32 v158, v158, v253
  v_mul_f32 v159, v159, v253
  v_accvgpr_write_b32 a124, v156
  v_accvgpr_write_b32 a125, v157
  v_accvgpr_write_b32 a126, v158
  v_accvgpr_write_b32 a127, v159
  s_nop 1
  v_exp_f32 v148, v16
  v_exp_f32 v149, v17
  v_exp_f32 v150, v18
  v_cvt_pk_bf16_f32 v80, v148, v149
  v_exp_f32 v151, v19
  v_exp_f32 v152, v20
  v_cvt_pk_bf16_f32 v81, v150, v151
  v_exp_f32 v153, v21
  v_exp_f32 v154, v22
  v_cvt_pk_bf16_f32 v82, v152, v153
  v_exp_f32 v155, v23
  v_exp_f32 v148, v24
  v_cvt_pk_bf16_f32 v83, v154, v155
  v_exp_f32 v149, v25
  v_exp_f32 v150, v26
  v_cvt_pk_bf16_f32 v84, v148, v149
  v_mfma_f32_16x16x32_bf16 v[128:131], v[244:247], v[80:83], v[224:227]
  v_exp_f32 v151, v27
  v_exp_f32 v152, v28
  v_cvt_pk_bf16_f32 v85, v150, v151
  v_exp_f32 v153, v29
  v_exp_f32 v154, v30
  v_cvt_pk_bf16_f32 v86, v152, v153
  v_exp_f32 v155, v31
  v_exp_f32 v148, v32
  v_cvt_pk_bf16_f32 v87, v154, v155
  v_exp_f32 v149, v33
  v_exp_f32 v150, v34
  v_cvt_pk_bf16_f32 v88, v148, v149
  v_mfma_f32_16x16x32_bf16 v[132:135], v[244:247], v[84:87], v[228:231]
  v_exp_f32 v151, v35
  v_exp_f32 v152, v36
  v_cvt_pk_bf16_f32 v89, v150, v151
  v_exp_f32 v153, v37
  v_exp_f32 v154, v38
  v_cvt_pk_bf16_f32 v90, v152, v153
  v_exp_f32 v155, v39
  v_exp_f32 v148, v40
  v_cvt_pk_bf16_f32 v91, v154, v155
  v_exp_f32 v149, v41
  v_exp_f32 v150, v42
  v_cvt_pk_bf16_f32 v92, v148, v149
  v_mfma_f32_16x16x32_bf16 v[136:139], v[244:247], v[88:91], v[232:235]
  v_exp_f32 v151, v43
  v_exp_f32 v152, v44
  v_cvt_pk_bf16_f32 v93, v150, v151
  v_exp_f32 v153, v45
  v_exp_f32 v154, v46
  v_cvt_pk_bf16_f32 v94, v152, v153
  v_exp_f32 v155, v47
  s_nop 0
  v_cvt_pk_bf16_f32 v95, v154, v155
  s_nop 1
  v_mfma_f32_16x16x32_bf16 v[140:143], v[244:247], v[92:95], v[236:239]
  s_nop 7
  s_branch K2_RARE_M_ret
K2_RARE_L:
  s_nop 15
  s_nop 7
  v_max3_f32 v252, v64, v65, v66
  v_max3_f32 v252, v252, v67, v68
  v_max3_f32 v252, v252, v69, v70
  v_max3_f32 v252, v252, v71, 0
  v_mov_b32 v253, v252
  s_nop 1
  v_permlane16_swap_b32 v252, v253
  s_nop 1
  v_max_f32 v252, v252, v253
  v_mov_b32 v253, v252
  s_nop 1
  v_permlane32_swap_b32 v252, v253
  s_nop 1
  v_max_f32 v252, v252, v253
  v_exp_f32 v253, -v252
  v_sub_f32 v120, v120, v252
  v_sub_f32 v121, v121, v252
  v_sub_f32 v122, v122, v252
  v_sub_f32 v123, v123, v252
  v_sub_f32 v64, v64, v252
  v_sub_f32 v65, v65, v252
  v_sub_f32 v66, v66, v252
  v_sub_f32 v67, v67, v252
  v_sub_f32 v68, v68, v252
  v_sub_f32 v69, v69, v252
  v_sub_f32 v70, v70, v252
  v_sub_f32 v71, v71, v252
  v_mul_f32 v136, v136, v253
  v_accvgpr_read_b32 v156, a32
  v_accvgpr_read_b32 v157, a33
  v_accvgpr_read_b32 v158, a34
  v_accvgpr_read_b32 v159, a35
  v_mul_f32 v156, v156, v253
  v_mul_f32 v157, v157, v253
  v_mul_f32 v158, v158, v253
  v_mul_f32 v159, v159, v253
  v_accvgpr_write_b32 a32, v156
  v_accvgpr_write_b32 a33, v157
  v_accvgpr_write_b32 a34, v158
  v_accvgpr_write_b32 a35, v159
  v_accvgpr_read_b32 v156, a36
  v_accvgpr_read_b32 v157, a37
  v_accvgpr_read_b32 v158, a38
  v_accvgpr_read_b32 v159, a39
  v_mul_f32 v156, v156, v253
  v_mul_f32 v157, v157, v253
  v_mul_f32 v158, v158, v253
  v_mul_f32 v159, v159, v253
  v_accvgpr_write_b32 a36, v156
  v_accvgpr_write_b32 a37, v157
  v_accvgpr_write_b32 a38, v158
  v_accvgpr_write_b32 a39, v159
  v_accvgpr_read_b32 v156, a40
  v_accvgpr_read_b32 v157, a41
  v_accvgpr_read_b32 v158, a42
  v_accvgpr_read_b32 v159, a43
  v_mul_f32 v156, v156, v253
  v_mul_f32 v157, v157, v253
  v_mul_f32 v158, v158, v253
  v_mul_f32 v159, v159, v253
  v_accvgpr_write_b32 a40, v156
  v_accvgpr_write_b32 a41, v157
  v_accvgpr_write_b32 a42, v158
  v_accvgpr_write_b32 a43, v159
  v_accvgpr_read_b32 v156, a44
  v_accvgpr_read_b32 v157, a45
  v_accvgpr_read_b32 v158, a46
  v_accvgpr_read_b32 v159, a47
  v_mul_f32 v156, v156, v253
  v_mul_f32 v157, v157, v253
  v_mul_f32 v158, v158, v253
  v_mul_f32 v159, v159, v253
  v_accvgpr_write_b32 a44, v156
  v_accvgpr_write_b32 a45, v157
  v_accvgpr_write_b32 a46, v158
  v_accvgpr_write_b32 a47, v159
  v_accvgpr_read_b32 v156, a96
  v_accvgpr_read_b32 v157, a97
  v_accvgpr_read_b32 v158, a98
  v_accvgpr_read_b32 v159, a99
  v_mul_f32 v156, v156, v253
  v_mul_f32 v157, v157, v253
  v_mul_f32 v158, v158, v253
  v_mul_f32 v159, v159, v253
  v_accvgpr_write_b32 a96, v156
  v_accvgpr_write_b32 a97, v157
  v_accvgpr_write_b32 a98, v158
  v_accvgpr_write_b32 a99, v159
  v_accvgpr_read_b32 v156, a100
  v_accvgpr_read_b32 v157, a101
  v_accvgpr_read_b32 v158, a102
  v_accvgpr_read_b32 v159, a103
  v_mul_f32 v156, v156, v253
  v_mul_f32 v157, v157, v253
  v_mul_f32 v158, v158, v253
  v_mul_f32 v159, v159, v253
  v_accvgpr_write_b32 a100, v156
  v_accvgpr_write_b32 a101, v157
  v_accvgpr_write_b32 a102, v158
  v_accvgpr_write_b32 a103, v159
  v_accvgpr_read_b32 v156, a104
  v_accvgpr_read_b32 v157, a105
  v_accvgpr_read_b32 v158, a106
  v_accvgpr_read_b32 v159, a107
  v_mul_f32 v156, v156, v253
  v_mul_f32 v157, v157, v253
  v_mul_f32 v158, v158, v253
  v_mul_f32 v159, v159, v253
  v_accvgpr_write_b32 a104, v156
  v_accvgpr_write_b32 a105, v157
  v_accvgpr_write_b32 a106, v158
  v_accvgpr_write_b32 a107, v159
  v_accvgpr_read_b32 v156, a108
  v_accvgpr_read_b32 v157, a109
  v_accvgpr_read_b32 v158, a110
  v_accvgpr_read_b32 v159, a111
  v_mul_f32 v156, v156, v253
  v_mul_f32 v157, v157, v253
  v_mul_f32 v158, v158, v253
  v_mul_f32 v159, v159, v253
  v_accvgpr_write_b32 a108, v156
  v_accvgpr_write_b32 a109, v157
  v_accvgpr_write_b32 a110, v158
  v_accvgpr_write_b32 a111, v159
  v_max3_f32 v252, v72, v73, v74
  v_max3_f32 v252, v252, v75, v76
  v_max3_f32 v252, v252, v77, v78
  v_max3_f32 v252, v252, v79, 0
  v_mov_b32 v253, v252
  s_nop 1
  v_permlane16_swap_b32 v252, v253
  s_nop 1
  v_max_f32 v252, v252, v253
  v_mov_b32 v253, v252
  s_nop 1
  v_permlane32_swap_b32 v252, v253
  s_nop 1
  v_max_f32 v252, v252, v253
  v_exp_f32 v253, -v252
  v_sub_f32 v124, v124, v252
  v_sub_f32 v125, v125, v252
  v_sub_f32 v126, v126, v252
  v_sub_f32 v127, v127, v252
  v_sub_f32 v72, v72, v252
  v_sub_f32 v73, v73, v252
  v_sub_f32 v74, v74, v252
  v_sub_f32 v75, v75, v252
  v_sub_f32 v76, v76, v252
  v_sub_f32 v77, v77, v252
  v_sub_f32 v78, v78, v252
  v_sub_f32 v79, v79, v252
  v_mul_f32 v140, v140, v253
  v_accvgpr_read_b32 v156, a48
  v_accvgpr_read_b32 v157, a49
  v_accvgpr_read_b32 v158, a50
  v_accvgpr_read_b32 v159, a51
  v_mul_f32 v156, v156, v253
  v_mul_f32 v157, v157, v253
  v_mul_f32 v158, v158, v253
  v_mul_f32 v159, v159, v253
  v_accvgpr_write_b32 a48, v156
  v_accvgpr_write_b32 a49, v157
  v_accvgpr_write_b32 a50, v158
  v_accvgpr_write_b32 a51, v159
  v_accvgpr_read_b32 v156, a52
  v_accvgpr_read_b32 v157, a53
  v_accvgpr_read_b32 v158, a54
  v_accvgpr_read_b32 v159, a55
  v_mul_f32 v156, v156, v253
  v_mul_f32 v157, v157, v253
  v_mul_f32 v158, v158, v253
  v_mul_f32 v159, v159, v253
  v_accvgpr_write_b32 a52, v156
  v_accvgpr_write_b32 a53, v157
  v_accvgpr_write_b32 a54, v158
  v_accvgpr_write_b32 a55, v159
  v_accvgpr_read_b32 v156, a56
  v_accvgpr_read_b32 v157, a57
  v_accvgpr_read_b32 v158, a58
  v_accvgpr_read_b32 v159, a59
  v_mul_f32 v156, v156, v253
  v_mul_f32 v157, v157, v253
  v_mul_f32 v158, v158, v253
  v_mul_f32 v159, v159, v253
  v_accvgpr_write_b32 a56, v156
  v_accvgpr_write_b32 a57, v157
  v_accvgpr_write_b32 a58, v158
  v_accvgpr_write_b32 a59, v159
  v_accvgpr_read_b32 v156, a60
  v_accvgpr_read_b32 v157, a61
  v_accvgpr_read_b32 v158, a62
  v_accvgpr_read_b32 v159, a63
  v_mul_f32 v156, v156, v253
  v_mul_f32 v157, v157, v253
  v_mul_f32 v158, v158, v253
  v_mul_f32 v159, v159, v253
  v_accvgpr_write_b32 a60, v156
  v_accvgpr_write_b32 a61, v157
  v_accvgpr_write_b32 a62, v158
  v_accvgpr_write_b32 a63, v159
  v_accvgpr_read_b32 v156, a112
  v_accvgpr_read_b32 v157, a113
  v_accvgpr_read_b32 v158, a114
  v_accvgpr_read_b32 v159, a115
  v_mul_f32 v156, v156, v253
  v_mul_f32 v157, v157, v253
  v_mul_f32 v158, v158, v253
  v_mul_f32 v159, v159, v253
  v_accvgpr_write_b32 a112, v156
  v_accvgpr_write_b32 a113, v157
  v_accvgpr_write_b32 a114, v158
  v_accvgpr_write_b32 a115, v159
  v_accvgpr_read_b32 v156, a116
  v_accvgpr_read_b32 v157, a117
  v_accvgpr_read_b32 v158, a118
  v_accvgpr_read_b32 v159, a119
  v_mul_f32 v156, v156, v253
  v_mul_f32 v157, v157, v253
  v_mul_f32 v158, v158, v253
  v_mul_f32 v159, v159, v253
  v_accvgpr_write_b32 a116, v156
  v_accvgpr_write_b32 a117, v157
  v_accvgpr_write_b32 a118, v158
  v_accvgpr_write_b32 a119, v159
  v_accvgpr_read_b32 v156, a120
  v_accvgpr_read_b32 v157, a121
  v_accvgpr_read_b32 v158, a122
  v_accvgpr_read_b32 v159, a123
  v_mul_f32 v156, v156, v253
  v_mul_f32 v157, v157, v253
  v_mul_f32 v158, v158, v253
  v_mul_f32 v159, v159, v253
  v_accvgpr_write_b32 a120, v156
  v_accvgpr_write_b32 a121, v157
  v_accvgpr_write_b32 a122, v158
  v_accvgpr_write_b32 a123, v159
  v_accvgpr_read_b32 v156, a124
  v_accvgpr_read_b32 v157, a125
  v_accvgpr_read_b32 v158, a126
  v_accvgpr_read_b32 v159, a127
  v_mul_f32 v156, v156, v253
  v_mul_f32 v157, v157, v253
  v_mul_f32 v158, v158, v253
  v_mul_f32 v159, v159, v253
  v_accvgpr_write_b32 a124, v156
  v_accvgpr_write_b32 a125, v157
  v_accvgpr_write_b32 a126, v158
  v_accvgpr_write_b32 a127, v159
  s_nop 1
  v_exp_f32 v148, v64
  v_exp_f32 v149, v65
  v_exp_f32 v150, v66
  v_cvt_pk_bf16_f32 v104, v148, v149
  v_exp_f32 v151, v67
  v_exp_f32 v152, v68
  v_cvt_pk_bf16_f32 v105, v150, v151
  v_exp_f32 v153, v69
  v_exp_f32 v154, v70
  v_cvt_pk_bf16_f32 v106, v152, v153
  v_exp_f32 v155, v71
  v_exp_f32 v148, v72
  v_cvt_pk_bf16_f32 v107, v154, v155
  v_exp_f32 v149, v73
  v_exp_f32 v150, v74
  v_cvt_pk_bf16_f32 v108, v148, v149
  v_mfma_f32_16x16x32_bf16 v[232:235], v[244:247], v[104:107], v[136:139]
  v_exp_f32 v151, v75
  v_exp_f32 v152, v76
  v_cvt_pk_bf16_f32 v109, v150, v151
  v_exp_f32 v153, v77
  v_exp_f32 v154, v78
  v_cvt_pk_bf16_f32 v110, v152, v153
  v_exp_f32 v155, v79
  s_nop 0
  v_cvt_pk_bf16_f32 v111, v154, v155
  s_nop 1
  v_mfma_f32_16x16x32_bf16 v[236:239], v[244:247], v[108:111], v[140:143]
  s_nop 7
  s_branch K2_RARE_L_ret
KA_SPIN:
  s_mov_b32 s54, 100000
KA_SPIN_L:
  s_sleep 24
  buffer_load_dword v24, v251, s[60:63], 0 offen sc1
  s_waitcnt vmcnt(0)
  v_readfirstlane_b32 s53, v24
  s_cmp_ge_u32 s53, 64
  s_cbranch_scc1 KA_SPIN_RET
  s_sub_u32 s54, s54, 1
  s_cmp_lg_u32 s54, 0
  s_cbranch_scc1 KA_SPIN_L
  s_branch KA_SPIN_RET
KA_HSPIN:
  s_mov_b32 s55, 200000
KA_HSPIN_L:
  s_sleep 4
  buffer_load_dword v22, v15, s[20:23], s54 offen sc1
  s_waitcnt vmcnt(0)
  v_cmp_ne_u32 vcc, v25, v22
  s_cbranch_vccz KA_HSPIN_RET
  s_sub_u32 s55, s55, 1
  s_cmp_lg_u32 s55, 0
  s_cbranch_scc1 KA_HSPIN_L
  s_branch KA_HSPIN_RET
KA_KSPIN:
  s_mov_b32 s55, 200000
KA_KSPIN_L:
  s_sleep 4
  buffer_load_dword v22, v15, s[20:23], s54 offen sc1
  s_waitcnt vmcnt(0)
  v_cmp_ne_u32 vcc, v25, v22
  s_cbranch_vccz KA_KSPIN_RET
  s_sub_u32 s55, s55, 1
  s_cmp_lg_u32 s55, 0
  s_cbranch_scc1 KA_KSPIN_L
  s_branch KA_KSPIN_RET
.section .rodata,"a"
.p2align 6
.amdhsa_kernel adaLN_cond__compressed_kv_cla__dense_activation_mish__prompt_kernel
  .amdhsa_next_free_vgpr 512
  .amdhsa_next_free_sgpr 102
  .amdhsa_accum_offset 256
  .amdhsa_group_segment_fixed_size 0
  .amdhsa_kernarg_size 120
  .amdhsa_user_sgpr_count 2
  .amdhsa_user_sgpr_kernarg_segment_ptr 1
  .amdhsa_system_sgpr_workgroup_id_x 1
  .amdhsa_float_denorm_mode_32 3
  .amdhsa_float_denorm_mode_16_64 3
.end_amdhsa_kernel
```
